```python
import torch

def _softmax(x, axis=-1):
    return torch.softmax(x, dim=axis)
def _gelu(x):
    return torch.nn.functional.gelu(x, approximate="tanh")
def _silu(x):
    return torch.nn.functional.silu(x)
def _sigmoid(x):
    return torch.sigmoid(x)
def _layernorm(x, axis=-1, eps=1e-5):
    m = x.mean(dim=axis, keepdim=True)
    v = x.var(dim=axis, keepdim=True, unbiased=False)
    return (x - m) / torch.sqrt(v + eps)
def _scatter_add(tgt, idx, src, axis=0):
    return tgt.clone().index_add_(axis, idx, src)
def _segment_sum(src, seg, n):
    out = torch.zeros((n,) + src.shape[1:], dtype=src.dtype)
    return out.index_add_(0, seg, src)
def _pad(x, pw):
    flat = tuple(v for pair in reversed(pw) for v in pair)
    return torch.nn.functional.pad(x, flat)

kernel_name = 'standalone__memory_aug_memorizing_tr__prompt'

def setup_inputs():

    _w = (lambda a: (lambda t: t.to(torch.bfloat16) if t.is_floating_point() else t)(torch.as_tensor(a)))
    B, H, S, D = 1, 32, 2048, 192
    M, K = 2048, 8
    return {
        "q": _w((lambda *s: torch.randn(*s, dtype=torch.bfloat16) * 0.8)(B, H, S, D)),
        "k": _w((lambda *s: torch.randn(*s, dtype=torch.bfloat16) * 0.8)(B, H, S, D)),
        "v": _w((lambda *s: torch.randn(*s, dtype=torch.bfloat16) * 0.05)(B, H, S, D)),
        "mem_k": _w((lambda *s: torch.randn(*s, dtype=torch.bfloat16) * 0.8)(B, H, M, D)),
        "mem_v": _w((lambda *s: torch.randn(*s, dtype=torch.bfloat16) * 0.05)(B, H, M, D)),
        "idx": _w(torch.randint(0, M, (B, H, S, K)).to(torch.int64)),
        "gate_bias": _w((lambda *s: torch.randn(*s, dtype=torch.bfloat16) * 0.2)(H)),
    }

def reference(q, k, v, mem_k, mem_v, idx, gate_bias):
    B, H, S, D = q.shape
    K = idx.shape[-1]
    scale = D ** -0.5
    sl = torch.einsum("bhqd,bhkd->bhqk", q, k) * scale
    cm = torch.tril(torch.ones((S, S), dtype=q.dtype))
    sl = torch.where(cm[None, None] > 0, sl, -1e9)
    pl = _softmax(sl, axis=-1)
    ol = torch.einsum("bhqk,bhkd->bhqd", pl, v)
    idx_e = (lambda x, n, axis: torch.repeat_interleave(x, n, dim=axis))(idx.reshape(B, H, S * K)[..., None], D, axis=-1)
    mk = (lambda x, i, axis: torch.take_along_dim(x, i, dim=axis))(mem_k, idx_e, axis=2).reshape(B, H, S, K, D)
    mv = (lambda x, i, axis: torch.take_along_dim(x, i, dim=axis))(mem_v, idx_e, axis=2).reshape(B, H, S, K, D)
    sm = torch.einsum("bhqd,bhqkd->bhqk", q, mk) * scale
    pm = _softmax(sm, axis=-1)
    om = torch.einsum("bhqk,bhqkd->bhqd", pm, mv)
    g = _sigmoid(gate_bias)[None, :, None, None]
    return g * om + (1 - g) * ol
```

```asm
; @launch grid=(256,1,1) block=(256,1,1) lds=163840
.amdgcn_target "amdgcn-amd-amdhsa--gfx950"
.text
.globl standalone__memory_aug_memorizing_tr__prompt_kernel
.p2align 8
.type standalone__memory_aug_memorizing_tr__prompt_kernel,@function
standalone__memory_aug_memorizing_tr__prompt_kernel:
s_cmp_ge_u32 s2, 256
s_cbranch_scc1 L_end
s_load_dwordx16 s[64:79], s[0:1], 0
s_load_dwordx4 s[80:83], s[0:1], 64
s_and_b32 s84, s2, 7
s_lshr_b32 s85, s2, 3
s_and_b32 s86, s85, 3
s_lshr_b32 s85, s85, 2
s_lshl_b32 s88, s84, 2
s_add_u32 s88, s88, s86
s_and_b32 s89, s85, 3
s_lshr_b32 s44, s85, 2
v_and_b32 v1, 63, v0
v_lshrrev_b32 v30, 6, v0
s_mov_b32 s37, 0x3dd53b95
v_readfirstlane_b32 s36, v30
s_mov_b32 s52, 0x47800000
s_lshl_b32 s92, s88, 2
s_add_u32 s92, s92, s89
s_sub_u32 s62, 7, s89
s_lshl_b32 s84, s89, 1
s_sub_u32 s85, 6, s84
s_cmp_eq_u32 s44, 1
s_cselect_b32 s45, s62, s89
s_cselect_b32 s43, -1, s85
s_mov_b32 s38, 344064
s_cselect_b32 s38, 331776, s38
s_lshl_b32 s84, s89, 3
s_sub_u32 s84, 28, s84
s_cmp_eq_u32 s44, 1
s_cselect_b32 s40, -1, s84
s_mul_i32 s41, s45, 98304
s_mov_b32 s39, s38
s_mov_b32 s99, 0
s_lshl_b32 s53, s36, 14
s_add_u32 s53, s53, 98304
s_mul_i32 s90, s62, 98304
s_mul_i32 s84, s36, 12288
s_add_u32 s90, s90, s84
s_and_b32 s84, s36, 1
s_mul_i32 s91, s84, 12288
s_add_u32 s91, s91, 24576
s_cmp_lt_u32 s36, 2
s_cselect_b32 s84, 49152, 0
s_add_u32 s91, s91, s84
s_mov_b32 s42, 0
v_and_b32 v22, 7, v1
v_and_b32 v23, 0x38, v1
v_add_u32 v24, 0, v1
v_mul_u32_u24 v24, 2731, v24
v_lshrrev_b32 v24, 16, v24
v_bfe_u32 v25, v24, 1, 3
v_xor_b32 v25, v25, v22
v_or_b32 v25, v25, v23
v_lshlrev_b32 v112, 4, v25
v_add_u32 v24, 64, v1
v_mul_u32_u24 v24, 2731, v24
v_lshrrev_b32 v24, 16, v24
v_bfe_u32 v25, v24, 1, 3
v_xor_b32 v25, v25, v22
v_or_b32 v25, v25, v23
v_lshlrev_b32 v113, 4, v25
v_add_u32 v24, 128, v1
v_mul_u32_u24 v24, 2731, v24
v_lshrrev_b32 v24, 16, v24
v_bfe_u32 v25, v24, 1, 3
v_xor_b32 v25, v25, v22
v_or_b32 v25, v25, v23
v_lshlrev_b32 v114, 4, v25
v_add_u32 v24, 192, v1
v_mul_u32_u24 v24, 2731, v24
v_lshrrev_b32 v24, 16, v24
v_bfe_u32 v25, v24, 1, 3
v_xor_b32 v25, v25, v22
v_or_b32 v25, v25, v23
v_lshlrev_b32 v115, 4, v25
v_add_u32 v24, 256, v1
v_mul_u32_u24 v24, 2731, v24
v_lshrrev_b32 v24, 16, v24
v_bfe_u32 v25, v24, 1, 3
v_xor_b32 v25, v25, v22
v_or_b32 v25, v25, v23
v_lshlrev_b32 v116, 4, v25
v_add_u32 v24, 320, v1
v_mul_u32_u24 v24, 2731, v24
v_lshrrev_b32 v24, 16, v24
v_bfe_u32 v25, v24, 1, 3
v_xor_b32 v25, v25, v22
v_or_b32 v25, v25, v23
v_lshlrev_b32 v117, 4, v25
s_mul_i32 s84, s36, 192
s_mul_i32 s48, s36, 3072
v_and_b32 v22, 7, v1
v_and_b32 v23, 0x38, v1
v_add_u32 v24, s84, v1
v_mul_u32_u24 v24, 2731, v24
v_lshrrev_b32 v24, 16, v24
v_bfe_u32 v25, v24, 1, 3
v_xor_b32 v25, v25, v22
v_or_b32 v25, v25, v23
v_lshlrev_b32 v25, 4, v25
v_add_u32 v8, s48, v25
v_bfe_u32 v25, v24, 1, 1
v_lshlrev_b32 v25, 2, v25
v_xor_b32 v25, v25, v22
v_or_b32 v25, v25, v23
v_lshlrev_b32 v25, 4, v25
v_add_u32 v11, s48, v25
v_add_u32 v24, s84, v1
v_add_u32 v24, 64, v24
v_mul_u32_u24 v24, 2731, v24
v_lshrrev_b32 v24, 16, v24
v_bfe_u32 v25, v24, 1, 3
v_xor_b32 v25, v25, v22
v_or_b32 v25, v25, v23
v_lshlrev_b32 v25, 4, v25
v_add_u32 v9, s48, v25
v_bfe_u32 v25, v24, 1, 1
v_lshlrev_b32 v25, 2, v25
v_xor_b32 v25, v25, v22
v_or_b32 v25, v25, v23
v_lshlrev_b32 v25, 4, v25
v_add_u32 v12, s48, v25
v_add_u32 v24, s84, v1
v_add_u32 v24, 128, v24
v_mul_u32_u24 v24, 2731, v24
v_lshrrev_b32 v24, 16, v24
v_bfe_u32 v25, v24, 1, 3
v_xor_b32 v25, v25, v22
v_or_b32 v25, v25, v23
v_lshlrev_b32 v25, 4, v25
v_add_u32 v10, s48, v25
v_bfe_u32 v25, v24, 1, 1
v_lshlrev_b32 v25, 2, v25
v_xor_b32 v25, v25, v22
v_or_b32 v25, v25, v23
v_lshlrev_b32 v25, 4, v25
v_add_u32 v13, s48, v25
s_add_u32 s49, s48, 49152
s_mul_i32 s84, s88, 786432
s_waitcnt lgkmcnt(0)
s_add_u32 s4, s64, s84
s_addc_u32 s5, s65, 0
s_and_b32 s5, s5, 0xffff
s_mov_b32 s6, 786432
s_mov_b32 s7, 0x20000
s_add_u32 m0, s53, 0
s_add_u32 s63, s90, 0
buffer_load_dwordx4 v112, s[4:7], s63 offen offset:0 lds
buffer_load_dwordx4 v113, s[4:7], s63 offen offset:1024 lds
buffer_load_dwordx4 v114, s[4:7], s63 offen offset:2048 lds
buffer_load_dwordx4 v115, s[4:7], s63 offen offset:3072 lds
s_add_u32 m0, s53, 4096
s_add_u32 s63, s90, 4096
buffer_load_dwordx4 v116, s[4:7], s63 offen offset:0 lds
buffer_load_dwordx4 v117, s[4:7], s63 offen offset:1024 lds
buffer_load_dwordx4 v112, s[4:7], s63 offen offset:2048 lds
buffer_load_dwordx4 v113, s[4:7], s63 offen offset:3072 lds
s_add_u32 m0, s53, 8192
s_add_u32 s63, s90, 8192
buffer_load_dwordx4 v114, s[4:7], s63 offen offset:0 lds
buffer_load_dwordx4 v115, s[4:7], s63 offen offset:1024 lds
buffer_load_dwordx4 v116, s[4:7], s63 offen offset:2048 lds
buffer_load_dwordx4 v117, s[4:7], s63 offen offset:3072 lds
s_add_u32 s8, s66, s84
s_addc_u32 s9, s67, 0
s_and_b32 s9, s9, 0xffff
s_mov_b32 s10, 786432
s_mov_b32 s11, 0x20000
s_add_u32 s28, s78, s84
s_addc_u32 s29, s79, 0
s_and_b32 s29, s29, 0xffff
s_mov_b32 s30, 786432
s_mov_b32 s31, 0x20000
s_mov_b32 s78, 12288
s_cmp_eq_u32 s44, 1
s_cselect_b32 s78, -12288, s78
s_mov_b32 s98, s78
s_add_u32 s85, s90, 49152
s_add_u32 m0, s91, 0
s_add_u32 s63, s85, 0
buffer_load_dwordx4 v112, s[4:7], s63 offen offset:0 lds
buffer_load_dwordx4 v113, s[4:7], s63 offen offset:1024 lds
buffer_load_dwordx4 v114, s[4:7], s63 offen offset:2048 lds
buffer_load_dwordx4 v115, s[4:7], s63 offen offset:3072 lds
s_add_u32 m0, s91, 4096
s_add_u32 s63, s85, 4096
buffer_load_dwordx4 v116, s[4:7], s63 offen offset:0 lds
buffer_load_dwordx4 v117, s[4:7], s63 offen offset:1024 lds
buffer_load_dwordx4 v112, s[4:7], s63 offen offset:2048 lds
buffer_load_dwordx4 v113, s[4:7], s63 offen offset:3072 lds
s_add_u32 m0, s91, 8192
s_add_u32 s63, s85, 8192
buffer_load_dwordx4 v114, s[4:7], s63 offen offset:0 lds
buffer_load_dwordx4 v115, s[4:7], s63 offen offset:1024 lds
buffer_load_dwordx4 v116, s[4:7], s63 offen offset:2048 lds
buffer_load_dwordx4 v117, s[4:7], s63 offen offset:3072 lds
s_add_u32 m0, s48, 0
s_nop 0
buffer_load_dwordx4 v8, s[8:11], s38 offen offset:0 lds
buffer_load_dwordx4 v9, s[8:11], s38 offen offset:1024 lds
buffer_load_dwordx4 v10, s[8:11], s38 offen offset:2048 lds
s_add_u32 s38, s38, s78
s_add_u32 s12, s68, s84
s_addc_u32 s13, s69, 0
s_and_b32 s13, s13, 0xffff
s_mov_b32 s14, 786432
s_mov_b32 s15, 0x20000
s_add_u32 m0, s48, 12288
s_nop 0
buffer_load_dwordx4 v8, s[8:11], s38 offen offset:0 lds
buffer_load_dwordx4 v9, s[8:11], s38 offen offset:1024 lds
buffer_load_dwordx4 v10, s[8:11], s38 offen offset:2048 lds
s_add_u32 s38, s38, s78
s_add_u32 m0, s49, 0
s_nop 0
buffer_load_dwordx4 v11, s[12:15], s39 offen offset:0 lds
buffer_load_dwordx4 v12, s[12:15], s39 offen offset:1024 lds
buffer_load_dwordx4 v13, s[12:15], s39 offen offset:2048 lds
s_add_u32 s39, s39, s98
s_add_u32 m0, s49, 12288
s_nop 0
buffer_load_dwordx4 v11, s[12:15], s39 offen offset:0 lds
buffer_load_dwordx4 v12, s[12:15], s39 offen offset:1024 lds
buffer_load_dwordx4 v13, s[12:15], s39 offen offset:2048 lds
s_add_u32 s39, s39, s98
s_add_u32 s16, s70, s84
s_addc_u32 s17, s71, 0
s_sub_u32 s16, s16, 1024
s_subb_u32 s17, s17, 0
s_and_b32 s17, s17, 0xffff
s_mov_b32 s18, 787456
s_mov_b32 s19, 0x20000
s_add_u32 s20, s72, s84
s_addc_u32 s21, s73, 0
s_sub_u32 s20, s20, 3072
s_subb_u32 s21, s21, 0
s_and_b32 s21, s21, 0xffff
s_mov_b32 s22, 789504
s_mov_b32 s23, 0x20000
s_lshl_b32 s85, s88, 16
s_add_u32 s24, s74, s85
s_addc_u32 s25, s75, 0
s_and_b32 s25, s25, 0xffff
s_mov_b32 s26, 65536
s_mov_b32 s27, 0x20000
s_mov_b32 s32, s82
s_and_b32 s33, s83, 0xffff
s_mov_b32 s34, 67108864
s_mov_b32 s35, 0x20000
s_lshl_b32 s84, s92, 2
s_add_u32 s84, s84, s36
s_mul_i32 s46, s84, 25600
s_lshl_b32 s84, s2, 2
s_add_u32 s84, s84, s36
s_mul_i32 s47, s84, 24576
s_add_u32 s47, s47, 33554432
s_lshr_b32 s84, s88, 1
s_lshl_b32 s84, s84, 2
s_load_dword s85, s[76:77], s84
v_and_b32 v22, 31, v1
v_lshrrev_b32 v23, 5, v1
v_bfe_u32 v24, v1, 1, 3
v_mul_u32_u24 v25, 384, v22
v_or_b32 v2, 0, v23
v_xor_b32 v2, v2, v24
v_lshl_add_u32 v2, v2, 4, v25
v_or_b32 v3, 2, v23
v_xor_b32 v3, v3, v24
v_lshl_add_u32 v3, v3, 4, v25
v_or_b32 v4, 4, v23
v_xor_b32 v4, v4, v24
v_lshl_add_u32 v4, v4, 4, v25
v_or_b32 v5, 6, v23
v_xor_b32 v5, v5, v24
v_lshl_add_u32 v5, v5, 4, v25
v_bfe_u32 v22, v1, 2, 2
v_lshl_add_u32 v24, v23, 2, v22
v_mul_u32_u24 v24, 384, v24
v_bfe_u32 v25, v1, 4, 1
v_lshlrev_b32 v25, 1, v25
v_bfe_u32 v23, v1, 1, 1
v_or_b32 v25, v25, v23
v_bfe_u32 v23, v1, 3, 1
v_lshlrev_b32 v23, 2, v23
v_xor_b32 v25, v25, v23
v_and_b32 v23, 1, v1
v_lshl_add_u32 v24, v23, 3, v24
v_add_u32 v24, 49152, v24
v_lshl_add_u32 v6, v25, 4, v24
v_xor_b32 v25, 4, v25
v_lshl_add_u32 v7, v25, 4, v24
v_mov_b32 v21, 0xff800000
s_waitcnt lgkmcnt(0)
s_bitcmp1_b32 s88, 0
s_cbranch_scc0 Lg_even
s_lshr_b32 s85, s85, 16
Lg_even:
s_lshl_b32 s85, s85, 16
v_mov_b32 v30, s85
v_mul_f32 v30, 0xbfb8aa3b, v30
v_exp_f32 v30, v30
s_nop 0
v_add_f32 v30, 1.0, v30
v_rcp_f32 v30, v30
s_nop 0
v_sub_f32 v31, 1.0, v30
s_nop 0
v_readfirstlane_b32 s50, v30
v_readfirstlane_b32 s51, v31
s_sub_u32 s88, 27, s40
s_mul_i32 s88, s88, 12288
s_mov_b32 s62, 0
s_lshl_b32 s84, s89, 2
s_add_u32 s84, s84, s36
s_mul_i32 s84, s84, 768
v_lshlrev_b32 v0, 4, v1
v_add_u32 v0, s84, v0
v_cmp_gt_u32 vcc, 48, v1
v_mov_b32 v31, 0x7f000000
s_nop 0
v_cndmask_b32 v0, v31, v0, vcc
v_mov_b32 v168, 0
v_mov_b32 v169, 0
v_mov_b32 v170, 0
v_mov_b32 v171, 0
v_mov_b32 v172, 0
v_mov_b32 v173, 0
v_mov_b32 v174, 0
v_mov_b32 v175, 0
v_mov_b32 v176, 0
v_mov_b32 v177, 0
v_mov_b32 v178, 0
v_mov_b32 v179, 0
v_mov_b32 v180, 0
v_mov_b32 v181, 0
v_mov_b32 v182, 0
v_mov_b32 v183, 0
v_mov_b32 v184, 0
v_mov_b32 v185, 0
v_mov_b32 v186, 0
v_mov_b32 v187, 0
v_mov_b32 v188, 0
v_mov_b32 v189, 0
v_mov_b32 v190, 0
v_mov_b32 v191, 0
v_mov_b32 v192, 0
v_mov_b32 v193, 0
v_mov_b32 v194, 0
v_mov_b32 v195, 0
v_mov_b32 v196, 0
v_mov_b32 v197, 0
v_mov_b32 v198, 0
v_mov_b32 v199, 0
v_mov_b32 v200, 0
v_mov_b32 v201, 0
v_mov_b32 v202, 0
v_mov_b32 v203, 0
v_mov_b32 v204, 0
v_mov_b32 v205, 0
v_mov_b32 v206, 0
v_mov_b32 v207, 0
v_mov_b32 v208, 0
v_mov_b32 v209, 0
v_mov_b32 v210, 0
v_mov_b32 v211, 0
v_mov_b32 v212, 0
v_mov_b32 v213, 0
v_mov_b32 v214, 0
v_mov_b32 v215, 0
v_mov_b32 v216, 0
v_mov_b32 v217, 0
v_mov_b32 v218, 0
v_mov_b32 v219, 0
v_mov_b32 v220, 0
v_mov_b32 v221, 0
v_mov_b32 v222, 0
v_mov_b32 v223, 0
v_mov_b32 v224, 0
v_mov_b32 v225, 0
v_mov_b32 v226, 0
v_mov_b32 v227, 0
v_mov_b32 v228, 0
v_mov_b32 v229, 0
v_mov_b32 v230, 0
v_mov_b32 v231, 0
v_mov_b32 v232, 0
v_mov_b32 v233, 0
v_mov_b32 v234, 0
v_mov_b32 v235, 0
v_mov_b32 v236, 0
v_mov_b32 v237, 0
v_mov_b32 v238, 0
v_mov_b32 v239, 0
v_mov_b32 v240, 0
v_mov_b32 v241, 0
v_mov_b32 v242, 0
v_mov_b32 v243, 0
v_mov_b32 v244, 0
v_mov_b32 v245, 0
v_mov_b32 v246, 0
v_mov_b32 v247, 0
v_mov_b32 v248, 0
v_mov_b32 v249, 0
v_mov_b32 v250, 0
v_mov_b32 v251, 0
v_mov_b32 v252, 0
v_mov_b32 v253, 0
v_mov_b32 v254, 0
v_mov_b32 v255, 0
v_and_b32 v22, 3, v1
v_cmp_eq_u32_e64 s[64:65], 0, v22
v_cmp_eq_u32_e64 s[66:67], 1, v22
v_cmp_eq_u32_e64 s[68:69], 2, v22
v_cmp_eq_u32_e64 s[70:71], 3, v22
v_bfe_u32 v22, v1, 2, 2
v_lshrrev_b32 v23, 4, v1
v_sub_u32 v22, v22, v23
v_and_b32 v253, 3, v22
v_lshrrev_b32 v252, 3, v1
s_mov_b32 s76, 384
v_and_b32 v22, 7, v1
v_lshrrev_b32 v23, 4, v1
v_xor_b32 v24, v22, v23
v_lshlrev_b32 v234, 4, v24
v_add_u32 v234, 1024, v234
v_xor_b32 v24, 4, v24
v_lshlrev_b32 v235, 4, v24
v_bfe_u32 v22, v1, 3, 1
v_lshlrev_b32 v22, 10, v22
v_and_b32 v23, 7, v1
v_lshl_add_u32 v22, v23, 7, v22
v_add_u32 v22, s53, v22
v_bfe_u32 v23, v1, 1, 3
v_lshrrev_b32 v24, 4, v1
v_xor_b32 v23, v23, v24
v_lshl_add_u32 v232, v23, 4, v22
v_xor_b32 v23, 4, v23
v_lshl_add_u32 v233, v23, 4, v22
v_and_b32 v22, 15, v1
v_lshrrev_b32 v23, 4, v1
v_lshl_add_u32 v22, v22, 2, v23
v_lshlrev_b32 v236, 2, v22
v_lshrrev_b32 v22, 3, v1
v_mul_u32_u24 v22, 384, v22
v_add_u32 v23, v22, v234
v_add_u32 v236, -1024, v23
v_add_u32 v23, v22, v235
v_add_u32 v237, 2048, v23
s_mov_b32 s87, 0
v_bfe_u32 v22, v1, 2, 2
v_add_u32 v22, s87, v22
v_and_b32 v22, 3, v22
v_bfe_u32 v23, v1, 1, 1
v_lshlrev_b32 v23, 3, v23
v_lshrrev_b32 v242, 4, v1
v_lshl_add_u32 v23, v242, 1, v23
v_and_b32 v242, 1, v1
v_add_u32 v23, v23, v242
v_lshl_add_u32 v23, v22, 2, v23
v_and_b32 v23, 15, v23
v_and_b32 v242, 1, v22
v_lshl_add_u32 v23, v242, 4, v23
v_lshrrev_b32 v22, 1, v22
v_lshl_add_u32 v23, v22, 7, v23
v_lshlrev_b32 v23, 5, v23
s_lshl_b32 s84, s45, 8
s_lshl_b32 s85, s36, 5
s_add_u32 s84, s84, s85
s_lshl_b32 s84, s84, 5
buffer_load_dwordx4 v[242:245], v23, s[24:27], s84 offen
buffer_load_dwordx4 v[246:249], v23, s[24:27], s84 offen offset:16
s_lshl_b32 s77, s87, 2
s_lshr_b32 s84, s87, 1
s_and_b32 s85, s87, 1
s_lshl_b32 s86, s45, 8
s_lshl_b32 s63, s36, 5
s_add_u32 s86, s86, s63
s_lshl_b32 s84, s84, 7
s_add_u32 s86, s86, s84
s_lshl_b32 s85, s85, 4
s_add_u32 s86, s86, s85
s_mul_i32 s79, s86, 384
s_add_u32 m0, s53, 12288
s_nop 0
buffer_load_dwordx4 v236, s[4:7], s79 offen offset:0 lds
buffer_load_dwordx4 v237, s[4:7], s79 offen offset:1024 lds
s_add_u32 m0, s53, 14208
s_nop 0
buffer_load_dwordx4 v236, s[4:7], s79 offen offset:128 lds
buffer_load_dwordx4 v237, s[4:7], s79 offen offset:1152 lds
v_lshlrev_b32 v240, 4, v1
v_add_u32 v241, 4096, v240
s_lshr_b32 s84, s2, 5
s_mul_i32 s84, s84, 98304
s_mul_i32 s85, s36, 24576
s_add_u32 s84, s84, s85
s_add_u32 s93, s84, 1024
v_add_u32 v22, s53, v2
v_add_u32 v23, s53, v3
v_add_u32 v24, s53, v4
v_add_u32 v25, s53, v5
s_waitcnt vmcnt(30)
ds_read_b128 a[192:195], v22 offset:0
ds_read_b128 a[196:199], v23 offset:0
ds_read_b128 a[200:203], v24 offset:0
ds_read_b128 a[204:207], v25 offset:0
ds_read_b128 a[208:211], v22 offset:128
ds_read_b128 a[212:215], v23 offset:128
ds_read_b128 a[216:219], v24 offset:128
ds_read_b128 a[220:223], v25 offset:128
ds_read_b128 a[224:227], v22 offset:256
ds_read_b128 a[228:231], v23 offset:256
ds_read_b128 a[232:235], v24 offset:256
ds_read_b128 a[236:239], v25 offset:256
v_add_u32 v22, s91, v2
v_add_u32 v23, s91, v3
v_add_u32 v24, s91, v4
v_add_u32 v25, s91, v5
s_waitcnt vmcnt(18)
ds_read_b128 a[240:243], v22 offset:0
ds_read_b128 a[244:247], v23 offset:0
ds_read_b128 a[248:251], v24 offset:0
ds_read_b128 a[252:255], v25 offset:0
ds_read_b128 v[32:35], v22 offset:128
ds_read_b128 v[36:39], v23 offset:128
ds_read_b128 v[40:43], v24 offset:128
ds_read_b128 v[44:47], v25 offset:128
ds_read_b128 v[48:51], v22 offset:256
ds_read_b128 v[52:55], v23 offset:256
ds_read_b128 v[56:59], v24 offset:256
ds_read_b128 v[60:63], v25 offset:256
s_waitcnt vmcnt(15) lgkmcnt(0)
s_barrier
s_add_u32 m0, s48, 24576
s_nop 0
buffer_load_dwordx4 v8, s[8:11], s38 offen offset:0 lds
buffer_load_dwordx4 v9, s[8:11], s38 offen offset:1024 lds
buffer_load_dwordx4 v10, s[8:11], s38 offen offset:2048 lds
s_add_u32 s38, s38, s78
s_add_u32 m0, s48, 36864
s_nop 0
buffer_load_dwordx4 v8, s[8:11], s38 offen offset:0 lds
buffer_load_dwordx4 v9, s[8:11], s38 offen offset:1024 lds
buffer_load_dwordx4 v10, s[8:11], s38 offen offset:2048 lds
s_add_u32 s38, s38, s78
s_add_u32 s99, s99, 4
s_cmp_eq_u32 s99, s40
s_cselect_b32 s38, s88, s38
s_cselect_b32 s78, -12288, s78
L_js:
ds_read_b128 v[136:139], v2 offset:0
ds_read_b128 v[140:143], v3 offset:0
ds_read_b128 v[144:147], v4 offset:0
ds_read_b128 v[148:151], v5 offset:0
s_waitcnt lgkmcnt(2)
v_mfma_f32_32x32x16_bf16 v[64:79], v[136:139], a[192:195], 0
ds_read_b128 v[152:155], v2 offset:128
ds_read_b128 v[156:159], v3 offset:128
v_accvgpr_write_b32 a0, 0
v_accvgpr_write_b32 a1, 0
v_accvgpr_write_b32 a2, 0
v_mfma_f32_32x32x16_bf16 v[80:95], v[136:139], a[240:243], 0
ds_read_b128 v[136:139], v4 offset:128
v_accvgpr_write_b32 a3, 0
v_accvgpr_write_b32 a4, 0
v_accvgpr_write_b32 a5, 0
v_accvgpr_write_b32 a6, 0
v_mfma_f32_32x32x16_bf16 v[64:79], v[140:143], a[196:199], v[64:79]
v_accvgpr_write_b32 a7, 0
v_accvgpr_write_b32 a8, 0
v_accvgpr_write_b32 a9, 0
v_accvgpr_write_b32 a10, 0
v_accvgpr_write_b32 a11, 0
v_mfma_f32_32x32x16_bf16 v[80:95], v[140:143], a[244:247], v[80:95]
ds_read_b128 v[140:143], v5 offset:128
v_accvgpr_write_b32 a12, 0
v_accvgpr_write_b32 a13, 0
v_accvgpr_write_b32 a14, 0
v_accvgpr_write_b32 a15, 0
s_waitcnt lgkmcnt(4)
v_mfma_f32_32x32x16_bf16 v[64:79], v[144:147], a[200:203], v[64:79]
v_accvgpr_write_b32 a16, 0
v_accvgpr_write_b32 a17, 0
v_accvgpr_write_b32 a18, 0
v_accvgpr_write_b32 a19, 0
v_accvgpr_write_b32 a20, 0
v_mfma_f32_32x32x16_bf16 v[80:95], v[144:147], a[248:251], v[80:95]
ds_read_b128 v[144:147], v2 offset:256
v_accvgpr_write_b32 a21, 0
v_accvgpr_write_b32 a22, 0
v_accvgpr_write_b32 a23, 0
v_accvgpr_write_b32 a24, 0
v_mfma_f32_32x32x16_bf16 v[64:79], v[148:151], a[204:207], v[64:79]
v_accvgpr_write_b32 a25, 0
v_accvgpr_write_b32 a26, 0
v_accvgpr_write_b32 a27, 0
v_accvgpr_write_b32 a28, 0
v_accvgpr_write_b32 a29, 0
v_mfma_f32_32x32x16_bf16 v[80:95], v[148:151], a[252:255], v[80:95]
ds_read_b128 v[148:151], v3 offset:256
v_accvgpr_write_b32 a30, 0
v_accvgpr_write_b32 a31, 0
v_accvgpr_write_b32 a32, 0
v_accvgpr_write_b32 a33, 0
s_waitcnt lgkmcnt(4)
v_mfma_f32_32x32x16_bf16 v[64:79], v[152:155], a[208:211], v[64:79]
v_accvgpr_write_b32 a34, 0
v_accvgpr_write_b32 a35, 0
v_accvgpr_write_b32 a36, 0
v_accvgpr_write_b32 a37, 0
v_accvgpr_write_b32 a38, 0
v_mfma_f32_32x32x16_bf16 v[80:95], v[152:155], v[32:35], v[80:95]
ds_read_b128 v[152:155], v4 offset:256
v_accvgpr_write_b32 a39, 0
v_accvgpr_write_b32 a40, 0
v_accvgpr_write_b32 a41, 0
v_accvgpr_write_b32 a42, 0
v_mfma_f32_32x32x16_bf16 v[64:79], v[156:159], a[212:215], v[64:79]
v_accvgpr_write_b32 a43, 0
v_accvgpr_write_b32 a44, 0
v_accvgpr_write_b32 a45, 0
v_accvgpr_write_b32 a46, 0
v_accvgpr_write_b32 a47, 0
v_mfma_f32_32x32x16_bf16 v[80:95], v[156:159], v[36:39], v[80:95]
ds_read_b128 v[156:159], v5 offset:256
v_accvgpr_write_b32 a48, 0
v_accvgpr_write_b32 a49, 0
v_accvgpr_write_b32 a50, 0
v_accvgpr_write_b32 a51, 0
s_waitcnt lgkmcnt(4)
v_mfma_f32_32x32x16_bf16 v[64:79], v[136:139], a[216:219], v[64:79]
v_accvgpr_write_b32 a52, 0
v_accvgpr_write_b32 a53, 0
v_accvgpr_write_b32 a54, 0
v_accvgpr_write_b32 a55, 0
v_accvgpr_write_b32 a56, 0
v_mfma_f32_32x32x16_bf16 v[80:95], v[136:139], v[40:43], v[80:95]
v_accvgpr_write_b32 a57, 0
v_accvgpr_write_b32 a58, 0
v_accvgpr_write_b32 a59, 0
v_accvgpr_write_b32 a60, 0
v_accvgpr_write_b32 a61, 0
v_mfma_f32_32x32x16_bf16 v[64:79], v[140:143], a[220:223], v[64:79]
v_accvgpr_write_b32 a62, 0
v_accvgpr_write_b32 a63, 0
v_accvgpr_write_b32 a64, 0
v_accvgpr_write_b32 a65, 0
v_accvgpr_write_b32 a66, 0
v_mfma_f32_32x32x16_bf16 v[80:95], v[140:143], v[44:47], v[80:95]
v_accvgpr_write_b32 a67, 0
v_accvgpr_write_b32 a68, 0
v_accvgpr_write_b32 a69, 0
v_accvgpr_write_b32 a70, 0
v_accvgpr_write_b32 a71, 0
s_waitcnt lgkmcnt(2)
v_mfma_f32_32x32x16_bf16 v[64:79], v[144:147], a[224:227], v[64:79]
v_accvgpr_write_b32 a72, 0
v_accvgpr_write_b32 a73, 0
v_accvgpr_write_b32 a74, 0
v_accvgpr_write_b32 a75, 0
v_accvgpr_write_b32 a76, 0
v_mfma_f32_32x32x16_bf16 v[80:95], v[144:147], v[48:51], v[80:95]
v_accvgpr_write_b32 a77, 0
v_accvgpr_write_b32 a78, 0
v_accvgpr_write_b32 a79, 0
v_accvgpr_write_b32 a80, 0
v_accvgpr_write_b32 a81, 0
v_mfma_f32_32x32x16_bf16 v[64:79], v[148:151], a[228:231], v[64:79]
v_accvgpr_write_b32 a82, 0
v_accvgpr_write_b32 a83, 0
v_accvgpr_write_b32 a84, 0
v_accvgpr_write_b32 a85, 0
v_accvgpr_write_b32 a86, 0
v_mfma_f32_32x32x16_bf16 v[80:95], v[148:151], v[52:55], v[80:95]
v_accvgpr_write_b32 a87, 0
v_accvgpr_write_b32 a88, 0
v_accvgpr_write_b32 a89, 0
v_accvgpr_write_b32 a90, 0
v_accvgpr_write_b32 a91, 0
s_waitcnt vmcnt(15) lgkmcnt(0)
v_mfma_f32_32x32x16_bf16 v[64:79], v[152:155], a[232:235], v[64:79]
s_barrier
v_accvgpr_write_b32 a92, 0
v_accvgpr_write_b32 a93, 0
v_accvgpr_write_b32 a94, 0
v_accvgpr_write_b32 a95, 0
v_accvgpr_write_b32 a96, 0
v_mfma_f32_32x32x16_bf16 v[80:95], v[152:155], v[56:59], v[80:95]
v_accvgpr_write_b32 a97, 0
v_accvgpr_write_b32 a98, 0
v_accvgpr_write_b32 a99, 0
v_accvgpr_write_b32 a100, 0
v_accvgpr_write_b32 a101, 0
v_mfma_f32_32x32x16_bf16 v[64:79], v[156:159], a[236:239], v[64:79]
v_accvgpr_write_b32 a102, 0
v_accvgpr_write_b32 a103, 0
v_accvgpr_write_b32 a104, 0
v_accvgpr_write_b32 a105, 0
v_accvgpr_write_b32 a106, 0
v_mfma_f32_32x32x16_bf16 v[80:95], v[156:159], v[60:63], v[80:95]
v_accvgpr_write_b32 a107, 0
v_accvgpr_write_b32 a108, 0
v_accvgpr_write_b32 a109, 0
v_accvgpr_write_b32 a110, 0
v_accvgpr_write_b32 a111, 0
v_accvgpr_write_b32 a112, 0
v_accvgpr_write_b32 a113, 0
v_accvgpr_write_b32 a114, 0
v_accvgpr_write_b32 a115, 0
v_accvgpr_write_b32 a116, 0
v_accvgpr_write_b32 a117, 0
v_accvgpr_write_b32 a118, 0
v_accvgpr_write_b32 a119, 0
v_accvgpr_write_b32 a120, 0
v_accvgpr_write_b32 a121, 0
v_accvgpr_write_b32 a122, 0
v_accvgpr_write_b32 a123, 0
v_accvgpr_write_b32 a124, 0
v_accvgpr_write_b32 a125, 0
v_accvgpr_write_b32 a126, 0
v_accvgpr_write_b32 a127, 0
v_accvgpr_write_b32 a128, 0
v_accvgpr_write_b32 a129, 0
v_accvgpr_write_b32 a130, 0
v_accvgpr_write_b32 a131, 0
v_accvgpr_write_b32 a132, 0
v_accvgpr_write_b32 a133, 0
v_accvgpr_write_b32 a134, 0
v_accvgpr_write_b32 a135, 0
v_accvgpr_write_b32 a136, 0
v_accvgpr_write_b32 a137, 0
v_accvgpr_write_b32 a138, 0
v_accvgpr_write_b32 a139, 0
v_accvgpr_write_b32 a140, 0
v_accvgpr_write_b32 a141, 0
v_accvgpr_write_b32 a142, 0
v_accvgpr_write_b32 a143, 0
v_accvgpr_write_b32 a144, 0
v_accvgpr_write_b32 a145, 0
v_accvgpr_write_b32 a146, 0
v_accvgpr_write_b32 a147, 0
v_accvgpr_write_b32 a148, 0
v_accvgpr_write_b32 a149, 0
v_accvgpr_write_b32 a150, 0
v_accvgpr_write_b32 a151, 0
v_accvgpr_write_b32 a152, 0
v_accvgpr_write_b32 a153, 0
v_accvgpr_write_b32 a154, 0
v_accvgpr_write_b32 a155, 0
v_accvgpr_write_b32 a156, 0
v_accvgpr_write_b32 a157, 0
v_accvgpr_write_b32 a158, 0
v_accvgpr_write_b32 a159, 0
v_accvgpr_write_b32 a160, 0
v_accvgpr_write_b32 a161, 0
v_accvgpr_write_b32 a162, 0
v_accvgpr_write_b32 a163, 0
v_accvgpr_write_b32 a164, 0
v_accvgpr_write_b32 a165, 0
v_accvgpr_write_b32 a166, 0
v_accvgpr_write_b32 a167, 0
v_accvgpr_write_b32 a168, 0
v_accvgpr_write_b32 a169, 0
v_accvgpr_write_b32 a170, 0
v_accvgpr_write_b32 a171, 0
v_accvgpr_write_b32 a172, 0
v_accvgpr_write_b32 a173, 0
v_accvgpr_write_b32 a174, 0
v_accvgpr_write_b32 a175, 0
v_accvgpr_write_b32 a176, 0
v_accvgpr_write_b32 a177, 0
v_accvgpr_write_b32 a178, 0
v_accvgpr_write_b32 a179, 0
v_accvgpr_write_b32 a180, 0
v_accvgpr_write_b32 a181, 0
v_accvgpr_write_b32 a182, 0
v_accvgpr_write_b32 a183, 0
v_accvgpr_write_b32 a184, 0
v_accvgpr_write_b32 a185, 0
v_accvgpr_write_b32 a186, 0
v_accvgpr_write_b32 a187, 0
v_accvgpr_write_b32 a188, 0
v_accvgpr_write_b32 a189, 0
v_accvgpr_write_b32 a190, 0
v_accvgpr_write_b32 a191, 0
L_js_post:
ds_read_b128 v[136:139], v2 offset:12288
ds_read_b128 v[140:143], v3 offset:12288
ds_read_b128 v[144:147], v4 offset:12288
ds_read_b128 v[148:151], v5 offset:12288
s_cmp_eq_u32 s42, 7
s_cbranch_scc1 L_b0m
s_cmp_eq_u32 s42, 0
s_cbranch_scc1 L_b0u_N
s_cmp_eq_u32 s42, 5
s_cbranch_scc1 L_b0u_V
s_branch L_b0u_K
L_b0u_N:
s_nop 7
s_nop 3
v_max3_f32 v28, v64, v65, v66
v_max3_f32 v28, v28, v67, v68
v_max3_f32 v28, v28, v69, v70
v_max3_f32 v28, v28, v71, v72
v_max3_f32 v28, v28, v73, v74
v_max3_f32 v28, v28, v75, v76
v_max3_f32 v28, v28, v77, v78
v_max_f32 v28, v28, v79
v_mov_b32 v29, v28
ds_read_b128 v[152:155], v2 offset:12416
ds_read_b128 v[156:159], v3 offset:12416
v_permlane32_swap_b32 v28, v29
v_max_f32 v28, v28, v29
v_mul_f32_e64 v14, -v28, s37
v_fma_f32 v22, v64, s37, v14
v_fma_f32 v23, v65, s37, v14
v_exp_f32 v22, v22
v_fma_f32 v24, v66, s37, v14
v_exp_f32 v23, v23
v_fma_f32 v25, v67, s37, v14
v_exp_f32 v24, v24
v_add_f32 v18, v22, v23
v_fma_f32 v26, v68, s37, v14
v_exp_f32 v25, v25
v_add_f32 v18, v18, v24
v_cvt_pk_bf16_f32 v112, v22, v23
v_fma_f32 v27, v69, s37, v14
v_exp_f32 v26, v26
v_add_f32 v18, v18, v25
v_fma_f32 v22, v70, s37, v14
v_exp_f32 v27, v27
v_add_f32 v18, v18, v26
v_cvt_pk_bf16_f32 v113, v24, v25
v_fma_f32 v23, v71, s37, v14
v_exp_f32 v22, v22
v_add_f32 v18, v18, v27
v_fma_f32 v24, v72, s37, v14
v_exp_f32 v23, v23
v_add_f32 v18, v18, v22
v_fma_f32 v25, v73, s37, v14
v_exp_f32 v24, v24
v_add_f32 v18, v18, v23
v_exp_f32 v25, v25
v_add_f32 v18, v18, v24
v_cvt_pk_bf16_f32 v114, v26, v27
v_cvt_pk_bf16_f32 v115, v22, v23
v_add_f32 v18, v18, v25
v_cvt_pk_bf16_f32 v116, v24, v25
v_fma_f32 v26, v74, s37, v14
v_fma_f32 v27, v75, s37, v14
v_fma_f32 v22, v76, s37, v14
v_fma_f32 v23, v77, s37, v14
v_fma_f32 v24, v78, s37, v14
v_fma_f32 v25, v79, s37, v14
s_waitcnt lgkmcnt(4)
v_mfma_f32_32x32x16_bf16 v[64:79], v[136:139], a[192:195], 0
s_add_u32 m0, s48, 0
v_max3_f32 v28, v80, v81, v82
buffer_load_dwordx4 v8, s[8:11], s38 offen offset:0 lds
v_max3_f32 v28, v28, v83, v84
v_max3_f32 v28, v28, v85, v86
v_mfma_f32_32x32x16_bf16 v[96:111], v[136:139], a[240:243], 0
ds_read_b128 v[136:139], v4 offset:12416
v_max3_f32 v28, v28, v87, v88
v_max3_f32 v28, v28, v89, v90
v_max3_f32 v28, v28, v91, v92
v_max3_f32 v28, v28, v93, v94
v_mfma_f32_32x32x16_bf16 v[64:79], v[140:143], a[196:199], v[64:79]
v_exp_f32 v26, v26
v_exp_f32 v27, v27
v_max_f32 v28, v28, v95
v_mfma_f32_32x32x16_bf16 v[96:111], v[140:143], a[244:247], v[96:111]
ds_read_b128 v[140:143], v5 offset:12416
buffer_load_dwordx4 v9, s[8:11], s38 offen offset:1024 lds
v_add_f32 v18, v18, v26
v_exp_f32 v22, v22
s_waitcnt lgkmcnt(4)
v_mfma_f32_32x32x16_bf16 v[64:79], v[144:147], a[200:203], v[64:79]
v_mov_b32 v29, v28
v_add_f32 v18, v18, v27
v_exp_f32 v23, v23
v_permlane32_swap_b32 v28, v29
v_mfma_f32_32x32x16_bf16 v[96:111], v[144:147], a[248:251], v[96:111]
ds_read_b128 v[144:147], v2 offset:12544
v_add_f32 v18, v18, v22
v_exp_f32 v24, v24
v_max_f32 v28, v28, v29
v_mfma_f32_32x32x16_bf16 v[64:79], v[148:151], a[204:207], v[64:79]
buffer_load_dwordx4 v10, s[8:11], s38 offen offset:2048 lds
v_exp_f32 v25, v25
v_add_f32 v18, v18, v23
v_cvt_pk_bf16_f32 v118, v22, v23
v_mfma_f32_32x32x16_bf16 v[96:111], v[148:151], a[252:255], v[96:111]
ds_read_b128 v[148:151], v3 offset:12544
v_mul_f32_e64 v15, -v28, s37
v_add_f32 v18, v18, v24
v_cvt_pk_bf16_f32 v119, v24, v25
v_fma_f32 v22, v80, s37, v15
s_waitcnt lgkmcnt(4)
v_mfma_f32_32x32x16_bf16 v[64:79], v[152:155], a[208:211], v[64:79]
v_fma_f32 v23, v81, s37, v15
v_add_f32 v18, v18, v25
v_exp_f32 v22, v22
v_fma_f32 v24, v82, s37, v15
v_mfma_f32_32x32x16_bf16 v[96:111], v[152:155], v[32:35], v[96:111]
ds_read_b128 v[152:155], v4 offset:12544
v_exp_f32 v23, v23
v_cvt_pk_bf16_f32 v117, v26, v27
v_fma_f32 v25, v83, s37, v15
v_mfma_f32_32x32x16_bf16 v[64:79], v[156:159], a[212:215], v[64:79]
v_exp_f32 v24, v24
v_add_f32 v19, v22, v23
v_fma_f32 v26, v84, s37, v15
v_add_f32 v19, v19, v24
v_mfma_f32_32x32x16_bf16 v[96:111], v[156:159], v[36:39], v[96:111]
ds_read_b128 v[156:159], v5 offset:12544
v_exp_f32 v25, v25
v_cvt_pk_bf16_f32 v128, v22, v23
v_fma_f32 v27, v85, s37, v15
s_waitcnt lgkmcnt(4)
v_mfma_f32_32x32x16_bf16 v[64:79], v[136:139], a[216:219], v[64:79]
v_exp_f32 v26, v26
v_add_f32 v19, v19, v25
v_fma_f32 v22, v86, s37, v15
s_add_u32 m0, s49, 24576
v_mfma_f32_32x32x16_bf16 v[96:111], v[136:139], v[40:43], v[96:111]
v_exp_f32 v27, v27
v_add_f32 v19, v19, v26
v_cvt_pk_bf16_f32 v129, v24, v25
v_fma_f32 v23, v87, s37, v15
v_mfma_f32_32x32x16_bf16 v[64:79], v[140:143], a[220:223], v[64:79]
v_exp_f32 v22, v22
buffer_load_dwordx4 v11, s[12:15], s39 offen offset:0 lds
v_add_f32 v19, v19, v27
v_fma_f32 v24, v88, s37, v15
v_mfma_f32_32x32x16_bf16 v[96:111], v[140:143], v[44:47], v[96:111]
v_exp_f32 v23, v23
v_add_f32 v19, v19, v22
v_cvt_pk_bf16_f32 v130, v26, v27
v_fma_f32 v25, v89, s37, v15
s_waitcnt lgkmcnt(2)
v_mfma_f32_32x32x16_bf16 v[64:79], v[144:147], a[224:227], v[64:79]
v_exp_f32 v24, v24
v_add_f32 v19, v19, v23
v_fma_f32 v26, v90, s37, v15
v_add_f32 v19, v19, v24
v_mfma_f32_32x32x16_bf16 v[96:111], v[144:147], v[48:51], v[96:111]
buffer_load_dwordx4 v12, s[12:15], s39 offen offset:1024 lds
v_exp_f32 v25, v25
v_cvt_pk_bf16_f32 v131, v22, v23
v_fma_f32 v27, v91, s37, v15
v_mfma_f32_32x32x16_bf16 v[64:79], v[148:151], a[228:231], v[64:79]
v_exp_f32 v26, v26
v_add_f32 v19, v19, v25
v_fma_f32 v22, v92, s37, v15
v_add_f32 v19, v19, v26
v_mfma_f32_32x32x16_bf16 v[96:111], v[148:151], v[52:55], v[96:111]
v_exp_f32 v27, v27
v_cvt_pk_bf16_f32 v132, v24, v25
v_fma_f32 v23, v93, s37, v15
v_add_f32 v19, v19, v27
s_waitcnt vmcnt(5) lgkmcnt(0)
v_mfma_f32_32x32x16_bf16 v[64:79], v[152:155], a[232:235], v[64:79]
s_barrier
buffer_load_dwordx4 v13, s[12:15], s39 offen offset:2048 lds
v_exp_f32 v22, v22
v_fma_f32 v24, v94, s37, v15
ds_read_b64_tr_b16 v[136:137], v6 offset:0
v_mfma_f32_32x32x16_bf16 v[96:111], v[152:155], v[56:59], v[96:111]
v_exp_f32 v23, v23
ds_read_b64_tr_b16 v[138:139], v6 offset:3072
ds_read_b64_tr_b16 v[140:141], v7 offset:0
ds_read_b64_tr_b16 v[142:143], v7 offset:3072
v_mfma_f32_32x32x16_bf16 v[64:79], v[156:159], a[236:239], v[64:79]
ds_read_b64_tr_b16 v[144:145], v6 offset:128
ds_read_b64_tr_b16 v[146:147], v6 offset:3200
ds_read_b64_tr_b16 v[148:149], v7 offset:128
ds_read_b64_tr_b16 v[150:151], v7 offset:3200
v_add_f32 v19, v19, v22
v_mfma_f32_32x32x16_bf16 v[96:111], v[156:159], v[60:63], v[96:111]
v_fma_f32 v25, v95, s37, v15
v_exp_f32 v24, v24
v_add_f32 v19, v19, v23
v_exp_f32 v25, v25
v_add_f32 v19, v19, v24
v_add_f32 v19, v19, v25
v_mov_b32 v16, v18
v_cvt_pk_bf16_f32 v133, v26, v27
v_cvt_pk_bf16_f32 v134, v22, v23
v_cvt_pk_bf16_f32 v135, v24, v25
s_add_u32 s38, s38, s78
s_add_u32 s39, s39, s98
v_mov_b32 v17, v19
s_cmp_eq_u32 s43, -2
s_cbranch_scc0 L_nf_b0uN
s_mov_b32 s43, -1
s_cmp_eq_u32 s36, 0
s_cbranch_scc0 L_sent_b0uN
s_lshr_b32 s84, s92, 2
s_lshl_b32 s84, s84, 2
s_add_u32 s84, s84, 128
s_and_b32 s85, s92, 3
s_lshl_b32 s85, s85, 3
s_lshl_b32 s85, 1, s85
v_mov_b32 v30, s84
v_mov_b32 v31, s85
v_cmp_eq_u32 vcc, 0, v1
s_and_saveexec_b64 s[54:55], vcc
global_atomic_or v30, v31, s[80:81] sc1
s_mov_b64 exec, s[54:55]
L_sent_b0uN:
L_nf_b0uN:
s_branch L_p1_N
.p2align 6
L_p0_N:
v_mfma_f32_32x32x16_bf16 a[0:15], v[136:139], v[120:123], a[0:15]
ds_read_b64_tr_b16 v[152:153], v6 offset:37120
ds_read_b64_tr_b16 v[154:155], v6 offset:40192
ds_read_b64_tr_b16 v[156:157], v7 offset:37120
ds_read_b64_tr_b16 v[158:159], v7 offset:40192
s_add_u32 m0, s48, 0
v_mfma_f32_32x32x16_bf16 a[96:111], v[136:139], v[128:131], a[96:111]
ds_read_b64_tr_b16 v[136:137], v6 offset:43008
ds_read_b64_tr_b16 v[138:139], v6 offset:46080
buffer_load_dwordx4 v8, s[8:11], s38 offen offset:0 lds
v_mfma_f32_32x32x16_bf16 a[16:31], v[140:143], v[120:123], a[16:31]
v_fma_f32 v22, v64, s37, v14
v_fma_f32 v23, v65, s37, v14
v_exp_f32 v22, v22
v_fma_f32 v24, v66, s37, v14
v_mfma_f32_32x32x16_bf16 a[112:127], v[140:143], v[128:131], a[112:127]
ds_read_b64_tr_b16 v[140:141], v7 offset:43008
ds_read_b64_tr_b16 v[142:143], v7 offset:46080
v_exp_f32 v23, v23
v_fma_f32 v25, v67, s37, v14
v_mfma_f32_32x32x16_bf16 a[32:47], v[144:147], v[120:123], a[32:47]
v_exp_f32 v24, v24
v_add_f32 v18, v22, v23
v_fma_f32 v26, v68, s37, v14
v_add_f32 v18, v18, v24
v_mfma_f32_32x32x16_bf16 a[128:143], v[144:147], v[128:131], a[128:143]
ds_read_b64_tr_b16 v[144:145], v6 offset:43136
ds_read_b64_tr_b16 v[146:147], v6 offset:46208
v_exp_f32 v25, v25
v_cvt_pk_bf16_f32 v112, v22, v23
v_mfma_f32_32x32x16_bf16 a[48:63], v[148:151], v[120:123], a[48:63]
v_fma_f32 v27, v69, s37, v14
v_exp_f32 v26, v26
v_add_f32 v18, v18, v25
v_fma_f32 v22, v70, s37, v14
v_mfma_f32_32x32x16_bf16 a[144:159], v[148:151], v[128:131], a[144:159]
ds_read_b64_tr_b16 v[148:149], v7 offset:43136
ds_read_b64_tr_b16 v[150:151], v7 offset:46208
v_exp_f32 v27, v27
v_add_f32 v18, v18, v26
v_mfma_f32_32x32x16_bf16 a[64:79], v[152:155], v[120:123], a[64:79]
v_cvt_pk_bf16_f32 v113, v24, v25
v_fma_f32 v23, v71, s37, v14
v_exp_f32 v22, v22
v_add_f32 v18, v18, v27
v_mfma_f32_32x32x16_bf16 a[160:175], v[152:155], v[128:131], a[160:175]
ds_read_b64_tr_b16 v[152:153], v6 offset:43264
ds_read_b64_tr_b16 v[154:155], v6 offset:46336
v_fma_f32 v24, v72, s37, v14
v_exp_f32 v23, v23
v_mfma_f32_32x32x16_bf16 a[80:95], v[156:159], v[120:123], a[80:95]
buffer_load_dwordx4 v9, s[8:11], s38 offen offset:1024 lds
v_add_f32 v18, v18, v22
v_cvt_pk_bf16_f32 v114, v26, v27
v_fma_f32 v25, v73, s37, v14
v_add_f32 v18, v18, v23
v_mfma_f32_32x32x16_bf16 a[176:191], v[156:159], v[128:131], a[176:191]
ds_read_b64_tr_b16 v[156:157], v7 offset:43264
ds_read_b64_tr_b16 v[158:159], v7 offset:46336
v_exp_f32 v24, v24
v_fma_f32 v26, v74, s37, v14
v_mfma_f32_32x32x16_bf16 a[0:15], v[136:139], v[124:127], a[0:15]
v_exp_f32 v25, v25
v_add_f32 v18, v18, v24
v_cvt_pk_bf16_f32 v115, v22, v23
v_fma_f32 v27, v75, s37, v14
v_mfma_f32_32x32x16_bf16 a[96:111], v[136:139], v[132:135], a[96:111]
ds_read_b128 v[136:139], v2 offset:12288
buffer_load_dwordx4 v10, s[8:11], s38 offen offset:2048 lds
v_exp_f32 v26, v26
v_add_f32 v18, v18, v25
v_mfma_f32_32x32x16_bf16 a[16:31], v[140:143], v[124:127], a[16:31]
v_fma_f32 v22, v76, s37, v14
v_exp_f32 v27, v27
v_add_f32 v18, v18, v26
v_cvt_pk_bf16_f32 v116, v24, v25
v_mfma_f32_32x32x16_bf16 a[112:127], v[140:143], v[132:135], a[112:127]
ds_read_b128 v[140:143], v3 offset:12288
v_fma_f32 v23, v77, s37, v14
v_exp_f32 v22, v22
v_add_f32 v18, v18, v27
v_mfma_f32_32x32x16_bf16 a[32:47], v[144:147], v[124:127], a[32:47]
v_fma_f32 v24, v78, s37, v14
v_exp_f32 v23, v23
v_add_f32 v18, v18, v22
v_fma_f32 v25, v79, s37, v14
v_mfma_f32_32x32x16_bf16 a[128:143], v[144:147], v[132:135], a[128:143]
ds_read_b128 v[144:147], v4 offset:12288
v_exp_f32 v24, v24
v_add_f32 v18, v18, v23
v_add_f32 v18, v18, v24
v_mfma_f32_32x32x16_bf16 a[48:63], v[148:151], v[124:127], a[48:63]
v_exp_f32 v25, v25
v_cvt_pk_bf16_f32 v117, v26, v27
v_cvt_pk_bf16_f32 v118, v22, v23
v_add_f32 v18, v18, v25
v_mfma_f32_32x32x16_bf16 a[144:159], v[148:151], v[132:135], a[144:159]
v_cvt_pk_bf16_f32 v119, v24, v25
ds_read_b128 v[148:151], v5 offset:12288
s_add_u32 m0, s49, 24576
s_add_u32 s38, s38, s78
buffer_load_dwordx4 v11, s[12:15], s39 offen offset:0 lds
v_mfma_f32_32x32x16_bf16 a[64:79], v[152:155], v[124:127], a[64:79]
v_mfma_f32_32x32x16_bf16 a[160:175], v[152:155], v[132:135], a[160:175]
ds_read_b128 v[152:155], v2 offset:12416
v_mfma_f32_32x32x16_bf16 a[80:95], v[156:159], v[124:127], a[80:95]
v_cmp_nge_f32 vcc, s52, v18
s_cbranch_vccnz Lst_p0N_X
Lct_p0N_X:
v_add_f32 v16, v16, v18
buffer_load_dwordx4 v12, s[12:15], s39 offen offset:1024 lds
v_fma_f32 v22, v80, s37, v15
v_mfma_f32_32x32x16_bf16 a[176:191], v[156:159], v[132:135], a[176:191]
ds_read_b128 v[156:159], v3 offset:12416
v_fma_f32 v23, v81, s37, v15
v_exp_f32 v22, v22
v_fma_f32 v24, v82, s37, v15
v_mfma_f32_32x32x16_bf16 v[64:79], v[136:139], a[192:195], 0
v_exp_f32 v23, v23
v_fma_f32 v25, v83, s37, v15
v_exp_f32 v24, v24
v_mfma_f32_32x32x16_bf16 v[96:111], v[136:139], a[240:243], 0
ds_read_b128 v[136:139], v4 offset:12416
buffer_load_dwordx4 v13, s[12:15], s39 offen offset:2048 lds
v_add_f32 v19, v22, v23
v_fma_f32 v26, v84, s37, v15
v_add_f32 v19, v19, v24
v_mfma_f32_32x32x16_bf16 v[64:79], v[140:143], a[196:199], v[64:79]
v_exp_f32 v25, v25
v_cvt_pk_bf16_f32 v128, v22, v23
v_fma_f32 v27, v85, s37, v15
v_add_f32 v19, v19, v25
v_mfma_f32_32x32x16_bf16 v[96:111], v[140:143], a[244:247], v[96:111]
ds_read_b128 v[140:143], v5 offset:12416
v_exp_f32 v26, v26
v_fma_f32 v22, v86, s37, v15
v_add_f32 v19, v19, v26
v_mfma_f32_32x32x16_bf16 v[64:79], v[144:147], a[200:203], v[64:79]
v_exp_f32 v27, v27
v_cvt_pk_bf16_f32 v129, v24, v25
v_fma_f32 v23, v87, s37, v15
v_add_f32 v19, v19, v27
v_mfma_f32_32x32x16_bf16 v[96:111], v[144:147], a[248:251], v[96:111]
ds_read_b128 v[144:147], v2 offset:12544
v_exp_f32 v22, v22
v_fma_f32 v24, v88, s37, v15
v_add_f32 v19, v19, v22
v_mfma_f32_32x32x16_bf16 v[64:79], v[148:151], a[204:207], v[64:79]
v_exp_f32 v23, v23
v_cvt_pk_bf16_f32 v130, v26, v27
v_fma_f32 v25, v89, s37, v15
v_add_f32 v19, v19, v23
v_mfma_f32_32x32x16_bf16 v[96:111], v[148:151], a[252:255], v[96:111]
ds_read_b128 v[148:151], v3 offset:12544
v_exp_f32 v24, v24
v_fma_f32 v26, v90, s37, v15
v_add_f32 v19, v19, v24
v_mfma_f32_32x32x16_bf16 v[64:79], v[152:155], a[208:211], v[64:79]
v_exp_f32 v25, v25
v_cvt_pk_bf16_f32 v131, v22, v23
v_fma_f32 v27, v91, s37, v15
v_add_f32 v19, v19, v25
v_mfma_f32_32x32x16_bf16 v[96:111], v[152:155], v[32:35], v[96:111]
ds_read_b128 v[152:155], v4 offset:12544
v_exp_f32 v26, v26
v_fma_f32 v22, v92, s37, v15
v_add_f32 v19, v19, v26
v_mfma_f32_32x32x16_bf16 v[64:79], v[156:159], a[212:215], v[64:79]
v_exp_f32 v27, v27
v_cvt_pk_bf16_f32 v132, v24, v25
v_fma_f32 v23, v93, s37, v15
v_add_f32 v19, v19, v27
v_mfma_f32_32x32x16_bf16 v[96:111], v[156:159], v[36:39], v[96:111]
ds_read_b128 v[156:159], v5 offset:12544
v_exp_f32 v22, v22
v_fma_f32 v24, v94, s37, v15
v_add_f32 v19, v19, v22
v_mfma_f32_32x32x16_bf16 v[64:79], v[136:139], a[216:219], v[64:79]
v_exp_f32 v23, v23
v_fma_f32 v25, v95, s37, v15
v_exp_f32 v24, v24
v_mfma_f32_32x32x16_bf16 v[96:111], v[136:139], v[40:43], v[96:111]
ds_read_b64_tr_b16 v[136:137], v6 offset:0
ds_read_b64_tr_b16 v[138:139], v6 offset:3072
v_add_f32 v19, v19, v23
v_exp_f32 v25, v25
v_mfma_f32_32x32x16_bf16 v[64:79], v[140:143], a[220:223], v[64:79]
v_add_f32 v19, v19, v24
v_cvt_pk_bf16_f32 v133, v26, v27
v_cvt_pk_bf16_f32 v134, v22, v23
v_add_f32 v19, v19, v25
v_cvt_pk_bf16_f32 v135, v24, v25
v_mfma_f32_32x32x16_bf16 v[96:111], v[140:143], v[44:47], v[96:111]
ds_read_b64_tr_b16 v[140:141], v7 offset:0
ds_read_b64_tr_b16 v[142:143], v7 offset:3072
s_add_u32 s39, s39, s98
v_cmp_nge_f32 vcc, s52, v19
s_cbranch_vccnz Lst_p0N_Y
Lct_p0N_Y:
v_add_f32 v17, v17, v19
v_mfma_f32_32x32x16_bf16 v[64:79], v[144:147], a[224:227], v[64:79]
v_mfma_f32_32x32x16_bf16 v[96:111], v[144:147], v[48:51], v[96:111]
ds_read_b64_tr_b16 v[144:145], v6 offset:128
ds_read_b64_tr_b16 v[146:147], v6 offset:3200
v_mfma_f32_32x32x16_bf16 v[64:79], v[148:151], a[228:231], v[64:79]
v_mfma_f32_32x32x16_bf16 v[96:111], v[148:151], v[52:55], v[96:111]
ds_read_b64_tr_b16 v[148:149], v7 offset:128
ds_read_b64_tr_b16 v[150:151], v7 offset:3200
v_mfma_f32_32x32x16_bf16 v[64:79], v[152:155], a[232:235], v[64:79]
s_barrier
v_mfma_f32_32x32x16_bf16 v[96:111], v[152:155], v[56:59], v[96:111]
v_mfma_f32_32x32x16_bf16 v[64:79], v[156:159], a[236:239], v[64:79]
v_mfma_f32_32x32x16_bf16 v[96:111], v[156:159], v[60:63], v[96:111]
L_p1_N:
s_waitcnt lgkmcnt(4)
v_mfma_f32_32x32x16_bf16 a[0:15], v[136:139], v[112:115], a[0:15]
ds_read_b64_tr_b16 v[152:153], v6 offset:256
ds_read_b64_tr_b16 v[154:155], v6 offset:3328
ds_read_b64_tr_b16 v[156:157], v7 offset:256
ds_read_b64_tr_b16 v[158:159], v7 offset:3328
s_add_u32 m0, s48, 12288
v_mfma_f32_32x32x16_bf16 a[96:111], v[136:139], v[128:131], a[96:111]
ds_read_b64_tr_b16 v[136:137], v6 offset:6144
ds_read_b64_tr_b16 v[138:139], v6 offset:9216
buffer_load_dwordx4 v8, s[8:11], s38 offen offset:0 lds
v_mfma_f32_32x32x16_bf16 a[16:31], v[140:143], v[112:115], a[16:31]
v_fma_f32 v22, v64, s37, v14
v_fma_f32 v23, v65, s37, v14
v_exp_f32 v22, v22
v_fma_f32 v24, v66, s37, v14
v_mfma_f32_32x32x16_bf16 a[112:127], v[140:143], v[128:131], a[112:127]
ds_read_b64_tr_b16 v[140:141], v7 offset:6144
ds_read_b64_tr_b16 v[142:143], v7 offset:9216
v_exp_f32 v23, v23
v_fma_f32 v25, v67, s37, v14
s_waitcnt lgkmcnt(8)
v_mfma_f32_32x32x16_bf16 a[32:47], v[144:147], v[112:115], a[32:47]
v_exp_f32 v24, v24
v_add_f32 v18, v22, v23
v_fma_f32 v26, v68, s37, v14
v_add_f32 v18, v18, v24
v_mfma_f32_32x32x16_bf16 a[128:143], v[144:147], v[128:131], a[128:143]
ds_read_b64_tr_b16 v[144:145], v6 offset:6272
ds_read_b64_tr_b16 v[146:147], v6 offset:9344
v_exp_f32 v25, v25
v_cvt_pk_bf16_f32 v120, v22, v23
v_mfma_f32_32x32x16_bf16 a[48:63], v[148:151], v[112:115], a[48:63]
v_fma_f32 v27, v69, s37, v14
v_exp_f32 v26, v26
v_add_f32 v18, v18, v25
v_fma_f32 v22, v70, s37, v14
v_mfma_f32_32x32x16_bf16 a[144:159], v[148:151], v[128:131], a[144:159]
ds_read_b64_tr_b16 v[148:149], v7 offset:6272
ds_read_b64_tr_b16 v[150:151], v7 offset:9344
v_exp_f32 v27, v27
v_add_f32 v18, v18, v26
s_waitcnt lgkmcnt(8)
v_mfma_f32_32x32x16_bf16 a[64:79], v[152:155], v[112:115], a[64:79]
v_cvt_pk_bf16_f32 v121, v24, v25
v_fma_f32 v23, v71, s37, v14
v_exp_f32 v22, v22
v_add_f32 v18, v18, v27
v_mfma_f32_32x32x16_bf16 a[160:175], v[152:155], v[128:131], a[160:175]
ds_read_b64_tr_b16 v[152:153], v6 offset:6400
ds_read_b64_tr_b16 v[154:155], v6 offset:9472
v_fma_f32 v24, v72, s37, v14
v_exp_f32 v23, v23
v_mfma_f32_32x32x16_bf16 a[80:95], v[156:159], v[112:115], a[80:95]
buffer_load_dwordx4 v9, s[8:11], s38 offen offset:1024 lds
v_add_f32 v18, v18, v22
v_cvt_pk_bf16_f32 v122, v26, v27
v_fma_f32 v25, v73, s37, v14
v_add_f32 v18, v18, v23
v_mfma_f32_32x32x16_bf16 a[176:191], v[156:159], v[128:131], a[176:191]
ds_read_b64_tr_b16 v[156:157], v7 offset:6400
ds_read_b64_tr_b16 v[158:159], v7 offset:9472
v_exp_f32 v24, v24
v_fma_f32 v26, v74, s37, v14
s_waitcnt lgkmcnt(8)
v_mfma_f32_32x32x16_bf16 a[0:15], v[136:139], v[116:119], a[0:15]
v_exp_f32 v25, v25
v_add_f32 v18, v18, v24
v_cvt_pk_bf16_f32 v123, v22, v23
v_fma_f32 v27, v75, s37, v14
v_mfma_f32_32x32x16_bf16 a[96:111], v[136:139], v[132:135], a[96:111]
ds_read_b128 v[136:139], v2 offset:24576
buffer_load_dwordx4 v10, s[8:11], s38 offen offset:2048 lds
v_exp_f32 v26, v26
v_add_f32 v18, v18, v25
v_mfma_f32_32x32x16_bf16 a[16:31], v[140:143], v[116:119], a[16:31]
v_fma_f32 v22, v76, s37, v14
v_exp_f32 v27, v27
v_add_f32 v18, v18, v26
v_cvt_pk_bf16_f32 v124, v24, v25
v_mfma_f32_32x32x16_bf16 a[112:127], v[140:143], v[132:135], a[112:127]
ds_read_b128 v[140:143], v3 offset:24576
v_fma_f32 v23, v77, s37, v14
v_exp_f32 v22, v22
v_add_f32 v18, v18, v27
s_waitcnt lgkmcnt(6)
v_mfma_f32_32x32x16_bf16 a[32:47], v[144:147], v[116:119], a[32:47]
v_fma_f32 v24, v78, s37, v14
v_exp_f32 v23, v23
v_add_f32 v18, v18, v22
v_fma_f32 v25, v79, s37, v14
v_mfma_f32_32x32x16_bf16 a[128:143], v[144:147], v[132:135], a[128:143]
ds_read_b128 v[144:147], v4 offset:24576
v_exp_f32 v24, v24
v_add_f32 v18, v18, v23
v_add_f32 v18, v18, v24
v_mfma_f32_32x32x16_bf16 a[48:63], v[148:151], v[116:119], a[48:63]
v_exp_f32 v25, v25
v_cvt_pk_bf16_f32 v125, v26, v27
v_cvt_pk_bf16_f32 v126, v22, v23
v_add_f32 v18, v18, v25
v_mfma_f32_32x32x16_bf16 a[144:159], v[148:151], v[132:135], a[144:159]
v_cvt_pk_bf16_f32 v127, v24, v25
ds_read_b128 v[148:151], v5 offset:24576
s_add_u32 m0, s49, 36864
s_add_u32 s38, s38, s78
buffer_load_dwordx4 v11, s[12:15], s39 offen offset:0 lds
s_waitcnt lgkmcnt(4)
v_mfma_f32_32x32x16_bf16 a[64:79], v[152:155], v[116:119], a[64:79]
v_mfma_f32_32x32x16_bf16 a[160:175], v[152:155], v[132:135], a[160:175]
ds_read_b128 v[152:155], v2 offset:24704
v_mfma_f32_32x32x16_bf16 a[80:95], v[156:159], v[116:119], a[80:95]
v_cmp_nge_f32 vcc, s52, v18
s_cbranch_vccnz Lst_p1N_X
Lct_p1N_X:
v_add_f32 v16, v16, v18
buffer_load_dwordx4 v12, s[12:15], s39 offen offset:1024 lds
v_fma_f32 v22, v96, s37, v15
v_mfma_f32_32x32x16_bf16 a[176:191], v[156:159], v[132:135], a[176:191]
ds_read_b128 v[156:159], v3 offset:24704
v_fma_f32 v23, v97, s37, v15
v_exp_f32 v22, v22
v_fma_f32 v24, v98, s37, v15
s_waitcnt lgkmcnt(4)
v_mfma_f32_32x32x16_bf16 v[64:79], v[136:139], a[192:195], 0
v_exp_f32 v23, v23
v_fma_f32 v25, v99, s37, v15
v_exp_f32 v24, v24
v_mfma_f32_32x32x16_bf16 v[80:95], v[136:139], a[240:243], 0
ds_read_b128 v[136:139], v4 offset:24704
buffer_load_dwordx4 v13, s[12:15], s39 offen offset:2048 lds
v_add_f32 v19, v22, v23
v_fma_f32 v26, v100, s37, v15
v_add_f32 v19, v19, v24
v_mfma_f32_32x32x16_bf16 v[64:79], v[140:143], a[196:199], v[64:79]
v_exp_f32 v25, v25
v_cvt_pk_bf16_f32 v128, v22, v23
v_fma_f32 v27, v101, s37, v15
v_add_f32 v19, v19, v25
v_mfma_f32_32x32x16_bf16 v[80:95], v[140:143], a[244:247], v[80:95]
ds_read_b128 v[140:143], v5 offset:24704
v_exp_f32 v26, v26
v_fma_f32 v22, v102, s37, v15
v_add_f32 v19, v19, v26
s_waitcnt lgkmcnt(4)
v_mfma_f32_32x32x16_bf16 v[64:79], v[144:147], a[200:203], v[64:79]
v_exp_f32 v27, v27
v_cvt_pk_bf16_f32 v129, v24, v25
v_fma_f32 v23, v103, s37, v15
v_add_f32 v19, v19, v27
v_mfma_f32_32x32x16_bf16 v[80:95], v[144:147], a[248:251], v[80:95]
ds_read_b128 v[144:147], v2 offset:24832
v_exp_f32 v22, v22
v_fma_f32 v24, v104, s37, v15
v_add_f32 v19, v19, v22
v_mfma_f32_32x32x16_bf16 v[64:79], v[148:151], a[204:207], v[64:79]
v_exp_f32 v23, v23
v_cvt_pk_bf16_f32 v130, v26, v27
v_fma_f32 v25, v105, s37, v15
v_add_f32 v19, v19, v23
v_mfma_f32_32x32x16_bf16 v[80:95], v[148:151], a[252:255], v[80:95]
ds_read_b128 v[148:151], v3 offset:24832
v_exp_f32 v24, v24
v_fma_f32 v26, v106, s37, v15
v_add_f32 v19, v19, v24
s_waitcnt lgkmcnt(4)
v_mfma_f32_32x32x16_bf16 v[64:79], v[152:155], a[208:211], v[64:79]
v_exp_f32 v25, v25
v_cvt_pk_bf16_f32 v131, v22, v23
v_fma_f32 v27, v107, s37, v15
v_add_f32 v19, v19, v25
v_mfma_f32_32x32x16_bf16 v[80:95], v[152:155], v[32:35], v[80:95]
ds_read_b128 v[152:155], v4 offset:24832
v_exp_f32 v26, v26
v_fma_f32 v22, v108, s37, v15
v_add_f32 v19, v19, v26
v_mfma_f32_32x32x16_bf16 v[64:79], v[156:159], a[212:215], v[64:79]
v_exp_f32 v27, v27
v_cvt_pk_bf16_f32 v132, v24, v25
v_fma_f32 v23, v109, s37, v15
v_add_f32 v19, v19, v27
v_mfma_f32_32x32x16_bf16 v[80:95], v[156:159], v[36:39], v[80:95]
ds_read_b128 v[156:159], v5 offset:24832
v_exp_f32 v22, v22
v_fma_f32 v24, v110, s37, v15
v_add_f32 v19, v19, v22
s_waitcnt lgkmcnt(4)
v_mfma_f32_32x32x16_bf16 v[64:79], v[136:139], a[216:219], v[64:79]
v_exp_f32 v23, v23
v_fma_f32 v25, v111, s37, v15
v_exp_f32 v24, v24
v_mfma_f32_32x32x16_bf16 v[80:95], v[136:139], v[40:43], v[80:95]
ds_read_b64_tr_b16 v[136:137], v6 offset:12288
ds_read_b64_tr_b16 v[138:139], v6 offset:15360
v_add_f32 v19, v19, v23
v_exp_f32 v25, v25
v_mfma_f32_32x32x16_bf16 v[64:79], v[140:143], a[220:223], v[64:79]
v_add_f32 v19, v19, v24
v_cvt_pk_bf16_f32 v133, v26, v27
v_cvt_pk_bf16_f32 v134, v22, v23
v_add_f32 v19, v19, v25
v_cvt_pk_bf16_f32 v135, v24, v25
v_mfma_f32_32x32x16_bf16 v[80:95], v[140:143], v[44:47], v[80:95]
ds_read_b64_tr_b16 v[140:141], v7 offset:12288
ds_read_b64_tr_b16 v[142:143], v7 offset:15360
v_cmp_nge_f32 vcc, s52, v19
s_cbranch_vccnz Lst_p1N_Y
Lct_p1N_Y:
v_add_f32 v17, v17, v19
s_waitcnt lgkmcnt(6)
v_mfma_f32_32x32x16_bf16 v[64:79], v[144:147], a[224:227], v[64:79]
s_add_u32 s39, s39, s98
s_add_u32 s62, s62, 4
s_cmp_eq_u32 s62, s40
s_cselect_b32 s39, s88, s39
s_cselect_b32 s98, -12288, s98
s_cmp_eq_u32 s62, 28
s_cselect_b32 s39, s41, s39
s_cselect_b32 s98, 12288, s98
v_mfma_f32_32x32x16_bf16 v[80:95], v[144:147], v[48:51], v[80:95]
ds_read_b64_tr_b16 v[144:145], v6 offset:12416
ds_read_b64_tr_b16 v[146:147], v6 offset:15488
v_mfma_f32_32x32x16_bf16 v[64:79], v[148:151], a[228:231], v[64:79]
v_mfma_f32_32x32x16_bf16 v[80:95], v[148:151], v[52:55], v[80:95]
ds_read_b64_tr_b16 v[148:149], v7 offset:12416
ds_read_b64_tr_b16 v[150:151], v7 offset:15488
s_waitcnt vmcnt(6) lgkmcnt(8)
v_mfma_f32_32x32x16_bf16 v[64:79], v[152:155], a[232:235], v[64:79]
s_barrier
v_mfma_f32_32x32x16_bf16 v[80:95], v[152:155], v[56:59], v[80:95]
v_mfma_f32_32x32x16_bf16 v[64:79], v[156:159], a[236:239], v[64:79]
v_mfma_f32_32x32x16_bf16 v[80:95], v[156:159], v[60:63], v[80:95]
v_mul_u32_u24 v242, 384, v242
v_mul_u32_u24 v243, 384, v243
v_mul_u32_u24 v244, 384, v244
v_mul_u32_u24 v245, 384, v245
v_mul_u32_u24 v246, 384, v246
v_mul_u32_u24 v247, 384, v247
v_mul_u32_u24 v248, 384, v248
v_mul_u32_u24 v249, 384, v249
ds_read_b128 v[184:187], v232 offset:12288
ds_read_b128 v[188:191], v233 offset:12288
ds_read_b128 v[192:195], v232 offset:14336
ds_read_b128 v[196:199], v233 offset:14336
s_waitcnt lgkmcnt(2)
s_add_u32 m0, s53, 12032
s_nop 0
buffer_load_dwordx4 v236, s[4:7], s79 offen offset:256 lds
buffer_load_dwordx4 v237, s[4:7], s79 offen offset:1280 lds
L_p2_N:
v_mfma_f32_32x32x16_bf16 a[0:15], v[136:139], v[120:123], a[0:15]
ds_read_b64_tr_b16 v[152:153], v6 offset:12544
ds_read_b64_tr_b16 v[154:155], v6 offset:15616
ds_read_b64_tr_b16 v[156:157], v7 offset:12544
ds_read_b64_tr_b16 v[158:159], v7 offset:15616
s_add_u32 m0, s48, 24576
v_mfma_f32_32x32x16_bf16 a[96:111], v[136:139], v[128:131], a[96:111]
ds_read_b64_tr_b16 v[136:137], v6 offset:18432
ds_read_b64_tr_b16 v[138:139], v6 offset:21504
buffer_load_dwordx4 v8, s[8:11], s38 offen offset:0 lds
v_mfma_f32_32x32x16_bf16 a[16:31], v[140:143], v[120:123], a[16:31]
v_fma_f32 v22, v64, s37, v14
v_fma_f32 v23, v65, s37, v14
v_exp_f32 v22, v22
v_fma_f32 v24, v66, s37, v14
v_mfma_f32_32x32x16_bf16 a[112:127], v[140:143], v[128:131], a[112:127]
ds_read_b64_tr_b16 v[140:141], v7 offset:18432
ds_read_b64_tr_b16 v[142:143], v7 offset:21504
v_exp_f32 v23, v23
v_fma_f32 v25, v67, s37, v14
v_mfma_f32_32x32x16_bf16 a[32:47], v[144:147], v[120:123], a[32:47]
v_exp_f32 v24, v24
v_add_f32 v18, v22, v23
v_fma_f32 v26, v68, s37, v14
v_add_f32 v18, v18, v24
v_mfma_f32_32x32x16_bf16 a[128:143], v[144:147], v[128:131], a[128:143]
ds_read_b64_tr_b16 v[144:145], v6 offset:18560
ds_read_b64_tr_b16 v[146:147], v6 offset:21632
v_exp_f32 v25, v25
v_cvt_pk_bf16_f32 v112, v22, v23
v_mfma_f32_32x32x16_bf16 a[48:63], v[148:151], v[120:123], a[48:63]
v_fma_f32 v27, v69, s37, v14
v_exp_f32 v26, v26
v_add_f32 v18, v18, v25
v_fma_f32 v22, v70, s37, v14
v_mfma_f32_32x32x16_bf16 a[144:159], v[148:151], v[128:131], a[144:159]
ds_read_b64_tr_b16 v[148:149], v7 offset:18560
ds_read_b64_tr_b16 v[150:151], v7 offset:21632
v_exp_f32 v27, v27
v_add_f32 v18, v18, v26
s_waitcnt lgkmcnt(8)
v_mfma_f32_32x32x16_bf16 a[64:79], v[152:155], v[120:123], a[64:79]
v_cvt_pk_bf16_f32 v113, v24, v25
v_fma_f32 v23, v71, s37, v14
v_exp_f32 v22, v22
v_add_f32 v18, v18, v27
v_mfma_f32_32x32x16_bf16 a[160:175], v[152:155], v[128:131], a[160:175]
ds_read_b64_tr_b16 v[152:153], v6 offset:18688
ds_read_b64_tr_b16 v[154:155], v6 offset:21760
v_fma_f32 v24, v72, s37, v14
v_exp_f32 v23, v23
v_mfma_f32_32x32x16_bf16 a[80:95], v[156:159], v[120:123], a[80:95]
buffer_load_dwordx4 v9, s[8:11], s38 offen offset:1024 lds
v_add_f32 v18, v18, v22
v_cvt_pk_bf16_f32 v114, v26, v27
v_fma_f32 v25, v73, s37, v14
v_add_f32 v18, v18, v23
v_mfma_f32_32x32x16_bf16 a[176:191], v[156:159], v[128:131], a[176:191]
ds_read_b64_tr_b16 v[156:157], v7 offset:18688
ds_read_b64_tr_b16 v[158:159], v7 offset:21760
v_exp_f32 v24, v24
v_fma_f32 v26, v74, s37, v14
s_waitcnt lgkmcnt(8)
v_mfma_f32_32x32x16_bf16 a[0:15], v[136:139], v[124:127], a[0:15]
v_exp_f32 v25, v25
v_add_f32 v18, v18, v24
v_cvt_pk_bf16_f32 v115, v22, v23
v_fma_f32 v27, v75, s37, v14
v_mfma_f32_32x32x16_bf16 a[96:111], v[136:139], v[132:135], a[96:111]
ds_read_b128 v[136:139], v2 offset:36864
buffer_load_dwordx4 v10, s[8:11], s38 offen offset:2048 lds
v_exp_f32 v26, v26
v_add_f32 v18, v18, v25
v_mfma_f32_32x32x16_bf16 a[16:31], v[140:143], v[124:127], a[16:31]
v_fma_f32 v22, v76, s37, v14
v_exp_f32 v27, v27
v_add_f32 v18, v18, v26
v_cvt_pk_bf16_f32 v116, v24, v25
v_mfma_f32_32x32x16_bf16 a[112:127], v[140:143], v[132:135], a[112:127]
ds_read_b128 v[140:143], v3 offset:36864
v_fma_f32 v23, v77, s37, v14
v_exp_f32 v22, v22
v_add_f32 v18, v18, v27
s_waitcnt lgkmcnt(6)
v_mfma_f32_32x32x16_bf16 a[32:47], v[144:147], v[124:127], a[32:47]
v_fma_f32 v24, v78, s37, v14
v_exp_f32 v23, v23
v_add_f32 v18, v18, v22
v_fma_f32 v25, v79, s37, v14
v_mfma_f32_32x32x16_bf16 a[128:143], v[144:147], v[132:135], a[128:143]
ds_read_b128 v[144:147], v4 offset:36864
v_exp_f32 v24, v24
v_add_f32 v18, v18, v23
v_add_f32 v18, v18, v24
v_mfma_f32_32x32x16_bf16 a[48:63], v[148:151], v[124:127], a[48:63]
v_exp_f32 v25, v25
v_cvt_pk_bf16_f32 v117, v26, v27
v_cvt_pk_bf16_f32 v118, v22, v23
v_add_f32 v18, v18, v25
v_mfma_f32_32x32x16_bf16 a[144:159], v[148:151], v[132:135], a[144:159]
v_cvt_pk_bf16_f32 v119, v24, v25
ds_read_b128 v[148:151], v5 offset:36864
s_add_u32 m0, s49, 0
s_add_u32 s38, s38, s78
buffer_load_dwordx4 v11, s[12:15], s39 offen offset:0 lds
s_waitcnt lgkmcnt(4)
v_mfma_f32_32x32x16_bf16 a[64:79], v[152:155], v[124:127], a[64:79]
v_mfma_f32_32x32x16_bf16 a[160:175], v[152:155], v[132:135], a[160:175]
ds_read_b128 v[152:155], v2 offset:36992
v_mfma_f32_32x32x16_bf16 a[80:95], v[156:159], v[124:127], a[80:95]
v_cmp_nge_f32 vcc, s52, v18
s_cbranch_vccnz Lst_p2N_X
Lct_p2N_X:
v_add_f32 v16, v16, v18
buffer_load_dwordx4 v12, s[12:15], s39 offen offset:1024 lds
v_fma_f32 v22, v80, s37, v15
v_mfma_f32_32x32x16_bf16 a[176:191], v[156:159], v[132:135], a[176:191]
ds_read_b128 v[156:159], v3 offset:36992
v_fma_f32 v23, v81, s37, v15
v_exp_f32 v22, v22
v_fma_f32 v24, v82, s37, v15
s_waitcnt lgkmcnt(4)
v_mfma_f32_32x32x16_bf16 v[64:79], v[136:139], a[192:195], 0
v_exp_f32 v23, v23
v_fma_f32 v25, v83, s37, v15
v_exp_f32 v24, v24
v_mfma_f32_32x32x16_bf16 v[96:111], v[136:139], a[240:243], 0
ds_read_b128 v[136:139], v4 offset:36992
buffer_load_dwordx4 v13, s[12:15], s39 offen offset:2048 lds
v_add_f32 v19, v22, v23
v_fma_f32 v26, v84, s37, v15
v_add_f32 v19, v19, v24
v_mfma_f32_32x32x16_bf16 v[64:79], v[140:143], a[196:199], v[64:79]
v_exp_f32 v25, v25
v_cvt_pk_bf16_f32 v128, v22, v23
v_fma_f32 v27, v85, s37, v15
v_add_f32 v19, v19, v25
v_mfma_f32_32x32x16_bf16 v[96:111], v[140:143], a[244:247], v[96:111]
ds_read_b128 v[140:143], v5 offset:36992
v_exp_f32 v26, v26
v_fma_f32 v22, v86, s37, v15
v_add_f32 v19, v19, v26
s_waitcnt lgkmcnt(4)
v_mfma_f32_32x32x16_bf16 v[64:79], v[144:147], a[200:203], v[64:79]
v_exp_f32 v27, v27
v_cvt_pk_bf16_f32 v129, v24, v25
v_fma_f32 v23, v87, s37, v15
v_add_f32 v19, v19, v27
v_mfma_f32_32x32x16_bf16 v[96:111], v[144:147], a[248:251], v[96:111]
ds_read_b128 v[144:147], v2 offset:37120
v_exp_f32 v22, v22
v_fma_f32 v24, v88, s37, v15
v_add_f32 v19, v19, v22
v_mfma_f32_32x32x16_bf16 v[64:79], v[148:151], a[204:207], v[64:79]
v_exp_f32 v23, v23
v_cvt_pk_bf16_f32 v130, v26, v27
v_fma_f32 v25, v89, s37, v15
v_add_f32 v19, v19, v23
v_mfma_f32_32x32x16_bf16 v[96:111], v[148:151], a[252:255], v[96:111]
ds_read_b128 v[148:151], v3 offset:37120
v_exp_f32 v24, v24
v_fma_f32 v26, v90, s37, v15
v_add_f32 v19, v19, v24
s_waitcnt lgkmcnt(4)
v_mfma_f32_32x32x16_bf16 v[64:79], v[152:155], a[208:211], v[64:79]
v_exp_f32 v25, v25
v_cvt_pk_bf16_f32 v131, v22, v23
v_fma_f32 v27, v91, s37, v15
v_add_f32 v19, v19, v25
v_mfma_f32_32x32x16_bf16 v[96:111], v[152:155], v[32:35], v[96:111]
ds_read_b128 v[152:155], v4 offset:37120
v_exp_f32 v26, v26
v_fma_f32 v22, v92, s37, v15
v_add_f32 v19, v19, v26
v_mfma_f32_32x32x16_bf16 v[64:79], v[156:159], a[212:215], v[64:79]
v_exp_f32 v27, v27
v_cvt_pk_bf16_f32 v132, v24, v25
v_fma_f32 v23, v93, s37, v15
v_add_f32 v19, v19, v27
v_mfma_f32_32x32x16_bf16 v[96:111], v[156:159], v[36:39], v[96:111]
ds_read_b128 v[156:159], v5 offset:37120
v_exp_f32 v22, v22
v_fma_f32 v24, v94, s37, v15
v_add_f32 v19, v19, v22
s_waitcnt lgkmcnt(4)
v_mfma_f32_32x32x16_bf16 v[64:79], v[136:139], a[216:219], v[64:79]
v_exp_f32 v23, v23
v_fma_f32 v25, v95, s37, v15
v_exp_f32 v24, v24
v_mfma_f32_32x32x16_bf16 v[96:111], v[136:139], v[40:43], v[96:111]
ds_read_b64_tr_b16 v[136:137], v6 offset:24576
ds_read_b64_tr_b16 v[138:139], v6 offset:27648
v_add_f32 v19, v19, v23
v_exp_f32 v25, v25
v_mfma_f32_32x32x16_bf16 v[64:79], v[140:143], a[220:223], v[64:79]
v_add_f32 v19, v19, v24
v_cvt_pk_bf16_f32 v133, v26, v27
v_cvt_pk_bf16_f32 v134, v22, v23
v_add_f32 v19, v19, v25
v_cvt_pk_bf16_f32 v135, v24, v25
v_mfma_f32_32x32x16_bf16 v[96:111], v[140:143], v[44:47], v[96:111]
ds_read_b64_tr_b16 v[140:141], v7 offset:24576
ds_read_b64_tr_b16 v[142:143], v7 offset:27648
s_add_u32 s39, s39, s98
v_cmp_nge_f32 vcc, s52, v19
s_cbranch_vccnz Lst_p2N_Y
Lct_p2N_Y:
v_add_f32 v17, v17, v19
s_waitcnt lgkmcnt(6)
v_mfma_f32_32x32x16_bf16 v[64:79], v[144:147], a[224:227], v[64:79]
v_mfma_f32_32x32x16_bf16 v[96:111], v[144:147], v[48:51], v[96:111]
ds_read_b64_tr_b16 v[144:145], v6 offset:24704
ds_read_b64_tr_b16 v[146:147], v6 offset:27776
v_mfma_f32_32x32x16_bf16 v[64:79], v[148:151], a[228:231], v[64:79]
v_mfma_f32_32x32x16_bf16 v[96:111], v[148:151], v[52:55], v[96:111]
ds_read_b64_tr_b16 v[148:149], v7 offset:24704
ds_read_b64_tr_b16 v[150:151], v7 offset:27776
s_waitcnt vmcnt(8) lgkmcnt(8)
v_mfma_f32_32x32x16_bf16 v[64:79], v[152:155], a[232:235], v[64:79]
s_barrier
v_mfma_f32_32x32x16_bf16 v[96:111], v[152:155], v[56:59], v[96:111]
v_mfma_f32_32x32x16_bf16 v[64:79], v[156:159], a[236:239], v[64:79]
v_mfma_f32_32x32x16_bf16 v[96:111], v[156:159], v[60:63], v[96:111]
s_cmp_eq_u32 s42, s43
s_cbranch_scc1 L_t3_N
s_waitcnt lgkmcnt(4)
v_mfma_f32_32x32x16_bf16 a[0:15], v[136:139], v[112:115], a[0:15]
ds_read_b64_tr_b16 v[152:153], v6 offset:24832
ds_read_b64_tr_b16 v[154:155], v6 offset:27904
ds_read_b64_tr_b16 v[156:157], v7 offset:24832
ds_read_b64_tr_b16 v[158:159], v7 offset:27904
v_add_u32_dpp v208, v242, v234 row_newbcast:0 row_mask:0xf bank_mask:0x3
v_mfma_f32_32x32x16_bf16 a[96:111], v[136:139], v[128:131], a[96:111]
ds_read_b64_tr_b16 v[136:137], v6 offset:30720
ds_read_b64_tr_b16 v[138:139], v6 offset:33792
v_add_u32_dpp v216, v242, v235 row_newbcast:2 row_mask:0xf bank_mask:0x3
v_add_u32_dpp v209, v243, v234 row_newbcast:0 row_mask:0xf bank_mask:0x3
v_add_u32_dpp v217, v243, v235 row_newbcast:2 row_mask:0xf bank_mask:0x3
v_mfma_f32_32x32x16_bf16 a[16:31], v[140:143], v[112:115], a[16:31]
v_add_u32_dpp v210, v244, v234 row_newbcast:0 row_mask:0xf bank_mask:0x3
v_add_u32_dpp v218, v244, v235 row_newbcast:2 row_mask:0xf bank_mask:0x3
v_add_u32_dpp v211, v245, v234 row_newbcast:0 row_mask:0xf bank_mask:0x3
v_add_u32_dpp v219, v245, v235 row_newbcast:2 row_mask:0xf bank_mask:0x3
v_add_u32_dpp v208, v242, v234 row_newbcast:1 row_mask:0xf bank_mask:0xc
v_mfma_f32_32x32x16_bf16 a[112:127], v[140:143], v[128:131], a[112:127]
ds_read_b64_tr_b16 v[140:141], v7 offset:30720
ds_read_b64_tr_b16 v[142:143], v7 offset:33792
v_add_u32_dpp v216, v242, v235 row_newbcast:3 row_mask:0xf bank_mask:0xc
v_add_u32_dpp v209, v243, v234 row_newbcast:1 row_mask:0xf bank_mask:0xc
v_add_u32_dpp v217, v243, v235 row_newbcast:3 row_mask:0xf bank_mask:0xc
s_waitcnt lgkmcnt(8)
v_mfma_f32_32x32x16_bf16 a[32:47], v[144:147], v[112:115], a[32:47]
v_add_u32_dpp v210, v244, v234 row_newbcast:1 row_mask:0xf bank_mask:0xc
v_add_u32_dpp v218, v244, v235 row_newbcast:3 row_mask:0xf bank_mask:0xc
v_add_u32_dpp v211, v245, v234 row_newbcast:1 row_mask:0xf bank_mask:0xc
v_add_u32_dpp v219, v245, v235 row_newbcast:3 row_mask:0xf bank_mask:0xc
v_mov_b32_dpp v242, v242 row_ror:12 row_mask:0xf bank_mask:0xf
v_mfma_f32_32x32x16_bf16 a[128:143], v[144:147], v[128:131], a[128:143]
ds_read_b64_tr_b16 v[144:145], v6 offset:30848
ds_read_b64_tr_b16 v[146:147], v6 offset:33920
v_mov_b32_dpp v243, v243 row_ror:12 row_mask:0xf bank_mask:0xf
v_mov_b32_dpp v244, v244 row_ror:12 row_mask:0xf bank_mask:0xf
v_mov_b32_dpp v245, v245 row_ror:12 row_mask:0xf bank_mask:0xf
v_mfma_f32_32x32x16_bf16 a[48:63], v[148:151], v[112:115], a[48:63]
s_add_u32 m0, s48, 36864
v_fma_f32 v22, v64, s37, v14
buffer_load_dwordx4 v8, s[8:11], s38 offen offset:0 lds
v_fma_f32 v23, v65, s37, v14
v_fma_f32 v24, v66, s37, v14
v_mfma_f32_32x32x16_bf16 a[144:159], v[148:151], v[128:131], a[144:159]
ds_read_b64_tr_b16 v[148:149], v7 offset:30848
ds_read_b64_tr_b16 v[150:151], v7 offset:33920
v_exp_f32 v22, v22
v_fma_f32 v25, v67, s37, v14
s_waitcnt lgkmcnt(8)
v_mfma_f32_32x32x16_bf16 a[64:79], v[152:155], v[112:115], a[64:79]
v_exp_f32 v23, v23
v_exp_f32 v24, v24
v_add_f32 v18, v22, v23
v_mfma_f32_32x32x16_bf16 a[160:175], v[152:155], v[128:131], a[160:175]
ds_read_b64_tr_b16 v[152:153], v6 offset:30976
ds_read_b64_tr_b16 v[154:155], v6 offset:34048
buffer_load_dwordx4 v9, s[8:11], s38 offen offset:1024 lds
v_fma_f32 v26, v68, s37, v14
v_add_f32 v18, v18, v24
v_mfma_f32_32x32x16_bf16 a[80:95], v[156:159], v[112:115], a[80:95]
v_exp_f32 v25, v25
v_cvt_pk_bf16_f32 v120, v22, v23
v_fma_f32 v27, v69, s37, v14
v_add_f32 v18, v18, v25
v_mfma_f32_32x32x16_bf16 a[176:191], v[156:159], v[128:131], a[176:191]
ds_read_b64_tr_b16 v[156:157], v7 offset:30976
ds_read_b64_tr_b16 v[158:159], v7 offset:34048
v_exp_f32 v26, v26
v_fma_f32 v22, v70, s37, v14
s_waitcnt lgkmcnt(8)
v_mfma_f32_32x32x16_bf16 a[0:15], v[136:139], v[116:119], a[0:15]
buffer_load_dwordx4 v10, s[8:11], s38 offen offset:2048 lds
s_add_u32 m0, s53, 0
v_exp_f32 v27, v27
v_add_f32 v18, v18, v26
v_mfma_f32_32x32x16_bf16 a[96:111], v[136:139], v[132:135], a[96:111]
ds_read_b128 v[136:139], v2 offset:0
v_cvt_pk_bf16_f32 v121, v24, v25
v_fma_f32 v23, v71, s37, v14
v_exp_f32 v22, v22
v_mfma_f32_32x32x16_bf16 a[16:31], v[140:143], v[116:119], a[16:31]
v_add_f32 v18, v18, v27
v_fma_f32 v24, v72, s37, v14
v_exp_f32 v23, v23
v_add_f32 v18, v18, v22
v_mfma_f32_32x32x16_bf16 a[112:127], v[140:143], v[132:135], a[112:127]
buffer_load_dwordx4 v208, s[16:19], 0 offen offset:0 lds
ds_read_b128 v[140:143], v3 offset:0
v_cvt_pk_bf16_f32 v122, v26, v27
v_fma_f32 v25, v73, s37, v14
v_add_f32 v18, v18, v23
s_waitcnt lgkmcnt(6)
v_mfma_f32_32x32x16_bf16 a[32:47], v[144:147], v[116:119], a[32:47]
v_exp_f32 v24, v24
v_fma_f32 v26, v74, s37, v14
v_exp_f32 v25, v25
v_mfma_f32_32x32x16_bf16 a[128:143], v[144:147], v[132:135], a[128:143]
ds_read_b128 v[144:147], v4 offset:0
v_add_f32 v18, v18, v24
v_cvt_pk_bf16_f32 v123, v22, v23
v_fma_f32 v27, v75, s37, v14
v_add_f32 v18, v18, v25
v_mfma_f32_32x32x16_bf16 a[48:63], v[148:151], v[116:119], a[48:63]
buffer_load_dwordx4 v216, s[16:19], 0 offen offset:1024 lds
v_exp_f32 v26, v26
v_fma_f32 v22, v76, s37, v14
v_add_f32 v18, v18, v26
v_mfma_f32_32x32x16_bf16 a[144:159], v[148:151], v[132:135], a[144:159]
v_exp_f32 v27, v27
v_cvt_pk_bf16_f32 v124, v24, v25
v_fma_f32 v23, v77, s37, v14
v_add_f32 v18, v18, v27
s_waitcnt lgkmcnt(3)
v_mfma_f32_32x32x16_bf16 a[64:79], v[152:155], v[116:119], a[64:79]
v_exp_f32 v22, v22
v_fma_f32 v24, v78, s37, v14
v_exp_f32 v23, v23
v_mfma_f32_32x32x16_bf16 a[160:175], v[152:155], v[132:135], a[160:175]
v_add_f32 v18, v18, v22
v_fma_f32 v25, v79, s37, v14
v_exp_f32 v24, v24
v_add_f32 v18, v18, v23
v_mfma_f32_32x32x16_bf16 a[80:95], v[156:159], v[116:119], a[80:95]
v_exp_f32 v25, v25
v_add_f32 v18, v18, v24
s_add_u32 m0, s49, 12288
v_cvt_pk_bf16_f32 v125, v26, v27
v_mfma_f32_32x32x16_bf16 a[176:191], v[156:159], v[132:135], a[176:191]
v_cvt_pk_bf16_f32 v126, v22, v23
v_add_f32 v18, v18, v25
v_cvt_pk_bf16_f32 v127, v24, v25
buffer_load_dwordx4 v11, s[12:15], s39 offen offset:0 lds
ds_read_b128 v[148:151], v5 offset:0
v_cmp_nge_f32 vcc, s52, v18
s_cbranch_vccnz Lst_p3N_X
Lct_p3N_X:
v_add_f32 v16, v16, v18
s_waitcnt lgkmcnt(2)
v_mfma_f32_32x32x16_bf16 v[64:79], v[136:139], a[192:195], 0
ds_read_b128 v[152:155], v2 offset:128
ds_read_b128 v[156:159], v3 offset:128
v_fma_f32 v22, v96, s37, v15
v_fma_f32 v23, v97, s37, v15
v_fma_f32 v24, v98, s37, v15
v_mfma_f32_32x32x16_bf16 v[80:95], v[136:139], a[240:243], 0
ds_read_b128 v[136:139], v4 offset:128
v_exp_f32 v22, v22
v_exp_f32 v23, v23
v_mfma_f32_32x32x16_bf16 v[64:79], v[140:143], a[196:199], v[64:79]
buffer_load_dwordx4 v12, s[12:15], s39 offen offset:1024 lds
v_fma_f32 v25, v99, s37, v15
v_exp_f32 v24, v24
v_add_f32 v19, v22, v23
v_mfma_f32_32x32x16_bf16 v[80:95], v[140:143], a[244:247], v[80:95]
ds_read_b128 v[140:143], v5 offset:128
v_fma_f32 v26, v100, s37, v15
v_exp_f32 v25, v25
v_add_f32 v19, v19, v24
s_waitcnt lgkmcnt(4)
v_mfma_f32_32x32x16_bf16 v[64:79], v[144:147], a[200:203], v[64:79]
v_cvt_pk_bf16_f32 v128, v22, v23
v_fma_f32 v27, v101, s37, v15
v_exp_f32 v26, v26
v_add_f32 v19, v19, v25
v_mfma_f32_32x32x16_bf16 v[80:95], v[144:147], a[248:251], v[80:95]
buffer_load_dwordx4 v13, s[12:15], s39 offen offset:2048 lds
s_add_u32 m0, s53, 2048
ds_read_b128 v[144:147], v2 offset:256
v_fma_f32 v22, v102, s37, v15
v_add_f32 v19, v19, v26
v_mfma_f32_32x32x16_bf16 v[64:79], v[148:151], a[204:207], v[64:79]
v_exp_f32 v27, v27
v_cvt_pk_bf16_f32 v129, v24, v25
v_fma_f32 v23, v103, s37, v15
v_add_f32 v19, v19, v27
v_mfma_f32_32x32x16_bf16 v[80:95], v[148:151], a[252:255], v[80:95]
ds_read_b128 v[148:151], v3 offset:256
v_exp_f32 v22, v22
v_fma_f32 v24, v104, s37, v15
v_add_f32 v19, v19, v22
s_waitcnt lgkmcnt(4)
v_mfma_f32_32x32x16_bf16 v[64:79], v[152:155], a[208:211], v[64:79]
buffer_load_dwordx4 v209, s[16:19], 0 offen offset:0 lds
v_exp_f32 v23, v23
v_cvt_pk_bf16_f32 v130, v26, v27
v_fma_f32 v25, v105, s37, v15
v_mfma_f32_32x32x16_bf16 v[80:95], v[152:155], v[32:35], v[80:95]
ds_read_b128 v[152:155], v4 offset:256
v_exp_f32 v24, v24
v_add_f32 v19, v19, v23
v_fma_f32 v26, v106, s37, v15
v_mfma_f32_32x32x16_bf16 v[64:79], v[156:159], a[212:215], v[64:79]
v_exp_f32 v25, v25
v_add_f32 v19, v19, v24
v_cvt_pk_bf16_f32 v131, v22, v23
v_fma_f32 v27, v107, s37, v15
v_mfma_f32_32x32x16_bf16 v[80:95], v[156:159], v[36:39], v[80:95]
buffer_load_dwordx4 v217, s[16:19], 0 offen offset:1024 lds
s_add_u32 m0, s53, 4096
ds_read_b128 v[156:159], v5 offset:256
v_exp_f32 v26, v26
s_waitcnt lgkmcnt(4)
v_mfma_f32_32x32x16_bf16 v[64:79], v[136:139], a[216:219], v[64:79]
v_add_f32 v19, v19, v25
v_fma_f32 v22, v108, s37, v15
v_exp_f32 v27, v27
v_add_f32 v19, v19, v26
v_mfma_f32_32x32x16_bf16 v[80:95], v[136:139], v[40:43], v[80:95]
ds_read_b64_tr_b16 v[136:137], v6 offset:36864
ds_read_b64_tr_b16 v[138:139], v6 offset:39936
v_cvt_pk_bf16_f32 v132, v24, v25
v_fma_f32 v23, v109, s37, v15
v_add_f32 v19, v19, v27
v_mfma_f32_32x32x16_bf16 v[64:79], v[140:143], a[220:223], v[64:79]
buffer_load_dwordx4 v210, s[16:19], 0 offen offset:0 lds
v_exp_f32 v22, v22
v_fma_f32 v24, v110, s37, v15
v_add_f32 v19, v19, v22
v_mfma_f32_32x32x16_bf16 v[80:95], v[140:143], v[44:47], v[80:95]
ds_read_b64_tr_b16 v[140:141], v7 offset:36864
ds_read_b64_tr_b16 v[142:143], v7 offset:39936
v_exp_f32 v23, v23
v_fma_f32 v25, v111, s37, v15
s_waitcnt lgkmcnt(6)
v_mfma_f32_32x32x16_bf16 v[64:79], v[144:147], a[224:227], v[64:79]
v_exp_f32 v24, v24
v_add_f32 v19, v19, v23
v_exp_f32 v25, v25
v_mfma_f32_32x32x16_bf16 v[80:95], v[144:147], v[48:51], v[80:95]
buffer_load_dwordx4 v218, s[16:19], 0 offen offset:1024 lds
s_add_u32 m0, s53, 6144
ds_read_b64_tr_b16 v[144:145], v6 offset:36992
ds_read_b64_tr_b16 v[146:147], v6 offset:40064
v_add_f32 v19, v19, v24
v_mfma_f32_32x32x16_bf16 v[64:79], v[148:151], a[228:231], v[64:79]
v_cvt_pk_bf16_f32 v133, v26, v27
v_cvt_pk_bf16_f32 v134, v22, v23
v_add_f32 v19, v19, v25
v_cvt_pk_bf16_f32 v135, v24, v25
s_add_u32 s39, s39, s98
v_mfma_f32_32x32x16_bf16 v[80:95], v[148:151], v[52:55], v[80:95]
ds_read_b64_tr_b16 v[148:149], v7 offset:36992
ds_read_b64_tr_b16 v[150:151], v7 offset:40064
v_cmp_nge_f32 vcc, s52, v19
s_cbranch_vccnz Lst_p3N_Y
Lct_p3N_Y:
v_add_f32 v17, v17, v19
s_waitcnt vmcnt(12) lgkmcnt(8)
v_mfma_f32_32x32x16_bf16 v[64:79], v[152:155], a[232:235], v[64:79]
s_barrier
buffer_load_dwordx4 v211, s[16:19], 0 offen offset:0 lds
v_mfma_f32_32x32x16_bf16 v[80:95], v[152:155], v[56:59], v[80:95]
s_add_u32 s38, s38, s78
s_add_u32 s99, s99, 4
s_cmp_eq_u32 s99, s40
s_cselect_b32 s38, s88, s38
s_cselect_b32 s78, -12288, s78
s_cmp_eq_u32 s99, 28
s_cselect_b32 s38, s41, s38
s_cselect_b32 s78, 12288, s78
v_mfma_f32_32x32x16_bf16 v[64:79], v[156:159], a[236:239], v[64:79]
v_mfma_f32_32x32x16_bf16 v[80:95], v[156:159], v[60:63], v[80:95]
buffer_load_dwordx4 v219, s[16:19], 0 offen offset:1024 lds
s_add_u32 m0, s53, 8064
s_nop 0
buffer_load_dwordx4 v208, s[16:19], 0 offen offset:128 lds
buffer_load_dwordx4 v216, s[16:19], 0 offen offset:1152 lds
s_add_u32 s42, s42, 1
s_branch L_enterK
L_b0u_K:
s_nop 7
s_nop 3
v_max3_f32 v28, v64, v65, v66
v_max3_f32 v28, v28, v67, v68
v_max3_f32 v28, v28, v69, v70
v_max3_f32 v28, v28, v71, v72
v_max3_f32 v28, v28, v73, v74
v_max3_f32 v28, v28, v75, v76
v_max3_f32 v28, v28, v77, v78
v_max_f32 v28, v28, v79
v_mov_b32 v29, v28
ds_read_b128 v[152:155], v2 offset:12416
ds_read_b128 v[156:159], v3 offset:12416
v_permlane32_swap_b32 v28, v29
v_max_f32 v28, v28, v29
v_mul_f32_e64 v14, -v28, s37
v_fma_f32 v22, v64, s37, v14
v_fma_f32 v23, v65, s37, v14
v_exp_f32 v22, v22
v_fma_f32 v24, v66, s37, v14
v_exp_f32 v23, v23
v_fma_f32 v25, v67, s37, v14
v_exp_f32 v24, v24
v_add_f32 v18, v22, v23
v_fma_f32 v26, v68, s37, v14
v_exp_f32 v25, v25
v_add_f32 v18, v18, v24
v_cvt_pk_bf16_f32 v112, v22, v23
v_fma_f32 v27, v69, s37, v14
v_exp_f32 v26, v26
v_add_f32 v18, v18, v25
v_fma_f32 v22, v70, s37, v14
v_exp_f32 v27, v27
v_add_f32 v18, v18, v26
v_cvt_pk_bf16_f32 v113, v24, v25
v_fma_f32 v23, v71, s37, v14
v_exp_f32 v22, v22
v_add_f32 v18, v18, v27
v_fma_f32 v24, v72, s37, v14
v_exp_f32 v23, v23
v_add_f32 v18, v18, v22
v_fma_f32 v25, v73, s37, v14
v_exp_f32 v24, v24
v_add_f32 v18, v18, v23
v_exp_f32 v25, v25
v_add_f32 v18, v18, v24
v_cvt_pk_bf16_f32 v114, v26, v27
v_cvt_pk_bf16_f32 v115, v22, v23
v_add_f32 v18, v18, v25
v_cvt_pk_bf16_f32 v116, v24, v25
v_fma_f32 v26, v74, s37, v14
v_fma_f32 v27, v75, s37, v14
v_fma_f32 v22, v76, s37, v14
v_fma_f32 v23, v77, s37, v14
v_fma_f32 v24, v78, s37, v14
v_fma_f32 v25, v79, s37, v14
s_waitcnt lgkmcnt(4)
v_mfma_f32_32x32x16_bf16 v[64:79], v[136:139], a[192:195], 0
v_max3_f32 v28, v80, v81, v82
v_max3_f32 v28, v28, v83, v84
v_max3_f32 v28, v28, v85, v86
v_max3_f32 v28, v28, v87, v88
v_max3_f32 v28, v28, v89, v90
v_mfma_f32_16x16x32_bf16 v[180:183], v[224:227], v[200:203], v[180:183]
v_max3_f32 v28, v28, v91, v92
v_max3_f32 v28, v28, v93, v94
v_mfma_f32_16x16x32_bf16 v[180:183], v[228:231], v[204:207], v[180:183]
s_waitcnt vmcnt(8)
ds_read_b128 v[224:227], v232 offset:0
ds_read_b128 v[228:231], v233 offset:0
v_mfma_f32_32x32x16_bf16 v[96:111], v[136:139], a[240:243], 0
s_add_u32 m0, s53, 10112
ds_read_b128 v[136:139], v4 offset:12416
buffer_load_dwordx4 v209, s[16:19], 0 offen offset:128 lds
v_cndmask_b32_e64 v240, v176, v177, s[66:67]
v_cndmask_b32_e64 v240, v240, v178, s[68:69]
v_mfma_f32_32x32x16_bf16 v[64:79], v[140:143], a[196:199], v[64:79]
v_cndmask_b32_e64 v240, v240, v179, s[70:71]
v_cndmask_b32_e64 v166, v166, v240, s[74:75]
v_exp_f32 v26, v26
v_max_f32 v28, v28, v95
v_mfma_f32_32x32x16_bf16 v[96:111], v[140:143], a[244:247], v[96:111]
ds_read_b128 v[140:143], v5 offset:12416
v_exp_f32 v27, v27
v_add_f32 v18, v18, v26
v_mov_b32 v29, v28
s_waitcnt lgkmcnt(6)
v_mfma_f32_32x32x16_bf16 v[64:79], v[144:147], a[200:203], v[64:79]
buffer_load_dwordx4 v217, s[16:19], 0 offen offset:1152 lds
s_add_u32 m0, s48, 0
v_exp_f32 v22, v22
v_add_f32 v18, v18, v27
s_waitcnt lgkmcnt(3)
v_mfma_f32_16x16x32_bf16 v[168:171], v[224:227], v[184:187], 0
v_exp_f32 v23, v23
s_waitcnt lgkmcnt(2)
v_mfma_f32_16x16x32_bf16 v[168:171], v[228:231], v[188:191], v[168:171]
s_waitcnt vmcnt(8)
ds_read_b128 v[224:227], v232 offset:2048
ds_read_b128 v[228:231], v233 offset:2048
v_mfma_f32_32x32x16_bf16 v[96:111], v[144:147], a[248:251], v[96:111]
ds_read_b128 v[144:147], v2 offset:12544
v_cndmask_b32_e64 v240, v180, v181, s[66:67]
v_cndmask_b32_e64 v240, v240, v182, s[68:69]
v_cndmask_b32_e64 v240, v240, v183, s[70:71]
v_cndmask_b32_e64 v167, v167, v240, s[74:75]
v_mfma_f32_32x32x16_bf16 v[64:79], v[148:151], a[204:207], v[64:79]
buffer_load_dwordx4 v8, s[8:11], s38 offen offset:0 lds
ds_read_b128 v[200:203], v232 offset:12288
ds_read_b128 v[204:207], v233 offset:12288
v_permlane32_swap_b32 v28, v29
v_add_f32 v18, v18, v22
v_mfma_f32_32x32x16_bf16 v[96:111], v[148:151], a[252:255], v[96:111]
ds_read_b128 v[148:151], v3 offset:12544
v_exp_f32 v24, v24
v_exp_f32 v25, v25
v_mfma_f32_32x32x16_bf16 v[64:79], v[152:155], a[208:211], v[64:79]
v_max_f32 v28, v28, v29
v_add_f32 v18, v18, v23
v_cvt_pk_bf16_f32 v118, v22, v23
v_mul_f32_e64 v15, -v28, s37
v_add_f32 v18, v18, v24
s_waitcnt lgkmcnt(5)
v_mfma_f32_16x16x32_bf16 v[172:175], v[224:227], v[184:187], 0
buffer_load_dwordx4 v9, s[8:11], s38 offen offset:1024 lds
v_cvt_pk_bf16_f32 v119, v24, v25
s_waitcnt lgkmcnt(4)
v_mfma_f32_16x16x32_bf16 v[172:175], v[228:231], v[188:191], v[172:175]
s_waitcnt vmcnt(8)
ds_read_b128 v[224:227], v232 offset:4096
ds_read_b128 v[228:231], v233 offset:4096
v_mfma_f32_32x32x16_bf16 v[96:111], v[152:155], v[32:35], v[96:111]
ds_read_b128 v[152:155], v4 offset:12544
v_add_u32_dpp v212, v246, v234 row_newbcast:0 row_mask:0xf bank_mask:0x3
v_add_u32_dpp v220, v246, v235 row_newbcast:2 row_mask:0xf bank_mask:0x3
v_add_u32_dpp v213, v247, v234 row_newbcast:0 row_mask:0xf bank_mask:0x3
v_add_u32_dpp v221, v247, v235 row_newbcast:2 row_mask:0xf bank_mask:0x3
v_mfma_f32_32x32x16_bf16 v[64:79], v[156:159], a[212:215], v[64:79]
buffer_load_dwordx4 v10, s[8:11], s38 offen offset:2048 lds
s_sub_u32 m0, s53, 128
v_add_u32_dpp v214, v248, v234 row_newbcast:0 row_mask:0xf bank_mask:0x3
v_add_u32_dpp v222, v248, v235 row_newbcast:2 row_mask:0xf bank_mask:0x3
v_add_u32_dpp v215, v249, v234 row_newbcast:0 row_mask:0xf bank_mask:0x3
v_mfma_f32_32x32x16_bf16 v[96:111], v[156:159], v[36:39], v[96:111]
v_add_u32_dpp v223, v249, v235 row_newbcast:2 row_mask:0xf bank_mask:0x3
v_add_u32_dpp v212, v246, v234 row_newbcast:1 row_mask:0xf bank_mask:0xc
v_add_u32_dpp v220, v246, v235 row_newbcast:3 row_mask:0xf bank_mask:0xc
v_add_u32_dpp v213, v247, v234 row_newbcast:1 row_mask:0xf bank_mask:0xc
v_add_u32_dpp v221, v247, v235 row_newbcast:3 row_mask:0xf bank_mask:0xc
v_mfma_f32_32x32x16_bf16 v[64:79], v[136:139], a[216:219], v[64:79]
v_add_u32_dpp v214, v248, v234 row_newbcast:1 row_mask:0xf bank_mask:0xc
v_add_u32_dpp v222, v248, v235 row_newbcast:3 row_mask:0xf bank_mask:0xc
v_add_u32_dpp v215, v249, v234 row_newbcast:1 row_mask:0xf bank_mask:0xc
v_add_u32_dpp v223, v249, v235 row_newbcast:3 row_mask:0xf bank_mask:0xc
v_mov_b32_dpp v246, v246 row_ror:12 row_mask:0xf bank_mask:0xf
s_waitcnt lgkmcnt(2)
v_mfma_f32_16x16x32_bf16 v[176:179], v[224:227], v[184:187], 0
buffer_load_dwordx4 v210, s[16:19], 0 offen offset:128 lds
v_mov_b32_dpp v247, v247 row_ror:12 row_mask:0xf bank_mask:0xf
s_waitcnt lgkmcnt(1)
v_mfma_f32_16x16x32_bf16 v[176:179], v[228:231], v[188:191], v[176:179]
s_waitcnt vmcnt(8)
ds_read_b128 v[224:227], v232 offset:6144
ds_read_b128 v[228:231], v233 offset:6144
v_mfma_f32_32x32x16_bf16 v[96:111], v[136:139], v[40:43], v[96:111]
v_mov_b32_dpp v248, v248 row_ror:12 row_mask:0xf bank_mask:0xf
v_mov_b32_dpp v249, v249 row_ror:12 row_mask:0xf bank_mask:0xf
ds_read_b128 v[156:159], v5 offset:12544
v_fma_f32 v22, v80, s37, v15
v_fma_f32 v23, v81, s37, v15
v_mfma_f32_32x32x16_bf16 v[64:79], v[140:143], a[220:223], v[64:79]
buffer_load_dwordx4 v218, s[16:19], 0 offen offset:1152 lds
s_add_u32 m0, s49, 24576
v_add_f32 v18, v18, v25
v_exp_f32 v22, v22
v_mfma_f32_32x32x16_bf16 v[96:111], v[140:143], v[44:47], v[96:111]
v_fma_f32 v24, v82, s37, v15
v_exp_f32 v23, v23
v_cvt_pk_bf16_f32 v117, v26, v27
v_fma_f32 v25, v83, s37, v15
v_mfma_f32_32x32x16_bf16 v[64:79], v[144:147], a[224:227], v[64:79]
v_exp_f32 v24, v24
v_add_f32 v19, v22, v23
v_fma_f32 v26, v84, s37, v15
v_add_f32 v19, v19, v24
s_waitcnt lgkmcnt(2)
v_mfma_f32_16x16x32_bf16 v[180:183], v[224:227], v[184:187], 0
buffer_load_dwordx4 v11, s[12:15], s39 offen offset:0 lds
v_cvt_pk_bf16_f32 v128, v22, v23
s_waitcnt lgkmcnt(1)
v_mfma_f32_16x16x32_bf16 v[180:183], v[228:231], v[188:191], v[180:183]
s_waitcnt vmcnt(8)
ds_read_b128 v[224:227], v232 offset:8192
ds_read_b128 v[228:231], v233 offset:8192
v_mfma_f32_32x32x16_bf16 v[96:111], v[144:147], v[48:51], v[96:111]
v_exp_f32 v25, v25
v_fma_f32 v27, v85, s37, v15
v_exp_f32 v26, v26
v_mfma_f32_32x32x16_bf16 v[64:79], v[148:151], a[228:231], v[64:79]
buffer_load_dwordx4 v12, s[12:15], s39 offen offset:1024 lds
v_add_f32 v19, v19, v25
v_fma_f32 v22, v86, s37, v15
v_exp_f32 v27, v27
v_mfma_f32_32x32x16_bf16 v[96:111], v[148:151], v[52:55], v[96:111]
v_add_f32 v19, v19, v26
v_cvt_pk_bf16_f32 v129, v24, v25
v_fma_f32 v23, v87, s37, v15
v_exp_f32 v22, v22
s_waitcnt lgkmcnt(2)
v_mfma_f32_32x32x16_bf16 v[64:79], v[152:155], a[232:235], v[64:79]
s_barrier
v_add_f32 v19, v19, v27
v_fma_f32 v24, v88, s37, v15
v_exp_f32 v23, v23
v_add_f32 v19, v19, v22
s_waitcnt lgkmcnt(1)
v_mfma_f32_16x16x32_bf16 v[168:171], v[224:227], v[192:195], v[168:171]
buffer_load_dwordx4 v13, s[12:15], s39 offen offset:2048 lds
s_add_u32 m0, s53, 1920
s_waitcnt lgkmcnt(0)
v_mfma_f32_16x16x32_bf16 v[168:171], v[228:231], v[196:199], v[168:171]
v_cvt_pk_bf16_f32 v130, v26, v27
v_fma_f32 v25, v89, s37, v15
v_mfma_f32_32x32x16_bf16 v[96:111], v[152:155], v[56:59], v[96:111]
v_exp_f32 v24, v24
v_add_f32 v19, v19, v23
v_fma_f32 v26, v90, s37, v15
v_exp_f32 v25, v25
v_mfma_f32_32x32x16_bf16 v[64:79], v[156:159], a[236:239], v[64:79]
buffer_load_dwordx4 v211, s[16:19], 0 offen offset:128 lds
v_add_f32 v19, v19, v24
v_cvt_pk_bf16_f32 v131, v22, v23
v_fma_f32 v27, v91, s37, v15
v_exp_f32 v26, v26
v_add_f32 v19, v19, v25
v_fma_f32 v22, v92, s37, v15
v_exp_f32 v27, v27
v_add_f32 v19, v19, v26
v_cvt_pk_bf16_f32 v132, v24, v25
v_fma_f32 v23, v93, s37, v15
v_exp_f32 v22, v22
v_add_f32 v19, v19, v27
v_fma_f32 v24, v94, s37, v15
v_exp_f32 v23, v23
ds_read_b64_tr_b16 v[136:137], v6 offset:0
ds_read_b64_tr_b16 v[138:139], v6 offset:3072
ds_read_b64_tr_b16 v[140:141], v7 offset:0
ds_read_b64_tr_b16 v[142:143], v7 offset:3072
ds_read_b64_tr_b16 v[144:145], v6 offset:128
ds_read_b64_tr_b16 v[146:147], v6 offset:3200
ds_read_b64_tr_b16 v[148:149], v7 offset:128
ds_read_b64_tr_b16 v[150:151], v7 offset:3200
s_waitcnt vmcnt(9)
ds_read_b128 v[224:227], v232 offset:10240
ds_read_b128 v[228:231], v233 offset:10240
v_mfma_f32_32x32x16_bf16 v[96:111], v[156:159], v[60:63], v[96:111]
buffer_load_dwordx4 v219, s[16:19], 0 offen offset:1152 lds
s_add_u32 m0, s53, 3840
v_add_f32 v19, v19, v22
buffer_load_dwordx4 v208, s[16:19], 0 offen offset:256 lds
buffer_load_dwordx4 v216, s[16:19], 0 offen offset:1280 lds
s_add_u32 m0, s53, 5888
v_fma_f32 v25, v95, s37, v15
buffer_load_dwordx4 v209, s[16:19], 0 offen offset:256 lds
buffer_load_dwordx4 v217, s[16:19], 0 offen offset:1280 lds
v_exp_f32 v24, v24
v_add_f32 v19, v19, v23
v_exp_f32 v25, v25
v_add_f32 v19, v19, v24
s_add_u32 m0, s53, 7936
v_add_f32 v19, v19, v25
buffer_load_dwordx4 v210, s[16:19], 0 offen offset:256 lds
v_mov_b32 v16, v18
v_cvt_pk_bf16_f32 v133, v26, v27
v_cvt_pk_bf16_f32 v134, v22, v23
v_cvt_pk_bf16_f32 v135, v24, v25
s_add_u32 s38, s38, s78
s_add_u32 s39, s39, s98
buffer_load_dwordx4 v218, s[16:19], 0 offen offset:1280 lds
v_mov_b32 v17, v19
s_cmp_eq_u32 s43, -2
s_cbranch_scc0 L_nf_b0uK
s_mov_b32 s43, -1
s_cmp_eq_u32 s36, 0
s_cbranch_scc0 L_sent_b0uK
s_lshr_b32 s84, s92, 2
s_lshl_b32 s84, s84, 2
s_add_u32 s84, s84, 128
s_and_b32 s85, s92, 3
s_lshl_b32 s85, s85, 3
s_lshl_b32 s85, 1, s85
v_mov_b32 v30, s84
v_mov_b32 v31, s85
v_cmp_eq_u32 vcc, 0, v1
s_and_saveexec_b64 s[54:55], vcc
global_atomic_or v30, v31, s[80:81] sc1
s_mov_b64 exec, s[54:55]
L_sent_b0uK:
L_nf_b0uK:
s_branch L_p1_K
.p2align 6
L_p0_K:
s_waitcnt lgkmcnt(4)
v_mfma_f32_32x32x16_bf16 a[0:15], v[136:139], v[120:123], a[0:15]
ds_read_b64_tr_b16 v[152:153], v6 offset:37120
ds_read_b64_tr_b16 v[154:155], v6 offset:40192
ds_read_b64_tr_b16 v[156:157], v7 offset:37120
ds_read_b64_tr_b16 v[158:159], v7 offset:40192
s_waitcnt lgkmcnt(9)
v_mfma_f32_16x16x32_bf16 v[180:183], v[224:227], v[200:203], v[180:183]
s_waitcnt lgkmcnt(8)
v_mfma_f32_16x16x32_bf16 v[180:183], v[228:231], v[204:207], v[180:183]
s_waitcnt vmcnt(11)
ds_read_b128 v[224:227], v232 offset:0
ds_read_b128 v[228:231], v233 offset:0
v_mfma_f32_32x32x16_bf16 a[96:111], v[136:139], v[128:131], a[96:111]
ds_read_b64_tr_b16 v[136:137], v6 offset:43008
ds_read_b64_tr_b16 v[138:139], v6 offset:46080
s_add_u32 m0, s53, 10112
v_cndmask_b32_e64 v240, v176, v177, s[66:67]
buffer_load_dwordx4 v209, s[16:19], 0 offen offset:128 lds
v_mfma_f32_32x32x16_bf16 a[16:31], v[140:143], v[120:123], a[16:31]
v_cndmask_b32_e64 v240, v240, v178, s[68:69]
v_cndmask_b32_e64 v240, v240, v179, s[70:71]
v_cndmask_b32_e64 v166, v166, v240, s[74:75]
v_fma_f32 v22, v64, s37, v14
v_fma_f32 v23, v65, s37, v14
v_mfma_f32_32x32x16_bf16 a[112:127], v[140:143], v[128:131], a[112:127]
ds_read_b64_tr_b16 v[140:141], v7 offset:43008
ds_read_b64_tr_b16 v[142:143], v7 offset:46080
v_exp_f32 v22, v22
v_fma_f32 v24, v66, s37, v14
s_waitcnt lgkmcnt(10)
v_mfma_f32_32x32x16_bf16 a[32:47], v[144:147], v[120:123], a[32:47]
buffer_load_dwordx4 v217, s[16:19], 0 offen offset:1152 lds
s_add_u32 m0, s48, 0
v_exp_f32 v23, v23
v_fma_f32 v25, v67, s37, v14
v_mfma_f32_32x32x16_bf16 a[128:143], v[144:147], v[128:131], a[128:143]
ds_read_b64_tr_b16 v[144:145], v6 offset:43136
ds_read_b64_tr_b16 v[146:147], v6 offset:46208
v_exp_f32 v24, v24
v_add_f32 v18, v22, v23
v_mfma_f32_32x32x16_bf16 a[48:63], v[148:151], v[120:123], a[48:63]
v_fma_f32 v26, v68, s37, v14
v_exp_f32 v25, v25
v_add_f32 v18, v18, v24
v_cvt_pk_bf16_f32 v112, v22, v23
v_mfma_f32_32x32x16_bf16 a[144:159], v[148:151], v[128:131], a[144:159]
ds_read_b64_tr_b16 v[148:149], v7 offset:43136
ds_read_b64_tr_b16 v[150:151], v7 offset:46208
buffer_load_dwordx4 v8, s[8:11], s38 offen offset:0 lds
v_fma_f32 v27, v69, s37, v14
v_add_f32 v18, v18, v25
s_waitcnt lgkmcnt(10)
v_mfma_f32_32x32x16_bf16 a[64:79], v[152:155], v[120:123], a[64:79]
v_exp_f32 v26, v26
v_fma_f32 v22, v70, s37, v14
v_exp_f32 v27, v27
s_waitcnt lgkmcnt(9)
v_mfma_f32_16x16x32_bf16 v[168:171], v[224:227], v[184:187], 0
v_add_f32 v18, v18, v26
v_cvt_pk_bf16_f32 v113, v24, v25
s_waitcnt lgkmcnt(8)
v_mfma_f32_16x16x32_bf16 v[168:171], v[228:231], v[188:191], v[168:171]
s_waitcnt vmcnt(9)
ds_read_b128 v[224:227], v232 offset:2048
ds_read_b128 v[228:231], v233 offset:2048
v_mfma_f32_32x32x16_bf16 a[160:175], v[152:155], v[128:131], a[160:175]
ds_read_b64_tr_b16 v[152:153], v6 offset:43264
ds_read_b64_tr_b16 v[154:155], v6 offset:46336
buffer_load_dwordx4 v9, s[8:11], s38 offen offset:1024 lds
v_cndmask_b32_e64 v240, v180, v181, s[66:67]
v_fma_f32 v23, v71, s37, v14
v_mfma_f32_32x32x16_bf16 a[80:95], v[156:159], v[120:123], a[80:95]
v_exp_f32 v22, v22
v_cndmask_b32_e64 v240, v240, v182, s[68:69]
v_add_f32 v18, v18, v27
v_fma_f32 v24, v72, s37, v14
v_mfma_f32_32x32x16_bf16 a[176:191], v[156:159], v[128:131], a[176:191]
ds_read_b64_tr_b16 v[156:157], v7 offset:43264
ds_read_b64_tr_b16 v[158:159], v7 offset:46336
v_exp_f32 v23, v23
v_cndmask_b32_e64 v240, v240, v183, s[70:71]
s_waitcnt lgkmcnt(10)
v_mfma_f32_32x32x16_bf16 a[0:15], v[136:139], v[124:127], a[0:15]
buffer_load_dwordx4 v10, s[8:11], s38 offen offset:2048 lds
s_sub_u32 m0, s53, 128
v_add_f32 v18, v18, v22
v_cvt_pk_bf16_f32 v114, v26, v27
v_fma_f32 v25, v73, s37, v14
v_mfma_f32_32x32x16_bf16 a[96:111], v[136:139], v[132:135], a[96:111]
ds_read_b128 v[136:139], v2 offset:12288
v_exp_f32 v24, v24
v_cndmask_b32_e64 v167, v167, v240, s[74:75]
ds_read_b128 v[200:203], v232 offset:12288
v_mfma_f32_32x32x16_bf16 a[16:31], v[140:143], v[124:127], a[16:31]
ds_read_b128 v[204:207], v233 offset:12288
v_add_f32 v18, v18, v23
v_fma_f32 v26, v74, s37, v14
v_exp_f32 v25, v25
v_mfma_f32_32x32x16_bf16 a[112:127], v[140:143], v[132:135], a[112:127]
buffer_load_dwordx4 v210, s[16:19], 0 offen offset:128 lds
ds_read_b128 v[140:143], v3 offset:12288
v_add_f32 v18, v18, v24
v_cvt_pk_bf16_f32 v115, v22, v23
v_fma_f32 v27, v75, s37, v14
s_waitcnt lgkmcnt(10)
v_mfma_f32_32x32x16_bf16 a[32:47], v[144:147], v[124:127], a[32:47]
v_exp_f32 v26, v26
v_add_f32 v18, v18, v25
v_fma_f32 v22, v76, s37, v14
v_add_f32 v18, v18, v26
s_waitcnt lgkmcnt(9)
v_mfma_f32_16x16x32_bf16 v[172:175], v[224:227], v[184:187], 0
v_exp_f32 v27, v27
s_waitcnt lgkmcnt(8)
v_mfma_f32_16x16x32_bf16 v[172:175], v[228:231], v[188:191], v[172:175]
s_waitcnt vmcnt(10)
ds_read_b128 v[224:227], v232 offset:4096
ds_read_b128 v[228:231], v233 offset:4096
v_mfma_f32_32x32x16_bf16 a[128:143], v[144:147], v[132:135], a[128:143]
buffer_load_dwordx4 v218, s[16:19], 0 offen offset:1152 lds
v_cvt_pk_bf16_f32 v116, v24, v25
v_fma_f32 v23, v77, s37, v14
v_exp_f32 v22, v22
v_mfma_f32_32x32x16_bf16 a[48:63], v[148:151], v[124:127], a[48:63]
v_add_f32 v18, v18, v27
v_fma_f32 v24, v78, s37, v14
v_exp_f32 v23, v23
ds_read_b128 v[144:147], v4 offset:12288
v_mfma_f32_32x32x16_bf16 a[144:159], v[148:151], v[132:135], a[144:159]
v_add_f32 v18, v18, v22
v_fma_f32 v25, v79, s37, v14
v_exp_f32 v24, v24
v_add_f32 v18, v18, v23
s_waitcnt lgkmcnt(7)
v_mfma_f32_32x32x16_bf16 a[64:79], v[152:155], v[124:127], a[64:79]
v_exp_f32 v25, v25
v_add_f32 v18, v18, v24
v_cvt_pk_bf16_f32 v117, v26, v27
v_cvt_pk_bf16_f32 v118, v22, v23
v_mfma_f32_32x32x16_bf16 a[160:175], v[152:155], v[132:135], a[160:175]
v_add_f32 v18, v18, v25
v_cvt_pk_bf16_f32 v119, v24, v25
ds_read_b128 v[148:151], v5 offset:12288
s_add_u32 m0, s49, 24576
ds_read_b128 v[152:155], v2 offset:12416
v_mfma_f32_32x32x16_bf16 a[80:95], v[156:159], v[124:127], a[80:95]
v_cmp_nge_f32 vcc, s52, v18
s_cbranch_vccnz Lst_p0K_X
Lct_p0K_X:
v_add_f32 v16, v16, v18
buffer_load_dwordx4 v11, s[12:15], s39 offen offset:0 lds
v_add_u32_dpp v212, v246, v234 row_newbcast:0 row_mask:0xf bank_mask:0x3
v_mfma_f32_32x32x16_bf16 a[176:191], v[156:159], v[132:135], a[176:191]
ds_read_b128 v[156:159], v3 offset:12416
v_add_u32_dpp v220, v246, v235 row_newbcast:2 row_mask:0xf bank_mask:0x3
v_add_u32_dpp v213, v247, v234 row_newbcast:0 row_mask:0xf bank_mask:0x3
v_add_u32_dpp v221, v247, v235 row_newbcast:2 row_mask:0xf bank_mask:0x3
v_add_u32_dpp v214, v248, v234 row_newbcast:0 row_mask:0xf bank_mask:0x3
s_waitcnt lgkmcnt(6)
v_mfma_f32_32x32x16_bf16 v[64:79], v[136:139], a[192:195], 0
v_add_u32_dpp v222, v248, v235 row_newbcast:2 row_mask:0xf bank_mask:0x3
v_add_u32_dpp v215, v249, v234 row_newbcast:0 row_mask:0xf bank_mask:0x3
v_add_u32_dpp v223, v249, v235 row_newbcast:2 row_mask:0xf bank_mask:0x3
v_add_u32_dpp v212, v246, v234 row_newbcast:1 row_mask:0xf bank_mask:0xc
v_add_u32_dpp v220, v246, v235 row_newbcast:3 row_mask:0xf bank_mask:0xc
s_waitcnt lgkmcnt(5)
v_mfma_f32_16x16x32_bf16 v[176:179], v[224:227], v[184:187], 0
buffer_load_dwordx4 v12, s[12:15], s39 offen offset:1024 lds
v_add_u32_dpp v213, v247, v234 row_newbcast:1 row_mask:0xf bank_mask:0xc
s_waitcnt lgkmcnt(4)
v_mfma_f32_16x16x32_bf16 v[176:179], v[228:231], v[188:191], v[176:179]
s_waitcnt vmcnt(11)
ds_read_b128 v[224:227], v232 offset:6144
ds_read_b128 v[228:231], v233 offset:6144
v_mfma_f32_32x32x16_bf16 v[96:111], v[136:139], a[240:243], 0
v_add_u32_dpp v221, v247, v235 row_newbcast:3 row_mask:0xf bank_mask:0xc
v_add_u32_dpp v214, v248, v234 row_newbcast:1 row_mask:0xf bank_mask:0xc
v_add_u32_dpp v222, v248, v235 row_newbcast:3 row_mask:0xf bank_mask:0xc
v_add_u32_dpp v215, v249, v234 row_newbcast:1 row_mask:0xf bank_mask:0xc
v_add_u32_dpp v223, v249, v235 row_newbcast:3 row_mask:0xf bank_mask:0xc
v_mfma_f32_32x32x16_bf16 v[64:79], v[140:143], a[196:199], v[64:79]
buffer_load_dwordx4 v13, s[12:15], s39 offen offset:2048 lds
s_add_u32 m0, s53, 1920
v_mov_b32_dpp v246, v246 row_ror:12 row_mask:0xf bank_mask:0xf
v_mov_b32_dpp v247, v247 row_ror:12 row_mask:0xf bank_mask:0xf
v_mov_b32_dpp v248, v248 row_ror:12 row_mask:0xf bank_mask:0xf
v_mfma_f32_32x32x16_bf16 v[96:111], v[140:143], a[244:247], v[96:111]
v_mov_b32_dpp v249, v249 row_ror:12 row_mask:0xf bank_mask:0xf
ds_read_b128 v[136:139], v4 offset:12416
ds_read_b128 v[140:143], v5 offset:12416
v_fma_f32 v22, v80, s37, v15
v_fma_f32 v23, v81, s37, v15
s_waitcnt lgkmcnt(6)
v_mfma_f32_32x32x16_bf16 v[64:79], v[144:147], a[200:203], v[64:79]
v_exp_f32 v22, v22
v_fma_f32 v24, v82, s37, v15
v_exp_f32 v23, v23
v_mfma_f32_32x32x16_bf16 v[96:111], v[144:147], a[248:251], v[96:111]
buffer_load_dwordx4 v211, s[16:19], 0 offen offset:128 lds
ds_read_b128 v[144:147], v2 offset:12544
v_fma_f32 v25, v83, s37, v15
v_exp_f32 v24, v24
v_mfma_f32_32x32x16_bf16 v[64:79], v[148:151], a[204:207], v[64:79]
v_add_f32 v19, v22, v23
v_fma_f32 v26, v84, s37, v15
v_exp_f32 v25, v25
v_add_f32 v19, v19, v24
v_mfma_f32_32x32x16_bf16 v[96:111], v[148:151], a[252:255], v[96:111]
ds_read_b128 v[148:151], v3 offset:12544
v_cvt_pk_bf16_f32 v128, v22, v23
v_fma_f32 v27, v85, s37, v15
v_exp_f32 v26, v26
s_waitcnt lgkmcnt(6)
v_mfma_f32_32x32x16_bf16 v[64:79], v[152:155], a[208:211], v[64:79]
buffer_load_dwordx4 v219, s[16:19], 0 offen offset:1152 lds
s_add_u32 m0, s53, 3840
v_add_f32 v19, v19, v25
v_fma_f32 v22, v86, s37, v15
v_add_f32 v19, v19, v26
s_waitcnt lgkmcnt(5)
v_mfma_f32_16x16x32_bf16 v[180:183], v[224:227], v[184:187], 0
v_exp_f32 v27, v27
s_waitcnt lgkmcnt(4)
v_mfma_f32_16x16x32_bf16 v[180:183], v[228:231], v[188:191], v[180:183]
s_waitcnt vmcnt(12)
ds_read_b128 v[224:227], v232 offset:8192
ds_read_b128 v[228:231], v233 offset:8192
v_mfma_f32_32x32x16_bf16 v[96:111], v[152:155], v[32:35], v[96:111]
ds_read_b128 v[152:155], v4 offset:12544
v_cvt_pk_bf16_f32 v129, v24, v25
v_fma_f32 v23, v87, s37, v15
v_exp_f32 v22, v22
v_mfma_f32_32x32x16_bf16 v[64:79], v[156:159], a[212:215], v[64:79]
buffer_load_dwordx4 v208, s[16:19], 0 offen offset:256 lds
v_add_f32 v19, v19, v27
v_fma_f32 v24, v88, s37, v15
v_exp_f32 v23, v23
v_mfma_f32_32x32x16_bf16 v[96:111], v[156:159], v[36:39], v[96:111]
ds_read_b128 v[156:159], v5 offset:12544
v_add_f32 v19, v19, v22
v_cvt_pk_bf16_f32 v130, v26, v27
v_fma_f32 v25, v89, s37, v15
v_add_f32 v19, v19, v23
s_waitcnt lgkmcnt(6)
v_mfma_f32_32x32x16_bf16 v[64:79], v[136:139], a[216:219], v[64:79]
v_exp_f32 v24, v24
v_fma_f32 v26, v90, s37, v15
v_exp_f32 v25, v25
v_mfma_f32_32x32x16_bf16 v[96:111], v[136:139], v[40:43], v[96:111]
buffer_load_dwordx4 v216, s[16:19], 0 offen offset:1280 lds
s_add_u32 m0, s53, 5888
ds_read_b64_tr_b16 v[136:137], v6 offset:0
ds_read_b64_tr_b16 v[138:139], v6 offset:3072
v_add_f32 v19, v19, v24
v_mfma_f32_32x32x16_bf16 v[64:79], v[140:143], a[220:223], v[64:79]
v_cvt_pk_bf16_f32 v131, v22, v23
v_fma_f32 v27, v91, s37, v15
v_exp_f32 v26, v26
v_add_f32 v19, v19, v25
v_mfma_f32_32x32x16_bf16 v[96:111], v[140:143], v[44:47], v[96:111]
ds_read_b64_tr_b16 v[140:141], v7 offset:0
ds_read_b64_tr_b16 v[142:143], v7 offset:3072
v_fma_f32 v22, v92, s37, v15
v_exp_f32 v27, v27
s_waitcnt lgkmcnt(8)
v_mfma_f32_32x32x16_bf16 v[64:79], v[144:147], a[224:227], v[64:79]
buffer_load_dwordx4 v209, s[16:19], 0 offen offset:256 lds
v_add_f32 v19, v19, v26
v_cvt_pk_bf16_f32 v132, v24, v25
v_fma_f32 v23, v93, s37, v15
v_add_f32 v19, v19, v27
s_waitcnt lgkmcnt(7)
v_mfma_f32_16x16x32_bf16 v[168:171], v[224:227], v[192:195], v[168:171]
v_exp_f32 v22, v22
s_waitcnt lgkmcnt(6)
v_mfma_f32_16x16x32_bf16 v[168:171], v[228:231], v[196:199], v[168:171]
s_waitcnt vmcnt(13)
ds_read_b128 v[224:227], v232 offset:10240
ds_read_b128 v[228:231], v233 offset:10240
v_mfma_f32_32x32x16_bf16 v[96:111], v[144:147], v[48:51], v[96:111]
ds_read_b64_tr_b16 v[144:145], v6 offset:128
ds_read_b64_tr_b16 v[146:147], v6 offset:3200
v_fma_f32 v24, v94, s37, v15
v_exp_f32 v23, v23
v_mfma_f32_32x32x16_bf16 v[64:79], v[148:151], a[228:231], v[64:79]
buffer_load_dwordx4 v217, s[16:19], 0 offen offset:1280 lds
v_add_f32 v19, v19, v22
v_fma_f32 v25, v95, s37, v15
v_exp_f32 v24, v24
v_mfma_f32_32x32x16_bf16 v[96:111], v[148:151], v[52:55], v[96:111]
ds_read_b64_tr_b16 v[148:149], v7 offset:128
ds_read_b64_tr_b16 v[150:151], v7 offset:3200
v_add_f32 v19, v19, v23
v_exp_f32 v25, v25
s_waitcnt lgkmcnt(10)
v_mfma_f32_32x32x16_bf16 v[64:79], v[152:155], a[232:235], v[64:79]
s_barrier
v_add_f32 v19, v19, v24
s_add_u32 m0, s53, 7936
v_cvt_pk_bf16_f32 v133, v26, v27
v_cvt_pk_bf16_f32 v134, v22, v23
v_add_f32 v19, v19, v25
v_mfma_f32_32x32x16_bf16 v[96:111], v[152:155], v[56:59], v[96:111]
v_cvt_pk_bf16_f32 v135, v24, v25
buffer_load_dwordx4 v210, s[16:19], 0 offen offset:256 lds
s_add_u32 s38, s38, s78
s_add_u32 s39, s39, s98
v_mfma_f32_32x32x16_bf16 v[64:79], v[156:159], a[236:239], v[64:79]
v_cmp_nge_f32 vcc, s52, v19
s_cbranch_vccnz Lst_p0K_Y
Lct_p0K_Y:
v_add_f32 v17, v17, v19
v_mfma_f32_32x32x16_bf16 v[96:111], v[156:159], v[60:63], v[96:111]
buffer_load_dwordx4 v218, s[16:19], 0 offen offset:1280 lds
L_p1_K:
s_waitcnt lgkmcnt(6)
v_mfma_f32_32x32x16_bf16 a[0:15], v[136:139], v[112:115], a[0:15]
ds_read_b64_tr_b16 v[152:153], v6 offset:256
ds_read_b64_tr_b16 v[154:155], v6 offset:3328
ds_read_b64_tr_b16 v[156:157], v7 offset:256
ds_read_b64_tr_b16 v[158:159], v7 offset:3328
s_waitcnt lgkmcnt(5)
v_mfma_f32_16x16x32_bf16 v[172:175], v[224:227], v[192:195], v[172:175]
s_waitcnt lgkmcnt(4)
v_mfma_f32_16x16x32_bf16 v[172:175], v[228:231], v[196:199], v[172:175]
s_waitcnt vmcnt(11)
ds_read_b128 v[224:227], v232 offset:0
ds_read_b128 v[228:231], v233 offset:0
v_mfma_f32_32x32x16_bf16 a[96:111], v[136:139], v[128:131], a[96:111]
ds_read_b64_tr_b16 v[136:137], v6 offset:6144
ds_read_b64_tr_b16 v[138:139], v6 offset:9216
s_add_u32 m0, s53, 9984
v_fma_f32 v22, v64, s37, v14
buffer_load_dwordx4 v211, s[16:19], 0 offen offset:256 lds
v_mfma_f32_32x32x16_bf16 a[16:31], v[140:143], v[112:115], a[16:31]
v_fma_f32 v23, v65, s37, v14
v_exp_f32 v22, v22
v_fma_f32 v24, v66, s37, v14
v_fma_f32 v25, v67, s37, v14
v_mfma_f32_32x32x16_bf16 a[112:127], v[140:143], v[128:131], a[112:127]
ds_read_b64_tr_b16 v[140:141], v7 offset:6144
ds_read_b64_tr_b16 v[142:143], v7 offset:9216
v_exp_f32 v23, v23
v_fma_f32 v26, v68, s37, v14
s_waitcnt lgkmcnt(10)
v_mfma_f32_32x32x16_bf16 a[32:47], v[144:147], v[112:115], a[32:47]
buffer_load_dwordx4 v219, s[16:19], 0 offen offset:1280 lds
s_add_u32 m0, s48, 12288
v_exp_f32 v24, v24
v_add_f32 v18, v22, v23
v_mfma_f32_32x32x16_bf16 a[128:143], v[144:147], v[128:131], a[128:143]
ds_read_b64_tr_b16 v[144:145], v6 offset:6272
ds_read_b64_tr_b16 v[146:147], v6 offset:9344
v_exp_f32 v25, v25
v_add_f32 v18, v18, v24
v_mfma_f32_32x32x16_bf16 a[48:63], v[148:151], v[112:115], a[48:63]
v_cvt_pk_bf16_f32 v120, v22, v23
v_fma_f32 v27, v69, s37, v14
v_exp_f32 v26, v26
v_add_f32 v18, v18, v25
v_mfma_f32_32x32x16_bf16 a[144:159], v[148:151], v[128:131], a[144:159]
ds_read_b64_tr_b16 v[148:149], v7 offset:6272
ds_read_b64_tr_b16 v[150:151], v7 offset:9344
buffer_load_dwordx4 v8, s[8:11], s38 offen offset:0 lds
v_fma_f32 v22, v70, s37, v14
v_add_f32 v18, v18, v26
s_waitcnt lgkmcnt(10)
v_mfma_f32_32x32x16_bf16 a[64:79], v[152:155], v[112:115], a[64:79]
v_exp_f32 v27, v27
v_cvt_pk_bf16_f32 v121, v24, v25
v_fma_f32 v23, v71, s37, v14
v_add_f32 v18, v18, v27
s_waitcnt lgkmcnt(9)
v_mfma_f32_16x16x32_bf16 v[176:179], v[224:227], v[192:195], v[176:179]
v_exp_f32 v22, v22
s_waitcnt lgkmcnt(8)
v_mfma_f32_16x16x32_bf16 v[176:179], v[228:231], v[196:199], v[176:179]
s_waitcnt vmcnt(9)
ds_read_b128 v[224:227], v232 offset:2048
ds_read_b128 v[228:231], v233 offset:2048
v_mfma_f32_32x32x16_bf16 a[160:175], v[152:155], v[128:131], a[160:175]
ds_read_b64_tr_b16 v[152:153], v6 offset:6400
ds_read_b64_tr_b16 v[154:155], v6 offset:9472
buffer_load_dwordx4 v9, s[8:11], s38 offen offset:1024 lds
v_fma_f32 v24, v72, s37, v14
v_add_f32 v18, v18, v22
v_mfma_f32_32x32x16_bf16 a[80:95], v[156:159], v[112:115], a[80:95]
v_exp_f32 v23, v23
v_cvt_pk_bf16_f32 v122, v26, v27
v_fma_f32 v25, v73, s37, v14
v_add_f32 v18, v18, v23
v_mfma_f32_32x32x16_bf16 a[176:191], v[156:159], v[128:131], a[176:191]
ds_read_b64_tr_b16 v[156:157], v7 offset:6400
ds_read_b64_tr_b16 v[158:159], v7 offset:9472
v_exp_f32 v24, v24
v_fma_f32 v26, v74, s37, v14
s_waitcnt lgkmcnt(10)
v_mfma_f32_32x32x16_bf16 a[0:15], v[136:139], v[116:119], a[0:15]
buffer_load_dwordx4 v10, s[8:11], s38 offen offset:2048 lds
s_add_u32 m0, s53, 0
v_exp_f32 v25, v25
v_add_f32 v18, v18, v24
v_mfma_f32_32x32x16_bf16 a[96:111], v[136:139], v[132:135], a[96:111]
ds_read_b128 v[136:139], v2 offset:24576
v_cvt_pk_bf16_f32 v123, v22, v23
v_fma_f32 v27, v75, s37, v14
v_exp_f32 v26, v26
v_mfma_f32_32x32x16_bf16 a[16:31], v[140:143], v[116:119], a[16:31]
v_add_f32 v18, v18, v25
v_fma_f32 v22, v76, s37, v14
v_exp_f32 v27, v27
v_add_f32 v18, v18, v26
v_mfma_f32_32x32x16_bf16 a[112:127], v[140:143], v[132:135], a[112:127]
buffer_load_dwordx4 v212, s[16:19], 0 offen offset:0 lds
ds_read_b128 v[140:143], v3 offset:24576
v_cvt_pk_bf16_f32 v124, v24, v25
v_fma_f32 v23, v77, s37, v14
v_add_f32 v18, v18, v27
s_waitcnt lgkmcnt(8)
v_mfma_f32_32x32x16_bf16 a[32:47], v[144:147], v[116:119], a[32:47]
v_exp_f32 v22, v22
v_fma_f32 v24, v78, s37, v14
v_exp_f32 v23, v23
s_waitcnt lgkmcnt(7)
v_mfma_f32_16x16x32_bf16 v[180:183], v[224:227], v[192:195], v[180:183]
v_add_f32 v18, v18, v22
v_fma_f32 v25, v79, s37, v14
s_waitcnt lgkmcnt(6)
v_mfma_f32_16x16x32_bf16 v[180:183], v[228:231], v[196:199], v[180:183]
s_waitcnt vmcnt(10)
ds_read_b128 v[224:227], v232 offset:4096
ds_read_b128 v[228:231], v233 offset:4096
v_mfma_f32_32x32x16_bf16 a[128:143], v[144:147], v[132:135], a[128:143]
buffer_load_dwordx4 v220, s[16:19], 0 offen offset:1024 lds
ds_read_b128 v[144:147], v4 offset:24576
v_exp_f32 v24, v24
v_add_f32 v18, v18, v23
v_mfma_f32_32x32x16_bf16 a[48:63], v[148:151], v[116:119], a[48:63]
v_exp_f32 v25, v25
v_add_f32 v18, v18, v24
v_cvt_pk_bf16_f32 v125, v26, v27
v_cvt_pk_bf16_f32 v126, v22, v23
v_mfma_f32_32x32x16_bf16 a[144:159], v[148:151], v[132:135], a[144:159]
v_add_f32 v18, v18, v25
v_cvt_pk_bf16_f32 v127, v24, v25
ds_read_b128 v[148:151], v5 offset:24576
s_add_u32 m0, s49, 36864
s_add_u32 s38, s38, s78
s_waitcnt lgkmcnt(6)
v_mfma_f32_32x32x16_bf16 a[64:79], v[152:155], v[116:119], a[64:79]
buffer_load_dwordx4 v11, s[12:15], s39 offen offset:0 lds
v_mfma_f32_32x32x16_bf16 a[160:175], v[152:155], v[132:135], a[160:175]
ds_read_b128 v[152:155], v2 offset:24704
v_mfma_f32_32x32x16_bf16 a[80:95], v[156:159], v[116:119], a[80:95]
v_cmp_nge_f32 vcc, s52, v18
s_cbranch_vccnz Lst_p1K_X
Lct_p1K_X:
v_add_f32 v16, v16, v18
v_fma_f32 v22, v96, s37, v15
v_fma_f32 v23, v97, s37, v15
v_mfma_f32_32x32x16_bf16 a[176:191], v[156:159], v[132:135], a[176:191]
buffer_load_dwordx4 v12, s[12:15], s39 offen offset:1024 lds
ds_read_b128 v[156:159], v3 offset:24704
v_exp_f32 v22, v22
v_fma_f32 v24, v98, s37, v15
s_waitcnt lgkmcnt(6)
v_mfma_f32_32x32x16_bf16 v[64:79], v[136:139], a[192:195], 0
v_exp_f32 v23, v23
v_fma_f32 v25, v99, s37, v15
v_exp_f32 v24, v24
s_waitcnt lgkmcnt(5)
v_mfma_f32_16x16x32_bf16 v[168:171], v[224:227], v[200:203], v[168:171]
v_add_f32 v19, v22, v23
v_fma_f32 v26, v100, s37, v15
s_waitcnt lgkmcnt(4)
v_mfma_f32_16x16x32_bf16 v[168:171], v[228:231], v[204:207], v[168:171]
s_waitcnt vmcnt(11)
ds_read_b128 v[224:227], v232 offset:6144
ds_read_b128 v[228:231], v233 offset:6144
v_mfma_f32_32x32x16_bf16 v[80:95], v[136:139], a[240:243], 0
buffer_load_dwordx4 v13, s[12:15], s39 offen offset:2048 lds
s_add_u32 m0, s53, 2048
ds_read_b128 v[136:139], v4 offset:24704
v_exp_f32 v25, v25
v_mfma_f32_32x32x16_bf16 v[64:79], v[140:143], a[196:199], v[64:79]
v_add_f32 v19, v19, v24
v_cvt_pk_bf16_f32 v128, v22, v23
v_fma_f32 v27, v101, s37, v15
v_exp_f32 v26, v26
v_mfma_f32_32x32x16_bf16 v[80:95], v[140:143], a[244:247], v[80:95]
ds_read_b128 v[140:143], v5 offset:24704
v_add_f32 v19, v19, v25
v_fma_f32 v22, v102, s37, v15
v_exp_f32 v27, v27
s_waitcnt lgkmcnt(6)
v_mfma_f32_32x32x16_bf16 v[64:79], v[144:147], a[200:203], v[64:79]
buffer_load_dwordx4 v213, s[16:19], 0 offen offset:0 lds
v_add_f32 v19, v19, v26
v_cvt_pk_bf16_f32 v129, v24, v25
v_fma_f32 v23, v103, s37, v15
v_add_f32 v19, v19, v27
v_mfma_f32_32x32x16_bf16 v[80:95], v[144:147], a[248:251], v[80:95]
ds_read_b128 v[144:147], v2 offset:24832
v_exp_f32 v22, v22
v_fma_f32 v24, v104, s37, v15
v_add_f32 v19, v19, v22
v_mfma_f32_32x32x16_bf16 v[64:79], v[148:151], a[204:207], v[64:79]
v_exp_f32 v23, v23
v_cvt_pk_bf16_f32 v130, v26, v27
v_fma_f32 v25, v105, s37, v15
v_add_f32 v19, v19, v23
v_mfma_f32_32x32x16_bf16 v[80:95], v[148:151], a[252:255], v[80:95]
buffer_load_dwordx4 v221, s[16:19], 0 offen offset:1024 lds
s_add_u32 m0, s53, 4096
ds_read_b128 v[148:151], v3 offset:24832
v_exp_f32 v24, v24
s_waitcnt lgkmcnt(6)
v_mfma_f32_32x32x16_bf16 v[64:79], v[152:155], a[208:211], v[64:79]
v_fma_f32 v26, v106, s37, v15
v_exp_f32 v25, v25
v_add_f32 v19, v19, v24
v_cvt_pk_bf16_f32 v131, v22, v23
s_waitcnt lgkmcnt(5)
v_mfma_f32_16x16x32_bf16 v[172:175], v[224:227], v[200:203], v[172:175]
v_fma_f32 v27, v107, s37, v15
v_add_f32 v19, v19, v25
s_waitcnt lgkmcnt(4)
v_mfma_f32_16x16x32_bf16 v[172:175], v[228:231], v[204:207], v[172:175]
s_waitcnt vmcnt(12)
ds_read_b128 v[224:227], v232 offset:8192
ds_read_b128 v[228:231], v233 offset:8192
v_mfma_f32_32x32x16_bf16 v[80:95], v[152:155], v[32:35], v[80:95]
buffer_load_dwordx4 v214, s[16:19], 0 offen offset:0 lds
ds_read_b128 v[152:155], v4 offset:24832
v_cndmask_b32_e64 v240, v168, v169, s[66:67]
v_cndmask_b32_e64 v240, v240, v170, s[68:69]
v_cndmask_b32_e64 v240, v240, v171, s[70:71]
v_mfma_f32_32x32x16_bf16 v[64:79], v[156:159], a[212:215], v[64:79]
v_cndmask_b32_e64 v160, v160, v240, s[72:73]
v_exp_f32 v26, v26
v_fma_f32 v22, v108, s37, v15
v_add_f32 v19, v19, v26
v_mfma_f32_32x32x16_bf16 v[80:95], v[156:159], v[36:39], v[80:95]
ds_read_b128 v[156:159], v5 offset:24832
v_exp_f32 v27, v27
v_cvt_pk_bf16_f32 v132, v24, v25
v_fma_f32 v23, v109, s37, v15
s_waitcnt lgkmcnt(6)
v_mfma_f32_32x32x16_bf16 v[64:79], v[136:139], a[216:219], v[64:79]
buffer_load_dwordx4 v222, s[16:19], 0 offen offset:1024 lds
s_add_u32 m0, s53, 12288
v_exp_f32 v22, v22
v_add_f32 v19, v19, v27
v_mfma_f32_32x32x16_bf16 v[80:95], v[136:139], v[40:43], v[80:95]
ds_read_b64_tr_b16 v[136:137], v6 offset:12288
ds_read_b64_tr_b16 v[138:139], v6 offset:15360
v_fma_f32 v24, v110, s37, v15
v_exp_f32 v23, v23
v_mfma_f32_32x32x16_bf16 v[64:79], v[140:143], a[220:223], v[64:79]
v_add_f32 v19, v19, v22
v_fma_f32 v25, v111, s37, v15
v_exp_f32 v24, v24
v_add_f32 v19, v19, v23
v_mfma_f32_32x32x16_bf16 v[80:95], v[140:143], v[44:47], v[80:95]
buffer_load_dwordx4 v236, s[4:7], s79 offen offset:0 lds
ds_read_b64_tr_b16 v[140:141], v7 offset:12288
ds_read_b64_tr_b16 v[142:143], v7 offset:15360
v_exp_f32 v25, v25
s_waitcnt lgkmcnt(8)
v_mfma_f32_32x32x16_bf16 v[64:79], v[144:147], a[224:227], v[64:79]
v_add_f32 v19, v19, v24
v_cvt_pk_bf16_f32 v133, v26, v27
v_cvt_pk_bf16_f32 v134, v22, v23
v_add_f32 v19, v19, v25
v_cvt_pk_bf16_f32 v135, v24, v25
s_waitcnt lgkmcnt(7)
v_mfma_f32_16x16x32_bf16 v[176:179], v[224:227], v[200:203], v[176:179]
v_cmp_nge_f32 vcc, s52, v19
s_cbranch_vccnz Lst_p1K_Y
Lct_p1K_Y:
v_add_f32 v17, v17, v19
s_waitcnt lgkmcnt(6)
v_mfma_f32_16x16x32_bf16 v[176:179], v[228:231], v[204:207], v[176:179]
s_waitcnt vmcnt(13)
ds_read_b128 v[224:227], v232 offset:10240
ds_read_b128 v[228:231], v233 offset:10240
v_mfma_f32_32x32x16_bf16 v[80:95], v[144:147], v[48:51], v[80:95]
buffer_load_dwordx4 v237, s[4:7], s79 offen offset:1024 lds
s_add_u32 m0, s53, 6144
ds_read_b64_tr_b16 v[144:145], v6 offset:12416
ds_read_b64_tr_b16 v[146:147], v6 offset:15488
v_cndmask_b32_e64 v240, v172, v173, s[66:67]
v_mfma_f32_32x32x16_bf16 v[64:79], v[148:151], a[228:231], v[64:79]
v_cndmask_b32_e64 v240, v240, v174, s[68:69]
v_cndmask_b32_e64 v240, v240, v175, s[70:71]
v_cndmask_b32_e64 v161, v161, v240, s[72:73]
v_mfma_f32_32x32x16_bf16 v[80:95], v[148:151], v[52:55], v[80:95]
ds_read_b64_tr_b16 v[148:149], v7 offset:12416
ds_read_b64_tr_b16 v[150:151], v7 offset:15488
s_waitcnt lgkmcnt(10)
v_mfma_f32_32x32x16_bf16 v[64:79], v[152:155], a[232:235], v[64:79]
s_barrier
buffer_load_dwordx4 v215, s[16:19], 0 offen offset:0 lds
v_mfma_f32_32x32x16_bf16 v[80:95], v[152:155], v[56:59], v[80:95]
s_add_u32 s39, s39, s98
s_add_u32 s62, s62, 4
s_cmp_eq_u32 s62, s40
s_cselect_b32 s39, s88, s39
s_cselect_b32 s98, -12288, s98
s_cmp_eq_u32 s62, 28
s_cselect_b32 s39, s41, s39
s_cselect_b32 s98, 12288, s98
v_mfma_f32_32x32x16_bf16 v[64:79], v[156:159], a[236:239], v[64:79]
v_mfma_f32_32x32x16_bf16 v[80:95], v[156:159], v[60:63], v[80:95]
buffer_load_dwordx4 v223, s[16:19], 0 offen offset:1024 lds
s_add_u32 m0, s53, 8064
s_nop 0
buffer_load_dwordx4 v212, s[16:19], 0 offen offset:128 lds
buffer_load_dwordx4 v220, s[16:19], 0 offen offset:1152 lds
L_p2_K:
s_waitcnt lgkmcnt(6)
v_mfma_f32_32x32x16_bf16 a[0:15], v[136:139], v[120:123], a[0:15]
ds_read_b64_tr_b16 v[152:153], v6 offset:12544
ds_read_b64_tr_b16 v[154:155], v6 offset:15616
ds_read_b64_tr_b16 v[156:157], v7 offset:12544
ds_read_b64_tr_b16 v[158:159], v7 offset:15616
s_waitcnt lgkmcnt(9)
v_mfma_f32_16x16x32_bf16 v[180:183], v[224:227], v[200:203], v[180:183]
s_waitcnt lgkmcnt(8)
v_mfma_f32_16x16x32_bf16 v[180:183], v[228:231], v[204:207], v[180:183]
s_waitcnt vmcnt(13)
ds_read_b128 v[224:227], v232 offset:0
ds_read_b128 v[228:231], v233 offset:0
v_mfma_f32_32x32x16_bf16 a[96:111], v[136:139], v[128:131], a[96:111]
ds_read_b64_tr_b16 v[136:137], v6 offset:18432
ds_read_b64_tr_b16 v[138:139], v6 offset:21504
s_add_u32 m0, s53, 10112
v_cndmask_b32_e64 v240, v176, v177, s[66:67]
buffer_load_dwordx4 v213, s[16:19], 0 offen offset:128 lds
v_mfma_f32_32x32x16_bf16 a[16:31], v[140:143], v[120:123], a[16:31]
v_cndmask_b32_e64 v240, v240, v178, s[68:69]
v_cndmask_b32_e64 v240, v240, v179, s[70:71]
v_cndmask_b32_e64 v162, v162, v240, s[72:73]
v_fma_f32 v22, v64, s37, v14
v_fma_f32 v23, v65, s37, v14
v_mfma_f32_32x32x16_bf16 a[112:127], v[140:143], v[128:131], a[112:127]
ds_read_b64_tr_b16 v[140:141], v7 offset:18432
ds_read_b64_tr_b16 v[142:143], v7 offset:21504
v_exp_f32 v22, v22
v_fma_f32 v24, v66, s37, v14
s_waitcnt lgkmcnt(10)
v_mfma_f32_32x32x16_bf16 a[32:47], v[144:147], v[120:123], a[32:47]
buffer_load_dwordx4 v221, s[16:19], 0 offen offset:1152 lds
s_add_u32 m0, s48, 24576
v_exp_f32 v23, v23
v_fma_f32 v25, v67, s37, v14
v_mfma_f32_32x32x16_bf16 a[128:143], v[144:147], v[128:131], a[128:143]
ds_read_b64_tr_b16 v[144:145], v6 offset:18560
ds_read_b64_tr_b16 v[146:147], v6 offset:21632
v_exp_f32 v24, v24
v_add_f32 v18, v22, v23
v_mfma_f32_32x32x16_bf16 a[48:63], v[148:151], v[120:123], a[48:63]
v_fma_f32 v26, v68, s37, v14
v_exp_f32 v25, v25
v_add_f32 v18, v18, v24
v_cvt_pk_bf16_f32 v112, v22, v23
v_mfma_f32_32x32x16_bf16 a[144:159], v[148:151], v[128:131], a[144:159]
ds_read_b64_tr_b16 v[148:149], v7 offset:18560
ds_read_b64_tr_b16 v[150:151], v7 offset:21632
buffer_load_dwordx4 v8, s[8:11], s38 offen offset:0 lds
v_fma_f32 v27, v69, s37, v14
v_add_f32 v18, v18, v25
s_waitcnt lgkmcnt(10)
v_mfma_f32_32x32x16_bf16 a[64:79], v[152:155], v[120:123], a[64:79]
v_exp_f32 v26, v26
v_fma_f32 v22, v70, s37, v14
v_exp_f32 v27, v27
s_waitcnt lgkmcnt(9)
v_mfma_f32_16x16x32_bf16 v[168:171], v[224:227], v[184:187], 0
v_add_f32 v18, v18, v26
v_cvt_pk_bf16_f32 v113, v24, v25
s_waitcnt lgkmcnt(8)
v_mfma_f32_16x16x32_bf16 v[168:171], v[228:231], v[188:191], v[168:171]
s_waitcnt vmcnt(11)
ds_read_b128 v[224:227], v232 offset:2048
ds_read_b128 v[228:231], v233 offset:2048
v_mfma_f32_32x32x16_bf16 a[160:175], v[152:155], v[128:131], a[160:175]
ds_read_b64_tr_b16 v[152:153], v6 offset:18688
ds_read_b64_tr_b16 v[154:155], v6 offset:21760
buffer_load_dwordx4 v9, s[8:11], s38 offen offset:1024 lds
v_cndmask_b32_e64 v240, v180, v181, s[66:67]
v_fma_f32 v23, v71, s37, v14
v_mfma_f32_32x32x16_bf16 a[80:95], v[156:159], v[120:123], a[80:95]
v_exp_f32 v22, v22
v_cndmask_b32_e64 v240, v240, v182, s[68:69]
v_add_f32 v18, v18, v27
v_fma_f32 v24, v72, s37, v14
v_mfma_f32_32x32x16_bf16 a[176:191], v[156:159], v[128:131], a[176:191]
ds_read_b64_tr_b16 v[156:157], v7 offset:18688
ds_read_b64_tr_b16 v[158:159], v7 offset:21760
v_exp_f32 v23, v23
v_cndmask_b32_e64 v240, v240, v183, s[70:71]
s_waitcnt lgkmcnt(10)
v_mfma_f32_32x32x16_bf16 a[0:15], v[136:139], v[124:127], a[0:15]
buffer_load_dwordx4 v10, s[8:11], s38 offen offset:2048 lds
s_sub_u32 m0, s53, 128
v_add_f32 v18, v18, v22
v_cvt_pk_bf16_f32 v114, v26, v27
v_fma_f32 v25, v73, s37, v14
v_mfma_f32_32x32x16_bf16 a[96:111], v[136:139], v[132:135], a[96:111]
ds_read_b128 v[136:139], v2 offset:36864
v_exp_f32 v24, v24
v_cndmask_b32_e64 v163, v163, v240, s[72:73]
v_add_f32 v18, v18, v23
v_mfma_f32_32x32x16_bf16 a[16:31], v[140:143], v[124:127], a[16:31]
v_fma_f32 v26, v74, s37, v14
v_exp_f32 v25, v25
v_add_f32 v18, v18, v24
v_cvt_pk_bf16_f32 v115, v22, v23
v_mfma_f32_32x32x16_bf16 a[112:127], v[140:143], v[132:135], a[112:127]
buffer_load_dwordx4 v214, s[16:19], 0 offen offset:128 lds
ds_read_b128 v[140:143], v3 offset:36864
v_fma_f32 v27, v75, s37, v14
v_exp_f32 v26, v26
s_waitcnt lgkmcnt(8)
v_mfma_f32_32x32x16_bf16 a[32:47], v[144:147], v[124:127], a[32:47]
v_add_f32 v18, v18, v25
v_fma_f32 v22, v76, s37, v14
v_exp_f32 v27, v27
v_add_f32 v18, v18, v26
s_waitcnt lgkmcnt(7)
v_mfma_f32_16x16x32_bf16 v[172:175], v[224:227], v[184:187], 0
v_cvt_pk_bf16_f32 v116, v24, v25
v_fma_f32 v23, v77, s37, v14
s_waitcnt lgkmcnt(6)
v_mfma_f32_16x16x32_bf16 v[172:175], v[228:231], v[188:191], v[172:175]
s_waitcnt vmcnt(12)
ds_read_b128 v[224:227], v232 offset:4096
ds_read_b128 v[228:231], v233 offset:4096
v_mfma_f32_32x32x16_bf16 a[128:143], v[144:147], v[132:135], a[128:143]
buffer_load_dwordx4 v222, s[16:19], 0 offen offset:1152 lds
s_add_u32 m0, s53, 14208
v_exp_f32 v22, v22
v_add_f32 v18, v18, v27
v_mfma_f32_32x32x16_bf16 a[48:63], v[148:151], v[124:127], a[48:63]
v_fma_f32 v24, v78, s37, v14
v_exp_f32 v23, v23
ds_read_b128 v[144:147], v4 offset:36864
v_add_f32 v18, v18, v22
v_mfma_f32_32x32x16_bf16 a[144:159], v[148:151], v[132:135], a[144:159]
v_fma_f32 v25, v79, s37, v14
v_exp_f32 v24, v24
v_add_f32 v18, v18, v23
v_add_f32 v18, v18, v24
s_waitcnt lgkmcnt(5)
v_mfma_f32_32x32x16_bf16 a[64:79], v[152:155], v[124:127], a[64:79]
buffer_load_dwordx4 v236, s[4:7], s79 offen offset:128 lds
v_exp_f32 v25, v25
v_cvt_pk_bf16_f32 v117, v26, v27
v_cvt_pk_bf16_f32 v118, v22, v23
v_mfma_f32_32x32x16_bf16 a[160:175], v[152:155], v[132:135], a[160:175]
v_add_f32 v18, v18, v25
v_cvt_pk_bf16_f32 v119, v24, v25
ds_read_b128 v[148:151], v5 offset:36864
ds_read_b128 v[152:155], v2 offset:36992
v_add_u32_dpp v208, v242, v234 row_newbcast:0 row_mask:0xf bank_mask:0x3
v_mfma_f32_32x32x16_bf16 a[80:95], v[156:159], v[124:127], a[80:95]
v_cmp_nge_f32 vcc, s52, v18
s_cbranch_vccnz Lst_p2K_X
Lct_p2K_X:
v_add_f32 v16, v16, v18
v_add_u32_dpp v216, v242, v235 row_newbcast:2 row_mask:0xf bank_mask:0x3
v_add_u32_dpp v209, v243, v234 row_newbcast:0 row_mask:0xf bank_mask:0x3
v_mfma_f32_32x32x16_bf16 a[176:191], v[156:159], v[132:135], a[176:191]
buffer_load_dwordx4 v237, s[4:7], s79 offen offset:1152 lds
s_add_u32 m0, s49, 0
ds_read_b128 v[156:159], v3 offset:36992
v_add_u32_dpp v217, v243, v235 row_newbcast:2 row_mask:0xf bank_mask:0x3
v_add_u32_dpp v210, v244, v234 row_newbcast:0 row_mask:0xf bank_mask:0x3
s_waitcnt lgkmcnt(6)
v_mfma_f32_32x32x16_bf16 v[64:79], v[136:139], a[192:195], 0
v_add_u32_dpp v218, v244, v235 row_newbcast:2 row_mask:0xf bank_mask:0x3
v_add_u32_dpp v211, v245, v234 row_newbcast:0 row_mask:0xf bank_mask:0x3
v_add_u32_dpp v219, v245, v235 row_newbcast:2 row_mask:0xf bank_mask:0x3
v_add_u32_dpp v208, v242, v234 row_newbcast:1 row_mask:0xf bank_mask:0xc
v_add_u32_dpp v216, v242, v235 row_newbcast:3 row_mask:0xf bank_mask:0xc
s_waitcnt lgkmcnt(5)
v_mfma_f32_16x16x32_bf16 v[176:179], v[224:227], v[184:187], 0
v_add_u32_dpp v209, v243, v234 row_newbcast:1 row_mask:0xf bank_mask:0xc
v_add_u32_dpp v217, v243, v235 row_newbcast:3 row_mask:0xf bank_mask:0xc
s_waitcnt lgkmcnt(4)
v_mfma_f32_16x16x32_bf16 v[176:179], v[228:231], v[188:191], v[176:179]
s_waitcnt vmcnt(11)
ds_read_b128 v[224:227], v232 offset:6144
ds_read_b128 v[228:231], v233 offset:6144
v_mfma_f32_32x32x16_bf16 v[96:111], v[136:139], a[240:243], 0
buffer_load_dwordx4 v11, s[12:15], s39 offen offset:0 lds
v_add_u32_dpp v210, v244, v234 row_newbcast:1 row_mask:0xf bank_mask:0xc
v_add_u32_dpp v218, v244, v235 row_newbcast:3 row_mask:0xf bank_mask:0xc
v_add_u32_dpp v211, v245, v234 row_newbcast:1 row_mask:0xf bank_mask:0xc
v_add_u32_dpp v219, v245, v235 row_newbcast:3 row_mask:0xf bank_mask:0xc
v_mfma_f32_32x32x16_bf16 v[64:79], v[140:143], a[196:199], v[64:79]
v_mov_b32_dpp v242, v242 row_ror:12 row_mask:0xf bank_mask:0xf
v_mov_b32_dpp v243, v243 row_ror:12 row_mask:0xf bank_mask:0xf
v_mov_b32_dpp v244, v244 row_ror:12 row_mask:0xf bank_mask:0xf
v_mov_b32_dpp v245, v245 row_ror:12 row_mask:0xf bank_mask:0xf
ds_read_b128 v[136:139], v4 offset:36992
v_mfma_f32_32x32x16_bf16 v[96:111], v[140:143], a[244:247], v[96:111]
ds_read_b128 v[140:143], v5 offset:36992
v_fma_f32 v22, v80, s37, v15
v_fma_f32 v23, v81, s37, v15
v_exp_f32 v22, v22
s_waitcnt lgkmcnt(6)
v_mfma_f32_32x32x16_bf16 v[64:79], v[144:147], a[200:203], v[64:79]
buffer_load_dwordx4 v12, s[12:15], s39 offen offset:1024 lds
v_fma_f32 v24, v82, s37, v15
v_exp_f32 v23, v23
v_fma_f32 v25, v83, s37, v15
v_mfma_f32_32x32x16_bf16 v[96:111], v[144:147], a[248:251], v[96:111]
ds_read_b128 v[144:147], v2 offset:37120
v_exp_f32 v24, v24
v_add_f32 v19, v22, v23
v_fma_f32 v26, v84, s37, v15
v_mfma_f32_32x32x16_bf16 v[64:79], v[148:151], a[204:207], v[64:79]
v_exp_f32 v25, v25
v_add_f32 v19, v19, v24
v_cvt_pk_bf16_f32 v128, v22, v23
v_fma_f32 v27, v85, s37, v15
v_mfma_f32_32x32x16_bf16 v[96:111], v[148:151], a[252:255], v[96:111]
buffer_load_dwordx4 v13, s[12:15], s39 offen offset:2048 lds
s_add_u32 m0, s53, 1920
ds_read_b128 v[148:151], v3 offset:37120
v_exp_f32 v26, v26
s_waitcnt lgkmcnt(6)
v_mfma_f32_32x32x16_bf16 v[64:79], v[152:155], a[208:211], v[64:79]
v_add_f32 v19, v19, v25
v_fma_f32 v22, v86, s37, v15
v_exp_f32 v27, v27
v_add_f32 v19, v19, v26
s_waitcnt lgkmcnt(5)
v_mfma_f32_16x16x32_bf16 v[180:183], v[224:227], v[184:187], 0
v_cvt_pk_bf16_f32 v129, v24, v25
v_fma_f32 v23, v87, s37, v15
s_waitcnt lgkmcnt(4)
v_mfma_f32_16x16x32_bf16 v[180:183], v[228:231], v[188:191], v[180:183]
s_waitcnt vmcnt(12)
ds_read_b128 v[224:227], v232 offset:8192
ds_read_b128 v[228:231], v233 offset:8192
v_mfma_f32_32x32x16_bf16 v[96:111], v[152:155], v[32:35], v[96:111]
buffer_load_dwordx4 v215, s[16:19], 0 offen offset:128 lds
ds_read_b128 v[152:155], v4 offset:37120
v_exp_f32 v22, v22
v_add_f32 v19, v19, v27
v_mfma_f32_32x32x16_bf16 v[64:79], v[156:159], a[212:215], v[64:79]
v_fma_f32 v24, v88, s37, v15
v_exp_f32 v23, v23
v_add_f32 v19, v19, v22
v_cvt_pk_bf16_f32 v130, v26, v27
v_mfma_f32_32x32x16_bf16 v[96:111], v[156:159], v[36:39], v[96:111]
ds_read_b128 v[156:159], v5 offset:37120
v_fma_f32 v25, v89, s37, v15
v_exp_f32 v24, v24
v_add_f32 v19, v19, v23
s_waitcnt lgkmcnt(6)
v_mfma_f32_32x32x16_bf16 v[64:79], v[136:139], a[216:219], v[64:79]
buffer_load_dwordx4 v223, s[16:19], 0 offen offset:1152 lds
s_add_u32 m0, s53, 3840
v_fma_f32 v26, v90, s37, v15
v_exp_f32 v25, v25
v_mfma_f32_32x32x16_bf16 v[96:111], v[136:139], v[40:43], v[96:111]
ds_read_b64_tr_b16 v[136:137], v6 offset:24576
ds_read_b64_tr_b16 v[138:139], v6 offset:27648
v_add_f32 v19, v19, v24
v_cvt_pk_bf16_f32 v131, v22, v23
v_fma_f32 v27, v91, s37, v15
v_mfma_f32_32x32x16_bf16 v[64:79], v[140:143], a[220:223], v[64:79]
v_exp_f32 v26, v26
v_add_f32 v19, v19, v25
v_fma_f32 v22, v92, s37, v15
v_add_f32 v19, v19, v26
v_mfma_f32_32x32x16_bf16 v[96:111], v[140:143], v[44:47], v[96:111]
buffer_load_dwordx4 v212, s[16:19], 0 offen offset:256 lds
ds_read_b64_tr_b16 v[140:141], v7 offset:24576
ds_read_b64_tr_b16 v[142:143], v7 offset:27648
v_exp_f32 v27, v27
s_waitcnt lgkmcnt(8)
v_mfma_f32_32x32x16_bf16 v[64:79], v[144:147], a[224:227], v[64:79]
v_cvt_pk_bf16_f32 v132, v24, v25
v_fma_f32 v23, v93, s37, v15
v_exp_f32 v22, v22
v_add_f32 v19, v19, v27
s_waitcnt lgkmcnt(7)
v_mfma_f32_16x16x32_bf16 v[168:171], v[224:227], v[192:195], v[168:171]
v_fma_f32 v24, v94, s37, v15
v_add_f32 v19, v19, v22
s_waitcnt lgkmcnt(6)
v_mfma_f32_16x16x32_bf16 v[168:171], v[228:231], v[196:199], v[168:171]
s_waitcnt vmcnt(13)
ds_read_b128 v[224:227], v232 offset:10240
ds_read_b128 v[228:231], v233 offset:10240
v_mfma_f32_32x32x16_bf16 v[96:111], v[144:147], v[48:51], v[96:111]
buffer_load_dwordx4 v220, s[16:19], 0 offen offset:1280 lds
s_add_u32 m0, s53, 5888
ds_read_b64_tr_b16 v[144:145], v6 offset:24704
ds_read_b64_tr_b16 v[146:147], v6 offset:27776
v_fma_f32 v25, v95, s37, v15
v_mfma_f32_32x32x16_bf16 v[64:79], v[148:151], a[228:231], v[64:79]
v_exp_f32 v23, v23
v_exp_f32 v24, v24
v_add_f32 v19, v19, v23
v_mfma_f32_32x32x16_bf16 v[96:111], v[148:151], v[52:55], v[96:111]
ds_read_b64_tr_b16 v[148:149], v7 offset:24704
ds_read_b64_tr_b16 v[150:151], v7 offset:27776
v_exp_f32 v25, v25
v_add_f32 v19, v19, v24
s_waitcnt lgkmcnt(10)
v_mfma_f32_32x32x16_bf16 v[64:79], v[152:155], a[232:235], v[64:79]
s_barrier
buffer_load_dwordx4 v213, s[16:19], 0 offen offset:256 lds
v_cvt_pk_bf16_f32 v133, v26, v27
v_cvt_pk_bf16_f32 v134, v22, v23
v_add_f32 v19, v19, v25
v_cvt_pk_bf16_f32 v135, v24, v25
v_mfma_f32_32x32x16_bf16 v[96:111], v[152:155], v[56:59], v[96:111]
s_add_u32 s38, s38, s78
s_add_u32 s39, s39, s98
ds_read_b128 v[184:187], v232 offset:12288
ds_read_b128 v[188:191], v233 offset:12288
v_mfma_f32_32x32x16_bf16 v[64:79], v[156:159], a[236:239], v[64:79]
v_cmp_nge_f32 vcc, s52, v19
s_cbranch_vccnz Lst_p2K_Y
Lct_p2K_Y:
v_add_f32 v17, v17, v19
v_mfma_f32_32x32x16_bf16 v[96:111], v[156:159], v[60:63], v[96:111]
buffer_load_dwordx4 v221, s[16:19], 0 offen offset:1280 lds
s_add_u32 m0, s53, 7936
s_nop 0
buffer_load_dwordx4 v214, s[16:19], 0 offen offset:256 lds
buffer_load_dwordx4 v222, s[16:19], 0 offen offset:1280 lds
s_cmp_eq_u32 s42, s43
s_cbranch_scc1 L_t3_K
s_cmp_eq_u32 s42, 4
s_cbranch_scc1 L_p3_Kl
s_waitcnt lgkmcnt(8)
v_mfma_f32_32x32x16_bf16 a[0:15], v[136:139], v[112:115], a[0:15]
ds_read_b64_tr_b16 v[152:153], v6 offset:24832
ds_read_b64_tr_b16 v[154:155], v6 offset:27904
ds_read_b64_tr_b16 v[156:157], v7 offset:24832
ds_read_b64_tr_b16 v[158:159], v7 offset:27904
s_waitcnt lgkmcnt(11)
v_mfma_f32_16x16x32_bf16 v[172:175], v[224:227], v[192:195], v[172:175]
s_waitcnt lgkmcnt(10)
v_mfma_f32_16x16x32_bf16 v[172:175], v[228:231], v[196:199], v[172:175]
s_waitcnt vmcnt(13)
ds_read_b128 v[224:227], v232 offset:0
ds_read_b128 v[228:231], v233 offset:0
v_mfma_f32_32x32x16_bf16 a[96:111], v[136:139], v[128:131], a[96:111]
ds_read_b64_tr_b16 v[136:137], v6 offset:30720
ds_read_b64_tr_b16 v[138:139], v6 offset:33792
s_add_u32 m0, s53, 9984
v_fma_f32 v22, v64, s37, v14
buffer_load_dwordx4 v215, s[16:19], 0 offen offset:256 lds
v_mfma_f32_32x32x16_bf16 a[16:31], v[140:143], v[112:115], a[16:31]
v_fma_f32 v23, v65, s37, v14
v_exp_f32 v22, v22
v_fma_f32 v24, v66, s37, v14
v_fma_f32 v25, v67, s37, v14
v_mfma_f32_32x32x16_bf16 a[112:127], v[140:143], v[128:131], a[112:127]
ds_read_b64_tr_b16 v[140:141], v7 offset:30720
ds_read_b64_tr_b16 v[142:143], v7 offset:33792
v_exp_f32 v23, v23
v_fma_f32 v26, v68, s37, v14
s_waitcnt lgkmcnt(12)
v_mfma_f32_32x32x16_bf16 a[32:47], v[144:147], v[112:115], a[32:47]
buffer_load_dwordx4 v223, s[16:19], 0 offen offset:1280 lds
s_add_u32 m0, s48, 36864
v_exp_f32 v24, v24
v_add_f32 v18, v22, v23
v_mfma_f32_32x32x16_bf16 a[128:143], v[144:147], v[128:131], a[128:143]
ds_read_b64_tr_b16 v[144:145], v6 offset:30848
ds_read_b64_tr_b16 v[146:147], v6 offset:33920
v_exp_f32 v25, v25
v_add_f32 v18, v18, v24
v_mfma_f32_32x32x16_bf16 a[48:63], v[148:151], v[112:115], a[48:63]
v_cvt_pk_bf16_f32 v120, v22, v23
v_fma_f32 v27, v69, s37, v14
v_exp_f32 v26, v26
v_add_f32 v18, v18, v25
v_mfma_f32_32x32x16_bf16 a[144:159], v[148:151], v[128:131], a[144:159]
ds_read_b64_tr_b16 v[148:149], v7 offset:30848
ds_read_b64_tr_b16 v[150:151], v7 offset:33920
buffer_load_dwordx4 v8, s[8:11], s38 offen offset:0 lds
v_fma_f32 v22, v70, s37, v14
v_add_f32 v18, v18, v26
s_waitcnt lgkmcnt(10)
v_mfma_f32_32x32x16_bf16 a[64:79], v[152:155], v[112:115], a[64:79]
v_exp_f32 v27, v27
v_cvt_pk_bf16_f32 v121, v24, v25
v_fma_f32 v23, v71, s37, v14
v_add_f32 v18, v18, v27
s_waitcnt lgkmcnt(9)
v_mfma_f32_16x16x32_bf16 v[176:179], v[224:227], v[192:195], v[176:179]
v_exp_f32 v22, v22
s_waitcnt lgkmcnt(8)
v_mfma_f32_16x16x32_bf16 v[176:179], v[228:231], v[196:199], v[176:179]
s_waitcnt vmcnt(9)
ds_read_b128 v[224:227], v232 offset:2048
ds_read_b128 v[228:231], v233 offset:2048
v_mfma_f32_32x32x16_bf16 a[160:175], v[152:155], v[128:131], a[160:175]
ds_read_b64_tr_b16 v[152:153], v6 offset:30976
ds_read_b64_tr_b16 v[154:155], v6 offset:34048
buffer_load_dwordx4 v9, s[8:11], s38 offen offset:1024 lds
v_fma_f32 v24, v72, s37, v14
v_add_f32 v18, v18, v22
v_mfma_f32_32x32x16_bf16 a[80:95], v[156:159], v[112:115], a[80:95]
v_exp_f32 v23, v23
v_cvt_pk_bf16_f32 v122, v26, v27
v_fma_f32 v25, v73, s37, v14
v_add_f32 v18, v18, v23
v_mfma_f32_32x32x16_bf16 a[176:191], v[156:159], v[128:131], a[176:191]
ds_read_b64_tr_b16 v[156:157], v7 offset:30976
ds_read_b64_tr_b16 v[158:159], v7 offset:34048
v_exp_f32 v24, v24
v_fma_f32 v26, v74, s37, v14
s_waitcnt lgkmcnt(10)
v_mfma_f32_32x32x16_bf16 a[0:15], v[136:139], v[116:119], a[0:15]
buffer_load_dwordx4 v10, s[8:11], s38 offen offset:2048 lds
s_add_u32 m0, s53, 0
v_exp_f32 v25, v25
v_add_f32 v18, v18, v24
v_mfma_f32_32x32x16_bf16 a[96:111], v[136:139], v[132:135], a[96:111]
ds_read_b128 v[136:139], v2 offset:0
v_cvt_pk_bf16_f32 v123, v22, v23
v_fma_f32 v27, v75, s37, v14
v_exp_f32 v26, v26
v_mfma_f32_32x32x16_bf16 a[16:31], v[140:143], v[116:119], a[16:31]
v_add_f32 v18, v18, v25
v_fma_f32 v22, v76, s37, v14
v_exp_f32 v27, v27
v_add_f32 v18, v18, v26
v_mfma_f32_32x32x16_bf16 a[112:127], v[140:143], v[132:135], a[112:127]
buffer_load_dwordx4 v208, s[16:19], 0 offen offset:0 lds
ds_read_b128 v[140:143], v3 offset:0
v_cvt_pk_bf16_f32 v124, v24, v25
v_fma_f32 v23, v77, s37, v14
v_add_f32 v18, v18, v27
s_waitcnt lgkmcnt(8)
v_mfma_f32_32x32x16_bf16 a[32:47], v[144:147], v[116:119], a[32:47]
v_exp_f32 v22, v22
v_fma_f32 v24, v78, s37, v14
v_exp_f32 v23, v23
s_waitcnt lgkmcnt(7)
v_mfma_f32_16x16x32_bf16 v[180:183], v[224:227], v[192:195], v[180:183]
v_add_f32 v18, v18, v22
v_fma_f32 v25, v79, s37, v14
s_waitcnt lgkmcnt(6)
v_mfma_f32_16x16x32_bf16 v[180:183], v[228:231], v[196:199], v[180:183]
s_waitcnt vmcnt(10)
ds_read_b128 v[224:227], v232 offset:4096
ds_read_b128 v[228:231], v233 offset:4096
v_mfma_f32_32x32x16_bf16 a[128:143], v[144:147], v[132:135], a[128:143]
buffer_load_dwordx4 v216, s[16:19], 0 offen offset:1024 lds
s_add_u32 m0, s53, 12032
ds_read_b128 v[144:147], v4 offset:0
v_exp_f32 v24, v24
v_mfma_f32_32x32x16_bf16 a[48:63], v[148:151], v[116:119], a[48:63]
v_add_f32 v18, v18, v23
v_exp_f32 v25, v25
v_add_f32 v18, v18, v24
v_cvt_pk_bf16_f32 v125, v26, v27
v_mfma_f32_32x32x16_bf16 a[144:159], v[148:151], v[132:135], a[144:159]
v_cvt_pk_bf16_f32 v126, v22, v23
v_add_f32 v18, v18, v25
v_cvt_pk_bf16_f32 v127, v24, v25
ds_read_b128 v[148:151], v5 offset:0
s_waitcnt lgkmcnt(6)
v_mfma_f32_32x32x16_bf16 a[64:79], v[152:155], v[116:119], a[64:79]
buffer_load_dwordx4 v236, s[4:7], s79 offen offset:256 lds
v_mfma_f32_32x32x16_bf16 a[160:175], v[152:155], v[132:135], a[160:175]
ds_read_b128 v[152:155], v2 offset:128
v_mfma_f32_32x32x16_bf16 a[80:95], v[156:159], v[116:119], a[80:95]
v_cmp_nge_f32 vcc, s52, v18
s_cbranch_vccnz Lst_p3K_X
Lct_p3K_X:
v_add_f32 v16, v16, v18
v_fma_f32 v22, v96, s37, v15
v_fma_f32 v23, v97, s37, v15
v_mfma_f32_32x32x16_bf16 a[176:191], v[156:159], v[132:135], a[176:191]
buffer_load_dwordx4 v237, s[4:7], s79 offen offset:1280 lds
s_add_u32 m0, s49, 12288
ds_read_b128 v[156:159], v3 offset:128
v_exp_f32 v22, v22
s_waitcnt lgkmcnt(6)
v_mfma_f32_32x32x16_bf16 v[64:79], v[136:139], a[192:195], 0
v_fma_f32 v24, v98, s37, v15
v_exp_f32 v23, v23
v_fma_f32 v25, v99, s37, v15
v_add_f32 v19, v22, v23
s_waitcnt lgkmcnt(5)
v_mfma_f32_16x16x32_bf16 v[168:171], v[224:227], v[200:203], v[168:171]
v_exp_f32 v24, v24
s_waitcnt lgkmcnt(4)
v_mfma_f32_16x16x32_bf16 v[168:171], v[228:231], v[204:207], v[168:171]
s_waitcnt vmcnt(11)
ds_read_b128 v[224:227], v232 offset:6144
ds_read_b128 v[228:231], v233 offset:6144
v_mfma_f32_32x32x16_bf16 v[80:95], v[136:139], a[240:243], 0
buffer_load_dwordx4 v11, s[12:15], s39 offen offset:0 lds
ds_read_b128 v[136:139], v4 offset:128
ds_read_b128 v[192:195], v232 offset:14336
ds_read_b128 v[196:199], v233 offset:14336
v_fma_f32 v26, v100, s37, v15
v_mfma_f32_32x32x16_bf16 v[64:79], v[140:143], a[196:199], v[64:79]
v_exp_f32 v25, v25
v_add_f32 v19, v19, v24
v_cvt_pk_bf16_f32 v128, v22, v23
v_fma_f32 v27, v101, s37, v15
v_mfma_f32_32x32x16_bf16 v[80:95], v[140:143], a[244:247], v[80:95]
ds_read_b128 v[140:143], v5 offset:128
v_exp_f32 v26, v26
v_add_f32 v19, v19, v25
v_fma_f32 v22, v102, s37, v15
s_waitcnt lgkmcnt(8)
v_mfma_f32_32x32x16_bf16 v[64:79], v[144:147], a[200:203], v[64:79]
buffer_load_dwordx4 v12, s[12:15], s39 offen offset:1024 lds
v_exp_f32 v27, v27
v_add_f32 v19, v19, v26
v_cvt_pk_bf16_f32 v129, v24, v25
v_mfma_f32_32x32x16_bf16 v[80:95], v[144:147], a[248:251], v[80:95]
ds_read_b128 v[144:147], v2 offset:256
v_fma_f32 v23, v103, s37, v15
v_exp_f32 v22, v22
v_add_f32 v19, v19, v27
v_mfma_f32_32x32x16_bf16 v[64:79], v[148:151], a[204:207], v[64:79]
v_fma_f32 v24, v104, s37, v15
v_exp_f32 v23, v23
v_add_f32 v19, v19, v22
v_cvt_pk_bf16_f32 v130, v26, v27
v_mfma_f32_32x32x16_bf16 v[80:95], v[148:151], a[252:255], v[80:95]
buffer_load_dwordx4 v13, s[12:15], s39 offen offset:2048 lds
s_add_u32 m0, s53, 2048
ds_read_b128 v[148:151], v3 offset:256
v_fma_f32 v25, v105, s37, v15
v_add_f32 v19, v19, v23
s_waitcnt lgkmcnt(8)
v_mfma_f32_32x32x16_bf16 v[64:79], v[152:155], a[208:211], v[64:79]
v_exp_f32 v24, v24
v_fma_f32 v26, v106, s37, v15
v_exp_f32 v25, v25
s_waitcnt lgkmcnt(7)
v_mfma_f32_16x16x32_bf16 v[172:175], v[224:227], v[200:203], v[172:175]
v_add_f32 v19, v19, v24
v_cvt_pk_bf16_f32 v131, v22, v23
s_waitcnt lgkmcnt(6)
v_mfma_f32_16x16x32_bf16 v[172:175], v[228:231], v[204:207], v[172:175]
s_waitcnt vmcnt(12)
ds_read_b128 v[224:227], v232 offset:8192
ds_read_b128 v[228:231], v233 offset:8192
v_mfma_f32_32x32x16_bf16 v[80:95], v[152:155], v[32:35], v[80:95]
buffer_load_dwordx4 v209, s[16:19], 0 offen offset:0 lds
ds_read_b128 v[152:155], v4 offset:256
v_cndmask_b32_e64 v240, v168, v169, s[66:67]
v_cndmask_b32_e64 v240, v240, v170, s[68:69]
v_cndmask_b32_e64 v240, v240, v171, s[70:71]
v_mfma_f32_32x32x16_bf16 v[64:79], v[156:159], a[212:215], v[64:79]
v_cndmask_b32_e64 v164, v164, v240, s[72:73]
v_fma_f32 v27, v107, s37, v15
v_exp_f32 v26, v26
v_add_f32 v19, v19, v25
v_mfma_f32_32x32x16_bf16 v[80:95], v[156:159], v[36:39], v[80:95]
ds_read_b128 v[156:159], v5 offset:256
v_fma_f32 v22, v108, s37, v15
v_exp_f32 v27, v27
v_add_f32 v19, v19, v26
s_waitcnt lgkmcnt(6)
v_mfma_f32_32x32x16_bf16 v[64:79], v[136:139], a[216:219], v[64:79]
buffer_load_dwordx4 v217, s[16:19], 0 offen offset:1024 lds
s_add_u32 m0, s53, 4096
v_cvt_pk_bf16_f32 v132, v24, v25
v_fma_f32 v23, v109, s37, v15
v_add_f32 v19, v19, v27
v_mfma_f32_32x32x16_bf16 v[80:95], v[136:139], v[40:43], v[80:95]
ds_read_b64_tr_b16 v[136:137], v6 offset:36864
ds_read_b64_tr_b16 v[138:139], v6 offset:39936
v_exp_f32 v22, v22
v_fma_f32 v24, v110, s37, v15
v_mfma_f32_32x32x16_bf16 v[64:79], v[140:143], a[220:223], v[64:79]
v_exp_f32 v23, v23
v_add_f32 v19, v19, v22
v_fma_f32 v25, v111, s37, v15
v_add_f32 v19, v19, v23
v_mfma_f32_32x32x16_bf16 v[80:95], v[140:143], v[44:47], v[80:95]
buffer_load_dwordx4 v210, s[16:19], 0 offen offset:0 lds
ds_read_b64_tr_b16 v[140:141], v7 offset:36864
ds_read_b64_tr_b16 v[142:143], v7 offset:39936
v_exp_f32 v24, v24
s_waitcnt lgkmcnt(8)
v_mfma_f32_32x32x16_bf16 v[64:79], v[144:147], a[224:227], v[64:79]
v_exp_f32 v25, v25
v_add_f32 v19, v19, v24
v_cvt_pk_bf16_f32 v133, v26, v27
v_cvt_pk_bf16_f32 v134, v22, v23
s_waitcnt lgkmcnt(7)
v_mfma_f32_16x16x32_bf16 v[176:179], v[224:227], v[200:203], v[176:179]
v_add_f32 v19, v19, v25
v_cvt_pk_bf16_f32 v135, v24, v25
s_waitcnt lgkmcnt(6)
v_mfma_f32_16x16x32_bf16 v[176:179], v[228:231], v[204:207], v[176:179]
s_waitcnt vmcnt(13)
ds_read_b128 v[224:227], v232 offset:10240
ds_read_b128 v[228:231], v233 offset:10240
v_mfma_f32_32x32x16_bf16 v[80:95], v[144:147], v[48:51], v[80:95]
buffer_load_dwordx4 v218, s[16:19], 0 offen offset:1024 lds
s_add_u32 m0, s53, 6144
ds_read_b64_tr_b16 v[144:145], v6 offset:36992
ds_read_b64_tr_b16 v[146:147], v6 offset:40064
v_cndmask_b32_e64 v240, v172, v173, s[66:67]
v_mfma_f32_32x32x16_bf16 v[64:79], v[148:151], a[228:231], v[64:79]
v_cndmask_b32_e64 v240, v240, v174, s[68:69]
v_cndmask_b32_e64 v240, v240, v175, s[70:71]
s_add_u32 s39, s39, s98
v_cndmask_b32_e64 v165, v165, v240, s[72:73]
v_mfma_f32_32x32x16_bf16 v[80:95], v[148:151], v[52:55], v[80:95]
ds_read_b64_tr_b16 v[148:149], v7 offset:36992
ds_read_b64_tr_b16 v[150:151], v7 offset:40064
v_cmp_nge_f32 vcc, s52, v19
s_cbranch_vccnz Lst_p3K_Y
Lct_p3K_Y:
v_add_f32 v17, v17, v19
s_waitcnt lgkmcnt(10)
v_mfma_f32_32x32x16_bf16 v[64:79], v[152:155], a[232:235], v[64:79]
s_barrier
buffer_load_dwordx4 v211, s[16:19], 0 offen offset:0 lds
v_mfma_f32_32x32x16_bf16 v[80:95], v[152:155], v[56:59], v[80:95]
s_add_u32 s38, s38, s78
s_add_u32 s99, s99, 4
s_cmp_eq_u32 s99, s40
s_cselect_b32 s38, s88, s38
s_cselect_b32 s78, -12288, s78
s_cmp_eq_u32 s99, 28
s_cselect_b32 s38, s41, s38
s_cselect_b32 s78, 12288, s78
v_mfma_f32_32x32x16_bf16 v[64:79], v[156:159], a[236:239], v[64:79]
v_mfma_f32_32x32x16_bf16 v[80:95], v[156:159], v[60:63], v[80:95]
buffer_load_dwordx4 v219, s[16:19], 0 offen offset:1024 lds
s_add_u32 m0, s53, 8064
s_nop 0
buffer_load_dwordx4 v208, s[16:19], 0 offen offset:128 lds
buffer_load_dwordx4 v216, s[16:19], 0 offen offset:1152 lds
s_add_u32 s42, s42, 1
s_sub_u32 s87, s42, 1
s_mov_b64 s[74:75], s[72:73]
v_cmp_eq_u32_e64 s[72:73], s87, v253
s_mov_b32 s3, s79
s_add_u32 s87, s87, 1
s_lshl_b32 s77, s87, 2
s_lshr_b32 s84, s87, 1
s_and_b32 s85, s87, 1
s_lshl_b32 s86, s45, 8
s_lshl_b32 s63, s36, 5
s_add_u32 s86, s86, s63
s_lshl_b32 s84, s84, 7
s_add_u32 s86, s86, s84
s_lshl_b32 s85, s85, 4
s_add_u32 s86, s86, s85
s_mul_i32 s79, s86, 384
s_branch L_p0_K
L_b0u_V:
s_nop 7
s_nop 3
v_max3_f32 v28, v64, v65, v66
v_max3_f32 v28, v28, v67, v68
v_max3_f32 v28, v28, v69, v70
v_max3_f32 v28, v28, v71, v72
v_max3_f32 v28, v28, v73, v74
v_max3_f32 v28, v28, v75, v76
v_max3_f32 v28, v28, v77, v78
v_max_f32 v28, v28, v79
v_mov_b32 v29, v28
ds_read_b128 v[152:155], v2 offset:12416
ds_read_b128 v[156:159], v3 offset:12416
v_permlane32_swap_b32 v28, v29
v_max_f32 v28, v28, v29
v_mul_f32_e64 v14, -v28, s37
v_fma_f32 v22, v64, s37, v14
v_fma_f32 v23, v65, s37, v14
v_exp_f32 v22, v22
v_fma_f32 v24, v66, s37, v14
v_exp_f32 v23, v23
v_fma_f32 v25, v67, s37, v14
v_exp_f32 v24, v24
v_add_f32 v18, v22, v23
v_fma_f32 v26, v68, s37, v14
v_exp_f32 v25, v25
v_add_f32 v18, v18, v24
v_cvt_pk_bf16_f32 v112, v22, v23
v_fma_f32 v27, v69, s37, v14
v_exp_f32 v26, v26
v_add_f32 v18, v18, v25
v_fma_f32 v22, v70, s37, v14
v_exp_f32 v27, v27
v_add_f32 v18, v18, v26
v_cvt_pk_bf16_f32 v113, v24, v25
v_fma_f32 v23, v71, s37, v14
v_exp_f32 v22, v22
v_add_f32 v18, v18, v27
v_fma_f32 v24, v72, s37, v14
v_exp_f32 v23, v23
v_add_f32 v18, v18, v22
v_fma_f32 v25, v73, s37, v14
v_exp_f32 v24, v24
v_add_f32 v18, v18, v23
v_exp_f32 v25, v25
v_add_f32 v18, v18, v24
v_cvt_pk_bf16_f32 v114, v26, v27
v_cvt_pk_bf16_f32 v115, v22, v23
v_add_f32 v18, v18, v25
v_cvt_pk_bf16_f32 v116, v24, v25
v_fma_f32 v26, v74, s37, v14
v_fma_f32 v27, v75, s37, v14
v_fma_f32 v22, v76, s37, v14
v_fma_f32 v23, v77, s37, v14
v_fma_f32 v24, v78, s37, v14
v_fma_f32 v25, v79, s37, v14
s_waitcnt lgkmcnt(4)
v_mfma_f32_32x32x16_bf16 v[64:79], v[136:139], a[192:195], 0
v_max3_f32 v28, v80, v81, v82
v_max3_f32 v28, v28, v83, v84
v_max3_f32 v28, v28, v85, v86
v_max3_f32 v28, v28, v87, v88
v_max3_f32 v28, v28, v89, v90
v_mfma_f32_16x16x32_bf16 v[176:179], v[224:227], v[204:207], v[176:179]
v_max3_f32 v28, v28, v91, v92
v_max3_f32 v28, v28, v93, v94
v_mfma_f32_16x16x32_bf16 v[180:183], v[228:231], v[204:207], v[180:183]
s_waitcnt vmcnt(8)
ds_read_b64_tr_b16 v[224:225], v232 offset:12288
ds_read_b64_tr_b16 v[226:227], v232 offset:14336
ds_read_b64_tr_b16 v[228:229], v233 offset:12288
ds_read_b64_tr_b16 v[230:231], v233 offset:14336
v_mfma_f32_32x32x16_bf16 v[96:111], v[136:139], a[240:243], 0
v_cvt_pk_bf16_f32 v184, v168, v169
v_cvt_pk_bf16_f32 v185, v170, v171
v_cvt_pk_bf16_f32 v186, v172, v173
v_cvt_pk_bf16_f32 v187, v174, v175
s_add_u32 m0, s53, 8192
v_mfma_f32_32x32x16_bf16 v[64:79], v[140:143], a[196:199], v[64:79]
buffer_load_dwordx4 v214, s[20:23], 0 offen offset:0 lds
ds_read_b128 v[136:139], v4 offset:12416
v_lshlrev_b32 v254, 4, v1
v_exp_f32 v26, v26
v_mfma_f32_32x32x16_bf16 v[96:111], v[140:143], a[244:247], v[96:111]
ds_read_b128 v[140:143], v5 offset:12416
v_exp_f32 v27, v27
v_max_f32 v28, v28, v95
v_add_f32 v18, v18, v26
s_waitcnt lgkmcnt(8)
v_mfma_f32_32x32x16_bf16 v[64:79], v[144:147], a[200:203], v[64:79]
v_exp_f32 v22, v22
v_mov_b32 v29, v28
v_add_f32 v18, v18, v27
v_add_f32 v18, v18, v22
s_waitcnt lgkmcnt(4)
v_mfma_f32_16x16x32_bf16 v[168:171], v[224:227], v[192:195], 0
buffer_load_dwordx4 v222, s[20:23], 0 offen offset:1024 lds
v_permlane32_swap_b32 v28, v29
s_waitcnt lgkmcnt(2)
v_mfma_f32_16x16x32_bf16 v[172:175], v[228:231], v[192:195], 0
ds_read_b64_tr_b16 v[224:225], v234 offset:12288
ds_read_b64_tr_b16 v[226:227], v234 offset:14336
ds_read_b64_tr_b16 v[228:229], v235 offset:12288
ds_read_b64_tr_b16 v[230:231], v235 offset:14336
v_mfma_f32_32x32x16_bf16 v[96:111], v[144:147], a[248:251], v[96:111]
v_cvt_pk_bf16_f32 v188, v176, v177
v_cvt_pk_bf16_f32 v189, v178, v179
v_cvt_pk_bf16_f32 v190, v180, v181
v_cvt_pk_bf16_f32 v191, v182, v183
ds_read_b128 v[144:147], v2 offset:12544
v_mfma_f32_32x32x16_bf16 v[64:79], v[148:151], a[204:207], v[64:79]
buffer_load_dwordx4 v215, s[20:23], 0 offen offset:2048 lds
v_and_b32 v204, v166, v250
v_and_b32 v205, v166, v251
v_and_b32 v206, v167, v250
v_and_b32 v207, v167, v251
v_mfma_f32_32x32x16_bf16 v[96:111], v[148:151], a[252:255], v[96:111]
ds_read_b128 v[148:151], v3 offset:12544
v_exp_f32 v23, v23
v_exp_f32 v24, v24
v_mfma_f32_32x32x16_bf16 v[64:79], v[152:155], a[208:211], v[64:79]
v_exp_f32 v25, v25
v_max_f32 v28, v28, v29
v_add_f32 v18, v18, v23
v_cvt_pk_bf16_f32 v118, v22, v23
s_waitcnt lgkmcnt(4)
v_mfma_f32_16x16x32_bf16 v[176:179], v[224:227], v[192:195], 0
buffer_load_dwordx4 v223, s[20:23], 0 offen offset:3072 lds
s_add_u32 m0, s48, 0
s_waitcnt lgkmcnt(2)
v_mfma_f32_16x16x32_bf16 v[180:183], v[228:231], v[192:195], 0
s_waitcnt vmcnt(8)
ds_read_b64_tr_b16 v[224:225], v232 offset:0
ds_read_b64_tr_b16 v[226:227], v232 offset:2048
ds_read_b64_tr_b16 v[228:229], v233 offset:0
ds_read_b64_tr_b16 v[230:231], v233 offset:2048
v_mfma_f32_32x32x16_bf16 v[96:111], v[152:155], v[32:35], v[96:111]
ds_read_b128 v[152:155], v4 offset:12544
v_mul_f32_e64 v15, -v28, s37
v_add_f32 v18, v18, v24
v_cvt_pk_bf16_f32 v119, v24, v25
v_fma_f32 v22, v80, s37, v15
v_mfma_f32_32x32x16_bf16 v[64:79], v[156:159], a[212:215], v[64:79]
buffer_store_dwordx4 v[184:187], v254, s[32:35], s74 offen offset:0
v_fma_f32 v23, v81, s37, v15
v_add_f32 v18, v18, v25
v_lshlrev_b32 v254, 4, v1
v_fma_f32 v24, v82, s37, v15
v_mfma_f32_32x32x16_bf16 v[96:111], v[156:159], v[36:39], v[96:111]
ds_read_b128 v[156:159], v5 offset:12544
v_exp_f32 v22, v22
v_exp_f32 v23, v23
v_mfma_f32_32x32x16_bf16 v[64:79], v[136:139], a[216:219], v[64:79]
v_cvt_pk_bf16_f32 v117, v26, v27
v_fma_f32 v25, v83, s37, v15
v_exp_f32 v24, v24
v_add_f32 v19, v22, v23
s_waitcnt lgkmcnt(4)
v_mfma_f32_16x16x32_bf16 v[168:171], v[224:227], v[196:199], v[168:171]
buffer_load_dwordx4 v8, s[8:11], s38 offen offset:0 lds
v_fma_f32 v26, v84, s37, v15
s_waitcnt lgkmcnt(2)
v_mfma_f32_16x16x32_bf16 v[172:175], v[228:231], v[196:199], v[172:175]
ds_read_b64_tr_b16 v[224:225], v234 offset:0
ds_read_b64_tr_b16 v[226:227], v234 offset:2048
ds_read_b64_tr_b16 v[228:229], v235 offset:0
ds_read_b64_tr_b16 v[230:231], v235 offset:2048
v_mfma_f32_32x32x16_bf16 v[96:111], v[136:139], v[40:43], v[96:111]
v_exp_f32 v25, v25
v_add_f32 v19, v19, v24
v_cvt_pk_bf16_f32 v128, v22, v23
v_fma_f32 v27, v85, s37, v15
v_mfma_f32_32x32x16_bf16 v[64:79], v[140:143], a[220:223], v[64:79]
buffer_load_dwordx4 v9, s[8:11], s38 offen offset:1024 lds
v_exp_f32 v26, v26
v_add_f32 v19, v19, v25
v_fma_f32 v22, v86, s37, v15
v_mfma_f32_32x32x16_bf16 v[96:111], v[140:143], v[44:47], v[96:111]
v_exp_f32 v27, v27
v_add_f32 v19, v19, v26
v_cvt_pk_bf16_f32 v129, v24, v25
v_fma_f32 v23, v87, s37, v15
v_mfma_f32_32x32x16_bf16 v[64:79], v[144:147], a[224:227], v[64:79]
v_exp_f32 v22, v22
v_add_f32 v19, v19, v27
v_fma_f32 v24, v88, s37, v15
v_add_f32 v19, v19, v22
s_waitcnt lgkmcnt(2)
v_mfma_f32_16x16x32_bf16 v[176:179], v[224:227], v[196:199], v[176:179]
buffer_load_dwordx4 v10, s[8:11], s38 offen offset:2048 lds
s_add_u32 m0, s49, 24576
s_waitcnt lgkmcnt(0)
v_mfma_f32_16x16x32_bf16 v[180:183], v[228:231], v[196:199], v[180:183]
s_waitcnt vmcnt(8)
ds_read_b64_tr_b16 v[224:225], v232 offset:4096
ds_read_b64_tr_b16 v[226:227], v232 offset:6144
ds_read_b64_tr_b16 v[228:229], v233 offset:4096
ds_read_b64_tr_b16 v[230:231], v233 offset:6144
v_mfma_f32_32x32x16_bf16 v[96:111], v[144:147], v[48:51], v[96:111]
v_exp_f32 v23, v23
v_cvt_pk_bf16_f32 v130, v26, v27
v_fma_f32 v25, v89, s37, v15
v_add_f32 v19, v19, v23
v_mfma_f32_32x32x16_bf16 v[64:79], v[148:151], a[228:231], v[64:79]
buffer_load_dwordx4 v11, s[12:15], s39 offen offset:0 lds
v_exp_f32 v24, v24
v_fma_f32 v26, v90, s37, v15
v_add_f32 v19, v19, v24
v_mfma_f32_32x32x16_bf16 v[96:111], v[148:151], v[52:55], v[96:111]
v_exp_f32 v25, v25
v_cvt_pk_bf16_f32 v131, v22, v23
v_fma_f32 v27, v91, s37, v15
v_add_f32 v19, v19, v25
v_mfma_f32_32x32x16_bf16 v[64:79], v[152:155], a[232:235], v[64:79]
s_barrier
v_exp_f32 v26, v26
v_fma_f32 v22, v92, s37, v15
v_exp_f32 v27, v27
s_waitcnt lgkmcnt(2)
v_mfma_f32_16x16x32_bf16 v[168:171], v[224:227], v[200:203], v[168:171]
buffer_load_dwordx4 v12, s[12:15], s39 offen offset:1024 lds
v_add_f32 v19, v19, v26
s_waitcnt lgkmcnt(0)
v_mfma_f32_16x16x32_bf16 v[172:175], v[228:231], v[200:203], v[172:175]
v_cvt_pk_bf16_f32 v132, v24, v25
v_fma_f32 v23, v93, s37, v15
v_mfma_f32_32x32x16_bf16 v[96:111], v[152:155], v[56:59], v[96:111]
v_exp_f32 v22, v22
v_add_f32 v19, v19, v27
v_fma_f32 v24, v94, s37, v15
ds_read_b64_tr_b16 v[136:137], v6 offset:0
v_mfma_f32_32x32x16_bf16 v[64:79], v[156:159], a[236:239], v[64:79]
buffer_load_dwordx4 v13, s[12:15], s39 offen offset:2048 lds
s_add_u32 m0, s53, 12160
v_exp_f32 v23, v23
ds_read_b64_tr_b16 v[138:139], v6 offset:3072
ds_read_b64_tr_b16 v[140:141], v7 offset:0
ds_read_b64_tr_b16 v[142:143], v7 offset:3072
ds_read_b64_tr_b16 v[144:145], v6 offset:128
ds_read_b64_tr_b16 v[146:147], v6 offset:3200
ds_read_b64_tr_b16 v[148:149], v7 offset:128
ds_read_b64_tr_b16 v[150:151], v7 offset:3200
ds_read_b64_tr_b16 v[224:225], v234 offset:4096
ds_read_b64_tr_b16 v[226:227], v234 offset:6144
ds_read_b64_tr_b16 v[228:229], v235 offset:4096
ds_read_b64_tr_b16 v[230:231], v235 offset:6144
v_mfma_f32_32x32x16_bf16 v[96:111], v[156:159], v[60:63], v[96:111]
buffer_store_dwordx4 v[188:191], v254, s[32:35], s74 offen offset:1024
buffer_load_dwordx4 v208, s[20:23], 0 offen offset:128 lds
buffer_load_dwordx4 v216, s[20:23], 0 offen offset:1152 lds
buffer_load_dwordx4 v209, s[20:23], 0 offen offset:2176 lds
buffer_load_dwordx4 v217, s[20:23], 0 offen offset:3200 lds
s_sub_u32 m0, s53, 128
v_add_f32 v19, v19, v22
buffer_load_dwordx4 v210, s[20:23], 0 offen offset:128 lds
buffer_load_dwordx4 v218, s[20:23], 0 offen offset:1152 lds
buffer_load_dwordx4 v211, s[20:23], 0 offen offset:2176 lds
buffer_load_dwordx4 v219, s[20:23], 0 offen offset:3200 lds
v_fma_f32 v25, v95, s37, v15
v_exp_f32 v24, v24
v_add_f32 v19, v19, v23
v_exp_f32 v25, v25
v_add_f32 v19, v19, v24
v_add_f32 v19, v19, v25
v_mov_b32 v16, v18
v_cvt_pk_bf16_f32 v133, v26, v27
v_cvt_pk_bf16_f32 v134, v22, v23
v_cvt_pk_bf16_f32 v135, v24, v25
s_add_u32 s38, s38, s78
s_add_u32 s39, s39, s98
v_mov_b32 v17, v19
s_cmp_eq_u32 s43, -2
s_cbranch_scc0 L_nf_b0uV
s_mov_b32 s43, -1
s_cmp_eq_u32 s36, 0
s_cbranch_scc0 L_sent_b0uV
s_lshr_b32 s84, s92, 2
s_lshl_b32 s84, s84, 2
s_add_u32 s84, s84, 128
s_and_b32 s85, s92, 3
s_lshl_b32 s85, s85, 3
s_lshl_b32 s85, 1, s85
v_mov_b32 v30, s84
v_mov_b32 v31, s85
v_cmp_eq_u32 vcc, 0, v1
s_and_saveexec_b64 s[54:55], vcc
global_atomic_or v30, v31, s[80:81] sc1
s_mov_b64 exec, s[54:55]
L_sent_b0uV:
L_nf_b0uV:
s_branch L_p1_V
.p2align 6
L_p0_V:
s_waitcnt lgkmcnt(8)
v_mfma_f32_32x32x16_bf16 a[0:15], v[136:139], v[120:123], a[0:15]
ds_read_b64_tr_b16 v[152:153], v6 offset:37120
ds_read_b64_tr_b16 v[154:155], v6 offset:40192
ds_read_b64_tr_b16 v[156:157], v7 offset:37120
ds_read_b64_tr_b16 v[158:159], v7 offset:40192
s_waitcnt lgkmcnt(10)
v_mfma_f32_16x16x32_bf16 v[176:179], v[224:227], v[204:207], v[176:179]
s_waitcnt lgkmcnt(8)
v_mfma_f32_16x16x32_bf16 v[180:183], v[228:231], v[204:207], v[180:183]
s_waitcnt vmcnt(14)
ds_read_b64_tr_b16 v[224:225], v232 offset:12288
ds_read_b64_tr_b16 v[226:227], v232 offset:14336
v_mfma_f32_32x32x16_bf16 a[96:111], v[136:139], v[128:131], a[96:111]
ds_read_b64_tr_b16 v[228:229], v233 offset:12288
ds_read_b64_tr_b16 v[230:231], v233 offset:14336
ds_read_b64_tr_b16 v[136:137], v6 offset:43008
ds_read_b64_tr_b16 v[138:139], v6 offset:46080
v_cvt_pk_bf16_f32 v184, v168, v169
v_mfma_f32_32x32x16_bf16 a[16:31], v[140:143], v[120:123], a[16:31]
v_cvt_pk_bf16_f32 v185, v170, v171
v_cvt_pk_bf16_f32 v186, v172, v173
v_cvt_pk_bf16_f32 v187, v174, v175
s_add_u32 m0, s53, 8192
v_lshlrev_b32 v254, 4, v1
v_mfma_f32_32x32x16_bf16 a[112:127], v[140:143], v[128:131], a[112:127]
ds_read_b64_tr_b16 v[140:141], v7 offset:43008
ds_read_b64_tr_b16 v[142:143], v7 offset:46080
buffer_load_dwordx4 v214, s[20:23], 0 offen offset:0 lds
v_fma_f32 v22, v64, s37, v14
v_fma_f32 v23, v65, s37, v14
s_waitcnt lgkmcnt(12)
v_mfma_f32_32x32x16_bf16 a[32:47], v[144:147], v[120:123], a[32:47]
v_exp_f32 v22, v22
v_fma_f32 v24, v66, s37, v14
v_exp_f32 v23, v23
v_mfma_f32_32x32x16_bf16 a[128:143], v[144:147], v[128:131], a[128:143]
ds_read_b64_tr_b16 v[144:145], v6 offset:43136
ds_read_b64_tr_b16 v[146:147], v6 offset:46208
v_fma_f32 v25, v67, s37, v14
v_exp_f32 v24, v24
v_mfma_f32_32x32x16_bf16 a[48:63], v[148:151], v[120:123], a[48:63]
buffer_load_dwordx4 v222, s[20:23], 0 offen offset:1024 lds
v_add_f32 v18, v22, v23
v_fma_f32 v26, v68, s37, v14
v_exp_f32 v25, v25
v_mfma_f32_32x32x16_bf16 a[144:159], v[148:151], v[128:131], a[144:159]
ds_read_b64_tr_b16 v[148:149], v7 offset:43136
ds_read_b64_tr_b16 v[150:151], v7 offset:46208
v_add_f32 v18, v18, v24
v_cvt_pk_bf16_f32 v112, v22, v23
v_fma_f32 v27, v69, s37, v14
s_waitcnt lgkmcnt(12)
v_mfma_f32_32x32x16_bf16 a[64:79], v[152:155], v[120:123], a[64:79]
v_exp_f32 v26, v26
v_add_f32 v18, v18, v25
v_fma_f32 v22, v70, s37, v14
v_add_f32 v18, v18, v26
s_waitcnt lgkmcnt(10)
v_mfma_f32_16x16x32_bf16 v[168:171], v[224:227], v[192:195], 0
buffer_load_dwordx4 v215, s[20:23], 0 offen offset:2048 lds
v_cvt_pk_bf16_f32 v113, v24, v25
s_waitcnt lgkmcnt(8)
v_mfma_f32_16x16x32_bf16 v[172:175], v[228:231], v[192:195], 0
ds_read_b64_tr_b16 v[224:225], v234 offset:12288
ds_read_b64_tr_b16 v[226:227], v234 offset:14336
v_mfma_f32_32x32x16_bf16 a[160:175], v[152:155], v[128:131], a[160:175]
ds_read_b64_tr_b16 v[228:229], v235 offset:12288
ds_read_b64_tr_b16 v[230:231], v235 offset:14336
ds_read_b64_tr_b16 v[152:153], v6 offset:43264
ds_read_b64_tr_b16 v[154:155], v6 offset:46336
v_cvt_pk_bf16_f32 v188, v176, v177
v_mfma_f32_32x32x16_bf16 a[80:95], v[156:159], v[120:123], a[80:95]
buffer_load_dwordx4 v223, s[20:23], 0 offen offset:3072 lds
v_cvt_pk_bf16_f32 v189, v178, v179
v_cvt_pk_bf16_f32 v190, v180, v181
v_cvt_pk_bf16_f32 v191, v182, v183
s_add_u32 m0, s48, 0
v_mfma_f32_32x32x16_bf16 a[176:191], v[156:159], v[128:131], a[176:191]
ds_read_b64_tr_b16 v[156:157], v7 offset:43264
ds_read_b64_tr_b16 v[158:159], v7 offset:46336
v_exp_f32 v27, v27
v_fma_f32 v23, v71, s37, v14
s_waitcnt lgkmcnt(12)
v_mfma_f32_32x32x16_bf16 a[0:15], v[136:139], v[124:127], a[0:15]
v_exp_f32 v22, v22
v_add_f32 v18, v18, v27
v_fma_f32 v24, v72, s37, v14
v_add_f32 v18, v18, v22
v_mfma_f32_32x32x16_bf16 a[96:111], v[136:139], v[132:135], a[96:111]
buffer_store_dwordx4 v[184:187], v254, s[32:35], s74 offen offset:0
ds_read_b128 v[136:139], v2 offset:12288
v_exp_f32 v23, v23
v_lshlrev_b32 v254, 4, v1
v_mfma_f32_32x32x16_bf16 a[16:31], v[140:143], v[124:127], a[16:31]
v_cvt_pk_bf16_f32 v114, v26, v27
v_fma_f32 v25, v73, s37, v14
v_exp_f32 v24, v24
v_and_b32 v204, v166, v250
v_mfma_f32_32x32x16_bf16 a[112:127], v[140:143], v[132:135], a[112:127]
ds_read_b128 v[140:143], v3 offset:12288
v_and_b32 v205, v166, v251
v_and_b32 v206, v167, v250
v_and_b32 v207, v167, v251
v_add_f32 v18, v18, v23
s_waitcnt lgkmcnt(10)
v_mfma_f32_32x32x16_bf16 a[32:47], v[144:147], v[124:127], a[32:47]
buffer_load_dwordx4 v8, s[8:11], s38 offen offset:0 lds
v_fma_f32 v26, v74, s37, v14
v_exp_f32 v25, v25
v_add_f32 v18, v18, v24
s_waitcnt lgkmcnt(8)
v_mfma_f32_16x16x32_bf16 v[176:179], v[224:227], v[192:195], 0
v_cvt_pk_bf16_f32 v115, v22, v23
v_fma_f32 v27, v75, s37, v14
s_waitcnt lgkmcnt(6)
v_mfma_f32_16x16x32_bf16 v[180:183], v[228:231], v[192:195], 0
s_waitcnt vmcnt(10)
ds_read_b64_tr_b16 v[224:225], v232 offset:0
ds_read_b64_tr_b16 v[226:227], v232 offset:2048
v_mfma_f32_32x32x16_bf16 a[128:143], v[144:147], v[132:135], a[128:143]
ds_read_b64_tr_b16 v[228:229], v233 offset:0
ds_read_b64_tr_b16 v[230:231], v233 offset:2048
v_exp_f32 v26, v26
v_add_f32 v18, v18, v25
v_mfma_f32_32x32x16_bf16 a[48:63], v[148:151], v[124:127], a[48:63]
buffer_load_dwordx4 v9, s[8:11], s38 offen offset:1024 lds
v_fma_f32 v22, v76, s37, v14
v_exp_f32 v27, v27
v_add_f32 v18, v18, v26
v_mfma_f32_32x32x16_bf16 a[144:159], v[148:151], v[132:135], a[144:159]
v_cvt_pk_bf16_f32 v116, v24, v25
v_fma_f32 v23, v77, s37, v14
v_exp_f32 v22, v22
v_add_f32 v18, v18, v27
s_waitcnt lgkmcnt(6)
v_mfma_f32_32x32x16_bf16 a[64:79], v[152:155], v[124:127], a[64:79]
v_fma_f32 v24, v78, s37, v14
v_exp_f32 v23, v23
ds_read_b128 v[144:147], v4 offset:12288
v_add_f32 v18, v18, v22
v_mfma_f32_32x32x16_bf16 a[160:175], v[152:155], v[132:135], a[160:175]
buffer_load_dwordx4 v10, s[8:11], s38 offen offset:2048 lds
v_fma_f32 v25, v79, s37, v14
v_exp_f32 v24, v24
v_add_f32 v18, v18, v23
v_mfma_f32_32x32x16_bf16 a[80:95], v[156:159], v[124:127], a[80:95]
v_exp_f32 v25, v25
v_add_f32 v18, v18, v24
v_cvt_pk_bf16_f32 v117, v26, v27
v_cvt_pk_bf16_f32 v118, v22, v23
v_mfma_f32_32x32x16_bf16 a[176:191], v[156:159], v[132:135], a[176:191]
v_add_f32 v18, v18, v25
v_cvt_pk_bf16_f32 v119, v24, v25
v_cmp_nge_f32 vcc, s52, v18
s_cbranch_vccnz Lst_p0V_X
Lct_p0V_X:
v_add_f32 v16, v16, v18
s_waitcnt lgkmcnt(5)
v_mfma_f32_32x32x16_bf16 v[64:79], v[136:139], a[192:195], 0
buffer_store_dwordx4 v[188:191], v254, s[32:35], s74 offen offset:1024
ds_read_b128 v[148:151], v5 offset:12288
s_add_u32 m0, s49, 24576
ds_read_b128 v[152:155], v2 offset:12416
ds_read_b128 v[156:159], v3 offset:12416
s_waitcnt lgkmcnt(6)
v_mfma_f32_16x16x32_bf16 v[168:171], v[224:227], v[196:199], v[168:171]
v_fma_f32 v22, v80, s37, v15
v_fma_f32 v23, v81, s37, v15
s_waitcnt lgkmcnt(4)
v_mfma_f32_16x16x32_bf16 v[172:175], v[228:231], v[196:199], v[172:175]
ds_read_b64_tr_b16 v[224:225], v234 offset:0
ds_read_b64_tr_b16 v[226:227], v234 offset:2048
v_mfma_f32_32x32x16_bf16 v[96:111], v[136:139], a[240:243], 0
ds_read_b64_tr_b16 v[228:229], v235 offset:0
ds_read_b64_tr_b16 v[230:231], v235 offset:2048
ds_read_b128 v[136:139], v4 offset:12416
v_exp_f32 v22, v22
v_mfma_f32_32x32x16_bf16 v[64:79], v[140:143], a[196:199], v[64:79]
buffer_load_dwordx4 v11, s[12:15], s39 offen offset:0 lds
v_fma_f32 v24, v82, s37, v15
v_exp_f32 v23, v23
v_fma_f32 v25, v83, s37, v15
v_mfma_f32_32x32x16_bf16 v[96:111], v[140:143], a[244:247], v[96:111]
ds_read_b128 v[140:143], v5 offset:12416
v_exp_f32 v24, v24
v_add_f32 v19, v22, v23
v_fma_f32 v26, v84, s37, v15
s_waitcnt lgkmcnt(8)
v_mfma_f32_32x32x16_bf16 v[64:79], v[144:147], a[200:203], v[64:79]
v_exp_f32 v25, v25
v_add_f32 v19, v19, v24
v_cvt_pk_bf16_f32 v128, v22, v23
v_fma_f32 v27, v85, s37, v15
v_mfma_f32_32x32x16_bf16 v[96:111], v[144:147], a[248:251], v[96:111]
buffer_load_dwordx4 v12, s[12:15], s39 offen offset:1024 lds
ds_read_b128 v[144:147], v2 offset:12544
v_exp_f32 v26, v26
v_add_f32 v19, v19, v25
v_mfma_f32_32x32x16_bf16 v[64:79], v[148:151], a[204:207], v[64:79]
v_fma_f32 v22, v86, s37, v15
v_exp_f32 v27, v27
v_add_f32 v19, v19, v26
v_cvt_pk_bf16_f32 v129, v24, v25
v_mfma_f32_32x32x16_bf16 v[96:111], v[148:151], a[252:255], v[96:111]
ds_read_b128 v[148:151], v3 offset:12544
v_fma_f32 v23, v87, s37, v15
v_exp_f32 v22, v22
v_add_f32 v19, v19, v27
s_waitcnt lgkmcnt(8)
v_mfma_f32_32x32x16_bf16 v[64:79], v[152:155], a[208:211], v[64:79]
buffer_load_dwordx4 v13, s[12:15], s39 offen offset:2048 lds
s_add_u32 m0, s53, 12160
v_fma_f32 v24, v88, s37, v15
v_exp_f32 v23, v23
s_waitcnt lgkmcnt(6)
v_mfma_f32_16x16x32_bf16 v[176:179], v[224:227], v[196:199], v[176:179]
v_add_f32 v19, v19, v22
v_cvt_pk_bf16_f32 v130, v26, v27
s_waitcnt lgkmcnt(4)
v_mfma_f32_16x16x32_bf16 v[180:183], v[228:231], v[196:199], v[180:183]
s_waitcnt vmcnt(12)
ds_read_b64_tr_b16 v[224:225], v232 offset:4096
ds_read_b64_tr_b16 v[226:227], v232 offset:6144
v_mfma_f32_32x32x16_bf16 v[96:111], v[152:155], v[32:35], v[96:111]
ds_read_b64_tr_b16 v[228:229], v233 offset:4096
ds_read_b64_tr_b16 v[230:231], v233 offset:6144
ds_read_b128 v[152:155], v4 offset:12544
v_fma_f32 v25, v89, s37, v15
v_add_f32 v19, v19, v23
v_mfma_f32_32x32x16_bf16 v[64:79], v[156:159], a[212:215], v[64:79]
buffer_load_dwordx4 v208, s[20:23], 0 offen offset:128 lds
v_exp_f32 v24, v24
v_fma_f32 v26, v90, s37, v15
v_add_f32 v19, v19, v24
v_mfma_f32_32x32x16_bf16 v[96:111], v[156:159], v[36:39], v[96:111]
ds_read_b128 v[156:159], v5 offset:12544
v_exp_f32 v25, v25
v_cvt_pk_bf16_f32 v131, v22, v23
v_fma_f32 v27, v91, s37, v15
s_waitcnt lgkmcnt(8)
v_mfma_f32_32x32x16_bf16 v[64:79], v[136:139], a[216:219], v[64:79]
v_exp_f32 v26, v26
v_add_f32 v19, v19, v25
v_fma_f32 v22, v92, s37, v15
v_add_f32 v19, v19, v26
v_mfma_f32_32x32x16_bf16 v[96:111], v[136:139], v[40:43], v[96:111]
buffer_load_dwordx4 v216, s[20:23], 0 offen offset:1152 lds
ds_read_b64_tr_b16 v[136:137], v6 offset:0
ds_read_b64_tr_b16 v[138:139], v6 offset:3072
v_exp_f32 v27, v27
v_mfma_f32_32x32x16_bf16 v[64:79], v[140:143], a[220:223], v[64:79]
v_cvt_pk_bf16_f32 v132, v24, v25
v_fma_f32 v23, v93, s37, v15
v_exp_f32 v22, v22
v_add_f32 v19, v19, v27
v_mfma_f32_32x32x16_bf16 v[96:111], v[140:143], v[44:47], v[96:111]
ds_read_b64_tr_b16 v[140:141], v7 offset:0
ds_read_b64_tr_b16 v[142:143], v7 offset:3072
v_fma_f32 v24, v94, s37, v15
v_exp_f32 v23, v23
s_waitcnt lgkmcnt(10)
v_mfma_f32_32x32x16_bf16 v[64:79], v[144:147], a[224:227], v[64:79]
buffer_load_dwordx4 v209, s[20:23], 0 offen offset:2176 lds
v_add_f32 v19, v19, v22
v_fma_f32 v25, v95, s37, v15
v_exp_f32 v24, v24
s_waitcnt lgkmcnt(8)
v_mfma_f32_16x16x32_bf16 v[168:171], v[224:227], v[200:203], v[168:171]
v_add_f32 v19, v19, v23
v_add_f32 v19, v19, v24
s_waitcnt lgkmcnt(6)
v_mfma_f32_16x16x32_bf16 v[172:175], v[228:231], v[200:203], v[172:175]
ds_read_b64_tr_b16 v[224:225], v234 offset:4096
ds_read_b64_tr_b16 v[226:227], v234 offset:6144
v_mfma_f32_32x32x16_bf16 v[96:111], v[144:147], v[48:51], v[96:111]
ds_read_b64_tr_b16 v[228:229], v235 offset:4096
ds_read_b64_tr_b16 v[230:231], v235 offset:6144
ds_read_b64_tr_b16 v[144:145], v6 offset:128
ds_read_b64_tr_b16 v[146:147], v6 offset:3200
v_cvt_pk_bf16_f32 v133, v26, v27
v_mfma_f32_32x32x16_bf16 v[64:79], v[148:151], a[228:231], v[64:79]
buffer_load_dwordx4 v217, s[20:23], 0 offen offset:3200 lds
s_sub_u32 m0, s53, 128
v_exp_f32 v25, v25
v_cvt_pk_bf16_f32 v134, v22, v23
v_mfma_f32_32x32x16_bf16 v[96:111], v[148:151], v[52:55], v[96:111]
ds_read_b64_tr_b16 v[148:149], v7 offset:128
ds_read_b64_tr_b16 v[150:151], v7 offset:3200
v_add_f32 v19, v19, v25
v_cvt_pk_bf16_f32 v135, v24, v25
s_add_u32 s38, s38, s78
s_waitcnt lgkmcnt(12)
v_mfma_f32_32x32x16_bf16 v[64:79], v[152:155], a[232:235], v[64:79]
s_barrier
s_add_u32 s39, s39, s98
v_cmp_nge_f32 vcc, s52, v19
s_cbranch_vccnz Lst_p0V_Y
Lct_p0V_Y:
v_add_f32 v17, v17, v19
v_mfma_f32_32x32x16_bf16 v[96:111], v[152:155], v[56:59], v[96:111]
buffer_load_dwordx4 v210, s[20:23], 0 offen offset:128 lds
v_mfma_f32_32x32x16_bf16 v[64:79], v[156:159], a[236:239], v[64:79]
v_mfma_f32_32x32x16_bf16 v[96:111], v[156:159], v[60:63], v[96:111]
buffer_load_dwordx4 v218, s[20:23], 0 offen offset:1152 lds
buffer_load_dwordx4 v211, s[20:23], 0 offen offset:2176 lds
buffer_load_dwordx4 v219, s[20:23], 0 offen offset:3200 lds
L_p1_V:
s_waitcnt lgkmcnt(8)
v_mfma_f32_32x32x16_bf16 a[0:15], v[136:139], v[112:115], a[0:15]
ds_read_b64_tr_b16 v[152:153], v6 offset:256
ds_read_b64_tr_b16 v[154:155], v6 offset:3328
ds_read_b64_tr_b16 v[156:157], v7 offset:256
ds_read_b64_tr_b16 v[158:159], v7 offset:3328
s_waitcnt lgkmcnt(6)
v_mfma_f32_16x16x32_bf16 v[176:179], v[224:227], v[200:203], v[176:179]
s_waitcnt lgkmcnt(4)
v_mfma_f32_16x16x32_bf16 v[180:183], v[228:231], v[200:203], v[180:183]
s_waitcnt vmcnt(16)
ds_read_b64_tr_b16 v[224:225], v232 offset:8192
ds_read_b64_tr_b16 v[226:227], v232 offset:10240
v_mfma_f32_32x32x16_bf16 a[96:111], v[136:139], v[128:131], a[96:111]
ds_read_b64_tr_b16 v[228:229], v233 offset:8192
ds_read_b64_tr_b16 v[230:231], v233 offset:10240
ds_read_b64_tr_b16 v[136:137], v6 offset:6144
ds_read_b64_tr_b16 v[138:139], v6 offset:9216
s_add_u32 m0, s53, 3968
v_mfma_f32_32x32x16_bf16 a[16:31], v[140:143], v[112:115], a[16:31]
buffer_load_dwordx4 v212, s[20:23], 0 offen offset:128 lds
v_fma_f32 v22, v64, s37, v14
v_fma_f32 v23, v65, s37, v14
v_exp_f32 v22, v22
v_mfma_f32_32x32x16_bf16 a[112:127], v[140:143], v[128:131], a[112:127]
ds_read_b64_tr_b16 v[140:141], v7 offset:6144
ds_read_b64_tr_b16 v[142:143], v7 offset:9216
v_fma_f32 v24, v66, s37, v14
v_exp_f32 v23, v23
s_waitcnt lgkmcnt(12)
v_mfma_f32_32x32x16_bf16 a[32:47], v[144:147], v[112:115], a[32:47]
v_fma_f32 v25, v67, s37, v14
v_exp_f32 v24, v24
v_add_f32 v18, v22, v23
v_fma_f32 v26, v68, s37, v14
v_mfma_f32_32x32x16_bf16 a[128:143], v[144:147], v[128:131], a[128:143]
buffer_load_dwordx4 v220, s[20:23], 0 offen offset:1152 lds
ds_read_b64_tr_b16 v[144:145], v6 offset:6272
ds_read_b64_tr_b16 v[146:147], v6 offset:9344
v_exp_f32 v25, v25
v_mfma_f32_32x32x16_bf16 a[48:63], v[148:151], v[112:115], a[48:63]
v_add_f32 v18, v18, v24
v_cvt_pk_bf16_f32 v120, v22, v23
v_fma_f32 v27, v69, s37, v14
v_exp_f32 v26, v26
v_mfma_f32_32x32x16_bf16 a[144:159], v[148:151], v[128:131], a[144:159]
ds_read_b64_tr_b16 v[148:149], v7 offset:6272
ds_read_b64_tr_b16 v[150:151], v7 offset:9344
v_add_f32 v18, v18, v25
v_fma_f32 v22, v70, s37, v14
v_add_f32 v18, v18, v26
s_waitcnt lgkmcnt(12)
v_mfma_f32_32x32x16_bf16 a[64:79], v[152:155], v[112:115], a[64:79]
buffer_load_dwordx4 v213, s[20:23], 0 offen offset:2176 lds
v_exp_f32 v27, v27
v_cvt_pk_bf16_f32 v121, v24, v25
v_fma_f32 v23, v71, s37, v14
s_waitcnt lgkmcnt(10)
v_mfma_f32_16x16x32_bf16 v[168:171], v[224:227], v[204:207], v[168:171]
v_exp_f32 v22, v22
s_waitcnt lgkmcnt(8)
v_mfma_f32_16x16x32_bf16 v[172:175], v[228:231], v[204:207], v[172:175]
ds_read_b64_tr_b16 v[224:225], v234 offset:8192
ds_read_b64_tr_b16 v[226:227], v234 offset:10240
v_mfma_f32_32x32x16_bf16 a[160:175], v[152:155], v[128:131], a[160:175]
ds_read_b64_tr_b16 v[228:229], v235 offset:8192
ds_read_b64_tr_b16 v[230:231], v235 offset:10240
ds_read_b64_tr_b16 v[152:153], v6 offset:6400
ds_read_b64_tr_b16 v[154:155], v6 offset:9472
v_add_f32 v18, v18, v27
v_mfma_f32_32x32x16_bf16 a[80:95], v[156:159], v[112:115], a[80:95]
buffer_load_dwordx4 v221, s[20:23], 0 offen offset:3200 lds
s_add_u32 m0, s48, 12288
v_fma_f32 v24, v72, s37, v14
v_exp_f32 v23, v23
v_mfma_f32_32x32x16_bf16 a[176:191], v[156:159], v[128:131], a[176:191]
ds_read_b64_tr_b16 v[156:157], v7 offset:6400
ds_read_b64_tr_b16 v[158:159], v7 offset:9472
v_add_f32 v18, v18, v22
v_cvt_pk_bf16_f32 v122, v26, v27
v_fma_f32 v25, v73, s37, v14
s_waitcnt lgkmcnt(12)
v_mfma_f32_32x32x16_bf16 a[0:15], v[136:139], v[116:119], a[0:15]
v_exp_f32 v24, v24
v_add_f32 v18, v18, v23
v_fma_f32 v26, v74, s37, v14
v_add_f32 v18, v18, v24
v_mfma_f32_32x32x16_bf16 a[96:111], v[136:139], v[132:135], a[96:111]
ds_read_b128 v[136:139], v2 offset:24576
buffer_load_dwordx4 v8, s[8:11], s38 offen offset:0 lds
v_exp_f32 v25, v25
v_cvt_pk_bf16_f32 v123, v22, v23
v_mfma_f32_32x32x16_bf16 a[16:31], v[140:143], v[116:119], a[16:31]
v_fma_f32 v27, v75, s37, v14
v_exp_f32 v26, v26
v_add_f32 v18, v18, v25
v_fma_f32 v22, v76, s37, v14
v_mfma_f32_32x32x16_bf16 a[112:127], v[140:143], v[132:135], a[112:127]
ds_read_b128 v[140:143], v3 offset:24576
v_exp_f32 v27, v27
v_add_f32 v18, v18, v26
v_cvt_pk_bf16_f32 v124, v24, v25
s_waitcnt lgkmcnt(10)
v_mfma_f32_32x32x16_bf16 a[32:47], v[144:147], v[116:119], a[32:47]
buffer_load_dwordx4 v9, s[8:11], s38 offen offset:1024 lds
v_fma_f32 v23, v77, s37, v14
v_exp_f32 v22, v22
v_add_f32 v18, v18, v27
s_waitcnt lgkmcnt(8)
v_mfma_f32_16x16x32_bf16 v[176:179], v[224:227], v[204:207], v[176:179]
v_fma_f32 v24, v78, s37, v14
v_add_f32 v18, v18, v22
s_waitcnt lgkmcnt(6)
v_mfma_f32_16x16x32_bf16 v[180:183], v[228:231], v[204:207], v[180:183]
s_waitcnt vmcnt(10)
ds_read_b64_tr_b16 v[224:225], v232 offset:12288
ds_read_b64_tr_b16 v[226:227], v232 offset:14336
v_mfma_f32_32x32x16_bf16 a[128:143], v[144:147], v[132:135], a[128:143]
ds_read_b64_tr_b16 v[228:229], v233 offset:12288
ds_read_b64_tr_b16 v[230:231], v233 offset:14336
v_exp_f32 v23, v23
ds_read_b128 v[144:147], v4 offset:24576
v_mfma_f32_32x32x16_bf16 a[48:63], v[148:151], v[116:119], a[48:63]
buffer_load_dwordx4 v10, s[8:11], s38 offen offset:2048 lds
v_fma_f32 v25, v79, s37, v14
v_exp_f32 v24, v24
v_add_f32 v18, v18, v23
v_mfma_f32_32x32x16_bf16 a[144:159], v[148:151], v[132:135], a[144:159]
v_exp_f32 v25, v25
v_add_f32 v18, v18, v24
v_cvt_pk_bf16_f32 v125, v26, v27
v_cvt_pk_bf16_f32 v126, v22, v23
s_waitcnt lgkmcnt(7)
v_mfma_f32_32x32x16_bf16 a[64:79], v[152:155], v[116:119], a[64:79]
v_add_f32 v18, v18, v25
v_cvt_pk_bf16_f32 v127, v24, v25
v_cvt_pk_bf16_f32 v184, v168, v169
v_cvt_pk_bf16_f32 v185, v170, v171
ds_read_b128 v[148:151], v5 offset:24576
v_mfma_f32_32x32x16_bf16 a[160:175], v[152:155], v[132:135], a[160:175]
s_add_u32 m0, s49, 36864
v_cvt_pk_bf16_f32 v186, v172, v173
buffer_load_dwordx4 v11, s[12:15], s39 offen offset:0 lds
v_cvt_pk_bf16_f32 v187, v174, v175
ds_read_b128 v[152:155], v2 offset:24704
v_mfma_f32_32x32x16_bf16 a[80:95], v[156:159], v[116:119], a[80:95]
v_cmp_nge_f32 vcc, s52, v18
s_cbranch_vccnz Lst_p1V_X
Lct_p1V_X:
v_add_f32 v16, v16, v18
v_lshlrev_b32 v254, 4, v1
v_fma_f32 v22, v96, s37, v15
v_mfma_f32_32x32x16_bf16 a[176:191], v[156:159], v[132:135], a[176:191]
ds_read_b128 v[156:159], v3 offset:24704
v_fma_f32 v23, v97, s37, v15
v_exp_f32 v22, v22
v_fma_f32 v24, v98, s37, v15
s_waitcnt lgkmcnt(8)
v_mfma_f32_32x32x16_bf16 v[64:79], v[136:139], a[192:195], 0
buffer_load_dwordx4 v12, s[12:15], s39 offen offset:1024 lds
v_exp_f32 v23, v23
v_fma_f32 v25, v99, s37, v15
v_add_f32 v19, v22, v23
s_waitcnt lgkmcnt(6)
v_mfma_f32_16x16x32_bf16 v[168:171], v[224:227], v[192:195], 0
v_exp_f32 v24, v24
s_waitcnt lgkmcnt(4)
v_mfma_f32_16x16x32_bf16 v[172:175], v[228:231], v[192:195], 0
ds_read_b64_tr_b16 v[224:225], v234 offset:12288
ds_read_b64_tr_b16 v[226:227], v234 offset:14336
v_mfma_f32_32x32x16_bf16 v[80:95], v[136:139], a[240:243], 0
ds_read_b64_tr_b16 v[228:229], v235 offset:12288
ds_read_b64_tr_b16 v[230:231], v235 offset:14336
ds_read_b128 v[136:139], v4 offset:24704
v_cvt_pk_bf16_f32 v188, v176, v177
v_cvt_pk_bf16_f32 v189, v178, v179
v_mfma_f32_32x32x16_bf16 v[64:79], v[140:143], a[196:199], v[64:79]
buffer_load_dwordx4 v13, s[12:15], s39 offen offset:2048 lds
s_add_u32 m0, s53, 8064
v_cvt_pk_bf16_f32 v190, v180, v181
v_cvt_pk_bf16_f32 v191, v182, v183
v_fma_f32 v26, v100, s37, v15
v_mfma_f32_32x32x16_bf16 v[80:95], v[140:143], a[244:247], v[80:95]
ds_read_b128 v[140:143], v5 offset:24704
v_exp_f32 v25, v25
v_add_f32 v19, v19, v24
v_cvt_pk_bf16_f32 v128, v22, v23
s_waitcnt lgkmcnt(8)
v_mfma_f32_32x32x16_bf16 v[64:79], v[144:147], a[200:203], v[64:79]
v_fma_f32 v27, v101, s37, v15
v_exp_f32 v26, v26
v_add_f32 v19, v19, v25
v_fma_f32 v22, v102, s37, v15
v_mfma_f32_32x32x16_bf16 v[80:95], v[144:147], a[248:251], v[80:95]
buffer_load_dwordx4 v214, s[20:23], 0 offen offset:128 lds
ds_read_b128 v[144:147], v2 offset:24832
v_exp_f32 v27, v27
v_add_f32 v19, v19, v26
v_mfma_f32_32x32x16_bf16 v[64:79], v[148:151], a[204:207], v[64:79]
v_cvt_pk_bf16_f32 v129, v24, v25
v_fma_f32 v23, v103, s37, v15
v_exp_f32 v22, v22
v_add_f32 v19, v19, v27
v_mfma_f32_32x32x16_bf16 v[80:95], v[148:151], a[252:255], v[80:95]
ds_read_b128 v[148:151], v3 offset:24832
v_fma_f32 v24, v104, s37, v15
v_exp_f32 v23, v23
v_add_f32 v19, v19, v22
s_waitcnt lgkmcnt(8)
v_mfma_f32_32x32x16_bf16 v[64:79], v[152:155], a[208:211], v[64:79]
buffer_load_dwordx4 v222, s[20:23], 0 offen offset:1152 lds
v_cvt_pk_bf16_f32 v130, v26, v27
v_fma_f32 v25, v105, s37, v15
v_exp_f32 v24, v24
s_waitcnt lgkmcnt(6)
v_mfma_f32_16x16x32_bf16 v[176:179], v[224:227], v[192:195], 0
v_add_f32 v19, v19, v23
v_fma_f32 v26, v106, s37, v15
s_waitcnt lgkmcnt(4)
v_mfma_f32_16x16x32_bf16 v[180:183], v[228:231], v[192:195], 0
s_waitcnt vmcnt(12)
ds_read_b64_tr_b16 v[224:225], v232 offset:0
ds_read_b64_tr_b16 v[226:227], v232 offset:2048
v_mfma_f32_32x32x16_bf16 v[80:95], v[152:155], v[32:35], v[80:95]
ds_read_b64_tr_b16 v[228:229], v233 offset:0
ds_read_b64_tr_b16 v[230:231], v233 offset:2048
ds_read_b128 v[152:155], v4 offset:24832
v_exp_f32 v25, v25
v_mfma_f32_32x32x16_bf16 v[64:79], v[156:159], a[212:215], v[64:79]
buffer_load_dwordx4 v215, s[20:23], 0 offen offset:2176 lds
v_add_f32 v19, v19, v24
v_cvt_pk_bf16_f32 v131, v22, v23
v_fma_f32 v27, v107, s37, v15
v_add_f32 v19, v19, v25
v_mfma_f32_32x32x16_bf16 v[80:95], v[156:159], v[36:39], v[80:95]
ds_read_b128 v[156:159], v5 offset:24832
v_exp_f32 v26, v26
v_fma_f32 v22, v108, s37, v15
v_add_f32 v19, v19, v26
s_waitcnt lgkmcnt(8)
v_mfma_f32_32x32x16_bf16 v[64:79], v[136:139], a[216:219], v[64:79]
v_exp_f32 v27, v27
v_cvt_pk_bf16_f32 v132, v24, v25
v_fma_f32 v23, v109, s37, v15
v_add_f32 v19, v19, v27
v_mfma_f32_32x32x16_bf16 v[80:95], v[136:139], v[40:43], v[80:95]
buffer_load_dwordx4 v223, s[20:23], 0 offen offset:3200 lds
s_add_u32 m0, s53, 12032
ds_read_b64_tr_b16 v[136:137], v6 offset:12288
ds_read_b64_tr_b16 v[138:139], v6 offset:15360
v_fma_f32 v24, v110, s37, v15
v_mfma_f32_32x32x16_bf16 v[64:79], v[140:143], a[220:223], v[64:79]
v_exp_f32 v22, v22
v_exp_f32 v23, v23
v_add_f32 v19, v19, v22
v_mfma_f32_32x32x16_bf16 v[80:95], v[140:143], v[44:47], v[80:95]
ds_read_b64_tr_b16 v[140:141], v7 offset:12288
ds_read_b64_tr_b16 v[142:143], v7 offset:15360
v_fma_f32 v25, v111, s37, v15
v_exp_f32 v24, v24
s_waitcnt lgkmcnt(10)
v_mfma_f32_32x32x16_bf16 v[64:79], v[144:147], a[224:227], v[64:79]
buffer_store_dwordx4 v[184:187], v254, s[32:35], s75 offen offset:0
v_add_f32 v19, v19, v23
v_exp_f32 v25, v25
v_lshlrev_b32 v254, 4, v1
s_waitcnt lgkmcnt(8)
v_mfma_f32_16x16x32_bf16 v[168:171], v[224:227], v[196:199], v[168:171]
v_add_f32 v19, v19, v24
v_cvt_pk_bf16_f32 v133, v26, v27
s_waitcnt lgkmcnt(6)
v_mfma_f32_16x16x32_bf16 v[172:175], v[228:231], v[196:199], v[172:175]
ds_read_b64_tr_b16 v[224:225], v234 offset:0
ds_read_b64_tr_b16 v[226:227], v234 offset:2048
v_mfma_f32_32x32x16_bf16 v[80:95], v[144:147], v[48:51], v[80:95]
ds_read_b64_tr_b16 v[228:229], v235 offset:0
ds_read_b64_tr_b16 v[230:231], v235 offset:2048
ds_read_b64_tr_b16 v[144:145], v6 offset:12416
ds_read_b64_tr_b16 v[146:147], v6 offset:15488
v_cvt_pk_bf16_f32 v134, v22, v23
v_mfma_f32_32x32x16_bf16 v[64:79], v[148:151], a[228:231], v[64:79]
buffer_store_dwordx4 v[188:191], v254, s[32:35], s75 offen offset:1024
v_add_f32 v19, v19, v25
v_cvt_pk_bf16_f32 v135, v24, v25
s_add_u32 s38, s38, s78
v_mfma_f32_32x32x16_bf16 v[80:95], v[148:151], v[52:55], v[80:95]
ds_read_b64_tr_b16 v[148:149], v7 offset:12416
ds_read_b64_tr_b16 v[150:151], v7 offset:15488
v_cmp_nge_f32 vcc, s52, v19
s_cbranch_vccnz Lst_p1V_Y
Lct_p1V_Y:
v_add_f32 v17, v17, v19
s_waitcnt lgkmcnt(12)
v_mfma_f32_32x32x16_bf16 v[64:79], v[152:155], a[232:235], v[64:79]
s_barrier
s_add_u32 s39, s39, s98
s_add_u32 s62, s62, 4
s_cmp_eq_u32 s62, s40
s_cselect_b32 s39, s88, s39
s_cselect_b32 s98, -12288, s98
s_cmp_eq_u32 s62, 28
s_cselect_b32 s39, s41, s39
s_cselect_b32 s98, 12288, s98
v_mfma_f32_32x32x16_bf16 v[80:95], v[152:155], v[56:59], v[80:95]
buffer_load_dwordx4 v208, s[20:23], 0 offen offset:256 lds
v_mfma_f32_32x32x16_bf16 v[64:79], v[156:159], a[236:239], v[64:79]
v_mfma_f32_32x32x16_bf16 v[80:95], v[156:159], v[60:63], v[80:95]
buffer_load_dwordx4 v216, s[20:23], 0 offen offset:1280 lds
buffer_load_dwordx4 v209, s[20:23], 0 offen offset:2304 lds
buffer_load_dwordx4 v217, s[20:23], 0 offen offset:3328 lds
L_p2_V:
s_waitcnt lgkmcnt(8)
v_mfma_f32_32x32x16_bf16 a[0:15], v[136:139], v[120:123], a[0:15]
ds_read_b64_tr_b16 v[152:153], v6 offset:12544
ds_read_b64_tr_b16 v[154:155], v6 offset:15616
ds_read_b64_tr_b16 v[156:157], v7 offset:12544
ds_read_b64_tr_b16 v[158:159], v7 offset:15616
s_waitcnt lgkmcnt(10)
v_mfma_f32_16x16x32_bf16 v[176:179], v[224:227], v[196:199], v[176:179]
s_waitcnt lgkmcnt(8)
v_mfma_f32_16x16x32_bf16 v[180:183], v[228:231], v[196:199], v[180:183]
s_waitcnt vmcnt(16)
ds_read_b64_tr_b16 v[224:225], v232 offset:4096
ds_read_b64_tr_b16 v[226:227], v232 offset:6144
v_mfma_f32_32x32x16_bf16 a[96:111], v[136:139], v[128:131], a[96:111]
ds_read_b64_tr_b16 v[228:229], v233 offset:4096
ds_read_b64_tr_b16 v[230:231], v233 offset:6144
ds_read_b64_tr_b16 v[136:137], v6 offset:18432
ds_read_b64_tr_b16 v[138:139], v6 offset:21504
s_sub_u32 m0, s53, 256
v_mfma_f32_32x32x16_bf16 a[16:31], v[140:143], v[120:123], a[16:31]
buffer_load_dwordx4 v210, s[20:23], 0 offen offset:256 lds
v_fma_f32 v22, v64, s37, v14
v_fma_f32 v23, v65, s37, v14
v_exp_f32 v22, v22
v_mfma_f32_32x32x16_bf16 a[112:127], v[140:143], v[128:131], a[112:127]
ds_read_b64_tr_b16 v[140:141], v7 offset:18432
ds_read_b64_tr_b16 v[142:143], v7 offset:21504
v_fma_f32 v24, v66, s37, v14
v_exp_f32 v23, v23
s_waitcnt lgkmcnt(12)
v_mfma_f32_32x32x16_bf16 a[32:47], v[144:147], v[120:123], a[32:47]
v_fma_f32 v25, v67, s37, v14
v_exp_f32 v24, v24
v_add_f32 v18, v22, v23
v_fma_f32 v26, v68, s37, v14
v_mfma_f32_32x32x16_bf16 a[128:143], v[144:147], v[128:131], a[128:143]
buffer_load_dwordx4 v218, s[20:23], 0 offen offset:1280 lds
ds_read_b64_tr_b16 v[144:145], v6 offset:18560
ds_read_b64_tr_b16 v[146:147], v6 offset:21632
v_exp_f32 v25, v25
v_mfma_f32_32x32x16_bf16 a[48:63], v[148:151], v[120:123], a[48:63]
v_add_f32 v18, v18, v24
v_cvt_pk_bf16_f32 v112, v22, v23
v_fma_f32 v27, v69, s37, v14
v_exp_f32 v26, v26
v_mfma_f32_32x32x16_bf16 a[144:159], v[148:151], v[128:131], a[144:159]
ds_read_b64_tr_b16 v[148:149], v7 offset:18560
ds_read_b64_tr_b16 v[150:151], v7 offset:21632
v_add_f32 v18, v18, v25
v_fma_f32 v22, v70, s37, v14
v_add_f32 v18, v18, v26
s_waitcnt lgkmcnt(12)
v_mfma_f32_32x32x16_bf16 a[64:79], v[152:155], v[120:123], a[64:79]
buffer_load_dwordx4 v211, s[20:23], 0 offen offset:2304 lds
v_exp_f32 v27, v27
v_cvt_pk_bf16_f32 v113, v24, v25
v_fma_f32 v23, v71, s37, v14
s_waitcnt lgkmcnt(10)
v_mfma_f32_16x16x32_bf16 v[168:171], v[224:227], v[200:203], v[168:171]
v_exp_f32 v22, v22
s_waitcnt lgkmcnt(8)
v_mfma_f32_16x16x32_bf16 v[172:175], v[228:231], v[200:203], v[172:175]
ds_read_b64_tr_b16 v[224:225], v234 offset:4096
ds_read_b64_tr_b16 v[226:227], v234 offset:6144
v_mfma_f32_32x32x16_bf16 a[160:175], v[152:155], v[128:131], a[160:175]
ds_read_b64_tr_b16 v[228:229], v235 offset:4096
ds_read_b64_tr_b16 v[230:231], v235 offset:6144
ds_read_b64_tr_b16 v[152:153], v6 offset:18688
ds_read_b64_tr_b16 v[154:155], v6 offset:21760
v_add_f32 v18, v18, v27
v_mfma_f32_32x32x16_bf16 a[80:95], v[156:159], v[120:123], a[80:95]
buffer_load_dwordx4 v219, s[20:23], 0 offen offset:3328 lds
s_add_u32 m0, s48, 24576
v_fma_f32 v24, v72, s37, v14
v_exp_f32 v23, v23
v_mfma_f32_32x32x16_bf16 a[176:191], v[156:159], v[128:131], a[176:191]
ds_read_b64_tr_b16 v[156:157], v7 offset:18688
ds_read_b64_tr_b16 v[158:159], v7 offset:21760
v_add_f32 v18, v18, v22
v_cvt_pk_bf16_f32 v114, v26, v27
v_fma_f32 v25, v73, s37, v14
s_waitcnt lgkmcnt(12)
v_mfma_f32_32x32x16_bf16 a[0:15], v[136:139], v[124:127], a[0:15]
v_exp_f32 v24, v24
v_add_f32 v18, v18, v23
v_fma_f32 v26, v74, s37, v14
v_add_f32 v18, v18, v24
v_mfma_f32_32x32x16_bf16 a[96:111], v[136:139], v[132:135], a[96:111]
ds_read_b128 v[136:139], v2 offset:36864
buffer_load_dwordx4 v8, s[8:11], s38 offen offset:0 lds
v_exp_f32 v25, v25
v_cvt_pk_bf16_f32 v115, v22, v23
v_mfma_f32_32x32x16_bf16 a[16:31], v[140:143], v[124:127], a[16:31]
v_fma_f32 v27, v75, s37, v14
v_exp_f32 v26, v26
v_add_f32 v18, v18, v25
v_fma_f32 v22, v76, s37, v14
v_mfma_f32_32x32x16_bf16 a[112:127], v[140:143], v[132:135], a[112:127]
ds_read_b128 v[140:143], v3 offset:36864
v_exp_f32 v27, v27
v_add_f32 v18, v18, v26
v_cvt_pk_bf16_f32 v116, v24, v25
s_waitcnt lgkmcnt(10)
v_mfma_f32_32x32x16_bf16 a[32:47], v[144:147], v[124:127], a[32:47]
buffer_load_dwordx4 v9, s[8:11], s38 offen offset:1024 lds
v_fma_f32 v23, v77, s37, v14
v_exp_f32 v22, v22
v_add_f32 v18, v18, v27
s_waitcnt lgkmcnt(8)
v_mfma_f32_16x16x32_bf16 v[176:179], v[224:227], v[200:203], v[176:179]
v_fma_f32 v24, v78, s37, v14
v_add_f32 v18, v18, v22
s_waitcnt lgkmcnt(6)
v_mfma_f32_16x16x32_bf16 v[180:183], v[228:231], v[200:203], v[180:183]
s_waitcnt vmcnt(12)
ds_read_b64_tr_b16 v[224:225], v232 offset:8192
ds_read_b64_tr_b16 v[226:227], v232 offset:10240
v_mfma_f32_32x32x16_bf16 a[128:143], v[144:147], v[132:135], a[128:143]
ds_read_b64_tr_b16 v[228:229], v233 offset:8192
ds_read_b64_tr_b16 v[230:231], v233 offset:10240
v_exp_f32 v23, v23
ds_read_b128 v[144:147], v4 offset:36864
v_mfma_f32_32x32x16_bf16 a[48:63], v[148:151], v[124:127], a[48:63]
buffer_load_dwordx4 v10, s[8:11], s38 offen offset:2048 lds
v_fma_f32 v25, v79, s37, v14
v_exp_f32 v24, v24
v_add_f32 v18, v18, v23
v_mfma_f32_32x32x16_bf16 a[144:159], v[148:151], v[132:135], a[144:159]
v_exp_f32 v25, v25
v_add_f32 v18, v18, v24
v_cvt_pk_bf16_f32 v117, v26, v27
v_cvt_pk_bf16_f32 v118, v22, v23
s_waitcnt lgkmcnt(7)
v_mfma_f32_32x32x16_bf16 a[64:79], v[152:155], v[124:127], a[64:79]
v_add_f32 v18, v18, v25
v_cvt_pk_bf16_f32 v119, v24, v25
ds_read_b128 v[148:151], v5 offset:36864
s_add_u32 m0, s49, 0
s_add_u32 s38, s38, s78
v_mfma_f32_32x32x16_bf16 a[160:175], v[152:155], v[132:135], a[160:175]
buffer_load_dwordx4 v11, s[12:15], s39 offen offset:0 lds
ds_read_b128 v[152:155], v2 offset:36992
v_mfma_f32_32x32x16_bf16 a[80:95], v[156:159], v[124:127], a[80:95]
v_cmp_nge_f32 vcc, s52, v18
s_cbranch_vccnz Lst_p2V_X
Lct_p2V_X:
v_add_f32 v16, v16, v18
v_fma_f32 v22, v80, s37, v15
v_fma_f32 v23, v81, s37, v15
v_mfma_f32_32x32x16_bf16 a[176:191], v[156:159], v[132:135], a[176:191]
ds_read_b128 v[156:159], v3 offset:36992
v_exp_f32 v22, v22
v_fma_f32 v24, v82, s37, v15
v_fma_f32 v25, v83, s37, v15
s_waitcnt lgkmcnt(8)
v_mfma_f32_32x32x16_bf16 v[64:79], v[136:139], a[192:195], 0
buffer_load_dwordx4 v12, s[12:15], s39 offen offset:1024 lds
v_exp_f32 v23, v23
v_exp_f32 v24, v24
s_waitcnt lgkmcnt(6)
v_mfma_f32_16x16x32_bf16 v[168:171], v[224:227], v[204:207], v[168:171]
v_add_f32 v19, v22, v23
v_fma_f32 v26, v84, s37, v15
s_waitcnt lgkmcnt(4)
v_mfma_f32_16x16x32_bf16 v[172:175], v[228:231], v[204:207], v[172:175]
ds_read_b64_tr_b16 v[224:225], v234 offset:8192
ds_read_b64_tr_b16 v[226:227], v234 offset:10240
v_mfma_f32_32x32x16_bf16 v[96:111], v[136:139], a[240:243], 0
ds_read_b64_tr_b16 v[228:229], v235 offset:8192
ds_read_b64_tr_b16 v[230:231], v235 offset:10240
ds_read_b128 v[136:139], v4 offset:36992
v_add_u32_dpp v208, v242, v236 row_newbcast:0 row_mask:0xf bank_mask:0x3
v_add_u32_dpp v216, v242, v237 row_newbcast:2 row_mask:0xf bank_mask:0x3
v_mfma_f32_32x32x16_bf16 v[64:79], v[140:143], a[196:199], v[64:79]
buffer_load_dwordx4 v13, s[12:15], s39 offen offset:2048 lds
s_add_u32 m0, s53, 3840
v_add_u32_dpp v209, v243, v238 row_newbcast:0 row_mask:0xf bank_mask:0x3
v_add_u32_dpp v217, v243, v239 row_newbcast:2 row_mask:0xf bank_mask:0x3
v_add_u32_dpp v210, v244, v236 row_newbcast:0 row_mask:0xf bank_mask:0x3
v_mfma_f32_32x32x16_bf16 v[96:111], v[140:143], a[244:247], v[96:111]
ds_read_b128 v[140:143], v5 offset:36992
v_add_u32_dpp v218, v244, v237 row_newbcast:2 row_mask:0xf bank_mask:0x3
v_add_u32_dpp v211, v245, v238 row_newbcast:0 row_mask:0xf bank_mask:0x3
v_add_u32_dpp v219, v245, v239 row_newbcast:2 row_mask:0xf bank_mask:0x3
v_add_u32_dpp v208, v242, v236 row_newbcast:1 row_mask:0xf bank_mask:0xc
s_waitcnt lgkmcnt(8)
v_mfma_f32_32x32x16_bf16 v[64:79], v[144:147], a[200:203], v[64:79]
v_add_u32_dpp v216, v242, v237 row_newbcast:3 row_mask:0xf bank_mask:0xc
v_add_u32_dpp v209, v243, v238 row_newbcast:1 row_mask:0xf bank_mask:0xc
v_add_u32_dpp v217, v243, v239 row_newbcast:3 row_mask:0xf bank_mask:0xc
v_add_u32_dpp v210, v244, v236 row_newbcast:1 row_mask:0xf bank_mask:0xc
v_add_u32_dpp v218, v244, v237 row_newbcast:3 row_mask:0xf bank_mask:0xc
v_mfma_f32_32x32x16_bf16 v[96:111], v[144:147], a[248:251], v[96:111]
buffer_load_dwordx4 v212, s[20:23], 0 offen offset:256 lds
ds_read_b128 v[144:147], v2 offset:37120
v_add_u32_dpp v211, v245, v238 row_newbcast:1 row_mask:0xf bank_mask:0xc
v_add_u32_dpp v219, v245, v239 row_newbcast:3 row_mask:0xf bank_mask:0xc
v_mov_b32_dpp v242, v242 row_ror:12 row_mask:0xf bank_mask:0xf
v_mfma_f32_32x32x16_bf16 v[64:79], v[148:151], a[204:207], v[64:79]
v_mov_b32_dpp v243, v243 row_ror:12 row_mask:0xf bank_mask:0xf
v_mov_b32_dpp v244, v244 row_ror:12 row_mask:0xf bank_mask:0xf
v_mov_b32_dpp v245, v245 row_ror:12 row_mask:0xf bank_mask:0xf
v_exp_f32 v25, v25
v_mfma_f32_32x32x16_bf16 v[96:111], v[148:151], a[252:255], v[96:111]
ds_read_b128 v[148:151], v3 offset:37120
v_add_f32 v19, v19, v24
v_cvt_pk_bf16_f32 v128, v22, v23
v_fma_f32 v27, v85, s37, v15
v_add_f32 v19, v19, v25
s_waitcnt lgkmcnt(8)
v_mfma_f32_32x32x16_bf16 v[64:79], v[152:155], a[208:211], v[64:79]
buffer_load_dwordx4 v220, s[20:23], 0 offen offset:1280 lds
v_exp_f32 v26, v26
v_fma_f32 v22, v86, s37, v15
v_add_f32 v19, v19, v26
s_waitcnt lgkmcnt(6)
v_mfma_f32_16x16x32_bf16 v[176:179], v[224:227], v[204:207], v[176:179]
v_exp_f32 v27, v27
s_waitcnt lgkmcnt(4)
v_mfma_f32_16x16x32_bf16 v[180:183], v[228:231], v[204:207], v[180:183]
s_waitcnt vmcnt(12)
ds_read_b64_tr_b16 v[224:225], v232 offset:12288
ds_read_b64_tr_b16 v[226:227], v232 offset:14336
v_mfma_f32_32x32x16_bf16 v[96:111], v[152:155], v[32:35], v[96:111]
ds_read_b64_tr_b16 v[228:229], v233 offset:12288
ds_read_b64_tr_b16 v[230:231], v233 offset:14336
ds_read_b128 v[152:155], v4 offset:37120
v_cvt_pk_bf16_f32 v184, v168, v169
v_cvt_pk_bf16_f32 v185, v170, v171
v_mfma_f32_32x32x16_bf16 v[64:79], v[156:159], a[212:215], v[64:79]
buffer_load_dwordx4 v213, s[20:23], 0 offen offset:2304 lds
v_cvt_pk_bf16_f32 v186, v172, v173
v_cvt_pk_bf16_f32 v187, v174, v175
v_cvt_pk_bf16_f32 v129, v24, v25
v_fma_f32 v23, v87, s37, v15
v_mfma_f32_32x32x16_bf16 v[96:111], v[156:159], v[36:39], v[96:111]
ds_read_b128 v[156:159], v5 offset:37120
v_exp_f32 v22, v22
s_lshr_b32 s63, s77, 2
v_add_f32 v19, v19, v27
s_waitcnt lgkmcnt(8)
v_mfma_f32_32x32x16_bf16 v[64:79], v[136:139], a[216:219], v[64:79]
v_fma_f32 v24, v88, s37, v15
v_exp_f32 v23, v23
v_lshlrev_b32 v254, 4, v1
v_cmp_eq_u32_e64 s[72:73], s63, v253
v_mfma_f32_32x32x16_bf16 v[96:111], v[136:139], v[40:43], v[96:111]
buffer_load_dwordx4 v221, s[20:23], 0 offen offset:3328 lds
s_add_u32 m0, s53, 7936
ds_read_b64_tr_b16 v[136:137], v6 offset:24576
ds_read_b64_tr_b16 v[138:139], v6 offset:27648
v_add_f32 v19, v19, v22
v_mfma_f32_32x32x16_bf16 v[64:79], v[140:143], a[220:223], v[64:79]
v_cvt_pk_bf16_f32 v130, v26, v27
v_fma_f32 v25, v89, s37, v15
v_exp_f32 v24, v24
v_cndmask_b32_e64 v250, 0, v240, s[72:73]
v_mfma_f32_32x32x16_bf16 v[96:111], v[140:143], v[44:47], v[96:111]
ds_read_b64_tr_b16 v[140:141], v7 offset:24576
ds_read_b64_tr_b16 v[142:143], v7 offset:27648
s_nop 1
v_cndmask_b32_e64 v251, 0, v241, s[72:73]
s_waitcnt lgkmcnt(10)
v_mfma_f32_32x32x16_bf16 v[64:79], v[144:147], a[224:227], v[64:79]
buffer_load_dwordx4 v214, s[20:23], 0 offen offset:256 lds
v_add_f32 v19, v19, v23
v_fma_f32 v26, v90, s37, v15
v_exp_f32 v25, v25
s_waitcnt lgkmcnt(8)
v_mfma_f32_16x16x32_bf16 v[168:171], v[224:227], v[192:195], 0
v_add_f32 v19, v19, v24
v_cvt_pk_bf16_f32 v131, v22, v23
s_waitcnt lgkmcnt(6)
v_mfma_f32_16x16x32_bf16 v[172:175], v[228:231], v[192:195], 0
ds_read_b64_tr_b16 v[224:225], v234 offset:12288
ds_read_b64_tr_b16 v[226:227], v234 offset:14336
v_mfma_f32_32x32x16_bf16 v[96:111], v[144:147], v[48:51], v[96:111]
ds_read_b64_tr_b16 v[228:229], v235 offset:12288
ds_read_b64_tr_b16 v[230:231], v235 offset:14336
ds_read_b64_tr_b16 v[144:145], v6 offset:24704
ds_read_b64_tr_b16 v[146:147], v6 offset:27776
v_fma_f32 v27, v91, s37, v15
v_mfma_f32_32x32x16_bf16 v[64:79], v[148:151], a[228:231], v[64:79]
buffer_load_dwordx4 v222, s[20:23], 0 offen offset:1280 lds
v_exp_f32 v26, v26
v_add_f32 v19, v19, v25
v_fma_f32 v22, v92, s37, v15
v_mfma_f32_32x32x16_bf16 v[96:111], v[148:151], v[52:55], v[96:111]
ds_read_b64_tr_b16 v[148:149], v7 offset:24704
ds_read_b64_tr_b16 v[150:151], v7 offset:27776
v_exp_f32 v27, v27
v_add_f32 v19, v19, v26
s_waitcnt lgkmcnt(12)
v_mfma_f32_32x32x16_bf16 v[64:79], v[152:155], a[232:235], v[64:79]
s_barrier
v_cvt_pk_bf16_f32 v132, v24, v25
v_fma_f32 v23, v93, s37, v15
v_exp_f32 v22, v22
v_add_f32 v19, v19, v27
v_mfma_f32_32x32x16_bf16 v[96:111], v[152:155], v[56:59], v[96:111]
buffer_load_dwordx4 v215, s[20:23], 0 offen offset:2304 lds
v_fma_f32 v24, v94, s37, v15
v_exp_f32 v23, v23
v_add_f32 v19, v19, v22
v_mfma_f32_32x32x16_bf16 v[64:79], v[156:159], a[236:239], v[64:79]
v_fma_f32 v25, v95, s37, v15
v_exp_f32 v24, v24
v_add_f32 v19, v19, v23
v_add_f32 v19, v19, v24
v_mfma_f32_32x32x16_bf16 v[96:111], v[156:159], v[60:63], v[96:111]
buffer_load_dwordx4 v223, s[20:23], 0 offen offset:3328 lds
buffer_store_dwordx4 v[184:187], v254, s[32:35], s75 offen offset:2048
v_exp_f32 v25, v25
v_cvt_pk_bf16_f32 v133, v26, v27
v_cvt_pk_bf16_f32 v134, v22, v23
v_add_f32 v19, v19, v25
v_cvt_pk_bf16_f32 v135, v24, v25
v_cvt_pk_bf16_f32 v188, v176, v177
v_cvt_pk_bf16_f32 v189, v178, v179
v_cvt_pk_bf16_f32 v190, v180, v181
v_cvt_pk_bf16_f32 v191, v182, v183
v_lshlrev_b32 v254, 4, v1
s_add_u32 s39, s39, s98
buffer_store_dwordx4 v[188:191], v254, s[32:35], s75 offen offset:3072
v_cmp_nge_f32 vcc, s52, v19
s_cbranch_vccnz Lst_p2V_Y
Lct_p2V_Y:
v_add_f32 v17, v17, v19
s_cmp_eq_u32 s42, s43
s_cbranch_scc1 L_t3_V
s_waitcnt lgkmcnt(8)
v_mfma_f32_32x32x16_bf16 a[0:15], v[136:139], v[112:115], a[0:15]
ds_read_b64_tr_b16 v[152:153], v6 offset:24832
ds_read_b64_tr_b16 v[154:155], v6 offset:27904
ds_read_b64_tr_b16 v[156:157], v7 offset:24832
ds_read_b64_tr_b16 v[158:159], v7 offset:27904
s_waitcnt lgkmcnt(10)
v_mfma_f32_16x16x32_bf16 v[176:179], v[224:227], v[192:195], 0
s_waitcnt lgkmcnt(8)
v_mfma_f32_16x16x32_bf16 v[180:183], v[228:231], v[192:195], 0
s_waitcnt vmcnt(16)
ds_read_b64_tr_b16 v[224:225], v232 offset:0
ds_read_b64_tr_b16 v[226:227], v232 offset:2048
v_mfma_f32_32x32x16_bf16 a[96:111], v[136:139], v[128:131], a[96:111]
ds_read_b64_tr_b16 v[228:229], v233 offset:0
ds_read_b64_tr_b16 v[230:231], v233 offset:2048
ds_read_b64_tr_b16 v[136:137], v6 offset:30720
ds_read_b64_tr_b16 v[138:139], v6 offset:33792
s_add_u32 m0, s53, 12288
v_mfma_f32_32x32x16_bf16 a[16:31], v[140:143], v[112:115], a[16:31]
buffer_load_dwordx4 v208, s[20:23], 0 offen offset:0 lds
v_fma_f32 v22, v64, s37, v14
v_fma_f32 v23, v65, s37, v14
v_exp_f32 v22, v22
v_mfma_f32_32x32x16_bf16 a[112:127], v[140:143], v[128:131], a[112:127]
ds_read_b64_tr_b16 v[140:141], v7 offset:30720
ds_read_b64_tr_b16 v[142:143], v7 offset:33792
v_fma_f32 v24, v66, s37, v14
v_exp_f32 v23, v23
s_waitcnt lgkmcnt(12)
v_mfma_f32_32x32x16_bf16 a[32:47], v[144:147], v[112:115], a[32:47]
v_fma_f32 v25, v67, s37, v14
v_exp_f32 v24, v24
v_add_f32 v18, v22, v23
v_fma_f32 v26, v68, s37, v14
v_mfma_f32_32x32x16_bf16 a[128:143], v[144:147], v[128:131], a[128:143]
buffer_load_dwordx4 v216, s[20:23], 0 offen offset:1024 lds
ds_read_b64_tr_b16 v[144:145], v6 offset:30848
ds_read_b64_tr_b16 v[146:147], v6 offset:33920
v_exp_f32 v25, v25
v_mfma_f32_32x32x16_bf16 a[48:63], v[148:151], v[112:115], a[48:63]
v_add_f32 v18, v18, v24
v_cvt_pk_bf16_f32 v120, v22, v23
v_fma_f32 v27, v69, s37, v14
v_exp_f32 v26, v26
v_mfma_f32_32x32x16_bf16 a[144:159], v[148:151], v[128:131], a[144:159]
ds_read_b64_tr_b16 v[148:149], v7 offset:30848
ds_read_b64_tr_b16 v[150:151], v7 offset:33920
v_add_f32 v18, v18, v25
v_fma_f32 v22, v70, s37, v14
v_add_f32 v18, v18, v26
s_waitcnt lgkmcnt(12)
v_mfma_f32_32x32x16_bf16 a[64:79], v[152:155], v[112:115], a[64:79]
buffer_load_dwordx4 v209, s[20:23], 0 offen offset:2048 lds
v_exp_f32 v27, v27
v_cvt_pk_bf16_f32 v121, v24, v25
v_fma_f32 v23, v71, s37, v14
s_waitcnt lgkmcnt(10)
v_mfma_f32_16x16x32_bf16 v[168:171], v[224:227], v[196:199], v[168:171]
v_exp_f32 v22, v22
s_waitcnt lgkmcnt(8)
v_mfma_f32_16x16x32_bf16 v[172:175], v[228:231], v[196:199], v[172:175]
ds_read_b64_tr_b16 v[224:225], v234 offset:0
ds_read_b64_tr_b16 v[226:227], v234 offset:2048
v_mfma_f32_32x32x16_bf16 a[160:175], v[152:155], v[128:131], a[160:175]
ds_read_b64_tr_b16 v[228:229], v235 offset:0
ds_read_b64_tr_b16 v[230:231], v235 offset:2048
ds_read_b64_tr_b16 v[152:153], v6 offset:30976
ds_read_b64_tr_b16 v[154:155], v6 offset:34048
v_add_f32 v18, v18, v27
v_mfma_f32_32x32x16_bf16 a[80:95], v[156:159], v[112:115], a[80:95]
buffer_load_dwordx4 v217, s[20:23], 0 offen offset:3072 lds
s_add_u32 m0, s48, 36864
v_fma_f32 v24, v72, s37, v14
v_exp_f32 v23, v23
v_mfma_f32_32x32x16_bf16 a[176:191], v[156:159], v[128:131], a[176:191]
ds_read_b64_tr_b16 v[156:157], v7 offset:30976
ds_read_b64_tr_b16 v[158:159], v7 offset:34048
v_add_f32 v18, v18, v22
v_cvt_pk_bf16_f32 v122, v26, v27
v_fma_f32 v25, v73, s37, v14
s_waitcnt lgkmcnt(12)
v_mfma_f32_32x32x16_bf16 a[0:15], v[136:139], v[116:119], a[0:15]
v_exp_f32 v24, v24
v_and_b32 v192, v160, v250
v_and_b32 v193, v160, v251
v_and_b32 v194, v161, v250
v_mfma_f32_32x32x16_bf16 a[96:111], v[136:139], v[132:135], a[96:111]
ds_read_b128 v[136:139], v2 offset:0
buffer_load_dwordx4 v8, s[8:11], s38 offen offset:0 lds
v_and_b32 v195, v161, v251
v_add_f32 v18, v18, v23
v_fma_f32 v26, v74, s37, v14
v_mfma_f32_32x32x16_bf16 a[16:31], v[140:143], v[116:119], a[16:31]
v_exp_f32 v25, v25
v_add_f32 v18, v18, v24
v_cvt_pk_bf16_f32 v123, v22, v23
v_fma_f32 v27, v75, s37, v14
v_mfma_f32_32x32x16_bf16 a[112:127], v[140:143], v[132:135], a[112:127]
ds_read_b128 v[140:143], v3 offset:0
v_exp_f32 v26, v26
v_add_f32 v18, v18, v25
v_fma_f32 v22, v76, s37, v14
s_waitcnt lgkmcnt(10)
v_mfma_f32_32x32x16_bf16 a[32:47], v[144:147], v[116:119], a[32:47]
buffer_load_dwordx4 v9, s[8:11], s38 offen offset:1024 lds
v_exp_f32 v27, v27
v_add_f32 v18, v18, v26
v_cvt_pk_bf16_f32 v124, v24, v25
s_waitcnt lgkmcnt(8)
v_mfma_f32_16x16x32_bf16 v[176:179], v[224:227], v[196:199], v[176:179]
v_fma_f32 v23, v77, s37, v14
v_add_f32 v18, v18, v27
s_waitcnt lgkmcnt(6)
v_mfma_f32_16x16x32_bf16 v[180:183], v[228:231], v[196:199], v[180:183]
s_waitcnt vmcnt(12)
ds_read_b64_tr_b16 v[224:225], v232 offset:4096
ds_read_b64_tr_b16 v[226:227], v232 offset:6144
v_mfma_f32_32x32x16_bf16 a[128:143], v[144:147], v[132:135], a[128:143]
ds_read_b64_tr_b16 v[228:229], v233 offset:4096
ds_read_b64_tr_b16 v[230:231], v233 offset:6144
v_exp_f32 v22, v22
v_fma_f32 v24, v78, s37, v14
v_mfma_f32_32x32x16_bf16 a[48:63], v[148:151], v[116:119], a[48:63]
buffer_load_dwordx4 v10, s[8:11], s38 offen offset:2048 lds
v_exp_f32 v23, v23
ds_read_b128 v[144:147], v4 offset:0
v_add_f32 v18, v18, v22
v_mfma_f32_32x32x16_bf16 a[144:159], v[148:151], v[132:135], a[144:159]
v_fma_f32 v25, v79, s37, v14
v_exp_f32 v24, v24
v_add_f32 v18, v18, v23
v_add_f32 v18, v18, v24
s_waitcnt lgkmcnt(7)
v_mfma_f32_32x32x16_bf16 a[64:79], v[152:155], v[116:119], a[64:79]
v_exp_f32 v25, v25
v_cvt_pk_bf16_f32 v125, v26, v27
v_cvt_pk_bf16_f32 v126, v22, v23
v_add_f32 v18, v18, v25
v_mfma_f32_32x32x16_bf16 a[160:175], v[152:155], v[132:135], a[160:175]
v_cvt_pk_bf16_f32 v127, v24, v25
ds_read_b128 v[148:151], v5 offset:0
s_add_u32 m0, s49, 12288
ds_read_b128 v[152:155], v2 offset:128
buffer_load_dwordx4 v11, s[12:15], s39 offen offset:0 lds
v_mfma_f32_32x32x16_bf16 a[80:95], v[156:159], v[116:119], a[80:95]
v_cmp_nge_f32 vcc, s52, v18
s_cbranch_vccnz Lst_p3V_X
Lct_p3V_X:
v_add_f32 v16, v16, v18
v_add_u32_dpp v212, v246, v236 row_newbcast:0 row_mask:0xf bank_mask:0x3
v_add_u32_dpp v220, v246, v237 row_newbcast:2 row_mask:0xf bank_mask:0x3
v_mfma_f32_32x32x16_bf16 a[176:191], v[156:159], v[132:135], a[176:191]
ds_read_b128 v[156:159], v3 offset:128
v_add_u32_dpp v213, v247, v238 row_newbcast:0 row_mask:0xf bank_mask:0x3
v_add_u32_dpp v221, v247, v239 row_newbcast:2 row_mask:0xf bank_mask:0x3
v_add_u32_dpp v214, v248, v236 row_newbcast:0 row_mask:0xf bank_mask:0x3
v_add_u32_dpp v222, v248, v237 row_newbcast:2 row_mask:0xf bank_mask:0x3
s_waitcnt lgkmcnt(8)
v_mfma_f32_32x32x16_bf16 v[64:79], v[136:139], a[192:195], 0
buffer_load_dwordx4 v12, s[12:15], s39 offen offset:1024 lds
v_add_u32_dpp v215, v249, v238 row_newbcast:0 row_mask:0xf bank_mask:0x3
v_add_u32_dpp v223, v249, v239 row_newbcast:2 row_mask:0xf bank_mask:0x3
v_add_u32_dpp v212, v246, v236 row_newbcast:1 row_mask:0xf bank_mask:0xc
v_add_u32_dpp v220, v246, v237 row_newbcast:3 row_mask:0xf bank_mask:0xc
s_waitcnt lgkmcnt(6)
v_mfma_f32_16x16x32_bf16 v[168:171], v[224:227], v[200:203], v[168:171]
v_add_u32_dpp v213, v247, v238 row_newbcast:1 row_mask:0xf bank_mask:0xc
v_add_u32_dpp v221, v247, v239 row_newbcast:3 row_mask:0xf bank_mask:0xc
s_waitcnt lgkmcnt(4)
v_mfma_f32_16x16x32_bf16 v[172:175], v[228:231], v[200:203], v[172:175]
ds_read_b64_tr_b16 v[224:225], v234 offset:4096
ds_read_b64_tr_b16 v[226:227], v234 offset:6144
v_mfma_f32_32x32x16_bf16 v[80:95], v[136:139], a[240:243], 0
ds_read_b64_tr_b16 v[228:229], v235 offset:4096
ds_read_b64_tr_b16 v[230:231], v235 offset:6144
v_add_u32_dpp v214, v248, v236 row_newbcast:1 row_mask:0xf bank_mask:0xc
v_add_u32_dpp v222, v248, v237 row_newbcast:3 row_mask:0xf bank_mask:0xc
v_add_u32_dpp v215, v249, v238 row_newbcast:1 row_mask:0xf bank_mask:0xc
v_mfma_f32_32x32x16_bf16 v[64:79], v[140:143], a[196:199], v[64:79]
buffer_load_dwordx4 v13, s[12:15], s39 offen offset:2048 lds
s_add_u32 m0, s53, 0
v_add_u32_dpp v223, v249, v239 row_newbcast:3 row_mask:0xf bank_mask:0xc
v_mov_b32_dpp v246, v246 row_ror:12 row_mask:0xf bank_mask:0xf
v_mov_b32_dpp v247, v247 row_ror:12 row_mask:0xf bank_mask:0xf
v_mfma_f32_32x32x16_bf16 v[80:95], v[140:143], a[244:247], v[80:95]
v_mov_b32_dpp v248, v248 row_ror:12 row_mask:0xf bank_mask:0xf
v_mov_b32_dpp v249, v249 row_ror:12 row_mask:0xf bank_mask:0xf
ds_read_b128 v[136:139], v4 offset:128
ds_read_b128 v[140:143], v5 offset:128
v_and_b32 v196, v162, v250
s_waitcnt lgkmcnt(8)
v_mfma_f32_32x32x16_bf16 v[64:79], v[144:147], a[200:203], v[64:79]
v_and_b32 v197, v162, v251
v_and_b32 v198, v163, v250
v_and_b32 v199, v163, v251
v_fma_f32 v22, v96, s37, v15
v_fma_f32 v23, v97, s37, v15
v_mfma_f32_32x32x16_bf16 v[80:95], v[144:147], a[248:251], v[80:95]
buffer_load_dwordx4 v210, s[20:23], 0 offen offset:0 lds
ds_read_b128 v[144:147], v2 offset:256
v_exp_f32 v22, v22
v_fma_f32 v24, v98, s37, v15
v_mfma_f32_32x32x16_bf16 v[64:79], v[148:151], a[204:207], v[64:79]
v_exp_f32 v23, v23
v_fma_f32 v25, v99, s37, v15
v_exp_f32 v24, v24
v_mfma_f32_32x32x16_bf16 v[80:95], v[148:151], a[252:255], v[80:95]
ds_read_b128 v[148:151], v3 offset:256
v_add_f32 v19, v22, v23
v_fma_f32 v26, v100, s37, v15
v_exp_f32 v25, v25
s_waitcnt lgkmcnt(8)
v_mfma_f32_32x32x16_bf16 v[64:79], v[152:155], a[208:211], v[64:79]
buffer_load_dwordx4 v218, s[20:23], 0 offen offset:1024 lds
v_add_f32 v19, v19, v24
v_cvt_pk_bf16_f32 v128, v22, v23
v_fma_f32 v27, v101, s37, v15
v_add_f32 v19, v19, v25
s_waitcnt lgkmcnt(6)
v_mfma_f32_16x16x32_bf16 v[176:179], v[224:227], v[200:203], v[176:179]
v_exp_f32 v26, v26
s_waitcnt lgkmcnt(4)
v_mfma_f32_16x16x32_bf16 v[180:183], v[228:231], v[200:203], v[180:183]
s_waitcnt vmcnt(14)
ds_read_b64_tr_b16 v[224:225], v232 offset:8192
ds_read_b64_tr_b16 v[226:227], v232 offset:10240
v_mfma_f32_32x32x16_bf16 v[80:95], v[152:155], v[32:35], v[80:95]
ds_read_b64_tr_b16 v[228:229], v233 offset:8192
ds_read_b64_tr_b16 v[230:231], v233 offset:10240
ds_read_b128 v[152:155], v4 offset:256
v_fma_f32 v22, v102, s37, v15
v_add_f32 v19, v19, v26
v_mfma_f32_32x32x16_bf16 v[64:79], v[156:159], a[212:215], v[64:79]
buffer_load_dwordx4 v211, s[20:23], 0 offen offset:2048 lds
v_exp_f32 v27, v27
v_cvt_pk_bf16_f32 v129, v24, v25
v_fma_f32 v23, v103, s37, v15
v_mfma_f32_32x32x16_bf16 v[80:95], v[156:159], v[36:39], v[80:95]
ds_read_b128 v[156:159], v5 offset:256
v_exp_f32 v22, v22
v_add_f32 v19, v19, v27
v_fma_f32 v24, v104, s37, v15
s_waitcnt lgkmcnt(8)
v_mfma_f32_32x32x16_bf16 v[64:79], v[136:139], a[216:219], v[64:79]
v_exp_f32 v23, v23
v_add_f32 v19, v19, v22
v_cvt_pk_bf16_f32 v130, v26, v27
v_fma_f32 v25, v105, s37, v15
v_mfma_f32_32x32x16_bf16 v[80:95], v[136:139], v[40:43], v[80:95]
buffer_load_dwordx4 v219, s[20:23], 0 offen offset:3072 lds
s_add_u32 m0, s53, 4096
ds_read_b64_tr_b16 v[136:137], v6 offset:36864
ds_read_b64_tr_b16 v[138:139], v6 offset:39936
v_add_f32 v19, v19, v23
v_mfma_f32_32x32x16_bf16 v[64:79], v[140:143], a[220:223], v[64:79]
v_exp_f32 v24, v24
v_fma_f32 v26, v106, s37, v15
v_exp_f32 v25, v25
v_mfma_f32_32x32x16_bf16 v[80:95], v[140:143], v[44:47], v[80:95]
ds_read_b64_tr_b16 v[140:141], v7 offset:36864
ds_read_b64_tr_b16 v[142:143], v7 offset:39936
v_add_f32 v19, v19, v24
v_cvt_pk_bf16_f32 v131, v22, v23
v_fma_f32 v27, v107, s37, v15
s_waitcnt lgkmcnt(10)
v_mfma_f32_32x32x16_bf16 v[64:79], v[144:147], a[224:227], v[64:79]
buffer_load_dwordx4 v212, s[20:23], 0 offen offset:0 lds
v_exp_f32 v26, v26
v_add_f32 v19, v19, v25
v_fma_f32 v22, v108, s37, v15
s_waitcnt lgkmcnt(8)
v_mfma_f32_16x16x32_bf16 v[168:171], v[224:227], v[204:207], v[168:171]
v_exp_f32 v27, v27
s_waitcnt lgkmcnt(6)
v_mfma_f32_16x16x32_bf16 v[172:175], v[228:231], v[204:207], v[172:175]
ds_read_b64_tr_b16 v[224:225], v234 offset:8192
ds_read_b64_tr_b16 v[226:227], v234 offset:10240
v_mfma_f32_32x32x16_bf16 v[80:95], v[144:147], v[48:51], v[80:95]
ds_read_b64_tr_b16 v[228:229], v235 offset:8192
ds_read_b64_tr_b16 v[230:231], v235 offset:10240
ds_read_b64_tr_b16 v[144:145], v6 offset:36992
ds_read_b64_tr_b16 v[146:147], v6 offset:40064
v_add_f32 v19, v19, v26
v_mfma_f32_32x32x16_bf16 v[64:79], v[148:151], a[228:231], v[64:79]
buffer_load_dwordx4 v220, s[20:23], 0 offen offset:1024 lds
v_cvt_pk_bf16_f32 v132, v24, v25
v_fma_f32 v23, v109, s37, v15
v_exp_f32 v22, v22
v_mfma_f32_32x32x16_bf16 v[80:95], v[148:151], v[52:55], v[80:95]
ds_read_b64_tr_b16 v[148:149], v7 offset:36992
ds_read_b64_tr_b16 v[150:151], v7 offset:40064
v_add_f32 v19, v19, v27
v_fma_f32 v24, v110, s37, v15
v_add_f32 v19, v19, v22
s_waitcnt lgkmcnt(12)
v_mfma_f32_32x32x16_bf16 v[64:79], v[152:155], a[232:235], v[64:79]
s_barrier
v_exp_f32 v23, v23
v_fma_f32 v25, v111, s37, v15
v_exp_f32 v24, v24
v_mfma_f32_32x32x16_bf16 v[80:95], v[152:155], v[56:59], v[80:95]
buffer_load_dwordx4 v213, s[20:23], 0 offen offset:2048 lds
v_add_f32 v19, v19, v23
v_exp_f32 v25, v25
v_add_f32 v19, v19, v24
v_mfma_f32_32x32x16_bf16 v[64:79], v[156:159], a[236:239], v[64:79]
v_cvt_pk_bf16_f32 v133, v26, v27
v_cvt_pk_bf16_f32 v134, v22, v23
v_add_f32 v19, v19, v25
v_cvt_pk_bf16_f32 v135, v24, v25
s_add_u32 s39, s39, s98
v_mfma_f32_32x32x16_bf16 v[80:95], v[156:159], v[60:63], v[80:95]
buffer_load_dwordx4 v221, s[20:23], 0 offen offset:3072 lds
s_add_u32 s38, s38, s78
s_add_u32 s99, s99, 4
s_cmp_eq_u32 s99, s40
s_cselect_b32 s38, s88, s38
s_cselect_b32 s78, -12288, s78
s_cmp_eq_u32 s99, 28
s_cselect_b32 s38, s41, s38
s_cselect_b32 s78, 12288, s78
v_and_b32 v200, v164, v250
v_and_b32 v201, v164, v251
v_and_b32 v202, v165, v250
v_and_b32 v203, v165, v251
v_cmp_nge_f32 vcc, s52, v19
s_cbranch_vccnz Lst_p3V_Y
Lct_p3V_Y:
v_add_f32 v17, v17, v19
s_add_u32 s42, s42, 1
s_sub_u32 s87, s42, 5
s_add_u32 s74, s75, 4096
s_mul_i32 s75, s87, 6144
s_add_u32 s75, s75, s47
s_add_u32 s87, s87, 1
s_lshl_b32 s77, s87, 2
s_lshr_b32 s84, s87, 1
s_and_b32 s85, s87, 1
s_lshl_b32 s86, s45, 8
s_lshl_b32 s63, s36, 5
s_add_u32 s86, s86, s63
s_lshl_b32 s84, s84, 7
s_add_u32 s86, s86, s84
s_lshl_b32 s85, s85, 4
s_add_u32 s86, s86, s85
s_mul_i32 s79, s86, 384
s_cmp_eq_u32 s42, 7
s_cbranch_scc0 L_p0_V
s_branch L_d0
L_enterK:
s_mov_b64 s[72:73], 0
s_mov_b32 s87, 0
s_mov_b64 s[74:75], s[72:73]
v_cmp_eq_u32_e64 s[72:73], s87, v253
s_mov_b32 s3, s79
s_add_u32 s87, s87, 1
s_lshl_b32 s77, s87, 2
s_lshr_b32 s84, s87, 1
s_and_b32 s85, s87, 1
s_lshl_b32 s86, s45, 8
s_lshl_b32 s63, s36, 5
s_add_u32 s86, s86, s63
s_lshl_b32 s84, s84, 7
s_add_u32 s86, s86, s84
s_lshl_b32 s85, s85, 4
s_add_u32 s86, s86, s85
s_mul_i32 s79, s86, 384
s_branch L_p0_K
L_p3_Kl:
s_waitcnt lgkmcnt(8)
v_mfma_f32_32x32x16_bf16 a[0:15], v[136:139], v[112:115], a[0:15]
ds_read_b64_tr_b16 v[152:153], v6 offset:24832
ds_read_b64_tr_b16 v[154:155], v6 offset:27904
ds_read_b64_tr_b16 v[156:157], v7 offset:24832
ds_read_b64_tr_b16 v[158:159], v7 offset:27904
s_waitcnt lgkmcnt(11)
v_mfma_f32_16x16x32_bf16 v[172:175], v[224:227], v[192:195], v[172:175]
s_waitcnt lgkmcnt(10)
v_mfma_f32_16x16x32_bf16 v[172:175], v[228:231], v[196:199], v[172:175]
s_waitcnt vmcnt(13)
ds_read_b128 v[224:227], v232 offset:0
ds_read_b128 v[228:231], v233 offset:0
v_mfma_f32_32x32x16_bf16 a[96:111], v[136:139], v[128:131], a[96:111]
ds_read_b64_tr_b16 v[136:137], v6 offset:30720
ds_read_b64_tr_b16 v[138:139], v6 offset:33792
v_bfe_u32 v236, v1, 4, 2
v_lshlrev_b32 v236, 1, v236
v_and_b32 v237, 7, v1
v_mfma_f32_32x32x16_bf16 a[16:31], v[140:143], v[112:115], a[16:31]
v_xor_b32 v236, v236, v237
s_add_u32 m0, s53, 9984
v_lshlrev_b32 v239, 4, v236
buffer_load_dwordx4 v215, s[16:19], 0 offen offset:256 lds
v_add_u32 v236, 3072, v239
v_mfma_f32_32x32x16_bf16 a[112:127], v[140:143], v[128:131], a[112:127]
ds_read_b64_tr_b16 v[140:141], v7 offset:30720
ds_read_b64_tr_b16 v[142:143], v7 offset:33792
v_mov_b32_dpp v242, v242 row_ror:4 row_mask:0xf bank_mask:0xf
v_add_u32 v237, 2048, v239
v_add_u32 v238, 1024, v239
s_waitcnt lgkmcnt(12)
v_mfma_f32_32x32x16_bf16 a[32:47], v[144:147], v[112:115], a[32:47]
v_add_u32_dpp v208, v242, v236 row_newbcast:0 row_mask:0xf bank_mask:0x3
v_mov_b32_dpp v243, v243 row_ror:4 row_mask:0xf bank_mask:0xf
v_add_u32_dpp v208, v242, v236 row_newbcast:1 row_mask:0xf bank_mask:0xc
v_add_u32_dpp v216, v242, v237 row_newbcast:2 row_mask:0xf bank_mask:0x3
v_add_u32_dpp v216, v242, v237 row_newbcast:3 row_mask:0xf bank_mask:0xc
v_mfma_f32_32x32x16_bf16 a[128:143], v[144:147], v[128:131], a[128:143]
buffer_load_dwordx4 v223, s[16:19], 0 offen offset:1280 lds
s_add_u32 m0, s53, 12288
v_add_u32_dpp v209, v243, v238 row_newbcast:0 row_mask:0xf bank_mask:0x3
v_add_u32_dpp v209, v243, v238 row_newbcast:1 row_mask:0xf bank_mask:0xc
v_add_u32_dpp v217, v243, v239 row_newbcast:2 row_mask:0xf bank_mask:0x3
v_mfma_f32_32x32x16_bf16 a[48:63], v[148:151], v[112:115], a[48:63]
v_add_u32_dpp v217, v243, v239 row_newbcast:3 row_mask:0xf bank_mask:0xc
ds_read_b64_tr_b16 v[144:145], v6 offset:30848
ds_read_b64_tr_b16 v[146:147], v6 offset:33920
v_mov_b32_dpp v244, v244 row_ror:4 row_mask:0xf bank_mask:0xf
v_mov_b32_dpp v245, v245 row_ror:4 row_mask:0xf bank_mask:0xf
v_mfma_f32_32x32x16_bf16 a[144:159], v[148:151], v[128:131], a[144:159]
ds_read_b64_tr_b16 v[148:149], v7 offset:30848
ds_read_b64_tr_b16 v[150:151], v7 offset:33920
v_add_u32_dpp v210, v244, v236 row_newbcast:0 row_mask:0xf bank_mask:0x3
v_add_u32_dpp v218, v244, v237 row_newbcast:2 row_mask:0xf bank_mask:0x3
v_add_u32_dpp v211, v245, v238 row_newbcast:0 row_mask:0xf bank_mask:0x3
s_waitcnt lgkmcnt(10)
v_mfma_f32_32x32x16_bf16 a[64:79], v[152:155], v[112:115], a[64:79]
s_waitcnt vmcnt(13)
buffer_load_dwordx4 v208, s[20:23], 0 offen offset:0 lds
v_add_u32_dpp v219, v245, v239 row_newbcast:2 row_mask:0xf bank_mask:0x3
v_add_u32_dpp v210, v244, v236 row_newbcast:1 row_mask:0xf bank_mask:0xc
v_add_u32_dpp v218, v244, v237 row_newbcast:3 row_mask:0xf bank_mask:0xc
v_add_u32_dpp v211, v245, v238 row_newbcast:1 row_mask:0xf bank_mask:0xc
s_waitcnt lgkmcnt(9)
v_mfma_f32_16x16x32_bf16 v[176:179], v[224:227], v[192:195], v[176:179]
v_add_u32_dpp v219, v245, v239 row_newbcast:3 row_mask:0xf bank_mask:0xc
v_mov_b32_dpp v242, v242 row_ror:12 row_mask:0xf bank_mask:0xf
s_waitcnt lgkmcnt(8)
v_mfma_f32_16x16x32_bf16 v[176:179], v[228:231], v[196:199], v[176:179]
s_waitcnt vmcnt(9)
ds_read_b128 v[224:227], v232 offset:2048
ds_read_b128 v[228:231], v233 offset:2048
v_mfma_f32_32x32x16_bf16 a[160:175], v[152:155], v[128:131], a[160:175]
v_mov_b32_dpp v243, v243 row_ror:12 row_mask:0xf bank_mask:0xf
v_mov_b32_dpp v244, v244 row_ror:12 row_mask:0xf bank_mask:0xf
v_mov_b32_dpp v245, v245 row_ror:12 row_mask:0xf bank_mask:0xf
ds_read_b64_tr_b16 v[152:153], v6 offset:30976
ds_read_b64_tr_b16 v[154:155], v6 offset:34048
v_mfma_f32_32x32x16_bf16 a[80:95], v[156:159], v[112:115], a[80:95]
buffer_load_dwordx4 v216, s[20:23], 0 offen offset:1024 lds
v_fma_f32 v22, v64, s37, v14
v_fma_f32 v23, v65, s37, v14
v_exp_f32 v22, v22
v_mfma_f32_32x32x16_bf16 a[176:191], v[156:159], v[128:131], a[176:191]
ds_read_b64_tr_b16 v[156:157], v7 offset:30976
ds_read_b64_tr_b16 v[158:159], v7 offset:34048
v_fma_f32 v24, v66, s37, v14
v_exp_f32 v23, v23
s_waitcnt lgkmcnt(10)
v_mfma_f32_32x32x16_bf16 a[0:15], v[136:139], v[116:119], a[0:15]
v_fma_f32 v25, v67, s37, v14
v_exp_f32 v24, v24
v_add_f32 v18, v22, v23
v_fma_f32 v26, v68, s37, v14
v_mfma_f32_32x32x16_bf16 a[96:111], v[136:139], v[132:135], a[96:111]
buffer_load_dwordx4 v209, s[20:23], 0 offen offset:2048 lds
ds_read_b128 v[136:139], v2 offset:0
v_exp_f32 v25, v25
v_add_f32 v18, v18, v24
v_mfma_f32_32x32x16_bf16 a[16:31], v[140:143], v[116:119], a[16:31]
v_cvt_pk_bf16_f32 v120, v22, v23
v_fma_f32 v27, v69, s37, v14
v_exp_f32 v26, v26
v_add_f32 v18, v18, v25
v_mfma_f32_32x32x16_bf16 a[112:127], v[140:143], v[132:135], a[112:127]
ds_read_b128 v[140:143], v3 offset:0
v_fma_f32 v22, v70, s37, v14
v_exp_f32 v27, v27
v_add_f32 v18, v18, v26
s_waitcnt lgkmcnt(8)
v_mfma_f32_32x32x16_bf16 a[32:47], v[144:147], v[116:119], a[32:47]
buffer_load_dwordx4 v217, s[20:23], 0 offen offset:3072 lds
s_add_u32 m0, s48, 36864
v_cvt_pk_bf16_f32 v121, v24, v25
v_fma_f32 v23, v71, s37, v14
v_add_f32 v18, v18, v27
s_waitcnt lgkmcnt(7)
v_mfma_f32_16x16x32_bf16 v[180:183], v[224:227], v[192:195], v[180:183]
v_exp_f32 v22, v22
s_waitcnt lgkmcnt(6)
v_mfma_f32_16x16x32_bf16 v[180:183], v[228:231], v[196:199], v[180:183]
s_waitcnt vmcnt(10)
ds_read_b128 v[224:227], v232 offset:4096
ds_read_b128 v[228:231], v233 offset:4096
v_mfma_f32_32x32x16_bf16 a[128:143], v[144:147], v[132:135], a[128:143]
v_fma_f32 v24, v72, s37, v14
v_exp_f32 v23, v23
v_add_f32 v18, v18, v22
v_cvt_pk_bf16_f32 v122, v26, v27
v_mfma_f32_32x32x16_bf16 a[48:63], v[148:151], v[116:119], a[48:63]
buffer_load_dwordx4 v8, s[8:11], s38 offen offset:0 lds
v_fma_f32 v25, v73, s37, v14
v_exp_f32 v24, v24
v_add_f32 v18, v18, v23
v_mfma_f32_32x32x16_bf16 a[144:159], v[148:151], v[132:135], a[144:159]
v_fma_f32 v26, v74, s37, v14
v_exp_f32 v25, v25
v_add_f32 v18, v18, v24
v_cvt_pk_bf16_f32 v123, v22, v23
s_waitcnt lgkmcnt(4)
v_mfma_f32_32x32x16_bf16 a[64:79], v[152:155], v[116:119], a[64:79]
v_fma_f32 v27, v75, s37, v14
v_exp_f32 v26, v26
v_add_f32 v18, v18, v25
v_fma_f32 v22, v76, s37, v14
v_mfma_f32_32x32x16_bf16 a[160:175], v[152:155], v[132:135], a[160:175]
buffer_load_dwordx4 v9, s[8:11], s38 offen offset:1024 lds
v_exp_f32 v27, v27
v_add_f32 v18, v18, v26
v_cvt_pk_bf16_f32 v124, v24, v25
v_mfma_f32_32x32x16_bf16 a[80:95], v[156:159], v[116:119], a[80:95]
v_fma_f32 v23, v77, s37, v14
v_exp_f32 v22, v22
v_add_f32 v18, v18, v27
v_fma_f32 v24, v78, s37, v14
v_exp_f32 v23, v23
ds_read_b128 v[144:147], v4 offset:0
v_mfma_f32_32x32x16_bf16 a[176:191], v[156:159], v[132:135], a[176:191]
v_add_f32 v18, v18, v22
v_fma_f32 v25, v79, s37, v14
v_exp_f32 v24, v24
v_add_f32 v18, v18, v23
v_exp_f32 v25, v25
v_add_f32 v18, v18, v24
v_cvt_pk_bf16_f32 v125, v26, v27
v_cvt_pk_bf16_f32 v126, v22, v23
v_add_f32 v18, v18, v25
v_cvt_pk_bf16_f32 v127, v24, v25
v_cmp_nge_f32 vcc, s52, v18
s_cbranch_vccnz Lst_p3Kl_X
Lct_p3Kl_X:
v_add_f32 v16, v16, v18
s_waitcnt lgkmcnt(3)
v_mfma_f32_32x32x16_bf16 v[64:79], v[136:139], a[192:195], 0
buffer_load_dwordx4 v10, s[8:11], s38 offen offset:2048 lds
ds_read_b128 v[148:151], v5 offset:0
s_add_u32 m0, s49, 12288
ds_read_b128 v[152:155], v2 offset:128
ds_read_b128 v[156:159], v3 offset:128
s_waitcnt lgkmcnt(5)
v_mfma_f32_16x16x32_bf16 v[168:171], v[224:227], v[200:203], v[168:171]
v_add_u32_dpp v212, v246, v236 row_newbcast:0 row_mask:0xf bank_mask:0x3
v_add_u32_dpp v220, v246, v237 row_newbcast:2 row_mask:0xf bank_mask:0x3
s_waitcnt lgkmcnt(4)
v_mfma_f32_16x16x32_bf16 v[168:171], v[228:231], v[204:207], v[168:171]
s_waitcnt vmcnt(11)
ds_read_b128 v[224:227], v232 offset:6144
ds_read_b128 v[228:231], v233 offset:6144
v_mfma_f32_32x32x16_bf16 v[80:95], v[136:139], a[240:243], 0
v_add_u32_dpp v213, v247, v238 row_newbcast:0 row_mask:0xf bank_mask:0x3
v_add_u32_dpp v221, v247, v239 row_newbcast:2 row_mask:0xf bank_mask:0x3
v_add_u32_dpp v214, v248, v236 row_newbcast:0 row_mask:0xf bank_mask:0x3
v_add_u32_dpp v222, v248, v237 row_newbcast:2 row_mask:0xf bank_mask:0x3
v_add_u32_dpp v215, v249, v238 row_newbcast:0 row_mask:0xf bank_mask:0x3
v_mfma_f32_32x32x16_bf16 v[64:79], v[140:143], a[196:199], v[64:79]
buffer_load_dwordx4 v11, s[12:15], s39 offen offset:0 lds
v_add_u32_dpp v223, v249, v239 row_newbcast:2 row_mask:0xf bank_mask:0x3
v_add_u32_dpp v212, v246, v236 row_newbcast:1 row_mask:0xf bank_mask:0xc
v_add_u32_dpp v220, v246, v237 row_newbcast:3 row_mask:0xf bank_mask:0xc
v_add_u32_dpp v213, v247, v238 row_newbcast:1 row_mask:0xf bank_mask:0xc
v_mfma_f32_32x32x16_bf16 v[80:95], v[140:143], a[244:247], v[80:95]
v_add_u32_dpp v221, v247, v239 row_newbcast:3 row_mask:0xf bank_mask:0xc
v_add_u32_dpp v214, v248, v236 row_newbcast:1 row_mask:0xf bank_mask:0xc
v_add_u32_dpp v222, v248, v237 row_newbcast:3 row_mask:0xf bank_mask:0xc
v_add_u32_dpp v215, v249, v238 row_newbcast:1 row_mask:0xf bank_mask:0xc
v_add_u32_dpp v223, v249, v239 row_newbcast:3 row_mask:0xf bank_mask:0xc
s_waitcnt lgkmcnt(4)
v_mfma_f32_32x32x16_bf16 v[64:79], v[144:147], a[200:203], v[64:79]
v_mov_b32_dpp v246, v246 row_ror:12 row_mask:0xf bank_mask:0xf
v_mov_b32_dpp v247, v247 row_ror:12 row_mask:0xf bank_mask:0xf
v_mov_b32_dpp v248, v248 row_ror:12 row_mask:0xf bank_mask:0xf
v_mov_b32_dpp v249, v249 row_ror:12 row_mask:0xf bank_mask:0xf
ds_read_b128 v[136:139], v4 offset:128
v_mfma_f32_32x32x16_bf16 v[80:95], v[144:147], a[248:251], v[80:95]
buffer_load_dwordx4 v12, s[12:15], s39 offen offset:1024 lds
ds_read_b128 v[140:143], v5 offset:128
ds_read_b128 v[144:147], v2 offset:256
v_fma_f32 v22, v96, s37, v15
v_fma_f32 v23, v97, s37, v15
v_mfma_f32_32x32x16_bf16 v[64:79], v[148:151], a[204:207], v[64:79]
v_exp_f32 v22, v22
v_fma_f32 v24, v98, s37, v15
v_exp_f32 v23, v23
v_mfma_f32_32x32x16_bf16 v[80:95], v[148:151], a[252:255], v[80:95]
ds_read_b128 v[148:151], v3 offset:256
v_fma_f32 v25, v99, s37, v15
v_exp_f32 v24, v24
v_add_f32 v19, v22, v23
s_waitcnt lgkmcnt(6)
v_mfma_f32_32x32x16_bf16 v[64:79], v[152:155], a[208:211], v[64:79]
buffer_load_dwordx4 v13, s[12:15], s39 offen offset:2048 lds
s_add_u32 m0, s53, 0
v_fma_f32 v26, v100, s37, v15
v_exp_f32 v25, v25
s_waitcnt lgkmcnt(5)
v_mfma_f32_16x16x32_bf16 v[172:175], v[224:227], v[200:203], v[172:175]
v_add_f32 v19, v19, v24
v_cvt_pk_bf16_f32 v128, v22, v23
s_waitcnt lgkmcnt(4)
v_mfma_f32_16x16x32_bf16 v[172:175], v[228:231], v[204:207], v[172:175]
s_waitcnt vmcnt(12)
ds_read_b128 v[224:227], v232 offset:8192
ds_read_b128 v[228:231], v233 offset:8192
v_mfma_f32_32x32x16_bf16 v[80:95], v[152:155], v[32:35], v[80:95]
ds_read_b128 v[152:155], v4 offset:256
v_fma_f32 v27, v101, s37, v15
v_exp_f32 v26, v26
v_add_f32 v19, v19, v25
v_mfma_f32_32x32x16_bf16 v[64:79], v[156:159], a[212:215], v[64:79]
buffer_load_dwordx4 v210, s[20:23], 0 offen offset:0 lds
v_fma_f32 v22, v102, s37, v15
v_exp_f32 v27, v27
v_cndmask_b32_e64 v240, v168, v169, s[66:67]
v_mfma_f32_32x32x16_bf16 v[80:95], v[156:159], v[36:39], v[80:95]
ds_read_b128 v[156:159], v5 offset:256
v_add_f32 v19, v19, v26
v_cvt_pk_bf16_f32 v129, v24, v25
v_fma_f32 v23, v103, s37, v15
v_cndmask_b32_e64 v240, v240, v170, s[68:69]
s_waitcnt lgkmcnt(6)
v_mfma_f32_32x32x16_bf16 v[64:79], v[136:139], a[216:219], v[64:79]
v_exp_f32 v22, v22
v_add_f32 v19, v19, v27
v_fma_f32 v24, v104, s37, v15
v_cndmask_b32_e64 v240, v240, v171, s[70:71]
v_mfma_f32_32x32x16_bf16 v[80:95], v[136:139], v[40:43], v[80:95]
buffer_load_dwordx4 v218, s[20:23], 0 offen offset:1024 lds
ds_read_b64_tr_b16 v[136:137], v6 offset:36864
ds_read_b64_tr_b16 v[138:139], v6 offset:39936
v_exp_f32 v23, v23
v_mfma_f32_32x32x16_bf16 v[64:79], v[140:143], a[220:223], v[64:79]
v_add_f32 v19, v19, v22
v_cvt_pk_bf16_f32 v130, v26, v27
v_fma_f32 v25, v105, s37, v15
v_exp_f32 v24, v24
v_mfma_f32_32x32x16_bf16 v[80:95], v[140:143], v[44:47], v[80:95]
ds_read_b64_tr_b16 v[140:141], v7 offset:36864
ds_read_b64_tr_b16 v[142:143], v7 offset:39936
v_cndmask_b32_e64 v164, v164, v240, s[72:73]
v_add_f32 v19, v19, v23
v_fma_f32 v26, v106, s37, v15
s_waitcnt lgkmcnt(8)
v_mfma_f32_32x32x16_bf16 v[64:79], v[144:147], a[224:227], v[64:79]
buffer_load_dwordx4 v211, s[20:23], 0 offen offset:2048 lds
v_exp_f32 v25, v25
v_add_f32 v19, v19, v24
v_cvt_pk_bf16_f32 v131, v22, v23
s_waitcnt lgkmcnt(7)
v_mfma_f32_16x16x32_bf16 v[176:179], v[224:227], v[200:203], v[176:179]
v_fma_f32 v27, v107, s37, v15
v_add_f32 v19, v19, v25
s_waitcnt lgkmcnt(6)
v_mfma_f32_16x16x32_bf16 v[176:179], v[228:231], v[204:207], v[176:179]
s_waitcnt vmcnt(13)
ds_read_b128 v[224:227], v232 offset:10240
ds_read_b128 v[228:231], v233 offset:10240
v_mfma_f32_32x32x16_bf16 v[80:95], v[144:147], v[48:51], v[80:95]
ds_read_b64_tr_b16 v[144:145], v6 offset:36992
ds_read_b64_tr_b16 v[146:147], v6 offset:40064
v_exp_f32 v26, v26
v_fma_f32 v22, v108, s37, v15
v_mfma_f32_32x32x16_bf16 v[64:79], v[148:151], a[228:231], v[64:79]
buffer_load_dwordx4 v219, s[20:23], 0 offen offset:3072 lds
s_add_u32 m0, s53, 4096
v_exp_f32 v27, v27
v_add_f32 v19, v19, v26
v_mfma_f32_32x32x16_bf16 v[80:95], v[148:151], v[52:55], v[80:95]
ds_read_b64_tr_b16 v[148:149], v7 offset:36992
ds_read_b64_tr_b16 v[150:151], v7 offset:40064
v_cvt_pk_bf16_f32 v132, v24, v25
v_fma_f32 v23, v109, s37, v15
v_add_f32 v19, v19, v27
s_waitcnt lgkmcnt(10)
v_mfma_f32_32x32x16_bf16 v[64:79], v[152:155], a[232:235], v[64:79]
s_barrier
v_exp_f32 v22, v22
v_fma_f32 v24, v110, s37, v15
v_exp_f32 v23, v23
v_mfma_f32_32x32x16_bf16 v[80:95], v[152:155], v[56:59], v[80:95]
buffer_load_dwordx4 v212, s[20:23], 0 offen offset:0 lds
v_add_f32 v19, v19, v22
v_fma_f32 v25, v111, s37, v15
v_exp_f32 v24, v24
v_mfma_f32_32x32x16_bf16 v[64:79], v[156:159], a[236:239], v[64:79]
v_add_f32 v19, v19, v23
v_exp_f32 v25, v25
v_cndmask_b32_e64 v240, v172, v173, s[66:67]
v_add_f32 v19, v19, v24
v_mfma_f32_32x32x16_bf16 v[80:95], v[156:159], v[60:63], v[80:95]
buffer_load_dwordx4 v220, s[20:23], 0 offen offset:1024 lds
buffer_load_dwordx4 v213, s[20:23], 0 offen offset:2048 lds
buffer_load_dwordx4 v221, s[20:23], 0 offen offset:3072 lds
v_cndmask_b32_e64 v240, v240, v174, s[68:69]
v_cvt_pk_bf16_f32 v133, v26, v27
v_cvt_pk_bf16_f32 v134, v22, v23
v_add_f32 v19, v19, v25
v_cvt_pk_bf16_f32 v135, v24, v25
v_cndmask_b32_e64 v240, v240, v175, s[70:71]
s_add_u32 s38, s38, s78
s_add_u32 s99, s99, 4
s_cmp_eq_u32 s99, s40
s_cselect_b32 s38, s88, s38
s_cselect_b32 s78, -12288, s78
s_cmp_eq_u32 s99, 28
s_cselect_b32 s38, s41, s38
s_cselect_b32 s78, 12288, s78
s_add_u32 s39, s39, s98
v_cndmask_b32_e64 v165, v165, v240, s[72:73]
v_cmp_nge_f32 vcc, s52, v19
s_cbranch_vccnz Lst_p3Kl_Y
Lct_p3Kl_Y:
v_add_f32 v17, v17, v19
s_add_u32 s42, s42, 1
s_waitcnt lgkmcnt(4)
v_mfma_f32_16x16x32_bf16 v[180:183], v[224:227], v[200:203], v[180:183]
v_mfma_f32_16x16x32_bf16 v[180:183], v[228:231], v[204:207], v[180:183]
s_nop 7
v_cndmask_b32_e64 v240, v176, v177, s[66:67]
v_cndmask_b32_e64 v240, v240, v178, s[68:69]
v_cndmask_b32_e64 v240, v240, v179, s[70:71]
v_cndmask_b32_e64 v166, v166, v240, s[72:73]
v_cndmask_b32_e64 v240, v180, v181, s[66:67]
v_cndmask_b32_e64 v240, v240, v182, s[68:69]
v_cndmask_b32_e64 v240, v240, v183, s[70:71]
v_cndmask_b32_e64 v167, v167, v240, s[72:73]
v_max3_f32 v22, v160, v161, v162
v_max3_f32 v22, v22, v163, v164
v_max3_f32 v22, v22, v165, v166
v_max_f32 v22, v22, v167
v_mul_f32_e64 v22, -v22, s37
v_fma_f32 v160, v160, s37, v22
v_fma_f32 v161, v161, s37, v22
v_fma_f32 v162, v162, s37, v22
v_fma_f32 v163, v163, s37, v22
v_fma_f32 v164, v164, s37, v22
v_fma_f32 v165, v165, s37, v22
v_fma_f32 v166, v166, s37, v22
v_fma_f32 v167, v167, s37, v22
v_exp_f32 v160, v160
v_exp_f32 v161, v161
v_exp_f32 v162, v162
v_exp_f32 v163, v163
v_exp_f32 v164, v164
v_exp_f32 v165, v165
v_exp_f32 v166, v166
v_exp_f32 v167, v167
s_nop 0
v_add_f32 v23, v160, v161
v_add_f32 v23, v23, v162
v_add_f32 v23, v23, v163
v_add_f32 v23, v23, v164
v_add_f32 v23, v23, v165
v_add_f32 v23, v23, v166
v_add_f32 v23, v23, v167
v_rcp_f32 v23, v23
s_nop 0
v_mul_f32 v23, s50, v23
v_mul_f32 v160, v160, v23
v_mul_f32 v161, v161, v23
v_mul_f32 v162, v162, v23
v_mul_f32 v163, v163, v23
v_mul_f32 v164, v164, v23
v_mul_f32 v165, v165, v23
v_mul_f32 v166, v166, v23
v_mul_f32 v167, v167, v23
v_cvt_pk_bf16_f32 v160, v160, v160
v_cvt_pk_bf16_f32 v161, v161, v161
v_cvt_pk_bf16_f32 v162, v162, v162
v_cvt_pk_bf16_f32 v163, v163, v163
v_cvt_pk_bf16_f32 v164, v164, v164
v_cvt_pk_bf16_f32 v165, v165, v165
v_cvt_pk_bf16_f32 v166, v166, v166
v_cvt_pk_bf16_f32 v167, v167, v167
v_lshrrev_b32 v22, 2, v1
v_lshrrev_b32 v23, 3, v22
v_lshlrev_b32 v23, 10, v23
v_and_b32 v24, 7, v22
v_lshl_add_u32 v23, v24, 7, v23
v_bfe_u32 v24, v1, 1, 1
v_lshl_add_u32 v23, v24, 3, v23
v_add_u32 v23, s53, v23
v_bfe_u32 v24, v22, 1, 2
v_lshlrev_b32 v24, 1, v24
v_and_b32 v25, 1, v1
v_or_b32 v24, v24, v25
v_xor_b32 v25, 0, v24
v_lshl_add_u32 v232, v25, 4, v23
v_xor_b32 v25, 2, v24
v_lshl_add_u32 v233, v25, 4, v23
v_xor_b32 v25, 4, v24
v_lshl_add_u32 v234, v25, 4, v23
v_xor_b32 v25, 6, v24
v_lshl_add_u32 v235, v25, 4, v23
v_mov_b32 v22, 0xffff
v_mov_b32 v23, 0xffff0000
v_cndmask_b32_e64 v240, 0, v22, s[64:65]
v_cndmask_b32_e64 v240, v240, v23, s[66:67]
v_cndmask_b32_e64 v241, 0, v22, s[68:69]
v_cndmask_b32_e64 v241, v241, v23, s[70:71]
s_mov_b32 s87, 0
s_lshl_b32 s77, s87, 2
s_lshr_b32 s84, s87, 1
s_and_b32 s85, s87, 1
s_lshl_b32 s86, s45, 8
s_lshl_b32 s63, s36, 5
s_add_u32 s86, s86, s63
s_lshl_b32 s84, s84, 7
s_add_u32 s86, s86, s84
s_lshl_b32 s85, s85, 4
s_add_u32 s86, s86, s85
s_mul_i32 s79, s86, 384
s_lshr_b32 s63, s77, 2
v_cmp_eq_u32_e64 s[72:73], s63, v253
s_nop 1
v_cndmask_b32_e64 v250, 0, v240, s[72:73]
v_cndmask_b32_e64 v251, 0, v241, s[72:73]
v_and_b32 v192, v160, v250
v_and_b32 v193, v160, v251
v_and_b32 v194, v161, v250
v_and_b32 v195, v161, v251
v_and_b32 v196, v162, v250
v_and_b32 v197, v162, v251
v_and_b32 v198, v163, v250
v_and_b32 v199, v163, v251
v_and_b32 v200, v164, v250
v_and_b32 v201, v164, v251
v_and_b32 v202, v165, v250
v_and_b32 v203, v165, v251
s_add_u32 s75, s47, 18432
s_mov_b32 s87, 0
s_add_u32 s74, s75, 4096
s_mul_i32 s75, s87, 6144
s_add_u32 s75, s75, s47
s_add_u32 s87, s87, 1
s_lshl_b32 s77, s87, 2
s_lshr_b32 s84, s87, 1
s_and_b32 s85, s87, 1
s_lshl_b32 s86, s45, 8
s_lshl_b32 s63, s36, 5
s_add_u32 s86, s86, s63
s_lshl_b32 s84, s84, 7
s_add_u32 s86, s86, s84
s_lshl_b32 s85, s85, 4
s_add_u32 s86, s86, s85
s_mul_i32 s79, s86, 384
s_branch L_p0_V
L_d0:
v_and_b32 v20, 31, v1
v_lshrrev_b32 v30, 5, v1
v_lshlrev_b32 v30, 2, v30
v_sub_u32 v20, v20, v30
s_lshl_b32 s84, s36, 5
v_add_u32 v20, s84, v20
s_waitcnt lgkmcnt(8)
v_mfma_f32_32x32x16_bf16 a[0:15], v[136:139], v[120:123], a[0:15]
ds_read_b64_tr_b16 v[152:153], v6 offset:37120
ds_read_b64_tr_b16 v[154:155], v6 offset:40192
ds_read_b64_tr_b16 v[156:157], v7 offset:37120
ds_read_b64_tr_b16 v[158:159], v7 offset:40192
s_waitcnt lgkmcnt(10)
v_mfma_f32_16x16x32_bf16 v[176:179], v[224:227], v[204:207], v[176:179]
s_waitcnt lgkmcnt(8)
v_mfma_f32_16x16x32_bf16 v[180:183], v[228:231], v[204:207], v[180:183]
s_waitcnt vmcnt(14)
ds_read_b64_tr_b16 v[224:225], v232 offset:12288
ds_read_b64_tr_b16 v[226:227], v232 offset:14336
v_mfma_f32_32x32x16_bf16 a[96:111], v[136:139], v[128:131], a[96:111]
ds_read_b64_tr_b16 v[228:229], v233 offset:12288
ds_read_b64_tr_b16 v[230:231], v233 offset:14336
ds_read_b64_tr_b16 v[136:137], v6 offset:43008
ds_read_b64_tr_b16 v[138:139], v6 offset:46080
v_cvt_pk_bf16_f32 v184, v168, v169
v_mfma_f32_32x32x16_bf16 a[16:31], v[140:143], v[120:123], a[16:31]
v_cvt_pk_bf16_f32 v185, v170, v171
v_cvt_pk_bf16_f32 v186, v172, v173
v_cvt_pk_bf16_f32 v187, v174, v175
s_add_u32 m0, s53, 8192
v_lshlrev_b32 v254, 4, v1
v_mfma_f32_32x32x16_bf16 a[112:127], v[140:143], v[128:131], a[112:127]
ds_read_b64_tr_b16 v[140:141], v7 offset:43008
ds_read_b64_tr_b16 v[142:143], v7 offset:46080
buffer_load_dwordx4 v214, s[20:23], 0 offen offset:0 lds
v_cmp_gt_i32_e64 s[54:55], 0, v20
v_cmp_gt_i32_e64 s[56:57], 1, v20
s_waitcnt lgkmcnt(12)
v_mfma_f32_32x32x16_bf16 a[32:47], v[144:147], v[120:123], a[32:47]
v_cmp_gt_i32_e64 s[58:59], 2, v20
v_cndmask_b32_e64 v64, v64, v21, s[54:55]
v_cndmask_b32_e64 v65, v65, v21, s[56:57]
v_cmp_gt_i32_e64 s[54:55], 3, v20
v_cndmask_b32_e64 v66, v66, v21, s[58:59]
v_mfma_f32_32x32x16_bf16 a[128:143], v[144:147], v[128:131], a[128:143]
ds_read_b64_tr_b16 v[144:145], v6 offset:43136
ds_read_b64_tr_b16 v[146:147], v6 offset:46208
v_fma_f32 v22, v64, s37, v14
v_fma_f32 v23, v65, s37, v14
v_cmp_gt_i32_e64 s[56:57], 8, v20
v_mfma_f32_32x32x16_bf16 a[48:63], v[148:151], v[120:123], a[48:63]
buffer_load_dwordx4 v222, s[20:23], 0 offen offset:1024 lds
v_cndmask_b32_e64 v67, v67, v21, s[54:55]
v_exp_f32 v22, v22
v_fma_f32 v24, v66, s37, v14
v_mfma_f32_32x32x16_bf16 a[144:159], v[148:151], v[128:131], a[144:159]
ds_read_b64_tr_b16 v[148:149], v7 offset:43136
ds_read_b64_tr_b16 v[150:151], v7 offset:46208
v_exp_f32 v23, v23
v_cmp_gt_i32_e64 s[58:59], 9, v20
s_waitcnt lgkmcnt(12)
v_mfma_f32_32x32x16_bf16 a[64:79], v[152:155], v[120:123], a[64:79]
v_cndmask_b32_e64 v68, v68, v21, s[56:57]
v_fma_f32 v25, v67, s37, v14
v_exp_f32 v24, v24
v_cmp_gt_i32_e64 s[54:55], 10, v20
s_waitcnt lgkmcnt(10)
v_mfma_f32_16x16x32_bf16 v[168:171], v[224:227], v[192:195], 0
buffer_load_dwordx4 v215, s[20:23], 0 offen offset:2048 lds
v_cndmask_b32_e64 v69, v69, v21, s[58:59]
s_waitcnt lgkmcnt(8)
v_mfma_f32_16x16x32_bf16 v[172:175], v[228:231], v[192:195], 0
ds_read_b64_tr_b16 v[224:225], v234 offset:12288
ds_read_b64_tr_b16 v[226:227], v234 offset:14336
v_mfma_f32_32x32x16_bf16 a[160:175], v[152:155], v[128:131], a[160:175]
ds_read_b64_tr_b16 v[228:229], v235 offset:12288
ds_read_b64_tr_b16 v[230:231], v235 offset:14336
ds_read_b64_tr_b16 v[152:153], v6 offset:43264
ds_read_b64_tr_b16 v[154:155], v6 offset:46336
v_cvt_pk_bf16_f32 v188, v176, v177
v_mfma_f32_32x32x16_bf16 a[80:95], v[156:159], v[120:123], a[80:95]
buffer_load_dwordx4 v223, s[20:23], 0 offen offset:3072 lds
v_cvt_pk_bf16_f32 v189, v178, v179
v_cvt_pk_bf16_f32 v190, v180, v181
v_cvt_pk_bf16_f32 v191, v182, v183
v_add_f32 v18, v22, v23
v_mfma_f32_32x32x16_bf16 a[176:191], v[156:159], v[128:131], a[176:191]
ds_read_b64_tr_b16 v[156:157], v7 offset:43264
ds_read_b64_tr_b16 v[158:159], v7 offset:46336
v_fma_f32 v26, v68, s37, v14
v_exp_f32 v25, v25
s_waitcnt lgkmcnt(12)
v_mfma_f32_32x32x16_bf16 a[0:15], v[136:139], v[124:127], a[0:15]
v_cmp_gt_i32_e64 s[56:57], 11, v20
v_cndmask_b32_e64 v70, v70, v21, s[54:55]
v_add_f32 v18, v18, v24
v_cvt_pk_bf16_f32 v112, v22, v23
v_fma_f32 v27, v69, s37, v14
v_mfma_f32_32x32x16_bf16 a[96:111], v[136:139], v[132:135], a[96:111]
buffer_store_dwordx4 v[184:187], v254, s[32:35], s74 offen offset:0
ds_read_b128 v[136:139], v2 offset:12288
v_exp_f32 v26, v26
v_cmp_gt_i32_e64 s[58:59], 16, v20
v_mfma_f32_32x32x16_bf16 a[16:31], v[140:143], v[124:127], a[16:31]
v_cndmask_b32_e64 v71, v71, v21, s[56:57]
v_add_f32 v18, v18, v25
v_fma_f32 v22, v70, s37, v14
v_exp_f32 v27, v27
v_mfma_f32_32x32x16_bf16 a[112:127], v[140:143], v[132:135], a[112:127]
ds_read_b128 v[140:143], v3 offset:12288
s_add_u32 m0, s48, 0
v_cmp_gt_i32_e64 s[54:55], 17, v20
v_cndmask_b32_e64 v72, v72, v21, s[58:59]
v_add_f32 v18, v18, v26
s_waitcnt lgkmcnt(10)
v_mfma_f32_32x32x16_bf16 a[32:47], v[144:147], v[124:127], a[32:47]
v_cvt_pk_bf16_f32 v113, v24, v25
v_fma_f32 v23, v71, s37, v14
v_exp_f32 v22, v22
buffer_load_dwordx4 v8, s[8:11], s38 offen offset:0 nt lds
s_waitcnt lgkmcnt(8)
v_mfma_f32_16x16x32_bf16 v[176:179], v[224:227], v[192:195], 0
v_cmp_gt_i32_e64 s[56:57], 18, v20
v_cndmask_b32_e64 v73, v73, v21, s[54:55]
s_waitcnt lgkmcnt(6)
v_mfma_f32_16x16x32_bf16 v[180:183], v[228:231], v[192:195], 0
s_waitcnt vmcnt(10)
ds_read_b64_tr_b16 v[224:225], v232 offset:0
ds_read_b64_tr_b16 v[226:227], v232 offset:2048
v_mfma_f32_32x32x16_bf16 a[128:143], v[144:147], v[132:135], a[128:143]
ds_read_b64_tr_b16 v[228:229], v233 offset:0
ds_read_b64_tr_b16 v[230:231], v233 offset:2048
v_add_f32 v18, v18, v27
v_fma_f32 v24, v72, s37, v14
v_lshlrev_b32 v254, 4, v1
v_mfma_f32_32x32x16_bf16 a[48:63], v[148:151], v[124:127], a[48:63]
v_exp_f32 v23, v23
buffer_load_dwordx4 v9, s[8:11], s38 offen offset:1024 nt lds
v_cmp_gt_i32_e64 s[58:59], 19, v20
v_cndmask_b32_e64 v74, v74, v21, s[56:57]
v_mfma_f32_32x32x16_bf16 a[144:159], v[148:151], v[132:135], a[144:159]
v_add_f32 v18, v18, v22
v_cvt_pk_bf16_f32 v114, v26, v27
v_fma_f32 v25, v73, s37, v14
v_exp_f32 v24, v24
s_waitcnt lgkmcnt(6)
v_mfma_f32_32x32x16_bf16 a[64:79], v[152:155], v[124:127], a[64:79]
v_and_b32 v204, v166, v250
v_and_b32 v205, v166, v251
v_and_b32 v206, v167, v250
v_and_b32 v207, v167, v251
v_cmp_gt_i32_e64 s[54:55], 24, v20
v_mfma_f32_32x32x16_bf16 a[160:175], v[152:155], v[132:135], a[160:175]
buffer_load_dwordx4 v10, s[8:11], s38 offen offset:2048 nt lds
v_cndmask_b32_e64 v75, v75, v21, s[58:59]
v_add_f32 v18, v18, v23
v_fma_f32 v26, v74, s37, v14
v_exp_f32 v25, v25
v_mfma_f32_32x32x16_bf16 a[80:95], v[156:159], v[124:127], a[80:95]
v_cmp_gt_i32_e64 s[56:57], 25, v20
v_cndmask_b32_e64 v76, v76, v21, s[54:55]
v_add_f32 v18, v18, v24
v_cvt_pk_bf16_f32 v115, v22, v23
v_fma_f32 v27, v75, s37, v14
v_exp_f32 v26, v26
v_cmp_gt_i32_e64 s[58:59], 26, v20
v_cndmask_b32_e64 v77, v77, v21, s[56:57]
v_add_f32 v18, v18, v25
v_fma_f32 v22, v76, s37, v14
v_exp_f32 v27, v27
v_cmp_gt_i32_e64 s[54:55], 27, v20
v_cndmask_b32_e64 v78, v78, v21, s[58:59]
v_add_f32 v18, v18, v26
v_cvt_pk_bf16_f32 v116, v24, v25
v_fma_f32 v23, v77, s37, v14
v_exp_f32 v22, v22
v_cndmask_b32_e64 v79, v79, v21, s[54:55]
v_add_f32 v18, v18, v27
v_fma_f32 v24, v78, s37, v14
v_exp_f32 v23, v23
ds_read_b128 v[144:147], v4 offset:12288
v_mfma_f32_32x32x16_bf16 a[176:191], v[156:159], v[132:135], a[176:191]
v_add_f32 v18, v18, v22
v_fma_f32 v25, v79, s37, v14
v_exp_f32 v24, v24
v_add_f32 v18, v18, v23
v_exp_f32 v25, v25
v_add_f32 v18, v18, v24
v_cvt_pk_bf16_f32 v117, v26, v27
v_cvt_pk_bf16_f32 v118, v22, v23
v_add_f32 v18, v18, v25
v_cvt_pk_bf16_f32 v119, v24, v25
v_cmp_nge_f32 vcc, s52, v18
s_cbranch_vccnz Lst_d0_X
Lct_d0_X:
v_add_f32 v16, v16, v18
s_waitcnt lgkmcnt(5)
v_mfma_f32_32x32x16_bf16 v[64:79], v[136:139], a[192:195], 0
buffer_store_dwordx4 v[188:191], v254, s[32:35], s74 offen offset:1024
ds_read_b128 v[148:151], v5 offset:12288
s_add_u32 m0, s49, 24576
ds_read_b128 v[152:155], v2 offset:12416
ds_read_b128 v[156:159], v3 offset:12416
s_waitcnt lgkmcnt(6)
v_mfma_f32_16x16x32_bf16 v[168:171], v[224:227], v[196:199], v[168:171]
v_fma_f32 v22, v80, s37, v15
v_fma_f32 v23, v81, s37, v15
s_waitcnt lgkmcnt(4)
v_mfma_f32_16x16x32_bf16 v[172:175], v[228:231], v[196:199], v[172:175]
ds_read_b64_tr_b16 v[224:225], v234 offset:0
ds_read_b64_tr_b16 v[226:227], v234 offset:2048
v_mfma_f32_32x32x16_bf16 v[96:111], v[136:139], a[240:243], 0
ds_read_b64_tr_b16 v[228:229], v235 offset:0
ds_read_b64_tr_b16 v[230:231], v235 offset:2048
ds_read_b128 v[136:139], v4 offset:12416
v_exp_f32 v22, v22
v_mfma_f32_32x32x16_bf16 v[64:79], v[140:143], a[196:199], v[64:79]
buffer_load_dwordx4 v11, s[12:15], s39 offen offset:0 nt lds
v_fma_f32 v24, v82, s37, v15
v_exp_f32 v23, v23
v_fma_f32 v25, v83, s37, v15
v_mfma_f32_32x32x16_bf16 v[96:111], v[140:143], a[244:247], v[96:111]
ds_read_b128 v[140:143], v5 offset:12416
v_exp_f32 v24, v24
v_add_f32 v19, v22, v23
v_fma_f32 v26, v84, s37, v15
s_waitcnt lgkmcnt(8)
v_mfma_f32_32x32x16_bf16 v[64:79], v[144:147], a[200:203], v[64:79]
v_exp_f32 v25, v25
v_add_f32 v19, v19, v24
v_cvt_pk_bf16_f32 v128, v22, v23
v_fma_f32 v27, v85, s37, v15
v_mfma_f32_32x32x16_bf16 v[96:111], v[144:147], a[248:251], v[96:111]
buffer_load_dwordx4 v12, s[12:15], s39 offen offset:1024 nt lds
ds_read_b128 v[144:147], v2 offset:12544
v_exp_f32 v26, v26
v_add_f32 v19, v19, v25
v_mfma_f32_32x32x16_bf16 v[64:79], v[148:151], a[204:207], v[64:79]
v_fma_f32 v22, v86, s37, v15
v_exp_f32 v27, v27
v_add_f32 v19, v19, v26
v_cvt_pk_bf16_f32 v129, v24, v25
v_mfma_f32_32x32x16_bf16 v[96:111], v[148:151], a[252:255], v[96:111]
ds_read_b128 v[148:151], v3 offset:12544
v_fma_f32 v23, v87, s37, v15
v_exp_f32 v22, v22
v_add_f32 v19, v19, v27
s_waitcnt lgkmcnt(8)
v_mfma_f32_32x32x16_bf16 v[64:79], v[152:155], a[208:211], v[64:79]
buffer_load_dwordx4 v13, s[12:15], s39 offen offset:2048 nt lds
s_add_u32 m0, s53, 12160
v_fma_f32 v24, v88, s37, v15
v_exp_f32 v23, v23
s_waitcnt lgkmcnt(6)
v_mfma_f32_16x16x32_bf16 v[176:179], v[224:227], v[196:199], v[176:179]
v_add_f32 v19, v19, v22
v_cvt_pk_bf16_f32 v130, v26, v27
s_waitcnt lgkmcnt(4)
v_mfma_f32_16x16x32_bf16 v[180:183], v[228:231], v[196:199], v[180:183]
s_waitcnt vmcnt(12)
ds_read_b64_tr_b16 v[224:225], v232 offset:4096
ds_read_b64_tr_b16 v[226:227], v232 offset:6144
v_mfma_f32_32x32x16_bf16 v[96:111], v[152:155], v[32:35], v[96:111]
ds_read_b64_tr_b16 v[228:229], v233 offset:4096
ds_read_b64_tr_b16 v[230:231], v233 offset:6144
ds_read_b128 v[152:155], v4 offset:12544
v_fma_f32 v25, v89, s37, v15
v_add_f32 v19, v19, v23
v_mfma_f32_32x32x16_bf16 v[64:79], v[156:159], a[212:215], v[64:79]
buffer_load_dwordx4 v208, s[20:23], 0 offen offset:128 lds
v_exp_f32 v24, v24
v_fma_f32 v26, v90, s37, v15
v_add_f32 v19, v19, v24
v_mfma_f32_32x32x16_bf16 v[96:111], v[156:159], v[36:39], v[96:111]
ds_read_b128 v[156:159], v5 offset:12544
v_exp_f32 v25, v25
v_cvt_pk_bf16_f32 v131, v22, v23
v_fma_f32 v27, v91, s37, v15
s_waitcnt lgkmcnt(8)
v_mfma_f32_32x32x16_bf16 v[64:79], v[136:139], a[216:219], v[64:79]
v_exp_f32 v26, v26
v_add_f32 v19, v19, v25
v_fma_f32 v22, v92, s37, v15
v_add_f32 v19, v19, v26
v_mfma_f32_32x32x16_bf16 v[96:111], v[136:139], v[40:43], v[96:111]
buffer_load_dwordx4 v216, s[20:23], 0 offen offset:1152 lds
ds_read_b64_tr_b16 v[136:137], v6 offset:0
ds_read_b64_tr_b16 v[138:139], v6 offset:3072
v_exp_f32 v27, v27
v_mfma_f32_32x32x16_bf16 v[64:79], v[140:143], a[220:223], v[64:79]
v_cvt_pk_bf16_f32 v132, v24, v25
v_fma_f32 v23, v93, s37, v15
v_exp_f32 v22, v22
v_add_f32 v19, v19, v27
v_mfma_f32_32x32x16_bf16 v[96:111], v[140:143], v[44:47], v[96:111]
ds_read_b64_tr_b16 v[140:141], v7 offset:0
ds_read_b64_tr_b16 v[142:143], v7 offset:3072
v_fma_f32 v24, v94, s37, v15
v_exp_f32 v23, v23
s_waitcnt lgkmcnt(10)
v_mfma_f32_32x32x16_bf16 v[64:79], v[144:147], a[224:227], v[64:79]
buffer_load_dwordx4 v209, s[20:23], 0 offen offset:2176 lds
v_add_f32 v19, v19, v22
v_fma_f32 v25, v95, s37, v15
v_exp_f32 v24, v24
s_waitcnt lgkmcnt(8)
v_mfma_f32_16x16x32_bf16 v[168:171], v[224:227], v[200:203], v[168:171]
v_add_f32 v19, v19, v23
v_add_f32 v19, v19, v24
s_waitcnt lgkmcnt(6)
v_mfma_f32_16x16x32_bf16 v[172:175], v[228:231], v[200:203], v[172:175]
ds_read_b64_tr_b16 v[224:225], v234 offset:4096
ds_read_b64_tr_b16 v[226:227], v234 offset:6144
v_mfma_f32_32x32x16_bf16 v[96:111], v[144:147], v[48:51], v[96:111]
ds_read_b64_tr_b16 v[228:229], v235 offset:4096
ds_read_b64_tr_b16 v[230:231], v235 offset:6144
ds_read_b64_tr_b16 v[144:145], v6 offset:128
ds_read_b64_tr_b16 v[146:147], v6 offset:3200
v_cvt_pk_bf16_f32 v133, v26, v27
v_mfma_f32_32x32x16_bf16 v[64:79], v[148:151], a[228:231], v[64:79]
buffer_load_dwordx4 v217, s[20:23], 0 offen offset:3200 lds
s_sub_u32 m0, s53, 128
v_exp_f32 v25, v25
v_cvt_pk_bf16_f32 v134, v22, v23
v_mfma_f32_32x32x16_bf16 v[96:111], v[148:151], v[52:55], v[96:111]
ds_read_b64_tr_b16 v[148:149], v7 offset:128
ds_read_b64_tr_b16 v[150:151], v7 offset:3200
v_add_f32 v19, v19, v25
v_cvt_pk_bf16_f32 v135, v24, v25
v_add_u32 v20, -32, v20
s_waitcnt lgkmcnt(12)
v_mfma_f32_32x32x16_bf16 v[64:79], v[152:155], a[232:235], v[64:79]
s_barrier
s_add_u32 s38, s38, s78
s_add_u32 s39, s39, s98
v_cmp_nge_f32 vcc, s52, v19
s_cbranch_vccnz Lst_d0_Y
Lct_d0_Y:
v_add_f32 v17, v17, v19
v_mfma_f32_32x32x16_bf16 v[96:111], v[152:155], v[56:59], v[96:111]
buffer_load_dwordx4 v210, s[20:23], 0 offen offset:128 lds
v_mfma_f32_32x32x16_bf16 v[64:79], v[156:159], a[236:239], v[64:79]
v_mfma_f32_32x32x16_bf16 v[96:111], v[156:159], v[60:63], v[96:111]
buffer_load_dwordx4 v218, s[20:23], 0 offen offset:1152 lds
buffer_load_dwordx4 v211, s[20:23], 0 offen offset:2176 lds
buffer_load_dwordx4 v219, s[20:23], 0 offen offset:3200 lds
L_d1:
s_waitcnt lgkmcnt(8)
v_mfma_f32_32x32x16_bf16 a[0:15], v[136:139], v[112:115], a[0:15]
ds_read_b64_tr_b16 v[152:153], v6 offset:256
ds_read_b64_tr_b16 v[154:155], v6 offset:3328
ds_read_b64_tr_b16 v[156:157], v7 offset:256
ds_read_b64_tr_b16 v[158:159], v7 offset:3328
s_waitcnt lgkmcnt(6)
v_mfma_f32_16x16x32_bf16 v[176:179], v[224:227], v[200:203], v[176:179]
s_waitcnt lgkmcnt(4)
v_mfma_f32_16x16x32_bf16 v[180:183], v[228:231], v[200:203], v[180:183]
s_waitcnt vmcnt(16)
ds_read_b64_tr_b16 v[224:225], v232 offset:8192
ds_read_b64_tr_b16 v[226:227], v232 offset:10240
v_mfma_f32_32x32x16_bf16 a[96:111], v[136:139], v[128:131], a[96:111]
ds_read_b64_tr_b16 v[228:229], v233 offset:8192
ds_read_b64_tr_b16 v[230:231], v233 offset:10240
ds_read_b64_tr_b16 v[136:137], v6 offset:6144
ds_read_b64_tr_b16 v[138:139], v6 offset:9216
s_add_u32 m0, s53, 3968
v_mfma_f32_32x32x16_bf16 a[16:31], v[140:143], v[112:115], a[16:31]
buffer_load_dwordx4 v212, s[20:23], 0 offen offset:128 lds
v_cmp_gt_i32_e64 s[54:55], 0, v20
v_cmp_gt_i32_e64 s[56:57], 1, v20
v_cmp_gt_i32_e64 s[58:59], 2, v20
v_cndmask_b32_e64 v64, v64, v21, s[54:55]
v_mfma_f32_32x32x16_bf16 a[112:127], v[140:143], v[128:131], a[112:127]
ds_read_b64_tr_b16 v[140:141], v7 offset:6144
ds_read_b64_tr_b16 v[142:143], v7 offset:9216
v_cndmask_b32_e64 v65, v65, v21, s[56:57]
v_cmp_gt_i32_e64 s[54:55], 3, v20
v_cndmask_b32_e64 v66, v66, v21, s[58:59]
s_waitcnt lgkmcnt(12)
v_mfma_f32_32x32x16_bf16 a[32:47], v[144:147], v[112:115], a[32:47]
v_fma_f32 v22, v64, s37, v14
v_fma_f32 v23, v65, s37, v14
v_cmp_gt_i32_e64 s[56:57], 8, v20
v_cndmask_b32_e64 v67, v67, v21, s[54:55]
v_fma_f32 v24, v66, s37, v14
v_mfma_f32_32x32x16_bf16 a[128:143], v[144:147], v[128:131], a[128:143]
buffer_load_dwordx4 v220, s[20:23], 0 offen offset:1152 lds
ds_read_b64_tr_b16 v[144:145], v6 offset:6272
ds_read_b64_tr_b16 v[146:147], v6 offset:9344
v_exp_f32 v22, v22
v_mfma_f32_32x32x16_bf16 a[48:63], v[148:151], v[112:115], a[48:63]
v_exp_f32 v23, v23
v_cmp_gt_i32_e64 s[58:59], 9, v20
v_cndmask_b32_e64 v68, v68, v21, s[56:57]
v_fma_f32 v25, v67, s37, v14
v_mfma_f32_32x32x16_bf16 a[144:159], v[148:151], v[128:131], a[144:159]
ds_read_b64_tr_b16 v[148:149], v7 offset:6272
ds_read_b64_tr_b16 v[150:151], v7 offset:9344
v_exp_f32 v24, v24
v_cmp_gt_i32_e64 s[54:55], 10, v20
s_waitcnt lgkmcnt(12)
v_mfma_f32_32x32x16_bf16 a[64:79], v[152:155], v[112:115], a[64:79]
buffer_load_dwordx4 v213, s[20:23], 0 offen offset:2176 lds
v_cndmask_b32_e64 v69, v69, v21, s[58:59]
v_add_f32 v18, v22, v23
v_fma_f32 v26, v68, s37, v14
v_cmp_gt_i32_e64 s[56:57], 11, v20
s_waitcnt lgkmcnt(10)
v_mfma_f32_16x16x32_bf16 v[168:171], v[224:227], v[204:207], v[168:171]
v_exp_f32 v25, v25
s_waitcnt lgkmcnt(8)
v_mfma_f32_16x16x32_bf16 v[172:175], v[228:231], v[204:207], v[172:175]
ds_read_b64_tr_b16 v[224:225], v234 offset:8192
ds_read_b64_tr_b16 v[226:227], v234 offset:10240
v_mfma_f32_32x32x16_bf16 a[160:175], v[152:155], v[128:131], a[160:175]
ds_read_b64_tr_b16 v[228:229], v235 offset:8192
ds_read_b64_tr_b16 v[230:231], v235 offset:10240
ds_read_b64_tr_b16 v[152:153], v6 offset:6400
ds_read_b64_tr_b16 v[154:155], v6 offset:9472
v_cndmask_b32_e64 v70, v70, v21, s[54:55]
v_mfma_f32_32x32x16_bf16 a[80:95], v[156:159], v[112:115], a[80:95]
buffer_load_dwordx4 v221, s[20:23], 0 offen offset:3200 lds
v_add_f32 v18, v18, v24
v_cvt_pk_bf16_f32 v120, v22, v23
v_fma_f32 v27, v69, s37, v14
v_cmp_gt_i32_e64 s[58:59], 16, v20
v_mfma_f32_32x32x16_bf16 a[176:191], v[156:159], v[128:131], a[176:191]
ds_read_b64_tr_b16 v[156:157], v7 offset:6400
ds_read_b64_tr_b16 v[158:159], v7 offset:9472
v_exp_f32 v26, v26
v_cndmask_b32_e64 v71, v71, v21, s[56:57]
s_waitcnt lgkmcnt(12)
v_mfma_f32_32x32x16_bf16 a[0:15], v[136:139], v[116:119], a[0:15]
v_add_f32 v18, v18, v25
v_fma_f32 v22, v70, s37, v14
v_exp_f32 v27, v27
s_add_u32 m0, s48, 12288
v_mfma_f32_32x32x16_bf16 a[96:111], v[136:139], v[132:135], a[96:111]
ds_read_b128 v[136:139], v2 offset:24576
v_cmp_gt_i32_e64 s[54:55], 17, v20
v_cndmask_b32_e64 v72, v72, v21, s[58:59]
v_add_f32 v18, v18, v26
v_cvt_pk_bf16_f32 v121, v24, v25
v_mfma_f32_32x32x16_bf16 a[16:31], v[140:143], v[116:119], a[16:31]
v_fma_f32 v23, v71, s37, v14
v_exp_f32 v22, v22
buffer_load_dwordx4 v8, s[8:11], s38 offen offset:0 nt lds
v_cmp_gt_i32_e64 s[56:57], 18, v20
v_mfma_f32_32x32x16_bf16 a[112:127], v[140:143], v[132:135], a[112:127]
ds_read_b128 v[140:143], v3 offset:24576
v_cndmask_b32_e64 v73, v73, v21, s[54:55]
v_add_f32 v18, v18, v27
v_fma_f32 v24, v72, s37, v14
v_cmp_gt_i32_e64 s[58:59], 19, v20
s_waitcnt lgkmcnt(10)
v_mfma_f32_32x32x16_bf16 a[32:47], v[144:147], v[116:119], a[32:47]
v_exp_f32 v23, v23
v_cndmask_b32_e64 v74, v74, v21, s[56:57]
v_add_f32 v18, v18, v22
v_cvt_pk_bf16_f32 v122, v26, v27
s_waitcnt lgkmcnt(8)
v_mfma_f32_16x16x32_bf16 v[176:179], v[224:227], v[204:207], v[176:179]
buffer_load_dwordx4 v9, s[8:11], s38 offen offset:1024 nt lds
v_fma_f32 v25, v73, s37, v14
s_waitcnt lgkmcnt(6)
v_mfma_f32_16x16x32_bf16 v[180:183], v[228:231], v[204:207], v[180:183]
s_waitcnt vmcnt(10)
ds_read_b64_tr_b16 v[224:225], v232 offset:12288
ds_read_b64_tr_b16 v[226:227], v232 offset:14336
v_mfma_f32_32x32x16_bf16 a[128:143], v[144:147], v[132:135], a[128:143]
ds_read_b64_tr_b16 v[228:229], v233 offset:12288
ds_read_b64_tr_b16 v[230:231], v233 offset:14336
v_exp_f32 v24, v24
v_cmp_gt_i32_e64 s[54:55], 24, v20
v_mfma_f32_32x32x16_bf16 a[48:63], v[148:151], v[116:119], a[48:63]
buffer_load_dwordx4 v10, s[8:11], s38 offen offset:2048 nt lds
v_cndmask_b32_e64 v75, v75, v21, s[58:59]
v_add_f32 v18, v18, v23
v_fma_f32 v26, v74, s37, v14
v_cmp_gt_i32_e64 s[56:57], 25, v20
v_mfma_f32_32x32x16_bf16 a[144:159], v[148:151], v[132:135], a[144:159]
v_exp_f32 v25, v25
v_cndmask_b32_e64 v76, v76, v21, s[54:55]
v_add_f32 v18, v18, v24
v_cvt_pk_bf16_f32 v123, v22, v23
s_waitcnt lgkmcnt(6)
v_mfma_f32_32x32x16_bf16 a[64:79], v[152:155], v[116:119], a[64:79]
v_fma_f32 v27, v75, s37, v14
v_exp_f32 v26, v26
v_cmp_gt_i32_e64 s[58:59], 26, v20
v_cndmask_b32_e64 v77, v77, v21, s[56:57]
v_mfma_f32_32x32x16_bf16 a[160:175], v[152:155], v[132:135], a[160:175]
v_add_f32 v18, v18, v25
v_fma_f32 v22, v76, s37, v14
v_exp_f32 v27, v27
v_cmp_gt_i32_e64 s[54:55], 27, v20
v_mfma_f32_32x32x16_bf16 a[80:95], v[156:159], v[116:119], a[80:95]
v_cndmask_b32_e64 v78, v78, v21, s[58:59]
v_add_f32 v18, v18, v26
v_cvt_pk_bf16_f32 v124, v24, v25
v_fma_f32 v23, v77, s37, v14
v_exp_f32 v22, v22
v_cndmask_b32_e64 v79, v79, v21, s[54:55]
v_add_f32 v18, v18, v27
v_fma_f32 v24, v78, s37, v14
v_exp_f32 v23, v23
ds_read_b128 v[144:147], v4 offset:24576
v_mfma_f32_32x32x16_bf16 a[176:191], v[156:159], v[132:135], a[176:191]
v_add_f32 v18, v18, v22
v_fma_f32 v25, v79, s37, v14
v_exp_f32 v24, v24
v_add_f32 v18, v18, v23
v_exp_f32 v25, v25
v_add_f32 v18, v18, v24
v_cvt_pk_bf16_f32 v125, v26, v27
v_cvt_pk_bf16_f32 v126, v22, v23
v_add_f32 v18, v18, v25
v_cvt_pk_bf16_f32 v127, v24, v25
v_cmp_nge_f32 vcc, s52, v18
s_cbranch_vccnz Lst_d1_X
Lct_d1_X:
v_add_f32 v16, v16, v18
s_waitcnt lgkmcnt(5)
v_mfma_f32_32x32x16_bf16 v[64:79], v[136:139], a[192:195], 0
v_cvt_pk_bf16_f32 v184, v168, v169
v_cvt_pk_bf16_f32 v185, v170, v171
ds_read_b128 v[148:151], v5 offset:24576
s_add_u32 m0, s49, 36864
v_cvt_pk_bf16_f32 v186, v172, v173
s_waitcnt lgkmcnt(4)
v_mfma_f32_16x16x32_bf16 v[168:171], v[224:227], v[192:195], 0
buffer_load_dwordx4 v11, s[12:15], s39 offen offset:0 nt lds
v_cvt_pk_bf16_f32 v187, v174, v175
s_waitcnt lgkmcnt(2)
v_mfma_f32_16x16x32_bf16 v[172:175], v[228:231], v[192:195], 0
ds_read_b128 v[152:155], v2 offset:24704
ds_read_b64_tr_b16 v[224:225], v234 offset:12288
v_mfma_f32_32x32x16_bf16 v[80:95], v[136:139], a[240:243], 0
ds_read_b64_tr_b16 v[226:227], v234 offset:14336
ds_read_b64_tr_b16 v[228:229], v235 offset:12288
ds_read_b64_tr_b16 v[230:231], v235 offset:14336
ds_read_b128 v[156:159], v3 offset:24704
v_lshlrev_b32 v254, 4, v1
v_mfma_f32_32x32x16_bf16 v[64:79], v[140:143], a[196:199], v[64:79]
buffer_load_dwordx4 v12, s[12:15], s39 offen offset:1024 nt lds
ds_read_b128 v[136:139], v4 offset:24704
v_cvt_pk_bf16_f32 v188, v176, v177
v_cvt_pk_bf16_f32 v189, v178, v179
v_cvt_pk_bf16_f32 v190, v180, v181
v_mfma_f32_32x32x16_bf16 v[80:95], v[140:143], a[244:247], v[80:95]
ds_read_b128 v[140:143], v5 offset:24704
v_cvt_pk_bf16_f32 v191, v182, v183
v_fma_f32 v22, v96, s37, v15
v_fma_f32 v23, v97, s37, v15
v_fma_f32 v24, v98, s37, v15
s_waitcnt lgkmcnt(8)
v_mfma_f32_32x32x16_bf16 v[64:79], v[144:147], a[200:203], v[64:79]
v_exp_f32 v22, v22
v_exp_f32 v23, v23
v_fma_f32 v25, v99, s37, v15
v_mfma_f32_32x32x16_bf16 v[80:95], v[144:147], a[248:251], v[80:95]
buffer_load_dwordx4 v13, s[12:15], s39 offen offset:2048 nt lds
s_add_u32 m0, s53, 8064
ds_read_b128 v[144:147], v2 offset:24832
v_exp_f32 v24, v24
v_mfma_f32_32x32x16_bf16 v[64:79], v[148:151], a[204:207], v[64:79]
v_add_f32 v19, v22, v23
v_fma_f32 v26, v100, s37, v15
v_exp_f32 v25, v25
v_add_f32 v19, v19, v24
v_mfma_f32_32x32x16_bf16 v[80:95], v[148:151], a[252:255], v[80:95]
ds_read_b128 v[148:151], v3 offset:24832
v_cvt_pk_bf16_f32 v128, v22, v23
v_fma_f32 v27, v101, s37, v15
v_exp_f32 v26, v26
s_waitcnt lgkmcnt(4)
v_mfma_f32_32x32x16_bf16 v[64:79], v[152:155], a[208:211], v[64:79]
buffer_load_dwordx4 v214, s[20:23], 0 offen offset:128 lds
v_add_f32 v19, v19, v25
v_fma_f32 v22, v102, s37, v15
v_exp_f32 v27, v27
v_mfma_f32_16x16x32_bf16 v[176:179], v[224:227], v[192:195], 0
v_add_f32 v19, v19, v26
v_cvt_pk_bf16_f32 v129, v24, v25
v_mfma_f32_16x16x32_bf16 v[180:183], v[228:231], v[192:195], 0
s_waitcnt vmcnt(11)
ds_read_b64_tr_b16 v[224:225], v232 offset:0
ds_read_b64_tr_b16 v[226:227], v232 offset:2048
v_mfma_f32_32x32x16_bf16 v[80:95], v[152:155], v[32:35], v[80:95]
ds_read_b64_tr_b16 v[228:229], v233 offset:0
ds_read_b64_tr_b16 v[230:231], v233 offset:2048
ds_read_b128 v[152:155], v4 offset:24832
v_fma_f32 v23, v103, s37, v15
v_add_f32 v19, v19, v27
v_mfma_f32_32x32x16_bf16 v[64:79], v[156:159], a[212:215], v[64:79]
buffer_load_dwordx4 v222, s[20:23], 0 offen offset:1152 lds
v_exp_f32 v22, v22
v_fma_f32 v24, v104, s37, v15
v_add_f32 v19, v19, v22
v_mfma_f32_32x32x16_bf16 v[80:95], v[156:159], v[36:39], v[80:95]
ds_read_b128 v[156:159], v5 offset:24832
v_exp_f32 v23, v23
v_cvt_pk_bf16_f32 v130, v26, v27
v_fma_f32 v25, v105, s37, v15
s_waitcnt lgkmcnt(8)
v_mfma_f32_32x32x16_bf16 v[64:79], v[136:139], a[216:219], v[64:79]
v_exp_f32 v24, v24
v_add_f32 v19, v19, v23
v_fma_f32 v26, v106, s37, v15
v_add_f32 v19, v19, v24
v_mfma_f32_32x32x16_bf16 v[80:95], v[136:139], v[40:43], v[80:95]
buffer_load_dwordx4 v215, s[20:23], 0 offen offset:2176 lds
ds_read_b64_tr_b16 v[136:137], v6 offset:12288
ds_read_b64_tr_b16 v[138:139], v6 offset:15360
v_exp_f32 v25, v25
v_mfma_f32_32x32x16_bf16 v[64:79], v[140:143], a[220:223], v[64:79]
v_cvt_pk_bf16_f32 v131, v22, v23
v_fma_f32 v27, v107, s37, v15
v_exp_f32 v26, v26
v_add_f32 v19, v19, v25
v_mfma_f32_32x32x16_bf16 v[80:95], v[140:143], v[44:47], v[80:95]
ds_read_b64_tr_b16 v[140:141], v7 offset:12288
ds_read_b64_tr_b16 v[142:143], v7 offset:15360
v_fma_f32 v22, v108, s37, v15
v_exp_f32 v27, v27
s_waitcnt lgkmcnt(10)
v_mfma_f32_32x32x16_bf16 v[64:79], v[144:147], a[224:227], v[64:79]
buffer_load_dwordx4 v223, s[20:23], 0 offen offset:3200 lds
s_add_u32 m0, s53, 12032
v_add_f32 v19, v19, v26
v_cvt_pk_bf16_f32 v132, v24, v25
v_fma_f32 v23, v109, s37, v15
s_waitcnt lgkmcnt(8)
v_mfma_f32_16x16x32_bf16 v[168:171], v[224:227], v[196:199], v[168:171]
v_exp_f32 v22, v22
s_waitcnt lgkmcnt(6)
v_mfma_f32_16x16x32_bf16 v[172:175], v[228:231], v[196:199], v[172:175]
ds_read_b64_tr_b16 v[224:225], v234 offset:0
ds_read_b64_tr_b16 v[226:227], v234 offset:2048
v_mfma_f32_32x32x16_bf16 v[80:95], v[144:147], v[48:51], v[80:95]
ds_read_b64_tr_b16 v[228:229], v235 offset:0
ds_read_b64_tr_b16 v[230:231], v235 offset:2048
ds_read_b64_tr_b16 v[144:145], v6 offset:12416
ds_read_b64_tr_b16 v[146:147], v6 offset:15488
v_add_f32 v19, v19, v27
v_mfma_f32_32x32x16_bf16 v[64:79], v[148:151], a[228:231], v[64:79]
buffer_store_dwordx4 v[184:187], v254, s[32:35], s75 offen offset:0
v_fma_f32 v24, v110, s37, v15
v_exp_f32 v23, v23
v_lshlrev_b32 v254, 4, v1
v_mfma_f32_32x32x16_bf16 v[80:95], v[148:151], v[52:55], v[80:95]
ds_read_b64_tr_b16 v[148:149], v7 offset:12416
ds_read_b64_tr_b16 v[150:151], v7 offset:15488
v_add_f32 v19, v19, v22
v_fma_f32 v25, v111, s37, v15
v_add_f32 v19, v19, v23
s_waitcnt lgkmcnt(12)
v_mfma_f32_32x32x16_bf16 v[64:79], v[152:155], a[232:235], v[64:79]
s_barrier
v_exp_f32 v24, v24
v_exp_f32 v25, v25
v_add_f32 v19, v19, v24
v_mfma_f32_32x32x16_bf16 v[80:95], v[152:155], v[56:59], v[80:95]
buffer_store_dwordx4 v[188:191], v254, s[32:35], s75 offen offset:1024
v_cvt_pk_bf16_f32 v133, v26, v27
v_cvt_pk_bf16_f32 v134, v22, v23
v_add_f32 v19, v19, v25
v_cvt_pk_bf16_f32 v135, v24, v25
v_mfma_f32_32x32x16_bf16 v[64:79], v[156:159], a[236:239], v[64:79]
v_add_u32 v20, -32, v20
s_add_u32 s38, s38, s78
v_cmp_nge_f32 vcc, s52, v19
s_cbranch_vccnz Lst_d1_Y
Lct_d1_Y:
v_add_f32 v17, v17, v19
v_mfma_f32_32x32x16_bf16 v[80:95], v[156:159], v[60:63], v[80:95]
buffer_load_dwordx4 v208, s[20:23], 0 offen offset:256 lds
buffer_load_dwordx4 v216, s[20:23], 0 offen offset:1280 lds
buffer_load_dwordx4 v209, s[20:23], 0 offen offset:2304 lds
buffer_load_dwordx4 v217, s[20:23], 0 offen offset:3328 lds
s_add_u32 s39, s39, s98
s_add_u32 s62, s62, 4
s_cmp_eq_u32 s62, s40
s_cselect_b32 s39, s88, s39
s_cselect_b32 s98, -12288, s98
s_cmp_eq_u32 s62, 28
s_cselect_b32 s39, s41, s39
s_cselect_b32 s98, 12288, s98
L_d2:
s_waitcnt lgkmcnt(8)
v_mfma_f32_32x32x16_bf16 a[0:15], v[136:139], v[120:123], a[0:15]
ds_read_b64_tr_b16 v[152:153], v6 offset:12544
ds_read_b64_tr_b16 v[154:155], v6 offset:15616
ds_read_b64_tr_b16 v[156:157], v7 offset:12544
ds_read_b64_tr_b16 v[158:159], v7 offset:15616
s_waitcnt lgkmcnt(10)
v_mfma_f32_16x16x32_bf16 v[176:179], v[224:227], v[196:199], v[176:179]
s_waitcnt lgkmcnt(8)
v_mfma_f32_16x16x32_bf16 v[180:183], v[228:231], v[196:199], v[180:183]
s_waitcnt vmcnt(16)
ds_read_b64_tr_b16 v[224:225], v232 offset:4096
ds_read_b64_tr_b16 v[226:227], v232 offset:6144
v_mfma_f32_32x32x16_bf16 a[96:111], v[136:139], v[128:131], a[96:111]
ds_read_b64_tr_b16 v[228:229], v233 offset:4096
ds_read_b64_tr_b16 v[230:231], v233 offset:6144
ds_read_b64_tr_b16 v[136:137], v6 offset:18432
ds_read_b64_tr_b16 v[138:139], v6 offset:21504
s_sub_u32 m0, s53, 256
v_mfma_f32_32x32x16_bf16 a[16:31], v[140:143], v[120:123], a[16:31]
buffer_load_dwordx4 v210, s[20:23], 0 offen offset:256 lds
v_cmp_gt_i32_e64 s[54:55], 0, v20
v_cmp_gt_i32_e64 s[56:57], 1, v20
v_cmp_gt_i32_e64 s[58:59], 2, v20
v_cndmask_b32_e64 v64, v64, v21, s[54:55]
v_mfma_f32_32x32x16_bf16 a[112:127], v[140:143], v[128:131], a[112:127]
ds_read_b64_tr_b16 v[140:141], v7 offset:18432
ds_read_b64_tr_b16 v[142:143], v7 offset:21504
v_cndmask_b32_e64 v65, v65, v21, s[56:57]
v_cmp_gt_i32_e64 s[54:55], 3, v20
v_cndmask_b32_e64 v66, v66, v21, s[58:59]
s_waitcnt lgkmcnt(12)
v_mfma_f32_32x32x16_bf16 a[32:47], v[144:147], v[120:123], a[32:47]
v_fma_f32 v22, v64, s37, v14
v_fma_f32 v23, v65, s37, v14
v_cmp_gt_i32_e64 s[56:57], 8, v20
v_cndmask_b32_e64 v67, v67, v21, s[54:55]
v_fma_f32 v24, v66, s37, v14
v_mfma_f32_32x32x16_bf16 a[128:143], v[144:147], v[128:131], a[128:143]
buffer_load_dwordx4 v218, s[20:23], 0 offen offset:1280 lds
ds_read_b64_tr_b16 v[144:145], v6 offset:18560
ds_read_b64_tr_b16 v[146:147], v6 offset:21632
v_exp_f32 v22, v22
v_mfma_f32_32x32x16_bf16 a[48:63], v[148:151], v[120:123], a[48:63]
v_exp_f32 v23, v23
v_cmp_gt_i32_e64 s[58:59], 9, v20
v_cndmask_b32_e64 v68, v68, v21, s[56:57]
v_fma_f32 v25, v67, s37, v14
v_mfma_f32_32x32x16_bf16 a[144:159], v[148:151], v[128:131], a[144:159]
ds_read_b64_tr_b16 v[148:149], v7 offset:18560
ds_read_b64_tr_b16 v[150:151], v7 offset:21632
v_exp_f32 v24, v24
v_cmp_gt_i32_e64 s[54:55], 10, v20
s_waitcnt lgkmcnt(12)
v_mfma_f32_32x32x16_bf16 a[64:79], v[152:155], v[120:123], a[64:79]
buffer_load_dwordx4 v211, s[20:23], 0 offen offset:2304 lds
v_cndmask_b32_e64 v69, v69, v21, s[58:59]
v_add_f32 v18, v22, v23
v_fma_f32 v26, v68, s37, v14
v_cmp_gt_i32_e64 s[56:57], 11, v20
s_waitcnt lgkmcnt(10)
v_mfma_f32_16x16x32_bf16 v[168:171], v[224:227], v[200:203], v[168:171]
v_exp_f32 v25, v25
s_waitcnt lgkmcnt(8)
v_mfma_f32_16x16x32_bf16 v[172:175], v[228:231], v[200:203], v[172:175]
ds_read_b64_tr_b16 v[224:225], v234 offset:4096
ds_read_b64_tr_b16 v[226:227], v234 offset:6144
v_mfma_f32_32x32x16_bf16 a[160:175], v[152:155], v[128:131], a[160:175]
ds_read_b64_tr_b16 v[228:229], v235 offset:4096
ds_read_b64_tr_b16 v[230:231], v235 offset:6144
ds_read_b64_tr_b16 v[152:153], v6 offset:18688
ds_read_b64_tr_b16 v[154:155], v6 offset:21760
v_cndmask_b32_e64 v70, v70, v21, s[54:55]
v_mfma_f32_32x32x16_bf16 a[80:95], v[156:159], v[120:123], a[80:95]
buffer_load_dwordx4 v219, s[20:23], 0 offen offset:3328 lds
v_add_f32 v18, v18, v24
v_cvt_pk_bf16_f32 v112, v22, v23
v_fma_f32 v27, v69, s37, v14
v_cmp_gt_i32_e64 s[58:59], 16, v20
v_mfma_f32_32x32x16_bf16 a[176:191], v[156:159], v[128:131], a[176:191]
ds_read_b64_tr_b16 v[156:157], v7 offset:18688
ds_read_b64_tr_b16 v[158:159], v7 offset:21760
v_exp_f32 v26, v26
v_cndmask_b32_e64 v71, v71, v21, s[56:57]
s_waitcnt lgkmcnt(12)
v_mfma_f32_32x32x16_bf16 a[0:15], v[136:139], v[124:127], a[0:15]
v_add_f32 v18, v18, v25
v_fma_f32 v22, v70, s37, v14
v_exp_f32 v27, v27
s_add_u32 m0, s48, 24576
v_mfma_f32_32x32x16_bf16 a[96:111], v[136:139], v[132:135], a[96:111]
ds_read_b128 v[136:139], v2 offset:36864
v_cmp_gt_i32_e64 s[54:55], 17, v20
v_cndmask_b32_e64 v72, v72, v21, s[58:59]
v_add_f32 v18, v18, v26
v_cvt_pk_bf16_f32 v113, v24, v25
v_mfma_f32_32x32x16_bf16 a[16:31], v[140:143], v[124:127], a[16:31]
v_fma_f32 v23, v71, s37, v14
v_exp_f32 v22, v22
buffer_load_dwordx4 v8, s[8:11], s38 offen offset:0 nt lds
v_cmp_gt_i32_e64 s[56:57], 18, v20
v_mfma_f32_32x32x16_bf16 a[112:127], v[140:143], v[132:135], a[112:127]
ds_read_b128 v[140:143], v3 offset:36864
v_cndmask_b32_e64 v73, v73, v21, s[54:55]
v_add_f32 v18, v18, v27
v_fma_f32 v24, v72, s37, v14
v_cmp_gt_i32_e64 s[58:59], 19, v20
s_waitcnt lgkmcnt(10)
v_mfma_f32_32x32x16_bf16 a[32:47], v[144:147], v[124:127], a[32:47]
v_exp_f32 v23, v23
v_cndmask_b32_e64 v74, v74, v21, s[56:57]
v_add_f32 v18, v18, v22
v_cvt_pk_bf16_f32 v114, v26, v27
s_waitcnt lgkmcnt(8)
v_mfma_f32_16x16x32_bf16 v[176:179], v[224:227], v[200:203], v[176:179]
buffer_load_dwordx4 v9, s[8:11], s38 offen offset:1024 nt lds
v_fma_f32 v25, v73, s37, v14
s_waitcnt lgkmcnt(6)
v_mfma_f32_16x16x32_bf16 v[180:183], v[228:231], v[200:203], v[180:183]
s_waitcnt vmcnt(12)
ds_read_b64_tr_b16 v[224:225], v232 offset:8192
ds_read_b64_tr_b16 v[226:227], v232 offset:10240
v_mfma_f32_32x32x16_bf16 a[128:143], v[144:147], v[132:135], a[128:143]
ds_read_b64_tr_b16 v[228:229], v233 offset:8192
ds_read_b64_tr_b16 v[230:231], v233 offset:10240
v_exp_f32 v24, v24
v_cmp_gt_i32_e64 s[54:55], 24, v20
v_mfma_f32_32x32x16_bf16 a[48:63], v[148:151], v[124:127], a[48:63]
buffer_load_dwordx4 v10, s[8:11], s38 offen offset:2048 nt lds
v_cndmask_b32_e64 v75, v75, v21, s[58:59]
v_add_f32 v18, v18, v23
v_fma_f32 v26, v74, s37, v14
v_cmp_gt_i32_e64 s[56:57], 25, v20
v_mfma_f32_32x32x16_bf16 a[144:159], v[148:151], v[132:135], a[144:159]
v_exp_f32 v25, v25
v_cndmask_b32_e64 v76, v76, v21, s[54:55]
v_add_f32 v18, v18, v24
v_cvt_pk_bf16_f32 v115, v22, v23
s_waitcnt lgkmcnt(6)
v_mfma_f32_32x32x16_bf16 a[64:79], v[152:155], v[124:127], a[64:79]
v_fma_f32 v27, v75, s37, v14
v_exp_f32 v26, v26
v_cmp_gt_i32_e64 s[58:59], 26, v20
v_cndmask_b32_e64 v77, v77, v21, s[56:57]
v_mfma_f32_32x32x16_bf16 a[160:175], v[152:155], v[132:135], a[160:175]
v_add_f32 v18, v18, v25
v_fma_f32 v22, v76, s37, v14
v_exp_f32 v27, v27
v_cmp_gt_i32_e64 s[54:55], 27, v20
v_mfma_f32_32x32x16_bf16 a[80:95], v[156:159], v[124:127], a[80:95]
v_cndmask_b32_e64 v78, v78, v21, s[58:59]
v_add_f32 v18, v18, v26
v_cvt_pk_bf16_f32 v116, v24, v25
v_fma_f32 v23, v77, s37, v14
v_exp_f32 v22, v22
v_cndmask_b32_e64 v79, v79, v21, s[54:55]
v_add_f32 v18, v18, v27
v_fma_f32 v24, v78, s37, v14
v_exp_f32 v23, v23
ds_read_b128 v[144:147], v4 offset:36864
v_mfma_f32_32x32x16_bf16 a[176:191], v[156:159], v[132:135], a[176:191]
v_add_f32 v18, v18, v22
v_fma_f32 v25, v79, s37, v14
v_exp_f32 v24, v24
v_add_f32 v18, v18, v23
v_exp_f32 v25, v25
v_add_f32 v18, v18, v24
v_cvt_pk_bf16_f32 v117, v26, v27
v_cvt_pk_bf16_f32 v118, v22, v23
v_add_f32 v18, v18, v25
v_cvt_pk_bf16_f32 v119, v24, v25
v_cmp_nge_f32 vcc, s52, v18
s_cbranch_vccnz Lst_d2_X
Lct_d2_X:
v_add_f32 v16, v16, v18
s_waitcnt lgkmcnt(5)
v_mfma_f32_32x32x16_bf16 v[64:79], v[136:139], a[192:195], 0
ds_read_b128 v[148:151], v5 offset:36864
s_add_u32 m0, s49, 0
ds_read_b128 v[152:155], v2 offset:36992
buffer_load_dwordx4 v11, s[12:15], s39 offen offset:0 nt lds
ds_read_b128 v[156:159], v3 offset:36992
s_waitcnt lgkmcnt(6)
v_mfma_f32_16x16x32_bf16 v[168:171], v[224:227], v[204:207], v[168:171]
v_fma_f32 v22, v80, s37, v15
v_fma_f32 v23, v81, s37, v15
s_waitcnt lgkmcnt(4)
v_mfma_f32_16x16x32_bf16 v[172:175], v[228:231], v[204:207], v[172:175]
ds_read_b64_tr_b16 v[224:225], v234 offset:8192
ds_read_b64_tr_b16 v[226:227], v234 offset:10240
v_mfma_f32_32x32x16_bf16 v[96:111], v[136:139], a[240:243], 0
ds_read_b64_tr_b16 v[228:229], v235 offset:8192
ds_read_b64_tr_b16 v[230:231], v235 offset:10240
ds_read_b128 v[136:139], v4 offset:36992
v_add_u32_dpp v208, v242, v236 row_newbcast:0 row_mask:0xf bank_mask:0x3
v_add_u32_dpp v216, v242, v237 row_newbcast:2 row_mask:0xf bank_mask:0x3
v_mfma_f32_32x32x16_bf16 v[64:79], v[140:143], a[196:199], v[64:79]
buffer_load_dwordx4 v12, s[12:15], s39 offen offset:1024 nt lds
v_add_u32_dpp v209, v243, v238 row_newbcast:0 row_mask:0xf bank_mask:0x3
v_add_u32_dpp v217, v243, v239 row_newbcast:2 row_mask:0xf bank_mask:0x3
v_add_u32_dpp v210, v244, v236 row_newbcast:0 row_mask:0xf bank_mask:0x3
v_add_u32_dpp v218, v244, v237 row_newbcast:2 row_mask:0xf bank_mask:0x3
v_mfma_f32_32x32x16_bf16 v[96:111], v[140:143], a[244:247], v[96:111]
ds_read_b128 v[140:143], v5 offset:36992
v_add_u32_dpp v211, v245, v238 row_newbcast:0 row_mask:0xf bank_mask:0x3
v_add_u32_dpp v219, v245, v239 row_newbcast:2 row_mask:0xf bank_mask:0x3
v_add_u32_dpp v208, v242, v236 row_newbcast:1 row_mask:0xf bank_mask:0xc
v_add_u32_dpp v216, v242, v237 row_newbcast:3 row_mask:0xf bank_mask:0xc
s_waitcnt lgkmcnt(8)
v_mfma_f32_32x32x16_bf16 v[64:79], v[144:147], a[200:203], v[64:79]
v_add_u32_dpp v209, v243, v238 row_newbcast:1 row_mask:0xf bank_mask:0xc
v_add_u32_dpp v217, v243, v239 row_newbcast:3 row_mask:0xf bank_mask:0xc
v_add_u32_dpp v210, v244, v236 row_newbcast:1 row_mask:0xf bank_mask:0xc
v_add_u32_dpp v218, v244, v237 row_newbcast:3 row_mask:0xf bank_mask:0xc
v_add_u32_dpp v211, v245, v238 row_newbcast:1 row_mask:0xf bank_mask:0xc
v_mfma_f32_32x32x16_bf16 v[96:111], v[144:147], a[248:251], v[96:111]
buffer_load_dwordx4 v13, s[12:15], s39 offen offset:2048 nt lds
s_add_u32 m0, s53, 3840
ds_read_b128 v[144:147], v2 offset:37120
v_add_u32_dpp v219, v245, v239 row_newbcast:3 row_mask:0xf bank_mask:0xc
v_mov_b32_dpp v242, v242 row_ror:12 row_mask:0xf bank_mask:0xf
v_mfma_f32_32x32x16_bf16 v[64:79], v[148:151], a[204:207], v[64:79]
v_mov_b32_dpp v243, v243 row_ror:12 row_mask:0xf bank_mask:0xf
v_mov_b32_dpp v244, v244 row_ror:12 row_mask:0xf bank_mask:0xf
v_mov_b32_dpp v245, v245 row_ror:12 row_mask:0xf bank_mask:0xf
v_exp_f32 v22, v22
v_mfma_f32_32x32x16_bf16 v[96:111], v[148:151], a[252:255], v[96:111]
ds_read_b128 v[148:151], v3 offset:37120
v_fma_f32 v24, v82, s37, v15
v_exp_f32 v23, v23
v_fma_f32 v25, v83, s37, v15
s_waitcnt lgkmcnt(8)
v_mfma_f32_32x32x16_bf16 v[64:79], v[152:155], a[208:211], v[64:79]
buffer_load_dwordx4 v212, s[20:23], 0 offen offset:256 lds
v_exp_f32 v24, v24
v_add_f32 v19, v22, v23
v_fma_f32 v26, v84, s37, v15
s_waitcnt lgkmcnt(6)
v_mfma_f32_16x16x32_bf16 v[176:179], v[224:227], v[204:207], v[176:179]
v_exp_f32 v25, v25
s_waitcnt lgkmcnt(4)
v_mfma_f32_16x16x32_bf16 v[180:183], v[228:231], v[204:207], v[180:183]
s_waitcnt vmcnt(11)
ds_read_b64_tr_b16 v[224:225], v232 offset:12288
ds_read_b64_tr_b16 v[226:227], v232 offset:14336
v_mfma_f32_32x32x16_bf16 v[96:111], v[152:155], v[32:35], v[96:111]
ds_read_b64_tr_b16 v[228:229], v233 offset:12288
ds_read_b64_tr_b16 v[230:231], v233 offset:14336
ds_read_b128 v[152:155], v4 offset:37120
v_cvt_pk_bf16_f32 v184, v168, v169
v_cvt_pk_bf16_f32 v185, v170, v171
v_mfma_f32_32x32x16_bf16 v[64:79], v[156:159], a[212:215], v[64:79]
buffer_load_dwordx4 v220, s[20:23], 0 offen offset:1280 lds
v_cvt_pk_bf16_f32 v186, v172, v173
v_cvt_pk_bf16_f32 v187, v174, v175
v_add_f32 v19, v19, v24
v_cvt_pk_bf16_f32 v128, v22, v23
v_mfma_f32_32x32x16_bf16 v[96:111], v[156:159], v[36:39], v[96:111]
ds_read_b128 v[156:159], v5 offset:37120
v_fma_f32 v27, v85, s37, v15
v_exp_f32 v26, v26
v_add_f32 v19, v19, v25
s_waitcnt lgkmcnt(8)
v_mfma_f32_32x32x16_bf16 v[64:79], v[136:139], a[216:219], v[64:79]
v_fma_f32 v22, v86, s37, v15
v_exp_f32 v27, v27
v_add_f32 v19, v19, v26
v_cvt_pk_bf16_f32 v129, v24, v25
v_mfma_f32_32x32x16_bf16 v[96:111], v[136:139], v[40:43], v[96:111]
buffer_load_dwordx4 v213, s[20:23], 0 offen offset:2304 lds
ds_read_b64_tr_b16 v[136:137], v6 offset:24576
ds_read_b64_tr_b16 v[138:139], v6 offset:27648
v_fma_f32 v23, v87, s37, v15
s_lshr_b32 s63, s77, 2
v_mfma_f32_32x32x16_bf16 v[64:79], v[140:143], a[220:223], v[64:79]
v_exp_f32 v22, v22
v_add_f32 v19, v19, v27
v_fma_f32 v24, v88, s37, v15
v_cmp_eq_u32_e64 s[72:73], s63, v253
v_mfma_f32_32x32x16_bf16 v[96:111], v[140:143], v[44:47], v[96:111]
ds_read_b64_tr_b16 v[140:141], v7 offset:24576
ds_read_b64_tr_b16 v[142:143], v7 offset:27648
v_exp_f32 v23, v23
v_add_f32 v19, v19, v22
s_waitcnt lgkmcnt(10)
v_mfma_f32_32x32x16_bf16 v[64:79], v[144:147], a[224:227], v[64:79]
buffer_load_dwordx4 v221, s[20:23], 0 offen offset:3328 lds
s_add_u32 m0, s53, 7936
v_cvt_pk_bf16_f32 v130, v26, v27
v_fma_f32 v25, v89, s37, v15
v_cndmask_b32_e64 v250, 0, v240, s[72:73]
s_waitcnt lgkmcnt(8)
v_mfma_f32_16x16x32_bf16 v[168:171], v[224:227], v[192:195], 0
v_exp_f32 v24, v24
s_waitcnt lgkmcnt(6)
v_mfma_f32_16x16x32_bf16 v[172:175], v[228:231], v[192:195], 0
ds_read_b64_tr_b16 v[224:225], v234 offset:12288
ds_read_b64_tr_b16 v[226:227], v234 offset:14336
v_mfma_f32_32x32x16_bf16 v[96:111], v[144:147], v[48:51], v[96:111]
ds_read_b64_tr_b16 v[228:229], v235 offset:12288
ds_read_b64_tr_b16 v[230:231], v235 offset:14336
s_nop 1
v_cndmask_b32_e64 v251, 0, v241, s[72:73]
v_mfma_f32_32x32x16_bf16 v[64:79], v[148:151], a[228:231], v[64:79]
buffer_load_dwordx4 v214, s[20:23], 0 offen offset:256 lds
ds_read_b64_tr_b16 v[144:145], v6 offset:24704
ds_read_b64_tr_b16 v[146:147], v6 offset:27776
v_add_f32 v19, v19, v23
v_fma_f32 v26, v90, s37, v15
v_mfma_f32_32x32x16_bf16 v[96:111], v[148:151], v[52:55], v[96:111]
ds_read_b64_tr_b16 v[148:149], v7 offset:24704
ds_read_b64_tr_b16 v[150:151], v7 offset:27776
v_exp_f32 v25, v25
v_add_f32 v19, v19, v24
s_waitcnt lgkmcnt(12)
v_mfma_f32_32x32x16_bf16 v[64:79], v[152:155], a[232:235], v[64:79]
s_barrier
v_cvt_pk_bf16_f32 v131, v22, v23
v_fma_f32 v27, v91, s37, v15
v_exp_f32 v26, v26
v_add_f32 v19, v19, v25
v_mfma_f32_32x32x16_bf16 v[96:111], v[152:155], v[56:59], v[96:111]
buffer_load_dwordx4 v222, s[20:23], 0 offen offset:1280 lds
v_fma_f32 v22, v92, s37, v15
v_exp_f32 v27, v27
v_add_f32 v19, v19, v26
v_mfma_f32_32x32x16_bf16 v[64:79], v[156:159], a[236:239], v[64:79]
v_cvt_pk_bf16_f32 v132, v24, v25
v_fma_f32 v23, v93, s37, v15
v_exp_f32 v22, v22
v_add_f32 v19, v19, v27
v_fma_f32 v24, v94, s37, v15
v_exp_f32 v23, v23
v_mfma_f32_32x32x16_bf16 v[96:111], v[156:159], v[60:63], v[96:111]
buffer_load_dwordx4 v215, s[20:23], 0 offen offset:2304 lds
buffer_load_dwordx4 v223, s[20:23], 0 offen offset:3328 lds
v_add_f32 v19, v19, v22
v_fma_f32 v25, v95, s37, v15
v_exp_f32 v24, v24
v_add_f32 v19, v19, v23
v_exp_f32 v25, v25
v_add_f32 v19, v19, v24
v_cvt_pk_bf16_f32 v133, v26, v27
v_cvt_pk_bf16_f32 v134, v22, v23
v_add_f32 v19, v19, v25
v_cvt_pk_bf16_f32 v135, v24, v25
v_cvt_pk_bf16_f32 v188, v176, v177
v_cvt_pk_bf16_f32 v189, v178, v179
v_cvt_pk_bf16_f32 v190, v180, v181
v_cvt_pk_bf16_f32 v191, v182, v183
v_add_u32 v20, -32, v20
s_add_u32 s38, s38, s78
s_add_u32 s39, s39, s98
v_accvgpr_write_b32 a224, v184
v_accvgpr_write_b32 a225, v185
v_accvgpr_write_b32 a226, v186
v_accvgpr_write_b32 a227, v187
v_accvgpr_write_b32 a228, v188
v_accvgpr_write_b32 a229, v189
v_accvgpr_write_b32 a230, v190
v_accvgpr_write_b32 a231, v191
v_cmp_nge_f32 vcc, s52, v19
s_cbranch_vccnz Lst_d2_Y
Lct_d2_Y:
v_add_f32 v17, v17, v19
s_waitcnt lgkmcnt(8)
v_mfma_f32_32x32x16_bf16 a[0:15], v[136:139], v[112:115], a[0:15]
ds_read_b64_tr_b16 v[152:153], v6 offset:24832
ds_read_b64_tr_b16 v[154:155], v6 offset:27904
ds_read_b64_tr_b16 v[156:157], v7 offset:24832
ds_read_b64_tr_b16 v[158:159], v7 offset:27904
s_waitcnt lgkmcnt(10)
v_mfma_f32_16x16x32_bf16 v[176:179], v[224:227], v[192:195], 0
s_waitcnt lgkmcnt(8)
v_mfma_f32_16x16x32_bf16 v[180:183], v[228:231], v[192:195], 0
s_waitcnt vmcnt(14)
ds_read_b64_tr_b16 v[224:225], v232 offset:0
ds_read_b64_tr_b16 v[226:227], v232 offset:2048
v_mfma_f32_32x32x16_bf16 a[96:111], v[136:139], v[128:131], a[96:111]
ds_read_b64_tr_b16 v[228:229], v233 offset:0
ds_read_b64_tr_b16 v[230:231], v233 offset:2048
ds_read_b64_tr_b16 v[136:137], v6 offset:30720
ds_read_b64_tr_b16 v[138:139], v6 offset:33792
s_add_u32 m0, s53, 12288
v_mfma_f32_32x32x16_bf16 a[16:31], v[140:143], v[112:115], a[16:31]
buffer_load_dwordx4 v208, s[20:23], 0 offen offset:0 lds
v_cmp_gt_i32_e64 s[54:55], 0, v20
v_cmp_gt_i32_e64 s[56:57], 1, v20
v_cmp_gt_i32_e64 s[58:59], 2, v20
v_cndmask_b32_e64 v64, v64, v21, s[54:55]
v_mfma_f32_32x32x16_bf16 a[112:127], v[140:143], v[128:131], a[112:127]
ds_read_b64_tr_b16 v[140:141], v7 offset:30720
ds_read_b64_tr_b16 v[142:143], v7 offset:33792
v_cndmask_b32_e64 v65, v65, v21, s[56:57]
v_cmp_gt_i32_e64 s[54:55], 3, v20
v_cndmask_b32_e64 v66, v66, v21, s[58:59]
s_waitcnt lgkmcnt(12)
v_mfma_f32_32x32x16_bf16 a[32:47], v[144:147], v[112:115], a[32:47]
v_fma_f32 v22, v64, s37, v14
v_fma_f32 v23, v65, s37, v14
v_cmp_gt_i32_e64 s[56:57], 8, v20
v_cndmask_b32_e64 v67, v67, v21, s[54:55]
v_fma_f32 v24, v66, s37, v14
v_mfma_f32_32x32x16_bf16 a[128:143], v[144:147], v[128:131], a[128:143]
buffer_load_dwordx4 v216, s[20:23], 0 offen offset:1024 lds
ds_read_b64_tr_b16 v[144:145], v6 offset:30848
ds_read_b64_tr_b16 v[146:147], v6 offset:33920
v_exp_f32 v22, v22
v_mfma_f32_32x32x16_bf16 a[48:63], v[148:151], v[112:115], a[48:63]
v_exp_f32 v23, v23
v_cmp_gt_i32_e64 s[58:59], 9, v20
v_cndmask_b32_e64 v68, v68, v21, s[56:57]
v_fma_f32 v25, v67, s37, v14
v_mfma_f32_32x32x16_bf16 a[144:159], v[148:151], v[128:131], a[144:159]
ds_read_b64_tr_b16 v[148:149], v7 offset:30848
ds_read_b64_tr_b16 v[150:151], v7 offset:33920
v_exp_f32 v24, v24
v_cmp_gt_i32_e64 s[54:55], 10, v20
s_waitcnt lgkmcnt(12)
v_mfma_f32_32x32x16_bf16 a[64:79], v[152:155], v[112:115], a[64:79]
buffer_load_dwordx4 v209, s[20:23], 0 offen offset:2048 lds
v_cndmask_b32_e64 v69, v69, v21, s[58:59]
v_add_f32 v18, v22, v23
v_fma_f32 v26, v68, s37, v14
v_cmp_gt_i32_e64 s[56:57], 11, v20
s_waitcnt lgkmcnt(10)
v_mfma_f32_16x16x32_bf16 v[168:171], v[224:227], v[196:199], v[168:171]
v_exp_f32 v25, v25
s_waitcnt lgkmcnt(8)
v_mfma_f32_16x16x32_bf16 v[172:175], v[228:231], v[196:199], v[172:175]
ds_read_b64_tr_b16 v[224:225], v234 offset:0
ds_read_b64_tr_b16 v[226:227], v234 offset:2048
v_mfma_f32_32x32x16_bf16 a[160:175], v[152:155], v[128:131], a[160:175]
ds_read_b64_tr_b16 v[228:229], v235 offset:0
ds_read_b64_tr_b16 v[230:231], v235 offset:2048
ds_read_b64_tr_b16 v[152:153], v6 offset:30976
ds_read_b64_tr_b16 v[154:155], v6 offset:34048
v_and_b32 v192, v160, v250
v_mfma_f32_32x32x16_bf16 a[80:95], v[156:159], v[112:115], a[80:95]
buffer_load_dwordx4 v217, s[20:23], 0 offen offset:3072 lds
s_add_u32 m0, s48, 36864
v_and_b32 v193, v160, v251
v_and_b32 v194, v161, v250
v_and_b32 v195, v161, v251
v_mfma_f32_32x32x16_bf16 a[176:191], v[156:159], v[128:131], a[176:191]
ds_read_b64_tr_b16 v[156:157], v7 offset:30976
ds_read_b64_tr_b16 v[158:159], v7 offset:34048
v_cndmask_b32_e64 v70, v70, v21, s[54:55]
v_add_f32 v18, v18, v24
v_cvt_pk_bf16_f32 v120, v22, v23
s_waitcnt lgkmcnt(12)
v_mfma_f32_32x32x16_bf16 a[0:15], v[136:139], v[116:119], a[0:15]
v_fma_f32 v27, v69, s37, v14
v_exp_f32 v26, v26
v_cmp_gt_i32_e64 s[58:59], 16, v20
v_cndmask_b32_e64 v71, v71, v21, s[56:57]
v_mfma_f32_32x32x16_bf16 a[96:111], v[136:139], v[132:135], a[96:111]
buffer_load_dwordx4 v8, s[8:11], s38 offen offset:0 nt lds
ds_read_b128 v[136:139], v2 offset:0
v_add_f32 v18, v18, v25
v_fma_f32 v22, v70, s37, v14
v_cmp_gt_i32_e64 s[54:55], 17, v20
v_mfma_f32_32x32x16_bf16 a[16:31], v[140:143], v[116:119], a[16:31]
v_exp_f32 v27, v27
v_cndmask_b32_e64 v72, v72, v21, s[58:59]
v_add_f32 v18, v18, v26
v_cvt_pk_bf16_f32 v121, v24, v25
v_mfma_f32_32x32x16_bf16 a[112:127], v[140:143], v[132:135], a[112:127]
ds_read_b128 v[140:143], v3 offset:0
v_fma_f32 v23, v71, s37, v14
v_exp_f32 v22, v22
v_cmp_gt_i32_e64 s[56:57], 18, v20
s_waitcnt lgkmcnt(10)
v_mfma_f32_32x32x16_bf16 a[32:47], v[144:147], v[116:119], a[32:47]
buffer_load_dwordx4 v9, s[8:11], s38 offen offset:1024 nt lds
v_cndmask_b32_e64 v73, v73, v21, s[54:55]
v_add_f32 v18, v18, v27
v_fma_f32 v24, v72, s37, v14
v_cmp_gt_i32_e64 s[58:59], 19, v20
s_waitcnt lgkmcnt(8)
v_mfma_f32_16x16x32_bf16 v[176:179], v[224:227], v[196:199], v[176:179]
v_exp_f32 v23, v23
s_waitcnt lgkmcnt(6)
v_mfma_f32_16x16x32_bf16 v[180:183], v[228:231], v[196:199], v[180:183]
s_waitcnt vmcnt(10)
ds_read_b64_tr_b16 v[224:225], v232 offset:4096
ds_read_b64_tr_b16 v[226:227], v232 offset:6144
v_mfma_f32_32x32x16_bf16 a[128:143], v[144:147], v[132:135], a[128:143]
ds_read_b64_tr_b16 v[228:229], v233 offset:4096
ds_read_b64_tr_b16 v[230:231], v233 offset:6144
ds_read_b128 v[144:147], v4 offset:0
v_add_u32_dpp v212, v246, v236 row_newbcast:0 row_mask:0xf bank_mask:0x3
v_add_u32_dpp v220, v246, v237 row_newbcast:2 row_mask:0xf bank_mask:0x3
v_mfma_f32_32x32x16_bf16 a[48:63], v[148:151], v[116:119], a[48:63]
buffer_load_dwordx4 v10, s[8:11], s38 offen offset:2048 nt lds
s_add_u32 m0, s49, 12288
v_add_u32_dpp v213, v247, v238 row_newbcast:0 row_mask:0xf bank_mask:0x3
v_add_u32_dpp v221, v247, v239 row_newbcast:2 row_mask:0xf bank_mask:0x3
v_add_u32_dpp v214, v248, v236 row_newbcast:0 row_mask:0xf bank_mask:0x3
v_mfma_f32_32x32x16_bf16 a[144:159], v[148:151], v[132:135], a[144:159]
ds_read_b128 v[148:151], v5 offset:0
v_add_u32_dpp v222, v248, v237 row_newbcast:2 row_mask:0xf bank_mask:0x3
v_add_u32_dpp v215, v249, v238 row_newbcast:0 row_mask:0xf bank_mask:0x3
v_add_u32_dpp v223, v249, v239 row_newbcast:2 row_mask:0xf bank_mask:0x3
v_add_u32_dpp v212, v246, v236 row_newbcast:1 row_mask:0xf bank_mask:0xc
s_waitcnt lgkmcnt(8)
v_mfma_f32_32x32x16_bf16 a[64:79], v[152:155], v[116:119], a[64:79]
v_add_u32_dpp v220, v246, v237 row_newbcast:3 row_mask:0xf bank_mask:0xc
v_add_u32_dpp v213, v247, v238 row_newbcast:1 row_mask:0xf bank_mask:0xc
v_add_u32_dpp v221, v247, v239 row_newbcast:3 row_mask:0xf bank_mask:0xc
v_add_u32_dpp v214, v248, v236 row_newbcast:1 row_mask:0xf bank_mask:0xc
v_add_u32_dpp v222, v248, v237 row_newbcast:3 row_mask:0xf bank_mask:0xc
v_mfma_f32_32x32x16_bf16 a[160:175], v[152:155], v[132:135], a[160:175]
ds_read_b128 v[152:155], v2 offset:128
buffer_load_dwordx4 v11, s[12:15], s39 offen offset:0 nt lds
v_add_u32_dpp v215, v249, v238 row_newbcast:1 row_mask:0xf bank_mask:0xc
v_add_u32_dpp v223, v249, v239 row_newbcast:3 row_mask:0xf bank_mask:0xc
v_mov_b32_dpp v246, v246 row_ror:12 row_mask:0xf bank_mask:0xf
v_mfma_f32_32x32x16_bf16 a[80:95], v[156:159], v[116:119], a[80:95]
v_mov_b32_dpp v247, v247 row_ror:12 row_mask:0xf bank_mask:0xf
v_mov_b32_dpp v248, v248 row_ror:12 row_mask:0xf bank_mask:0xf
v_mov_b32_dpp v249, v249 row_ror:12 row_mask:0xf bank_mask:0xf
v_cndmask_b32_e64 v74, v74, v21, s[56:57]
v_add_f32 v18, v18, v22
v_mfma_f32_32x32x16_bf16 a[176:191], v[156:159], v[132:135], a[176:191]
ds_read_b128 v[156:159], v3 offset:128
v_cvt_pk_bf16_f32 v122, v26, v27
v_fma_f32 v25, v73, s37, v14
v_exp_f32 v24, v24
s_waitcnt lgkmcnt(8)
v_mfma_f32_32x32x16_bf16 v[80:95], v[136:139], a[240:243], 0
buffer_load_dwordx4 v12, s[12:15], s39 offen offset:1024 nt lds
ds_read_b128 v[136:139], v4 offset:128
v_cmp_gt_i32_e64 s[54:55], 24, v20
v_cndmask_b32_e64 v75, v75, v21, s[58:59]
v_add_f32 v18, v18, v23
s_waitcnt lgkmcnt(7)
v_mfma_f32_16x16x32_bf16 v[168:171], v[224:227], v[200:203], v[168:171]
v_fma_f32 v26, v74, s37, v14
v_cmp_gt_i32_e64 s[56:57], 25, v20
s_waitcnt lgkmcnt(5)
v_mfma_f32_16x16x32_bf16 v[172:175], v[228:231], v[200:203], v[172:175]
ds_read_b64_tr_b16 v[224:225], v234 offset:4096
ds_read_b64_tr_b16 v[226:227], v234 offset:6144
ds_read_b64_tr_b16 v[228:229], v235 offset:4096
ds_read_b64_tr_b16 v[230:231], v235 offset:6144
v_mfma_f32_32x32x16_bf16 v[80:95], v[140:143], a[244:247], v[80:95]
ds_read_b128 v[140:143], v5 offset:128
v_exp_f32 v25, v25
v_cndmask_b32_e64 v76, v76, v21, s[54:55]
v_add_f32 v18, v18, v24
s_waitcnt lgkmcnt(8)
v_mfma_f32_32x32x16_bf16 v[80:95], v[144:147], a[248:251], v[80:95]
buffer_load_dwordx4 v13, s[12:15], s39 offen offset:2048 nt lds
s_add_u32 m0, s53, 0
ds_read_b128 v[144:147], v2 offset:256
v_cvt_pk_bf16_f32 v123, v22, v23
v_fma_f32 v27, v75, s37, v14
v_mfma_f32_32x32x16_bf16 v[80:95], v[148:151], a[252:255], v[80:95]
ds_read_b128 v[148:151], v3 offset:256
v_exp_f32 v26, v26
v_cmp_gt_i32_e64 s[58:59], 26, v20
v_cmp_gt_i32_e64 s[54:55], 27, v20
s_waitcnt lgkmcnt(8)
v_mfma_f32_32x32x16_bf16 v[80:95], v[152:155], v[32:35], v[80:95]
ds_read_b128 v[152:155], v4 offset:256
v_cndmask_b32_e64 v77, v77, v21, s[56:57]
v_add_f32 v18, v18, v25
v_fma_f32 v22, v76, s37, v14
v_cndmask_b32_e64 v78, v78, v21, s[58:59]
s_waitcnt lgkmcnt(6)
v_mfma_f32_16x16x32_bf16 v[176:179], v[224:227], v[200:203], v[176:179]
buffer_load_dwordx4 v210, s[20:23], 0 offen offset:0 lds
v_cndmask_b32_e64 v79, v79, v21, s[54:55]
s_waitcnt lgkmcnt(4)
v_mfma_f32_16x16x32_bf16 v[180:183], v[228:231], v[200:203], v[180:183]
s_waitcnt vmcnt(11)
ds_read_b64_tr_b16 v[224:225], v232 offset:8192
ds_read_b64_tr_b16 v[226:227], v232 offset:10240
ds_read_b64_tr_b16 v[228:229], v233 offset:8192
ds_read_b64_tr_b16 v[230:231], v233 offset:10240
v_mfma_f32_32x32x16_bf16 v[80:95], v[156:159], v[36:39], v[80:95]
ds_read_b128 v[156:159], v5 offset:256
v_exp_f32 v27, v27
v_add_f32 v18, v18, v26
v_cvt_pk_bf16_f32 v124, v24, v25
s_waitcnt lgkmcnt(8)
v_mfma_f32_32x32x16_bf16 v[80:95], v[136:139], v[40:43], v[80:95]
buffer_load_dwordx4 v218, s[20:23], 0 offen offset:1024 lds
v_fma_f32 v23, v77, s37, v14
v_exp_f32 v22, v22
v_add_f32 v18, v18, v27
v_mfma_f32_32x32x16_bf16 v[80:95], v[140:143], v[44:47], v[80:95]
v_fma_f32 v24, v78, s37, v14
v_exp_f32 v23, v23
v_fma_f32 v25, v79, s37, v14
v_add_f32 v18, v18, v22
s_waitcnt lgkmcnt(6)
v_mfma_f32_32x32x16_bf16 v[80:95], v[144:147], v[48:51], v[80:95]
v_exp_f32 v24, v24
v_exp_f32 v25, v25
v_add_f32 v18, v18, v23
s_waitcnt lgkmcnt(3)
v_mfma_f32_16x16x32_bf16 v[168:171], v[224:227], v[204:207], v[168:171]
buffer_load_dwordx4 v211, s[20:23], 0 offen offset:2048 lds
v_cvt_pk_bf16_f32 v126, v22, v23
v_add_f32 v18, v18, v24
v_cvt_pk_bf16_f32 v127, v24, v25
v_fma_f32 v22, v96, s37, v15
v_fma_f32 v23, v97, s37, v15
v_add_f32 v18, v18, v25
v_exp_f32 v22, v22
v_fma_f32 v24, v98, s37, v15
v_exp_f32 v23, v23
v_cvt_pk_bf16_f32 v125, v26, v27
v_fma_f32 v25, v99, s37, v15
v_exp_f32 v24, v24
ds_read_b64_tr_b16 v[136:137], v6 offset:36864
ds_read_b64_tr_b16 v[138:139], v6 offset:39936
ds_read_b64_tr_b16 v[140:141], v7 offset:36864
ds_read_b64_tr_b16 v[142:143], v7 offset:39936
v_add_f32 v19, v22, v23
v_fma_f32 v26, v100, s37, v15
v_exp_f32 v25, v25
s_waitcnt lgkmcnt(5)
v_mfma_f32_16x16x32_bf16 v[172:175], v[228:231], v[204:207], v[172:175]
v_add_f32 v19, v19, v24
v_cvt_pk_bf16_f32 v128, v22, v23
v_fma_f32 v27, v101, s37, v15
v_exp_f32 v26, v26
v_add_f32 v19, v19, v25
v_fma_f32 v22, v102, s37, v15
v_exp_f32 v27, v27
v_add_f32 v19, v19, v26
v_cvt_pk_bf16_f32 v129, v24, v25
v_fma_f32 v23, v103, s37, v15
v_exp_f32 v22, v22
v_add_f32 v19, v19, v27
v_fma_f32 v24, v104, s37, v15
v_exp_f32 v23, v23
v_mfma_f32_32x32x16_bf16 v[80:95], v[148:151], v[52:55], v[80:95]
v_add_f32 v19, v19, v22
v_cvt_pk_bf16_f32 v130, v26, v27
v_fma_f32 v25, v105, s37, v15
v_exp_f32 v24, v24
v_add_f32 v19, v19, v23
v_fma_f32 v26, v106, s37, v15
v_exp_f32 v25, v25
v_add_f32 v19, v19, v24
v_cvt_pk_bf16_f32 v131, v22, v23
v_fma_f32 v27, v107, s37, v15
v_exp_f32 v26, v26
v_add_f32 v19, v19, v25
v_fma_f32 v22, v108, s37, v15
v_exp_f32 v27, v27
v_and_b32 v196, v162, v250
v_and_b32 v197, v162, v251
v_and_b32 v198, v163, v250
v_and_b32 v199, v163, v251
ds_read_b64_tr_b16 v[144:145], v6 offset:36992
ds_read_b64_tr_b16 v[146:147], v6 offset:40064
ds_read_b64_tr_b16 v[148:149], v7 offset:36992
ds_read_b64_tr_b16 v[150:151], v7 offset:40064
v_add_f32 v19, v19, v26
v_cvt_pk_bf16_f32 v132, v24, v25
v_fma_f32 v23, v109, s37, v15
v_exp_f32 v22, v22
s_waitcnt lgkmcnt(8)
v_mfma_f32_32x32x16_bf16 v[80:95], v[152:155], v[56:59], v[80:95]
s_barrier
buffer_load_dwordx4 v219, s[20:23], 0 offen offset:3072 lds
s_add_u32 m0, s53, 4096
v_add_f32 v19, v19, v27
v_fma_f32 v24, v110, s37, v15
v_exp_f32 v23, v23
v_add_f32 v19, v19, v22
v_fma_f32 v25, v111, s37, v15
v_exp_f32 v24, v24
v_add_f32 v19, v19, v23
v_exp_f32 v25, v25
v_add_f32 v19, v19, v24
ds_read_b64_tr_b16 v[224:225], v234 offset:8192
ds_read_b64_tr_b16 v[226:227], v234 offset:10240
ds_read_b64_tr_b16 v[228:229], v235 offset:8192
ds_read_b64_tr_b16 v[230:231], v235 offset:10240
v_mfma_f32_32x32x16_bf16 v[80:95], v[156:159], v[60:63], v[80:95]
buffer_load_dwordx4 v212, s[20:23], 0 offen offset:0 lds
buffer_load_dwordx4 v220, s[20:23], 0 offen offset:1024 lds
buffer_load_dwordx4 v213, s[20:23], 0 offen offset:2048 lds
buffer_load_dwordx4 v221, s[20:23], 0 offen offset:3072 lds
v_cvt_pk_bf16_f32 v133, v26, v27
v_cvt_pk_bf16_f32 v134, v22, v23
v_add_f32 v19, v19, v25
v_cvt_pk_bf16_f32 v135, v24, v25
v_cmp_nge_f32 vcc, s52, v18
s_cbranch_vccnz Lst_d3_X
Lct_d3_X:
v_add_f32 v16, v16, v18
v_add_u32 v20, -32, v20
s_add_u32 s38, s38, s78
s_add_u32 s99, s99, 4
s_cmp_eq_u32 s99, s40
s_cselect_b32 s38, s88, s38
s_cselect_b32 s78, -12288, s78
s_cmp_eq_u32 s99, 28
s_cselect_b32 s38, s41, s38
s_cselect_b32 s78, 12288, s78
s_add_u32 s39, s39, s98
v_and_b32 v200, v164, v250
v_and_b32 v201, v164, v251
v_and_b32 v202, v165, v250
v_and_b32 v203, v165, v251
v_cmp_nge_f32 vcc, s52, v19
s_cbranch_vccnz Lst_d3_Y
Lct_d3_Y:
v_add_f32 v17, v17, v19
v_and_b32 v20, 31, v1
v_lshrrev_b32 v30, 5, v1
v_lshlrev_b32 v30, 2, v30
v_sub_u32 v20, v20, v30
s_lshl_b32 s84, s36, 5
v_add_u32 v20, s84, v20
s_mov_b32 s87, 3
s_add_u32 s74, s75, 4096
s_mul_i32 s75, s87, 6144
s_add_u32 s75, s75, s47
s_add_u32 s87, s87, 1
s_lshl_b32 s77, s87, 2
s_lshr_b32 s84, s87, 1
s_and_b32 s85, s87, 1
s_lshl_b32 s86, s45, 8
s_lshl_b32 s63, s36, 5
s_add_u32 s86, s86, s63
s_lshl_b32 s84, s84, 7
s_add_u32 s86, s86, s84
s_lshl_b32 s85, s85, 4
s_add_u32 s86, s86, s85
s_mul_i32 s79, s86, 384
s_waitcnt lgkmcnt(8)
v_mfma_f32_32x32x16_bf16 a[0:15], v[136:139], v[120:123], a[0:15]
ds_read_b64_tr_b16 v[152:153], v6 offset:37120
ds_read_b64_tr_b16 v[154:155], v6 offset:40192
ds_read_b64_tr_b16 v[156:157], v7 offset:37120
ds_read_b64_tr_b16 v[158:159], v7 offset:40192
s_waitcnt lgkmcnt(6)
v_mfma_f32_16x16x32_bf16 v[176:179], v[224:227], v[204:207], v[176:179]
s_waitcnt lgkmcnt(4)
v_mfma_f32_16x16x32_bf16 v[180:183], v[228:231], v[204:207], v[180:183]
s_waitcnt vmcnt(14)
ds_read_b64_tr_b16 v[224:225], v232 offset:12288
ds_read_b64_tr_b16 v[226:227], v232 offset:14336
v_mfma_f32_32x32x16_bf16 a[96:111], v[136:139], v[128:131], a[96:111]
ds_read_b64_tr_b16 v[228:229], v233 offset:12288
ds_read_b64_tr_b16 v[230:231], v233 offset:14336
ds_read_b64_tr_b16 v[136:137], v6 offset:43008
ds_read_b64_tr_b16 v[138:139], v6 offset:46080
s_add_u32 m0, s53, 8192
v_mfma_f32_32x32x16_bf16 a[16:31], v[140:143], v[120:123], a[16:31]
buffer_load_dwordx4 v214, s[20:23], 0 offen offset:0 lds
v_cvt_pk_bf16_f32 v184, v168, v169
v_cvt_pk_bf16_f32 v185, v170, v171
v_cvt_pk_bf16_f32 v186, v172, v173
v_cvt_pk_bf16_f32 v187, v174, v175
v_mfma_f32_32x32x16_bf16 a[112:127], v[140:143], v[128:131], a[112:127]
ds_read_b64_tr_b16 v[140:141], v7 offset:43008
ds_read_b64_tr_b16 v[142:143], v7 offset:46080
v_accvgpr_write_b32 a192, v184
v_accvgpr_write_b32 a193, v185
v_accvgpr_write_b32 a194, v186
v_mfma_f32_32x32x16_bf16 a[32:47], v[144:147], v[120:123], a[32:47]
v_accvgpr_write_b32 a195, v187
v_cmp_gt_i32_e64 s[54:55], 0, v20
v_cmp_gt_i32_e64 s[56:57], 1, v20
v_cmp_gt_i32_e64 s[58:59], 2, v20
v_cndmask_b32_e64 v80, v80, v21, s[54:55]
v_mfma_f32_32x32x16_bf16 a[128:143], v[144:147], v[128:131], a[128:143]
buffer_load_dwordx4 v222, s[20:23], 0 offen offset:1024 lds
ds_read_b64_tr_b16 v[144:145], v6 offset:43136
ds_read_b64_tr_b16 v[146:147], v6 offset:46208
v_cndmask_b32_e64 v81, v81, v21, s[56:57]
v_cmp_gt_i32_e64 s[54:55], 3, v20
v_mfma_f32_32x32x16_bf16 a[48:63], v[148:151], v[120:123], a[48:63]
v_cndmask_b32_e64 v82, v82, v21, s[58:59]
v_fma_f32 v22, v80, s37, v15
v_fma_f32 v23, v81, s37, v15
v_cmp_gt_i32_e64 s[56:57], 8, v20
v_cndmask_b32_e64 v83, v83, v21, s[54:55]
v_mfma_f32_32x32x16_bf16 a[144:159], v[148:151], v[128:131], a[144:159]
ds_read_b64_tr_b16 v[148:149], v7 offset:43136
ds_read_b64_tr_b16 v[150:151], v7 offset:46208
v_exp_f32 v22, v22
v_fma_f32 v24, v82, s37, v15
s_waitcnt lgkmcnt(12)
v_mfma_f32_32x32x16_bf16 a[64:79], v[152:155], v[120:123], a[64:79]
buffer_load_dwordx4 v215, s[20:23], 0 offen offset:2048 lds
v_exp_f32 v23, v23
v_cmp_gt_i32_e64 s[58:59], 9, v20
v_cndmask_b32_e64 v84, v84, v21, s[56:57]
s_waitcnt lgkmcnt(10)
v_mfma_f32_16x16x32_bf16 v[168:171], v[224:227], v[192:195], 0
v_fma_f32 v25, v83, s37, v15
v_cmp_gt_i32_e64 s[54:55], 10, v20
s_waitcnt lgkmcnt(8)
v_mfma_f32_16x16x32_bf16 v[172:175], v[228:231], v[192:195], 0
ds_read_b64_tr_b16 v[224:225], v234 offset:12288
ds_read_b64_tr_b16 v[226:227], v234 offset:14336
v_mfma_f32_32x32x16_bf16 a[160:175], v[152:155], v[128:131], a[160:175]
ds_read_b64_tr_b16 v[228:229], v235 offset:12288
ds_read_b64_tr_b16 v[230:231], v235 offset:14336
ds_read_b64_tr_b16 v[152:153], v6 offset:43264
ds_read_b64_tr_b16 v[154:155], v6 offset:46336
v_cvt_pk_bf16_f32 v188, v176, v177
v_mfma_f32_32x32x16_bf16 a[80:95], v[156:159], v[120:123], a[80:95]
buffer_load_dwordx4 v223, s[20:23], 0 offen offset:3072 lds
v_cvt_pk_bf16_f32 v189, v178, v179
v_cvt_pk_bf16_f32 v190, v180, v181
v_cvt_pk_bf16_f32 v191, v182, v183
v_accvgpr_write_b32 a196, v188
v_mfma_f32_32x32x16_bf16 a[176:191], v[156:159], v[128:131], a[176:191]
ds_read_b64_tr_b16 v[156:157], v7 offset:43264
ds_read_b64_tr_b16 v[158:159], v7 offset:46336
v_accvgpr_write_b32 a197, v189
v_accvgpr_write_b32 a198, v190
v_accvgpr_write_b32 a199, v191
s_waitcnt lgkmcnt(12)
v_mfma_f32_32x32x16_bf16 a[0:15], v[136:139], v[124:127], a[0:15]
v_and_b32 v204, v166, v250
v_and_b32 v205, v166, v251
v_and_b32 v206, v167, v250
v_and_b32 v207, v167, v251
s_add_u32 m0, s49, 24576
v_mfma_f32_32x32x16_bf16 a[96:111], v[136:139], v[132:135], a[96:111]
ds_read_b128 v[136:139], v2 offset:12288
buffer_load_dwordx4 v11, s[12:15], s39 offen offset:0 nt lds
v_exp_f32 v24, v24
v_cndmask_b32_e64 v85, v85, v21, s[58:59]
v_mfma_f32_32x32x16_bf16 a[16:31], v[140:143], v[124:127], a[16:31]
v_add_f32 v19, v22, v23
v_fma_f32 v26, v84, s37, v15
v_exp_f32 v25, v25
v_cmp_gt_i32_e64 s[56:57], 11, v20
v_mfma_f32_32x32x16_bf16 a[112:127], v[140:143], v[132:135], a[112:127]
ds_read_b128 v[140:143], v3 offset:12288
v_cndmask_b32_e64 v86, v86, v21, s[54:55]
v_add_f32 v19, v19, v24
v_cvt_pk_bf16_f32 v112, v22, v23
v_fma_f32 v27, v85, s37, v15
s_waitcnt lgkmcnt(10)
v_mfma_f32_32x32x16_bf16 a[32:47], v[144:147], v[124:127], a[32:47]
buffer_load_dwordx4 v12, s[12:15], s39 offen offset:1024 nt lds
v_exp_f32 v26, v26
v_cmp_gt_i32_e64 s[58:59], 16, v20
v_cndmask_b32_e64 v87, v87, v21, s[56:57]
s_waitcnt lgkmcnt(8)
v_mfma_f32_16x16x32_bf16 v[176:179], v[224:227], v[192:195], 0
v_add_f32 v19, v19, v25
v_fma_f32 v22, v86, s37, v15
s_waitcnt lgkmcnt(6)
v_mfma_f32_16x16x32_bf16 v[180:183], v[228:231], v[192:195], 0
s_waitcnt vmcnt(10)
ds_read_b64_tr_b16 v[224:225], v232 offset:0
ds_read_b64_tr_b16 v[226:227], v232 offset:2048
v_mfma_f32_32x32x16_bf16 a[128:143], v[144:147], v[132:135], a[128:143]
ds_read_b64_tr_b16 v[228:229], v233 offset:0
ds_read_b64_tr_b16 v[230:231], v233 offset:2048
ds_read_b128 v[144:147], v4 offset:12288
v_exp_f32 v27, v27
v_mfma_f32_32x32x16_bf16 a[48:63], v[148:151], v[124:127], a[48:63]
buffer_load_dwordx4 v13, s[12:15], s39 offen offset:2048 nt lds
s_add_u32 m0, s53, 12160
v_cmp_gt_i32_e64 s[54:55], 17, v20
v_cndmask_b32_e64 v88, v88, v21, s[58:59]
v_add_f32 v19, v19, v26
v_mfma_f32_32x32x16_bf16 a[144:159], v[148:151], v[132:135], a[144:159]
ds_read_b128 v[148:151], v5 offset:12288
v_cvt_pk_bf16_f32 v113, v24, v25
v_fma_f32 v23, v87, s37, v15
v_exp_f32 v22, v22
s_waitcnt lgkmcnt(8)
v_mfma_f32_32x32x16_bf16 a[64:79], v[152:155], v[124:127], a[64:79]
v_cmp_gt_i32_e64 s[56:57], 18, v20
v_cndmask_b32_e64 v89, v89, v21, s[54:55]
v_add_f32 v19, v19, v27
v_fma_f32 v24, v88, s37, v15
v_cmp_gt_i32_e64 s[58:59], 19, v20
v_mfma_f32_32x32x16_bf16 a[160:175], v[152:155], v[132:135], a[160:175]
ds_read_b128 v[152:155], v2 offset:12416
buffer_load_dwordx4 v208, s[20:23], 0 offen offset:128 lds
v_exp_f32 v23, v23
v_cndmask_b32_e64 v90, v90, v21, s[56:57]
v_mfma_f32_32x32x16_bf16 a[80:95], v[156:159], v[124:127], a[80:95]
v_add_f32 v19, v19, v22
v_cvt_pk_bf16_f32 v114, v26, v27
v_fma_f32 v25, v89, s37, v15
v_exp_f32 v24, v24
v_mfma_f32_32x32x16_bf16 a[176:191], v[156:159], v[132:135], a[176:191]
ds_read_b128 v[156:159], v3 offset:12416
v_cmp_gt_i32_e64 s[54:55], 24, v20
v_cndmask_b32_e64 v91, v91, v21, s[58:59]
v_add_f32 v19, v19, v23
v_fma_f32 v26, v90, s37, v15
s_waitcnt lgkmcnt(8)
v_mfma_f32_32x32x16_bf16 v[96:111], v[136:139], a[240:243], 0
buffer_load_dwordx4 v216, s[20:23], 0 offen offset:1152 lds
ds_read_b128 v[136:139], v4 offset:12416
v_exp_f32 v25, v25
v_cmp_gt_i32_e64 s[56:57], 25, v20
s_waitcnt lgkmcnt(7)
v_mfma_f32_16x16x32_bf16 v[168:171], v[224:227], v[196:199], v[168:171]
v_cndmask_b32_e64 v92, v92, v21, s[54:55]
v_add_f32 v19, v19, v24
s_waitcnt lgkmcnt(5)
v_mfma_f32_16x16x32_bf16 v[172:175], v[228:231], v[196:199], v[172:175]
ds_read_b64_tr_b16 v[224:225], v234 offset:0
ds_read_b64_tr_b16 v[226:227], v234 offset:2048
ds_read_b64_tr_b16 v[228:229], v235 offset:0
ds_read_b64_tr_b16 v[230:231], v235 offset:2048
v_mfma_f32_32x32x16_bf16 v[96:111], v[140:143], a[244:247], v[96:111]
ds_read_b128 v[140:143], v5 offset:12416
v_cvt_pk_bf16_f32 v115, v22, v23
v_fma_f32 v27, v91, s37, v15
v_exp_f32 v26, v26
s_waitcnt lgkmcnt(8)
v_mfma_f32_32x32x16_bf16 v[96:111], v[144:147], a[248:251], v[96:111]
buffer_load_dwordx4 v209, s[20:23], 0 offen offset:2176 lds
ds_read_b128 v[144:147], v2 offset:12544
v_cmp_gt_i32_e64 s[58:59], 26, v20
v_cndmask_b32_e64 v93, v93, v21, s[56:57]
v_add_f32 v19, v19, v25
v_mfma_f32_32x32x16_bf16 v[96:111], v[148:151], a[252:255], v[96:111]
ds_read_b128 v[148:151], v3 offset:12544
v_fma_f32 v22, v92, s37, v15
v_exp_f32 v27, v27
v_cmp_gt_i32_e64 s[54:55], 27, v20
s_waitcnt lgkmcnt(8)
v_mfma_f32_32x32x16_bf16 v[96:111], v[152:155], v[32:35], v[96:111]
ds_read_b128 v[152:155], v4 offset:12544
v_cndmask_b32_e64 v94, v94, v21, s[58:59]
v_add_f32 v19, v19, v26
v_cvt_pk_bf16_f32 v116, v24, v25
v_fma_f32 v23, v93, s37, v15
s_waitcnt lgkmcnt(6)
v_mfma_f32_16x16x32_bf16 v[176:179], v[224:227], v[196:199], v[176:179]
buffer_load_dwordx4 v217, s[20:23], 0 offen offset:3200 lds
v_cndmask_b32_e64 v95, v95, v21, s[54:55]
s_waitcnt lgkmcnt(4)
v_mfma_f32_16x16x32_bf16 v[180:183], v[228:231], v[196:199], v[180:183]
s_waitcnt vmcnt(11)
ds_read_b64_tr_b16 v[224:225], v232 offset:4096
ds_read_b64_tr_b16 v[226:227], v232 offset:6144
ds_read_b64_tr_b16 v[228:229], v233 offset:4096
ds_read_b64_tr_b16 v[230:231], v233 offset:6144
v_mfma_f32_32x32x16_bf16 v[96:111], v[156:159], v[36:39], v[96:111]
ds_read_b128 v[156:159], v5 offset:12544
s_sub_u32 m0, s53, 128
v_exp_f32 v22, v22
v_add_f32 v19, v19, v27
s_waitcnt lgkmcnt(8)
v_mfma_f32_32x32x16_bf16 v[96:111], v[136:139], v[40:43], v[96:111]
ds_read_b64_tr_b16 v[136:137], v6 offset:0
ds_read_b64_tr_b16 v[138:139], v6 offset:3072
buffer_load_dwordx4 v210, s[20:23], 0 offen offset:128 lds
v_fma_f32 v24, v94, s37, v15
v_add_f32 v19, v19, v22
v_mfma_f32_32x32x16_bf16 v[96:111], v[140:143], v[44:47], v[96:111]
ds_read_b64_tr_b16 v[140:141], v7 offset:0
ds_read_b64_tr_b16 v[142:143], v7 offset:3072
v_exp_f32 v23, v23
v_fma_f32 v25, v95, s37, v15
s_waitcnt lgkmcnt(10)
v_mfma_f32_32x32x16_bf16 v[96:111], v[144:147], v[48:51], v[96:111]
ds_read_b64_tr_b16 v[144:145], v6 offset:128
ds_read_b64_tr_b16 v[146:147], v6 offset:3200
v_exp_f32 v24, v24
v_add_f32 v19, v19, v23
s_waitcnt lgkmcnt(9)
v_mfma_f32_16x16x32_bf16 v[168:171], v[224:227], v[200:203], v[168:171]
buffer_load_dwordx4 v218, s[20:23], 0 offen offset:1152 lds
v_add_f32 v19, v19, v24
s_waitcnt lgkmcnt(7)
v_mfma_f32_16x16x32_bf16 v[172:175], v[228:231], v[200:203], v[172:175]
ds_read_b64_tr_b16 v[224:225], v234 offset:4096
ds_read_b64_tr_b16 v[226:227], v234 offset:6144
v_mfma_f32_32x32x16_bf16 v[96:111], v[148:151], v[52:55], v[96:111]
ds_read_b64_tr_b16 v[148:149], v7 offset:128
ds_read_b64_tr_b16 v[150:151], v7 offset:3200
ds_read_b64_tr_b16 v[228:229], v235 offset:4096
ds_read_b64_tr_b16 v[230:231], v235 offset:6144
v_cvt_pk_bf16_f32 v117, v26, v27
s_waitcnt lgkmcnt(12)
v_mfma_f32_32x32x16_bf16 v[96:111], v[152:155], v[56:59], v[96:111]
s_barrier
buffer_load_dwordx4 v211, s[20:23], 0 offen offset:2176 lds
v_exp_f32 v25, v25
v_cvt_pk_bf16_f32 v118, v22, v23
v_add_f32 v19, v19, v25
v_mfma_f32_32x32x16_bf16 v[96:111], v[156:159], v[60:63], v[96:111]
buffer_load_dwordx4 v219, s[20:23], 0 offen offset:3200 lds
v_cvt_pk_bf16_f32 v119, v24, v25
s_add_u32 s39, s39, s98
v_add_u32 v20, -32, v20
v_cmp_nge_f32 vcc, s52, v19
s_cbranch_vccnz Lst_d4_Y
Lct_d4_Y:
v_add_f32 v17, v17, v19
ds_read_b64_tr_b16 v[152:153], v6 offset:256
ds_read_b64_tr_b16 v[154:155], v6 offset:3328
s_waitcnt lgkmcnt(10)
v_mfma_f32_32x32x16_bf16 a[96:111], v[136:139], v[112:115], a[96:111]
ds_read_b64_tr_b16 v[156:157], v7 offset:256
ds_read_b64_tr_b16 v[158:159], v7 offset:3328
ds_read_b64_tr_b16 v[136:137], v6 offset:6144
ds_read_b64_tr_b16 v[138:139], v6 offset:9216
s_waitcnt lgkmcnt(10)
v_mfma_f32_16x16x32_bf16 v[176:179], v[224:227], v[200:203], v[176:179]
s_waitcnt lgkmcnt(6)
v_mfma_f32_16x16x32_bf16 v[180:183], v[228:231], v[200:203], v[180:183]
s_waitcnt vmcnt(11)
ds_read_b64_tr_b16 v[224:225], v232 offset:8192
ds_read_b64_tr_b16 v[226:227], v232 offset:10240
ds_read_b64_tr_b16 v[228:229], v233 offset:8192
ds_read_b64_tr_b16 v[230:231], v233 offset:10240
v_mfma_f32_32x32x16_bf16 a[112:127], v[140:143], v[112:115], a[112:127]
ds_read_b64_tr_b16 v[140:141], v7 offset:6144
ds_read_b64_tr_b16 v[142:143], v7 offset:9216
s_add_u32 m0, s53, 3968
v_cmp_gt_i32_e64 s[54:55], 0, v20
buffer_load_dwordx4 v212, s[20:23], 0 offen offset:128 lds
v_mfma_f32_32x32x16_bf16 a[128:143], v[144:147], v[112:115], a[128:143]
ds_read_b64_tr_b16 v[144:145], v6 offset:6272
ds_read_b64_tr_b16 v[146:147], v6 offset:9344
v_cmp_gt_i32_e64 s[56:57], 1, v20
v_cmp_gt_i32_e64 s[58:59], 2, v20
v_cndmask_b32_e64 v96, v96, v21, s[54:55]
v_mfma_f32_32x32x16_bf16 a[144:159], v[148:151], v[112:115], a[144:159]
ds_read_b64_tr_b16 v[148:149], v7 offset:6272
ds_read_b64_tr_b16 v[150:151], v7 offset:9344
v_cndmask_b32_e64 v97, v97, v21, s[56:57]
v_cmp_gt_i32_e64 s[54:55], 3, v20
v_cndmask_b32_e64 v98, v98, v21, s[58:59]
s_waitcnt lgkmcnt(12)
v_mfma_f32_32x32x16_bf16 a[160:175], v[152:155], v[112:115], a[160:175]
buffer_load_dwordx4 v220, s[20:23], 0 offen offset:1152 lds
ds_read_b64_tr_b16 v[152:153], v6 offset:6400
ds_read_b64_tr_b16 v[154:155], v6 offset:9472
v_fma_f32 v22, v96, s37, v15
v_fma_f32 v23, v97, s37, v15
s_waitcnt lgkmcnt(10)
v_mfma_f32_16x16x32_bf16 v[168:171], v[224:227], v[204:207], v[168:171]
v_cmp_gt_i32_e64 s[56:57], 8, v20
v_cndmask_b32_e64 v99, v99, v21, s[54:55]
s_waitcnt lgkmcnt(8)
v_mfma_f32_16x16x32_bf16 v[172:175], v[228:231], v[204:207], v[172:175]
ds_read_b64_tr_b16 v[224:225], v234 offset:8192
ds_read_b64_tr_b16 v[226:227], v234 offset:10240
ds_read_b64_tr_b16 v[228:229], v235 offset:8192
ds_read_b64_tr_b16 v[230:231], v235 offset:10240
v_mfma_f32_32x32x16_bf16 a[176:191], v[156:159], v[112:115], a[176:191]
ds_read_b64_tr_b16 v[156:157], v7 offset:6400
ds_read_b64_tr_b16 v[158:159], v7 offset:9472
v_exp_f32 v22, v22
v_fma_f32 v24, v98, s37, v15
s_waitcnt lgkmcnt(12)
v_mfma_f32_32x32x16_bf16 a[96:111], v[136:139], v[116:119], a[96:111]
buffer_load_dwordx4 v213, s[20:23], 0 offen offset:2176 lds
ds_read_b128 v[136:139], v2 offset:24576
v_exp_f32 v23, v23
v_cmp_gt_i32_e64 s[58:59], 9, v20
v_mfma_f32_32x32x16_bf16 a[112:127], v[140:143], v[116:119], a[112:127]
ds_read_b128 v[140:143], v3 offset:24576
v_cndmask_b32_e64 v100, v100, v21, s[56:57]
v_fma_f32 v25, v99, s37, v15
v_exp_f32 v24, v24
s_waitcnt lgkmcnt(10)
v_mfma_f32_32x32x16_bf16 a[128:143], v[144:147], v[116:119], a[128:143]
ds_read_b128 v[144:147], v4 offset:24576
v_cmp_gt_i32_e64 s[54:55], 10, v20
v_cndmask_b32_e64 v101, v101, v21, s[58:59]
v_add_f32 v19, v22, v23
v_fma_f32 v26, v100, s37, v15
s_waitcnt lgkmcnt(7)
v_mfma_f32_16x16x32_bf16 v[176:179], v[224:227], v[204:207], v[176:179]
buffer_load_dwordx4 v221, s[20:23], 0 offen offset:3200 lds
s_add_u32 m0, s49, 36864
s_waitcnt lgkmcnt(5)
v_mfma_f32_16x16x32_bf16 v[180:183], v[228:231], v[204:207], v[180:183]
s_waitcnt vmcnt(8)
ds_read_b64_tr_b16 v[224:225], v232 offset:12288
ds_read_b64_tr_b16 v[226:227], v232 offset:14336
ds_read_b64_tr_b16 v[228:229], v233 offset:12288
ds_read_b64_tr_b16 v[230:231], v233 offset:14336
v_mfma_f32_32x32x16_bf16 a[144:159], v[148:151], v[116:119], a[144:159]
ds_read_b128 v[148:151], v5 offset:24576
v_cvt_pk_bf16_f32 v184, v168, v169
v_cvt_pk_bf16_f32 v185, v170, v171
v_cvt_pk_bf16_f32 v186, v172, v173
v_cvt_pk_bf16_f32 v187, v174, v175
s_waitcnt lgkmcnt(8)
v_mfma_f32_32x32x16_bf16 a[160:175], v[152:155], v[116:119], a[160:175]
ds_read_b128 v[152:155], v2 offset:24704
buffer_load_dwordx4 v11, s[12:15], s39 offen offset:0 nt lds
v_accvgpr_write_b32 a200, v184
v_accvgpr_write_b32 a201, v185
v_accvgpr_write_b32 a202, v186
v_mfma_f32_32x32x16_bf16 a[176:191], v[156:159], v[116:119], a[176:191]
ds_read_b128 v[156:159], v3 offset:24704
v_accvgpr_write_b32 a203, v187
v_exp_f32 v25, v25
v_cmp_gt_i32_e64 s[56:57], 11, v20
s_waitcnt lgkmcnt(8)
v_mfma_f32_32x32x16_bf16 v[80:95], v[136:139], a[240:243], 0
ds_read_b128 v[136:139], v4 offset:24704
v_cndmask_b32_e64 v102, v102, v21, s[54:55]
v_add_f32 v19, v19, v24
v_cvt_pk_bf16_f32 v120, v22, v23
v_fma_f32 v27, v101, s37, v15
s_waitcnt lgkmcnt(6)
v_mfma_f32_16x16x32_bf16 v[168:171], v[224:227], v[192:195], 0
buffer_load_dwordx4 v12, s[12:15], s39 offen offset:1024 nt lds
v_cmp_gt_i32_e64 s[58:59], 16, v20
s_waitcnt lgkmcnt(4)
v_mfma_f32_16x16x32_bf16 v[172:175], v[228:231], v[192:195], 0
ds_read_b64_tr_b16 v[224:225], v234 offset:12288
ds_read_b64_tr_b16 v[226:227], v234 offset:14336
ds_read_b64_tr_b16 v[228:229], v235 offset:12288
ds_read_b64_tr_b16 v[230:231], v235 offset:14336
v_mfma_f32_32x32x16_bf16 v[80:95], v[140:143], a[244:247], v[80:95]
ds_read_b128 v[140:143], v5 offset:24704
v_cvt_pk_bf16_f32 v188, v176, v177
v_cvt_pk_bf16_f32 v189, v178, v179
v_cvt_pk_bf16_f32 v190, v180, v181
v_cvt_pk_bf16_f32 v191, v182, v183
s_waitcnt lgkmcnt(8)
v_mfma_f32_32x32x16_bf16 v[80:95], v[144:147], a[248:251], v[80:95]
buffer_load_dwordx4 v13, s[12:15], s39 offen offset:2048 nt lds
s_add_u32 m0, s53, 8064
ds_read_b128 v[144:147], v2 offset:24832
v_accvgpr_write_b32 a204, v188
v_accvgpr_write_b32 a205, v189
v_mfma_f32_32x32x16_bf16 v[80:95], v[148:151], a[252:255], v[80:95]
ds_read_b128 v[148:151], v3 offset:24832
v_accvgpr_write_b32 a206, v190
v_accvgpr_write_b32 a207, v191
v_exp_f32 v26, v26
s_waitcnt lgkmcnt(8)
v_mfma_f32_32x32x16_bf16 v[80:95], v[152:155], v[32:35], v[80:95]
ds_read_b128 v[152:155], v4 offset:24832
v_cndmask_b32_e64 v103, v103, v21, s[56:57]
v_add_f32 v19, v19, v25
v_fma_f32 v22, v102, s37, v15
v_cmp_gt_i32_e64 s[54:55], 17, v20
s_waitcnt lgkmcnt(6)
v_mfma_f32_16x16x32_bf16 v[176:179], v[224:227], v[192:195], 0
buffer_load_dwordx4 v214, s[20:23], 0 offen offset:128 lds
v_cndmask_b32_e64 v104, v104, v21, s[58:59]
s_waitcnt lgkmcnt(4)
v_mfma_f32_16x16x32_bf16 v[180:183], v[228:231], v[192:195], 0
s_waitcnt vmcnt(8)
ds_read_b64_tr_b16 v[224:225], v232 offset:0
ds_read_b64_tr_b16 v[226:227], v232 offset:2048
ds_read_b64_tr_b16 v[228:229], v233 offset:0
ds_read_b64_tr_b16 v[230:231], v233 offset:2048
v_mfma_f32_32x32x16_bf16 v[80:95], v[156:159], v[36:39], v[80:95]
ds_read_b128 v[156:159], v5 offset:24832
v_exp_f32 v27, v27
v_add_f32 v19, v19, v26
v_cvt_pk_bf16_f32 v121, v24, v25
s_waitcnt lgkmcnt(8)
v_mfma_f32_32x32x16_bf16 v[80:95], v[136:139], v[40:43], v[80:95]
buffer_load_dwordx4 v222, s[20:23], 0 offen offset:1152 lds
v_fma_f32 v23, v103, s37, v15
v_exp_f32 v22, v22
v_cmp_gt_i32_e64 s[56:57], 18, v20
v_mfma_f32_32x32x16_bf16 v[80:95], v[140:143], v[44:47], v[80:95]
v_cndmask_b32_e64 v105, v105, v21, s[54:55]
v_add_f32 v19, v19, v27
v_fma_f32 v24, v104, s37, v15
v_exp_f32 v23, v23
s_waitcnt lgkmcnt(6)
v_mfma_f32_32x32x16_bf16 v[80:95], v[144:147], v[48:51], v[80:95]
v_cmp_gt_i32_e64 s[58:59], 19, v20
v_cndmask_b32_e64 v106, v106, v21, s[56:57]
v_add_f32 v19, v19, v22
v_cvt_pk_bf16_f32 v122, v26, v27
v_fma_f32 v25, v105, s37, v15
s_waitcnt lgkmcnt(3)
v_mfma_f32_16x16x32_bf16 v[168:171], v[224:227], v[196:199], v[168:171]
buffer_load_dwordx4 v215, s[20:23], 0 offen offset:2176 lds
v_cmp_gt_i32_e64 s[54:55], 24, v20
s_waitcnt lgkmcnt(1)
v_mfma_f32_16x16x32_bf16 v[172:175], v[228:231], v[196:199], v[172:175]
v_exp_f32 v24, v24
v_mfma_f32_32x32x16_bf16 v[80:95], v[148:151], v[52:55], v[80:95]
v_cndmask_b32_e64 v107, v107, v21, s[58:59]
v_add_f32 v19, v19, v23
v_fma_f32 v26, v106, s37, v15
v_exp_f32 v25, v25
s_waitcnt lgkmcnt(0)
v_mfma_f32_32x32x16_bf16 v[80:95], v[152:155], v[56:59], v[80:95]
s_barrier
buffer_load_dwordx4 v223, s[20:23], 0 offen offset:3200 lds
s_add_u32 m0, s53, 12032
v_cmp_gt_i32_e64 s[56:57], 25, v20
v_cndmask_b32_e64 v108, v108, v21, s[54:55]
v_add_f32 v19, v19, v24
v_cvt_pk_bf16_f32 v123, v22, v23
v_fma_f32 v27, v107, s37, v15
v_exp_f32 v26, v26
v_cmp_gt_i32_e64 s[58:59], 26, v20
v_cndmask_b32_e64 v109, v109, v21, s[56:57]
v_add_f32 v19, v19, v25
v_fma_f32 v22, v108, s37, v15
v_exp_f32 v27, v27
v_cmp_gt_i32_e64 s[54:55], 27, v20
v_cndmask_b32_e64 v110, v110, v21, s[58:59]
v_add_f32 v19, v19, v26
v_cvt_pk_bf16_f32 v124, v24, v25
v_fma_f32 v23, v109, s37, v15
v_exp_f32 v22, v22
v_cndmask_b32_e64 v111, v111, v21, s[54:55]
v_add_f32 v19, v19, v27
v_fma_f32 v24, v110, s37, v15
v_exp_f32 v23, v23
ds_read_b64_tr_b16 v[136:137], v6 offset:12288
ds_read_b64_tr_b16 v[138:139], v6 offset:15360
ds_read_b64_tr_b16 v[140:141], v7 offset:12288
ds_read_b64_tr_b16 v[142:143], v7 offset:15360
ds_read_b64_tr_b16 v[224:225], v234 offset:0
ds_read_b64_tr_b16 v[226:227], v234 offset:2048
ds_read_b64_tr_b16 v[228:229], v235 offset:0
ds_read_b64_tr_b16 v[230:231], v235 offset:2048
ds_read_b64_tr_b16 v[144:145], v6 offset:12416
ds_read_b64_tr_b16 v[146:147], v6 offset:15488
ds_read_b64_tr_b16 v[148:149], v7 offset:12416
ds_read_b64_tr_b16 v[150:151], v7 offset:15488
v_mfma_f32_32x32x16_bf16 v[80:95], v[156:159], v[60:63], v[80:95]
buffer_load_dwordx4 v208, s[20:23], 0 offen offset:256 lds
buffer_load_dwordx4 v216, s[20:23], 0 offen offset:1280 lds
buffer_load_dwordx4 v209, s[20:23], 0 offen offset:2304 lds
buffer_load_dwordx4 v217, s[20:23], 0 offen offset:3328 lds
v_add_f32 v19, v19, v22
v_fma_f32 v25, v111, s37, v15
v_exp_f32 v24, v24
v_add_f32 v19, v19, v23
v_exp_f32 v25, v25
v_add_f32 v19, v19, v24
v_cvt_pk_bf16_f32 v125, v26, v27
v_cvt_pk_bf16_f32 v126, v22, v23
v_add_f32 v19, v19, v25
v_cvt_pk_bf16_f32 v127, v24, v25
s_add_u32 s39, s39, s98
s_add_u32 s62, s62, 4
s_cmp_eq_u32 s62, s40
s_cselect_b32 s39, s88, s39
s_cselect_b32 s98, -12288, s98
s_cmp_eq_u32 s62, 28
s_cselect_b32 s39, s41, s39
s_cselect_b32 s98, 12288, s98
v_add_u32 v20, -32, v20
v_cmp_nge_f32 vcc, s52, v19
s_cbranch_vccnz Lst_d5_Y
Lct_d5_Y:
v_add_f32 v17, v17, v19
ds_read_b64_tr_b16 v[152:153], v6 offset:12544
ds_read_b64_tr_b16 v[154:155], v6 offset:15616
s_waitcnt lgkmcnt(10)
v_mfma_f32_32x32x16_bf16 a[96:111], v[136:139], v[120:123], a[96:111]
ds_read_b64_tr_b16 v[156:157], v7 offset:12544
ds_read_b64_tr_b16 v[158:159], v7 offset:15616
ds_read_b64_tr_b16 v[136:137], v6 offset:18432
ds_read_b64_tr_b16 v[138:139], v6 offset:21504
s_waitcnt lgkmcnt(12)
v_mfma_f32_16x16x32_bf16 v[176:179], v[224:227], v[196:199], v[176:179]
s_waitcnt lgkmcnt(10)
v_mfma_f32_16x16x32_bf16 v[180:183], v[228:231], v[196:199], v[180:183]
s_waitcnt vmcnt(11)
ds_read_b64_tr_b16 v[224:225], v232 offset:4096
ds_read_b64_tr_b16 v[226:227], v232 offset:6144
ds_read_b64_tr_b16 v[228:229], v233 offset:4096
ds_read_b64_tr_b16 v[230:231], v233 offset:6144
v_mfma_f32_32x32x16_bf16 a[112:127], v[140:143], v[120:123], a[112:127]
ds_read_b64_tr_b16 v[140:141], v7 offset:18432
ds_read_b64_tr_b16 v[142:143], v7 offset:21504
s_sub_u32 m0, s53, 256
v_cmp_gt_i32_e64 s[54:55], 0, v20
buffer_load_dwordx4 v210, s[20:23], 0 offen offset:256 lds
s_waitcnt lgkmcnt(12)
v_mfma_f32_32x32x16_bf16 a[128:143], v[144:147], v[120:123], a[128:143]
ds_read_b64_tr_b16 v[144:145], v6 offset:18560
ds_read_b64_tr_b16 v[146:147], v6 offset:21632
v_cmp_gt_i32_e64 s[56:57], 1, v20
v_cmp_gt_i32_e64 s[58:59], 2, v20
v_cndmask_b32_e64 v80, v80, v21, s[54:55]
v_mfma_f32_32x32x16_bf16 a[144:159], v[148:151], v[120:123], a[144:159]
ds_read_b64_tr_b16 v[148:149], v7 offset:18560
ds_read_b64_tr_b16 v[150:151], v7 offset:21632
v_cndmask_b32_e64 v81, v81, v21, s[56:57]
v_cmp_gt_i32_e64 s[54:55], 3, v20
v_cndmask_b32_e64 v82, v82, v21, s[58:59]
s_waitcnt lgkmcnt(12)
v_mfma_f32_32x32x16_bf16 a[160:175], v[152:155], v[120:123], a[160:175]
buffer_load_dwordx4 v218, s[20:23], 0 offen offset:1280 lds
ds_read_b64_tr_b16 v[152:153], v6 offset:18688
ds_read_b64_tr_b16 v[154:155], v6 offset:21760
v_fma_f32 v22, v80, s37, v15
v_fma_f32 v23, v81, s37, v15
s_waitcnt lgkmcnt(10)
v_mfma_f32_16x16x32_bf16 v[168:171], v[224:227], v[200:203], v[168:171]
v_cmp_gt_i32_e64 s[56:57], 8, v20
v_cndmask_b32_e64 v83, v83, v21, s[54:55]
s_waitcnt lgkmcnt(8)
v_mfma_f32_16x16x32_bf16 v[172:175], v[228:231], v[200:203], v[172:175]
ds_read_b64_tr_b16 v[224:225], v234 offset:4096
ds_read_b64_tr_b16 v[226:227], v234 offset:6144
ds_read_b64_tr_b16 v[228:229], v235 offset:4096
ds_read_b64_tr_b16 v[230:231], v235 offset:6144
v_mfma_f32_32x32x16_bf16 a[176:191], v[156:159], v[120:123], a[176:191]
ds_read_b64_tr_b16 v[156:157], v7 offset:18688
ds_read_b64_tr_b16 v[158:159], v7 offset:21760
v_exp_f32 v22, v22
v_fma_f32 v24, v82, s37, v15
s_waitcnt lgkmcnt(12)
v_mfma_f32_32x32x16_bf16 a[96:111], v[136:139], v[124:127], a[96:111]
buffer_load_dwordx4 v211, s[20:23], 0 offen offset:2304 lds
ds_read_b128 v[136:139], v2 offset:36864
v_exp_f32 v23, v23
v_cmp_gt_i32_e64 s[58:59], 9, v20
v_mfma_f32_32x32x16_bf16 a[112:127], v[140:143], v[124:127], a[112:127]
ds_read_b128 v[140:143], v3 offset:36864
v_cndmask_b32_e64 v84, v84, v21, s[56:57]
v_fma_f32 v25, v83, s37, v15
v_exp_f32 v24, v24
s_waitcnt lgkmcnt(10)
v_mfma_f32_32x32x16_bf16 a[128:143], v[144:147], v[124:127], a[128:143]
ds_read_b128 v[144:147], v4 offset:36864
v_cmp_gt_i32_e64 s[54:55], 10, v20
v_cndmask_b32_e64 v85, v85, v21, s[58:59]
v_add_f32 v19, v22, v23
v_fma_f32 v26, v84, s37, v15
s_waitcnt lgkmcnt(7)
v_mfma_f32_16x16x32_bf16 v[176:179], v[224:227], v[200:203], v[176:179]
buffer_load_dwordx4 v219, s[20:23], 0 offen offset:3328 lds
v_cmp_gt_i32_e64 s[56:57], 11, v20
s_waitcnt lgkmcnt(5)
v_mfma_f32_16x16x32_bf16 v[180:183], v[228:231], v[200:203], v[180:183]
s_waitcnt vmcnt(8)
ds_read_b64_tr_b16 v[224:225], v232 offset:8192
ds_read_b64_tr_b16 v[226:227], v232 offset:10240
ds_read_b64_tr_b16 v[228:229], v233 offset:8192
ds_read_b64_tr_b16 v[230:231], v233 offset:10240
v_mfma_f32_32x32x16_bf16 a[144:159], v[148:151], v[124:127], a[144:159]
ds_read_b128 v[148:151], v5 offset:36864
s_add_u32 m0, s53, 3840
v_exp_f32 v25, v25
v_cndmask_b32_e64 v86, v86, v21, s[54:55]
s_waitcnt lgkmcnt(8)
v_mfma_f32_32x32x16_bf16 a[160:175], v[152:155], v[124:127], a[160:175]
ds_read_b128 v[152:155], v2 offset:36992
buffer_load_dwordx4 v212, s[20:23], 0 offen offset:256 lds
v_add_f32 v19, v19, v24
v_cvt_pk_bf16_f32 v112, v22, v23
v_fma_f32 v27, v85, s37, v15
v_mfma_f32_32x32x16_bf16 a[176:191], v[156:159], v[124:127], a[176:191]
ds_read_b128 v[156:159], v3 offset:36992
v_exp_f32 v26, v26
v_cmp_gt_i32_e64 s[58:59], 16, v20
v_cndmask_b32_e64 v87, v87, v21, s[56:57]
s_waitcnt lgkmcnt(8)
v_mfma_f32_32x32x16_bf16 v[96:111], v[136:139], a[240:243], 0
ds_read_b128 v[136:139], v4 offset:36992
v_add_f32 v19, v19, v25
v_fma_f32 v22, v86, s37, v15
v_exp_f32 v27, v27
s_waitcnt lgkmcnt(6)
v_mfma_f32_16x16x32_bf16 v[168:171], v[224:227], v[204:207], v[168:171]
buffer_load_dwordx4 v220, s[20:23], 0 offen offset:1280 lds
v_cmp_gt_i32_e64 s[54:55], 17, v20
s_waitcnt lgkmcnt(4)
v_mfma_f32_16x16x32_bf16 v[172:175], v[228:231], v[204:207], v[172:175]
ds_read_b64_tr_b16 v[224:225], v234 offset:8192
ds_read_b64_tr_b16 v[226:227], v234 offset:10240
ds_read_b64_tr_b16 v[228:229], v235 offset:8192
ds_read_b64_tr_b16 v[230:231], v235 offset:10240
v_mfma_f32_32x32x16_bf16 v[96:111], v[140:143], a[244:247], v[96:111]
ds_read_b128 v[140:143], v5 offset:36992
v_add_u32_dpp v208, v242, v236 row_newbcast:0 row_mask:0xf bank_mask:0x3
v_add_u32_dpp v216, v242, v237 row_newbcast:2 row_mask:0xf bank_mask:0x3
v_add_u32_dpp v209, v243, v238 row_newbcast:0 row_mask:0xf bank_mask:0x3
v_add_u32_dpp v217, v243, v239 row_newbcast:2 row_mask:0xf bank_mask:0x3
s_waitcnt lgkmcnt(8)
v_mfma_f32_32x32x16_bf16 v[96:111], v[144:147], a[248:251], v[96:111]
buffer_load_dwordx4 v213, s[20:23], 0 offen offset:2304 lds
ds_read_b128 v[144:147], v2 offset:37120
v_add_u32_dpp v210, v244, v236 row_newbcast:0 row_mask:0xf bank_mask:0x3
v_add_u32_dpp v218, v244, v237 row_newbcast:2 row_mask:0xf bank_mask:0x3
v_add_u32_dpp v211, v245, v238 row_newbcast:0 row_mask:0xf bank_mask:0x3
v_mfma_f32_32x32x16_bf16 v[96:111], v[148:151], a[252:255], v[96:111]
ds_read_b128 v[148:151], v3 offset:37120
v_add_u32_dpp v219, v245, v239 row_newbcast:2 row_mask:0xf bank_mask:0x3
v_add_u32_dpp v208, v242, v236 row_newbcast:1 row_mask:0xf bank_mask:0xc
v_add_u32_dpp v216, v242, v237 row_newbcast:3 row_mask:0xf bank_mask:0xc
v_add_u32_dpp v209, v243, v238 row_newbcast:1 row_mask:0xf bank_mask:0xc
s_waitcnt lgkmcnt(8)
v_mfma_f32_32x32x16_bf16 v[96:111], v[152:155], v[32:35], v[96:111]
ds_read_b128 v[152:155], v4 offset:37120
v_add_u32_dpp v217, v243, v239 row_newbcast:3 row_mask:0xf bank_mask:0xc
v_add_u32_dpp v210, v244, v236 row_newbcast:1 row_mask:0xf bank_mask:0xc
v_add_u32_dpp v218, v244, v237 row_newbcast:3 row_mask:0xf bank_mask:0xc
v_add_u32_dpp v211, v245, v238 row_newbcast:1 row_mask:0xf bank_mask:0xc
s_waitcnt lgkmcnt(6)
v_mfma_f32_16x16x32_bf16 v[176:179], v[224:227], v[204:207], v[176:179]
buffer_load_dwordx4 v221, s[20:23], 0 offen offset:3328 lds
v_add_u32_dpp v219, v245, v239 row_newbcast:3 row_mask:0xf bank_mask:0xc
s_waitcnt lgkmcnt(4)
v_mfma_f32_16x16x32_bf16 v[180:183], v[228:231], v[204:207], v[180:183]
s_waitcnt vmcnt(8)
ds_read_b64_tr_b16 v[224:225], v232 offset:12288
ds_read_b64_tr_b16 v[226:227], v232 offset:14336
ds_read_b64_tr_b16 v[228:229], v233 offset:12288
ds_read_b64_tr_b16 v[230:231], v233 offset:14336
v_mfma_f32_32x32x16_bf16 v[96:111], v[156:159], v[36:39], v[96:111]
ds_read_b128 v[156:159], v5 offset:37120
v_cvt_pk_bf16_f32 v184, v168, v169
v_cvt_pk_bf16_f32 v185, v170, v171
v_mov_b32_dpp v242, v242 row_ror:12 row_mask:0xf bank_mask:0xf
v_mov_b32_dpp v243, v243 row_ror:12 row_mask:0xf bank_mask:0xf
s_waitcnt lgkmcnt(8)
v_mfma_f32_32x32x16_bf16 v[96:111], v[136:139], v[40:43], v[96:111]
v_mov_b32_dpp v244, v244 row_ror:12 row_mask:0xf bank_mask:0xf
v_mov_b32_dpp v245, v245 row_ror:12 row_mask:0xf bank_mask:0xf
v_cvt_pk_bf16_f32 v186, v172, v173
v_cvt_pk_bf16_f32 v187, v174, v175
s_add_u32 m0, s53, 7936
v_mfma_f32_32x32x16_bf16 v[96:111], v[140:143], v[44:47], v[96:111]
buffer_load_dwordx4 v214, s[20:23], 0 offen offset:256 lds
v_cndmask_b32_e64 v88, v88, v21, s[58:59]
v_add_f32 v19, v19, v26
v_cvt_pk_bf16_f32 v113, v24, v25
v_fma_f32 v23, v87, s37, v15
s_waitcnt lgkmcnt(6)
v_mfma_f32_32x32x16_bf16 v[96:111], v[144:147], v[48:51], v[96:111]
v_exp_f32 v22, v22
v_cmp_gt_i32_e64 s[56:57], 18, v20
v_cndmask_b32_e64 v89, v89, v21, s[54:55]
v_add_f32 v19, v19, v27
s_waitcnt lgkmcnt(3)
v_mfma_f32_16x16x32_bf16 v[168:171], v[224:227], v[192:195], 0
v_fma_f32 v24, v88, s37, v15
v_cmp_gt_i32_e64 s[58:59], 19, v20
s_waitcnt lgkmcnt(1)
v_mfma_f32_16x16x32_bf16 v[172:175], v[228:231], v[192:195], 0
v_exp_f32 v23, v23
v_mfma_f32_32x32x16_bf16 v[96:111], v[148:151], v[52:55], v[96:111]
buffer_load_dwordx4 v222, s[20:23], 0 offen offset:1280 lds
v_cndmask_b32_e64 v90, v90, v21, s[56:57]
v_add_f32 v19, v19, v22
v_cvt_pk_bf16_f32 v114, v26, v27
v_fma_f32 v25, v89, s37, v15
v_exp_f32 v24, v24
v_cmp_gt_i32_e64 s[54:55], 24, v20
v_cndmask_b32_e64 v91, v91, v21, s[58:59]
v_add_f32 v19, v19, v23
v_fma_f32 v26, v90, s37, v15
v_exp_f32 v25, v25
s_waitcnt lgkmcnt(0)
v_mfma_f32_32x32x16_bf16 v[96:111], v[152:155], v[56:59], v[96:111]
s_barrier
v_cmp_gt_i32_e64 s[56:57], 25, v20
v_cndmask_b32_e64 v92, v92, v21, s[54:55]
v_add_f32 v19, v19, v24
v_cvt_pk_bf16_f32 v115, v22, v23
v_fma_f32 v27, v91, s37, v15
v_exp_f32 v26, v26
v_cmp_gt_i32_e64 s[58:59], 26, v20
v_cndmask_b32_e64 v93, v93, v21, s[56:57]
v_add_f32 v19, v19, v25
v_fma_f32 v22, v92, s37, v15
v_exp_f32 v27, v27
v_cmp_gt_i32_e64 s[54:55], 27, v20
v_cndmask_b32_e64 v94, v94, v21, s[58:59]
v_add_f32 v19, v19, v26
v_cvt_pk_bf16_f32 v116, v24, v25
v_fma_f32 v23, v93, s37, v15
v_exp_f32 v22, v22
v_cndmask_b32_e64 v95, v95, v21, s[54:55]
v_add_f32 v19, v19, v27
v_fma_f32 v24, v94, s37, v15
v_exp_f32 v23, v23
ds_read_b64_tr_b16 v[136:137], v6 offset:24576
ds_read_b64_tr_b16 v[138:139], v6 offset:27648
ds_read_b64_tr_b16 v[140:141], v7 offset:24576
ds_read_b64_tr_b16 v[142:143], v7 offset:27648
ds_read_b64_tr_b16 v[224:225], v234 offset:12288
ds_read_b64_tr_b16 v[226:227], v234 offset:14336
ds_read_b64_tr_b16 v[228:229], v235 offset:12288
ds_read_b64_tr_b16 v[230:231], v235 offset:14336
ds_read_b64_tr_b16 v[144:145], v6 offset:24704
ds_read_b64_tr_b16 v[146:147], v6 offset:27776
ds_read_b64_tr_b16 v[148:149], v7 offset:24704
ds_read_b64_tr_b16 v[150:151], v7 offset:27776
v_mfma_f32_32x32x16_bf16 v[96:111], v[156:159], v[60:63], v[96:111]
buffer_load_dwordx4 v215, s[20:23], 0 offen offset:2304 lds
buffer_load_dwordx4 v223, s[20:23], 0 offen offset:3328 lds
v_add_f32 v19, v19, v22
v_fma_f32 v25, v95, s37, v15
v_exp_f32 v24, v24
v_add_f32 v19, v19, v23
v_exp_f32 v25, v25
v_add_f32 v19, v19, v24
s_lshr_b32 s63, s77, 2
v_cvt_pk_bf16_f32 v117, v26, v27
v_cvt_pk_bf16_f32 v118, v22, v23
v_add_f32 v19, v19, v25
v_cvt_pk_bf16_f32 v119, v24, v25
v_cmp_eq_u32_e64 s[72:73], s63, v253
v_cvt_pk_bf16_f32 v188, v176, v177
v_cvt_pk_bf16_f32 v189, v178, v179
v_cvt_pk_bf16_f32 v190, v180, v181
v_cvt_pk_bf16_f32 v191, v182, v183
v_add_u32 v20, -32, v20
v_accvgpr_write_b32 a208, v184
v_accvgpr_write_b32 a209, v185
v_accvgpr_write_b32 a210, v186
v_accvgpr_write_b32 a211, v187
s_nop 1
v_cndmask_b32_e64 v250, 0, v240, s[72:73]
v_cndmask_b32_e64 v251, 0, v241, s[72:73]
v_accvgpr_write_b32 a212, v188
v_accvgpr_write_b32 a213, v189
v_accvgpr_write_b32 a214, v190
v_accvgpr_write_b32 a215, v191
v_cmp_nge_f32 vcc, s52, v19
s_cbranch_vccnz Lst_d6_Y
Lct_d6_Y:
v_add_f32 v17, v17, v19
ds_read_b64_tr_b16 v[152:153], v6 offset:24832
ds_read_b64_tr_b16 v[154:155], v6 offset:27904
s_waitcnt lgkmcnt(10)
v_mfma_f32_32x32x16_bf16 a[96:111], v[136:139], v[112:115], a[96:111]
ds_read_b64_tr_b16 v[156:157], v7 offset:24832
ds_read_b64_tr_b16 v[158:159], v7 offset:27904
ds_read_b64_tr_b16 v[136:137], v6 offset:30720
ds_read_b64_tr_b16 v[138:139], v6 offset:33792
s_waitcnt lgkmcnt(12)
v_mfma_f32_16x16x32_bf16 v[176:179], v[224:227], v[192:195], 0
s_waitcnt lgkmcnt(10)
v_mfma_f32_16x16x32_bf16 v[180:183], v[228:231], v[192:195], 0
s_waitcnt vmcnt(8)
ds_read_b64_tr_b16 v[224:225], v232 offset:0
ds_read_b64_tr_b16 v[226:227], v232 offset:2048
ds_read_b64_tr_b16 v[228:229], v233 offset:0
ds_read_b64_tr_b16 v[230:231], v233 offset:2048
v_mfma_f32_32x32x16_bf16 a[112:127], v[140:143], v[112:115], a[112:127]
ds_read_b64_tr_b16 v[140:141], v7 offset:30720
ds_read_b64_tr_b16 v[142:143], v7 offset:33792
v_cmp_gt_i32_e64 s[54:55], 0, v20
v_cmp_gt_i32_e64 s[56:57], 1, v20
v_cmp_gt_i32_e64 s[58:59], 2, v20
s_waitcnt lgkmcnt(12)
v_mfma_f32_32x32x16_bf16 a[128:143], v[144:147], v[112:115], a[128:143]
ds_read_b64_tr_b16 v[144:145], v6 offset:30848
ds_read_b64_tr_b16 v[146:147], v6 offset:33920
v_cndmask_b32_e64 v96, v96, v21, s[54:55]
v_cndmask_b32_e64 v97, v97, v21, s[56:57]
v_cmp_gt_i32_e64 s[54:55], 3, v20
s_waitcnt lgkmcnt(6)
v_mfma_f32_16x16x32_bf16 v[168:171], v[224:227], v[196:199], v[168:171]
v_cndmask_b32_e64 v98, v98, v21, s[58:59]
v_fma_f32 v22, v96, s37, v15
s_waitcnt lgkmcnt(4)
v_mfma_f32_16x16x32_bf16 v[172:175], v[228:231], v[196:199], v[172:175]
ds_read_b64_tr_b16 v[224:225], v234 offset:0
ds_read_b64_tr_b16 v[226:227], v234 offset:2048
ds_read_b64_tr_b16 v[228:229], v235 offset:0
ds_read_b64_tr_b16 v[230:231], v235 offset:2048
v_mfma_f32_32x32x16_bf16 a[144:159], v[148:151], v[112:115], a[144:159]
ds_read_b64_tr_b16 v[148:149], v7 offset:30848
ds_read_b64_tr_b16 v[150:151], v7 offset:33920
v_fma_f32 v23, v97, s37, v15
v_cmp_gt_i32_e64 s[56:57], 8, v20
v_cndmask_b32_e64 v99, v99, v21, s[54:55]
v_mfma_f32_32x32x16_bf16 a[160:175], v[152:155], v[112:115], a[160:175]
ds_read_b64_tr_b16 v[152:153], v6 offset:30976
ds_read_b64_tr_b16 v[154:155], v6 offset:34048
v_exp_f32 v22, v22
v_fma_f32 v24, v98, s37, v15
s_waitcnt lgkmcnt(6)
v_mfma_f32_16x16x32_bf16 v[176:179], v[224:227], v[196:199], v[176:179]
v_exp_f32 v23, v23
s_waitcnt lgkmcnt(4)
v_mfma_f32_16x16x32_bf16 v[180:183], v[228:231], v[196:199], v[180:183]
s_waitcnt vmcnt(4)
ds_read_b64_tr_b16 v[224:225], v232 offset:4096
ds_read_b64_tr_b16 v[226:227], v232 offset:6144
ds_read_b64_tr_b16 v[228:229], v233 offset:4096
ds_read_b64_tr_b16 v[230:231], v233 offset:6144
v_mfma_f32_32x32x16_bf16 a[176:191], v[156:159], v[112:115], a[176:191]
ds_read_b64_tr_b16 v[156:157], v7 offset:30976
ds_read_b64_tr_b16 v[158:159], v7 offset:34048
v_cmp_gt_i32_e64 s[58:59], 9, v20
v_cndmask_b32_e64 v100, v100, v21, s[56:57]
v_fma_f32 v25, v99, s37, v15
v_mfma_f32_32x32x16_bf16 a[96:111], v[136:139], v[116:119], a[96:111]
v_exp_f32 v24, v24
v_cmp_gt_i32_e64 s[54:55], 10, v20
v_cndmask_b32_e64 v101, v101, v21, s[58:59]
v_add_f32 v19, v22, v23
s_waitcnt lgkmcnt(4)
v_mfma_f32_16x16x32_bf16 v[168:171], v[224:227], v[200:203], v[168:171]
v_fma_f32 v26, v100, s37, v15
v_cmp_gt_i32_e64 s[56:57], 11, v20
s_waitcnt lgkmcnt(2)
v_mfma_f32_16x16x32_bf16 v[172:175], v[228:231], v[200:203], v[172:175]
ds_read_b64_tr_b16 v[224:225], v234 offset:4096
ds_read_b64_tr_b16 v[226:227], v234 offset:6144
ds_read_b64_tr_b16 v[228:229], v235 offset:4096
ds_read_b64_tr_b16 v[230:231], v235 offset:6144
v_mfma_f32_32x32x16_bf16 a[112:127], v[140:143], v[116:119], a[112:127]
v_exp_f32 v25, v25
v_cndmask_b32_e64 v102, v102, v21, s[54:55]
v_add_f32 v19, v19, v24
v_cvt_pk_bf16_f32 v120, v22, v23
v_mfma_f32_32x32x16_bf16 a[128:143], v[144:147], v[116:119], a[128:143]
v_fma_f32 v27, v101, s37, v15
v_exp_f32 v26, v26
v_cmp_gt_i32_e64 s[58:59], 16, v20
v_cndmask_b32_e64 v103, v103, v21, s[56:57]
s_waitcnt lgkmcnt(2)
v_mfma_f32_16x16x32_bf16 v[176:179], v[224:227], v[200:203], v[176:179]
v_add_f32 v19, v19, v25
v_fma_f32 v22, v102, s37, v15
s_waitcnt lgkmcnt(0)
v_mfma_f32_16x16x32_bf16 v[180:183], v[228:231], v[200:203], v[180:183]
s_waitcnt vmcnt(0)
ds_read_b64_tr_b16 v[224:225], v232 offset:8192
ds_read_b64_tr_b16 v[226:227], v232 offset:10240
ds_read_b64_tr_b16 v[228:229], v233 offset:8192
ds_read_b64_tr_b16 v[230:231], v233 offset:10240
v_mfma_f32_32x32x16_bf16 a[144:159], v[148:151], v[116:119], a[144:159]
v_exp_f32 v27, v27
v_cmp_gt_i32_e64 s[54:55], 17, v20
v_cndmask_b32_e64 v104, v104, v21, s[58:59]
v_add_f32 v19, v19, v26
v_mfma_f32_32x32x16_bf16 a[160:175], v[152:155], v[116:119], a[160:175]
v_cvt_pk_bf16_f32 v121, v24, v25
v_fma_f32 v23, v103, s37, v15
v_exp_f32 v22, v22
v_cmp_gt_i32_e64 s[56:57], 18, v20
s_waitcnt lgkmcnt(2)
v_mfma_f32_16x16x32_bf16 v[168:171], v[224:227], v[204:207], v[168:171]
v_cndmask_b32_e64 v105, v105, v21, s[54:55]
v_add_f32 v19, v19, v27
v_fma_f32 v24, v104, s37, v15
v_exp_f32 v23, v23
v_cmp_gt_i32_e64 s[58:59], 19, v20
v_cndmask_b32_e64 v106, v106, v21, s[56:57]
v_add_f32 v19, v19, v22
v_cvt_pk_bf16_f32 v122, v26, v27
v_fma_f32 v25, v105, s37, v15
v_exp_f32 v24, v24
v_cmp_gt_i32_e64 s[54:55], 24, v20
v_cndmask_b32_e64 v107, v107, v21, s[58:59]
v_add_f32 v19, v19, v23
v_fma_f32 v26, v106, s37, v15
v_exp_f32 v25, v25
s_waitcnt lgkmcnt(0)
v_mfma_f32_16x16x32_bf16 v[172:175], v[228:231], v[204:207], v[172:175]
v_cmp_gt_i32_e64 s[56:57], 25, v20
v_cndmask_b32_e64 v108, v108, v21, s[54:55]
v_add_f32 v19, v19, v24
v_cvt_pk_bf16_f32 v123, v22, v23
v_fma_f32 v27, v107, s37, v15
v_exp_f32 v26, v26
v_cmp_gt_i32_e64 s[58:59], 26, v20
v_cndmask_b32_e64 v109, v109, v21, s[56:57]
v_add_f32 v19, v19, v25
v_fma_f32 v22, v108, s37, v15
v_exp_f32 v27, v27
v_cmp_gt_i32_e64 s[54:55], 27, v20
v_cndmask_b32_e64 v110, v110, v21, s[58:59]
v_add_f32 v19, v19, v26
v_cvt_pk_bf16_f32 v124, v24, v25
v_fma_f32 v23, v109, s37, v15
v_exp_f32 v22, v22
v_cndmask_b32_e64 v111, v111, v21, s[54:55]
v_add_f32 v19, v19, v27
v_fma_f32 v24, v110, s37, v15
v_exp_f32 v23, v23
ds_read_b64_tr_b16 v[136:137], v6 offset:36864
ds_read_b64_tr_b16 v[138:139], v6 offset:39936
ds_read_b64_tr_b16 v[140:141], v7 offset:36864
ds_read_b64_tr_b16 v[142:143], v7 offset:39936
ds_read_b64_tr_b16 v[144:145], v6 offset:36992
ds_read_b64_tr_b16 v[146:147], v6 offset:40064
ds_read_b64_tr_b16 v[148:149], v7 offset:36992
ds_read_b64_tr_b16 v[150:151], v7 offset:40064
v_mfma_f32_32x32x16_bf16 a[176:191], v[156:159], v[116:119], a[176:191]
v_add_f32 v19, v19, v22
v_fma_f32 v25, v111, s37, v15
v_exp_f32 v24, v24
v_add_f32 v19, v19, v23
v_exp_f32 v25, v25
v_add_f32 v19, v19, v24
v_cvt_pk_bf16_f32 v125, v26, v27
v_cvt_pk_bf16_f32 v126, v22, v23
v_add_f32 v19, v19, v25
v_cvt_pk_bf16_f32 v127, v24, v25
ds_read_b64_tr_b16 v[224:225], v234 offset:8192
ds_read_b64_tr_b16 v[226:227], v234 offset:10240
ds_read_b64_tr_b16 v[228:229], v235 offset:8192
ds_read_b64_tr_b16 v[230:231], v235 offset:10240
v_add_u32 v20, -32, v20
v_cmp_nge_f32 vcc, s52, v19
s_cbranch_vccnz Lst_d7_Y
Lct_d7_Y:
v_add_f32 v17, v17, v19
ds_read_b64_tr_b16 v[152:153], v6 offset:37120
ds_read_b64_tr_b16 v[154:155], v6 offset:40192
ds_read_b64_tr_b16 v[156:157], v7 offset:37120
ds_read_b64_tr_b16 v[158:159], v7 offset:40192
s_waitcnt lgkmcnt(12)
v_mfma_f32_32x32x16_bf16 a[96:111], v[136:139], v[120:123], a[96:111]
ds_read_b64_tr_b16 v[136:137], v6 offset:43008
ds_read_b64_tr_b16 v[138:139], v6 offset:46080
v_mfma_f32_32x32x16_bf16 a[112:127], v[140:143], v[120:123], a[112:127]
ds_read_b64_tr_b16 v[140:141], v7 offset:43008
ds_read_b64_tr_b16 v[142:143], v7 offset:46080
s_waitcnt lgkmcnt(12)
v_mfma_f32_32x32x16_bf16 a[128:143], v[144:147], v[120:123], a[128:143]
ds_read_b64_tr_b16 v[144:145], v6 offset:43136
ds_read_b64_tr_b16 v[146:147], v6 offset:46208
v_mfma_f32_32x32x16_bf16 a[144:159], v[148:151], v[120:123], a[144:159]
ds_read_b64_tr_b16 v[148:149], v7 offset:43136
ds_read_b64_tr_b16 v[150:151], v7 offset:46208
s_waitcnt lgkmcnt(8)
v_mfma_f32_32x32x16_bf16 a[160:175], v[152:155], v[120:123], a[160:175]
ds_read_b64_tr_b16 v[152:153], v6 offset:43264
ds_read_b64_tr_b16 v[154:155], v6 offset:46336
v_mfma_f32_32x32x16_bf16 a[176:191], v[156:159], v[120:123], a[176:191]
ds_read_b64_tr_b16 v[156:157], v7 offset:43264
ds_read_b64_tr_b16 v[158:159], v7 offset:46336
s_waitcnt lgkmcnt(8)
v_mfma_f32_32x32x16_bf16 a[96:111], v[136:139], v[124:127], a[96:111]
v_mfma_f32_32x32x16_bf16 a[112:127], v[140:143], v[124:127], a[112:127]
s_waitcnt lgkmcnt(4)
v_mfma_f32_32x32x16_bf16 a[128:143], v[144:147], v[124:127], a[128:143]
v_mfma_f32_32x32x16_bf16 a[144:159], v[148:151], v[124:127], a[144:159]
s_waitcnt lgkmcnt(0)
v_mfma_f32_32x32x16_bf16 a[160:175], v[152:155], v[124:127], a[160:175]
v_mfma_f32_32x32x16_bf16 a[176:191], v[156:159], v[124:127], a[176:191]
v_mfma_f32_16x16x32_bf16 v[176:179], v[224:227], v[204:207], v[176:179]
v_mfma_f32_16x16x32_bf16 v[180:183], v[228:231], v[204:207], v[180:183]
s_nop 7
v_cvt_pk_bf16_f32 v184, v168, v169
v_cvt_pk_bf16_f32 v185, v170, v171
v_cvt_pk_bf16_f32 v186, v172, v173
v_cvt_pk_bf16_f32 v187, v174, v175
v_accvgpr_write_b32 a216, v184
v_accvgpr_write_b32 a217, v185
v_accvgpr_write_b32 a218, v186
v_accvgpr_write_b32 a219, v187
v_cvt_pk_bf16_f32 v188, v176, v177
v_cvt_pk_bf16_f32 v189, v178, v179
v_cvt_pk_bf16_f32 v190, v180, v181
v_cvt_pk_bf16_f32 v191, v182, v183
v_accvgpr_write_b32 a220, v188
v_accvgpr_write_b32 a221, v189
v_accvgpr_write_b32 a222, v190
v_accvgpr_write_b32 a223, v191
s_nop 15
s_cmp_eq_u32 s44, 1
s_cbranch_scc0 L_final_s
v_lshlrev_b32 v10, 4, v1
s_cmp_eq_u32 s36, 0
s_cbranch_scc0 L_rwait_done
s_lshr_b32 s84, s92, 2
s_lshl_b32 s84, s84, 2
s_add_u32 s84, s84, 128
s_and_b32 s85, s92, 3
s_lshl_b32 s85, s85, 3
s_lshl_b32 s85, 1, s85
v_mov_b32 v30, s84
s_mov_b32 s86, 200000
L_rpoll:
global_load_dword v31, v30, s[80:81] sc1
s_waitcnt vmcnt(0)
v_readfirstlane_b32 s84, v31
s_nop 1
s_and_b32 s84, s84, s85
s_cbranch_scc1 L_rwait_done
s_sub_u32 s86, s86, 1
s_cmp_eq_u32 s86, 0
s_cbranch_scc1 L_rwait_done
s_sleep 4
s_branch L_rpoll
L_rwait_done:
s_barrier
buffer_load_dwordx4 v[28:31], v10, s[32:35], s46 offen sc1
s_add_u32 s84, s47, 12288
buffer_load_dwordx4 v[112:115], v10, s[32:35], s84 offen offset:0 sc1
s_add_u32 s84, s46, 13312
buffer_load_dwordx4 v[208:211], v10, s[32:35], s84 offen offset:0 sc1
s_add_u32 s84, s47, 12288
buffer_load_dwordx4 v[116:119], v10, s[32:35], s84 offen offset:1024 sc1
s_add_u32 s84, s46, 13312
buffer_load_dwordx4 v[212:215], v10, s[32:35], s84 offen offset:1024 sc1
s_add_u32 s84, s46, 13312
buffer_load_dwordx4 v[216:219], v10, s[32:35], s84 offen offset:2048 sc1
s_add_u32 s84, s46, 13312
buffer_load_dwordx4 v[220:223], v10, s[32:35], s84 offen offset:3072 sc1
s_add_u32 s84, s46, 17408
buffer_load_dwordx4 v[224:227], v10, s[32:35], s84 offen offset:0 sc1
s_add_u32 s84, s46, 17408
buffer_load_dwordx4 v[228:231], v10, s[32:35], s84 offen offset:1024 sc1
s_add_u32 s84, s46, 17408
buffer_load_dwordx4 v[232:235], v10, s[32:35], s84 offen offset:2048 sc1
s_add_u32 s84, s46, 17408
buffer_load_dwordx4 v[236:239], v10, s[32:35], s84 offen offset:3072 sc1
s_add_u32 s84, s46, 21504
buffer_load_dwordx4 v[240:243], v10, s[32:35], s84 offen offset:0 sc1
s_add_u32 s84, s46, 21504
buffer_load_dwordx4 v[244:247], v10, s[32:35], s84 offen offset:1024 sc1
s_add_u32 s84, s46, 21504
buffer_load_dwordx4 v[248:251], v10, s[32:35], s84 offen offset:2048 sc1
s_add_u32 s84, s46, 21504
buffer_load_dwordx4 v[252:255], v10, s[32:35], s84 offen offset:3072 sc1
v_and_b32 v11, 31, v1
v_mul_u32_u24 v11, 400, v11
v_lshrrev_b32 v22, 5, v1
v_lshl_add_u32 v11, v22, 3, v11
v_add_u32 v11, s53, v11
v_add_u32 v22, 0, v1
v_mul_u32_u24 v23, 2731, v22
v_lshrrev_b32 v23, 16, v23
v_mul_u32_u24 v24, 24, v23
v_sub_u32 v22, v22, v24
v_mul_u32_u24 v23, 400, v23
v_lshl_add_u32 v12, v22, 4, v23
v_add_u32 v12, s53, v12
v_add_u32 v22, 64, v1
v_mul_u32_u24 v23, 2731, v22
v_lshrrev_b32 v23, 16, v23
v_mul_u32_u24 v24, 24, v23
v_sub_u32 v22, v22, v24
v_mul_u32_u24 v23, 400, v23
v_lshl_add_u32 v13, v22, 4, v23
v_add_u32 v13, s53, v13
v_add_u32 v22, 128, v1
v_mul_u32_u24 v23, 2731, v22
v_lshrrev_b32 v23, 16, v23
v_mul_u32_u24 v24, 24, v23
v_sub_u32 v22, v22, v24
v_mul_u32_u24 v23, 400, v23
v_lshl_add_u32 v20, v22, 4, v23
v_add_u32 v20, s53, v20
s_waitcnt vmcnt(14)
v_min_f32 v22, v14, v28
v_sub_f32 v23, v22, v14
v_sub_f32 v24, v22, v28
v_exp_f32 v23, v23
v_exp_f32 v24, v24
s_nop 0
v_mul_f32 v22, v23, v16
v_fma_f32 v22, v24, v30, v22
v_mov_b32 v25, v22
s_nop 1
v_permlane32_swap_b32 v22, v25
s_nop 0
v_add_f32 v22, v22, v25
v_rcp_f32 v22, v22
s_nop 0
v_mul_f32 v22, s51, v22
v_mul_f32 v2, v22, v23
v_mul_f32 v6, v22, v24
v_min_f32 v22, v15, v29
v_sub_f32 v23, v22, v15
v_sub_f32 v24, v22, v29
v_exp_f32 v23, v23
v_exp_f32 v24, v24
s_nop 0
v_mul_f32 v22, v23, v17
v_fma_f32 v22, v24, v31, v22
v_mov_b32 v25, v22
s_nop 1
v_permlane32_swap_b32 v22, v25
s_nop 0
v_add_f32 v22, v22, v25
v_rcp_f32 v22, v22
s_nop 0
v_mul_f32 v22, s51, v22
v_mul_f32 v4, v22, v23
v_mul_f32 v8, v22, v24
v_accvgpr_read_b32 v62, a200
v_accvgpr_read_b32 v63, a201
s_waitcnt vmcnt(12)
s_nop 0
v_permlane16_swap_b32 v112, v62
v_permlane16_swap_b32 v113, v63
v_accvgpr_read_b32 v32, a96
v_accvgpr_read_b32 v46, a100
v_accvgpr_read_b32 v33, a97
v_accvgpr_read_b32 v47, a101
v_accvgpr_read_b32 v34, a98
v_accvgpr_read_b32 v48, a102
v_accvgpr_read_b32 v35, a99
v_accvgpr_read_b32 v49, a103
v_lshlrev_b32 v40, 16, v208
v_lshlrev_b32 v54, 16, v210
v_and_b32 v41, 0xffff0000, v208
v_and_b32 v55, 0xffff0000, v210
v_lshlrev_b32 v42, 16, v209
v_lshlrev_b32 v56, 16, v211
v_and_b32 v43, 0xffff0000, v209
v_and_b32 v57, 0xffff0000, v211
v_lshlrev_b32 v36, 16, v112
v_lshlrev_b32 v50, 16, v62
v_and_b32 v37, 0xffff0000, v112
v_and_b32 v51, 0xffff0000, v62
v_lshlrev_b32 v38, 16, v113
v_lshlrev_b32 v52, 16, v63
v_and_b32 v39, 0xffff0000, v113
v_and_b32 v53, 0xffff0000, v63
v_pk_fma_f32 v[32:33], v[32:33], v[4:5], v[36:37] op_sel_hi:[1,0,1]
v_pk_fma_f32 v[46:47], v[46:47], v[4:5], v[50:51] op_sel_hi:[1,0,1]
v_pk_fma_f32 v[34:35], v[34:35], v[4:5], v[38:39] op_sel_hi:[1,0,1]
v_pk_fma_f32 v[48:49], v[48:49], v[4:5], v[52:53] op_sel_hi:[1,0,1]
v_pk_fma_f32 v[32:33], v[40:41], v[8:9], v[32:33] op_sel_hi:[1,0,1]
v_pk_fma_f32 v[46:47], v[54:55], v[8:9], v[46:47] op_sel_hi:[1,0,1]
v_pk_fma_f32 v[34:35], v[42:43], v[8:9], v[34:35] op_sel_hi:[1,0,1]
v_pk_fma_f32 v[48:49], v[56:57], v[8:9], v[48:49] op_sel_hi:[1,0,1]
v_cvt_pk_bf16_f32 v44, v32, v33
v_cvt_pk_bf16_f32 v58, v46, v47
v_cvt_pk_bf16_f32 v45, v34, v35
v_cvt_pk_bf16_f32 v59, v48, v49
ds_write_b64 v11, v[44:45] offset:0
ds_write_b64 v11, v[58:59] offset:16
s_add_u32 s84, s47, 0
buffer_load_dwordx4 v[64:67], v10, s[32:35], s84 offen offset:0 sc1
s_add_u32 s84, s46, 1024
buffer_load_dwordx4 v[160:163], v10, s[32:35], s84 offen offset:0 sc1
v_accvgpr_read_b32 v62, a202
v_accvgpr_read_b32 v63, a203
s_waitcnt vmcnt(12)
s_nop 0
v_permlane16_swap_b32 v114, v62
v_permlane16_swap_b32 v115, v63
v_accvgpr_read_b32 v32, a104
v_accvgpr_read_b32 v46, a108
v_accvgpr_read_b32 v33, a105
v_accvgpr_read_b32 v47, a109
v_accvgpr_read_b32 v34, a106
v_accvgpr_read_b32 v48, a110
v_accvgpr_read_b32 v35, a107
v_accvgpr_read_b32 v49, a111
v_lshlrev_b32 v40, 16, v212
v_lshlrev_b32 v54, 16, v214
v_and_b32 v41, 0xffff0000, v212
v_and_b32 v55, 0xffff0000, v214
v_lshlrev_b32 v42, 16, v213
v_lshlrev_b32 v56, 16, v215
v_and_b32 v43, 0xffff0000, v213
v_and_b32 v57, 0xffff0000, v215
v_lshlrev_b32 v36, 16, v114
v_lshlrev_b32 v50, 16, v62
v_and_b32 v37, 0xffff0000, v114
v_and_b32 v51, 0xffff0000, v62
v_lshlrev_b32 v38, 16, v115
v_lshlrev_b32 v52, 16, v63
v_and_b32 v39, 0xffff0000, v115
v_and_b32 v53, 0xffff0000, v63
v_pk_fma_f32 v[32:33], v[32:33], v[4:5], v[36:37] op_sel_hi:[1,0,1]
v_pk_fma_f32 v[46:47], v[46:47], v[4:5], v[50:51] op_sel_hi:[1,0,1]
v_pk_fma_f32 v[34:35], v[34:35], v[4:5], v[38:39] op_sel_hi:[1,0,1]
v_pk_fma_f32 v[48:49], v[48:49], v[4:5], v[52:53] op_sel_hi:[1,0,1]
v_pk_fma_f32 v[32:33], v[40:41], v[8:9], v[32:33] op_sel_hi:[1,0,1]
v_pk_fma_f32 v[46:47], v[54:55], v[8:9], v[46:47] op_sel_hi:[1,0,1]
v_pk_fma_f32 v[34:35], v[42:43], v[8:9], v[34:35] op_sel_hi:[1,0,1]
v_pk_fma_f32 v[48:49], v[56:57], v[8:9], v[48:49] op_sel_hi:[1,0,1]
v_cvt_pk_bf16_f32 v44, v32, v33
v_cvt_pk_bf16_f32 v58, v46, v47
v_cvt_pk_bf16_f32 v45, v34, v35
v_cvt_pk_bf16_f32 v59, v48, v49
ds_write_b64 v11, v[44:45] offset:32
ds_write_b64 v11, v[58:59] offset:48
s_add_u32 s84, s47, 6144
buffer_load_dwordx4 v[88:91], v10, s[32:35], s84 offen offset:0 sc1
s_add_u32 s84, s46, 1024
buffer_load_dwordx4 v[164:167], v10, s[32:35], s84 offen offset:1024 sc1
v_accvgpr_read_b32 v62, a204
v_accvgpr_read_b32 v63, a205
s_waitcnt vmcnt(13)
s_nop 0
v_permlane16_swap_b32 v116, v62
v_permlane16_swap_b32 v117, v63
v_accvgpr_read_b32 v32, a112
v_accvgpr_read_b32 v46, a116
v_accvgpr_read_b32 v33, a113
v_accvgpr_read_b32 v47, a117
v_accvgpr_read_b32 v34, a114
v_accvgpr_read_b32 v48, a118
v_accvgpr_read_b32 v35, a115
v_accvgpr_read_b32 v49, a119
v_lshlrev_b32 v40, 16, v216
v_lshlrev_b32 v54, 16, v218
v_and_b32 v41, 0xffff0000, v216
v_and_b32 v55, 0xffff0000, v218
v_lshlrev_b32 v42, 16, v217
v_lshlrev_b32 v56, 16, v219
v_and_b32 v43, 0xffff0000, v217
v_and_b32 v57, 0xffff0000, v219
v_lshlrev_b32 v36, 16, v116
v_lshlrev_b32 v50, 16, v62
v_and_b32 v37, 0xffff0000, v116
v_and_b32 v51, 0xffff0000, v62
v_lshlrev_b32 v38, 16, v117
v_lshlrev_b32 v52, 16, v63
v_and_b32 v39, 0xffff0000, v117
v_and_b32 v53, 0xffff0000, v63
v_pk_fma_f32 v[32:33], v[32:33], v[4:5], v[36:37] op_sel_hi:[1,0,1]
v_pk_fma_f32 v[46:47], v[46:47], v[4:5], v[50:51] op_sel_hi:[1,0,1]
v_pk_fma_f32 v[34:35], v[34:35], v[4:5], v[38:39] op_sel_hi:[1,0,1]
v_pk_fma_f32 v[48:49], v[48:49], v[4:5], v[52:53] op_sel_hi:[1,0,1]
v_pk_fma_f32 v[32:33], v[40:41], v[8:9], v[32:33] op_sel_hi:[1,0,1]
v_pk_fma_f32 v[46:47], v[54:55], v[8:9], v[46:47] op_sel_hi:[1,0,1]
v_pk_fma_f32 v[34:35], v[42:43], v[8:9], v[34:35] op_sel_hi:[1,0,1]
v_pk_fma_f32 v[48:49], v[56:57], v[8:9], v[48:49] op_sel_hi:[1,0,1]
v_cvt_pk_bf16_f32 v44, v32, v33
v_cvt_pk_bf16_f32 v58, v46, v47
v_cvt_pk_bf16_f32 v45, v34, v35
v_cvt_pk_bf16_f32 v59, v48, v49
ds_write_b64 v11, v[44:45] offset:64
ds_write_b64 v11, v[58:59] offset:80
s_add_u32 s84, s47, 0
buffer_load_dwordx4 v[68:71], v10, s[32:35], s84 offen offset:1024 sc1
s_add_u32 s84, s46, 1024
buffer_load_dwordx4 v[168:171], v10, s[32:35], s84 offen offset:2048 sc1
v_accvgpr_read_b32 v62, a206
v_accvgpr_read_b32 v63, a207
s_waitcnt vmcnt(14)
s_nop 0
v_permlane16_swap_b32 v118, v62
v_permlane16_swap_b32 v119, v63
v_accvgpr_read_b32 v32, a120
v_accvgpr_read_b32 v46, a124
v_accvgpr_read_b32 v33, a121
v_accvgpr_read_b32 v47, a125
v_accvgpr_read_b32 v34, a122
v_accvgpr_read_b32 v48, a126
v_accvgpr_read_b32 v35, a123
v_accvgpr_read_b32 v49, a127
v_lshlrev_b32 v40, 16, v220
v_lshlrev_b32 v54, 16, v222
v_and_b32 v41, 0xffff0000, v220
v_and_b32 v55, 0xffff0000, v222
v_lshlrev_b32 v42, 16, v221
v_lshlrev_b32 v56, 16, v223
v_and_b32 v43, 0xffff0000, v221
v_and_b32 v57, 0xffff0000, v223
v_lshlrev_b32 v36, 16, v118
v_lshlrev_b32 v50, 16, v62
v_and_b32 v37, 0xffff0000, v118
v_and_b32 v51, 0xffff0000, v62
v_lshlrev_b32 v38, 16, v119
v_lshlrev_b32 v52, 16, v63
v_and_b32 v39, 0xffff0000, v119
v_and_b32 v53, 0xffff0000, v63
v_pk_fma_f32 v[32:33], v[32:33], v[4:5], v[36:37] op_sel_hi:[1,0,1]
v_pk_fma_f32 v[46:47], v[46:47], v[4:5], v[50:51] op_sel_hi:[1,0,1]
v_pk_fma_f32 v[34:35], v[34:35], v[4:5], v[38:39] op_sel_hi:[1,0,1]
v_pk_fma_f32 v[48:49], v[48:49], v[4:5], v[52:53] op_sel_hi:[1,0,1]
v_pk_fma_f32 v[32:33], v[40:41], v[8:9], v[32:33] op_sel_hi:[1,0,1]
v_pk_fma_f32 v[46:47], v[54:55], v[8:9], v[46:47] op_sel_hi:[1,0,1]
v_pk_fma_f32 v[34:35], v[42:43], v[8:9], v[34:35] op_sel_hi:[1,0,1]
v_pk_fma_f32 v[48:49], v[56:57], v[8:9], v[48:49] op_sel_hi:[1,0,1]
v_cvt_pk_bf16_f32 v44, v32, v33
v_cvt_pk_bf16_f32 v58, v46, v47
v_cvt_pk_bf16_f32 v45, v34, v35
v_cvt_pk_bf16_f32 v59, v48, v49
ds_write_b64 v11, v[44:45] offset:96
ds_write_b64 v11, v[58:59] offset:112
s_add_u32 s84, s47, 6144
buffer_load_dwordx4 v[92:95], v10, s[32:35], s84 offen offset:1024 sc1
s_add_u32 s84, s46, 1024
buffer_load_dwordx4 v[172:175], v10, s[32:35], s84 offen offset:3072 sc1
v_accvgpr_read_b32 v60, a224
v_accvgpr_read_b32 v61, a225
v_accvgpr_read_b32 v62, a208
v_accvgpr_read_b32 v63, a209
s_waitcnt vmcnt(15)
s_nop 0
v_permlane16_swap_b32 v60, v62
v_permlane16_swap_b32 v61, v63
v_accvgpr_read_b32 v32, a128
v_accvgpr_read_b32 v46, a132
v_accvgpr_read_b32 v33, a129
v_accvgpr_read_b32 v47, a133
v_accvgpr_read_b32 v34, a130
v_accvgpr_read_b32 v48, a134
v_accvgpr_read_b32 v35, a131
v_accvgpr_read_b32 v49, a135
v_lshlrev_b32 v40, 16, v224
v_lshlrev_b32 v54, 16, v226
v_and_b32 v41, 0xffff0000, v224
v_and_b32 v55, 0xffff0000, v226
v_lshlrev_b32 v42, 16, v225
v_lshlrev_b32 v56, 16, v227
v_and_b32 v43, 0xffff0000, v225
v_and_b32 v57, 0xffff0000, v227
v_lshlrev_b32 v36, 16, v60
v_lshlrev_b32 v50, 16, v62
v_and_b32 v37, 0xffff0000, v60
v_and_b32 v51, 0xffff0000, v62
v_lshlrev_b32 v38, 16, v61
v_lshlrev_b32 v52, 16, v63
v_and_b32 v39, 0xffff0000, v61
v_and_b32 v53, 0xffff0000, v63
v_pk_fma_f32 v[32:33], v[32:33], v[4:5], v[36:37] op_sel_hi:[1,0,1]
v_pk_fma_f32 v[46:47], v[46:47], v[4:5], v[50:51] op_sel_hi:[1,0,1]
v_pk_fma_f32 v[34:35], v[34:35], v[4:5], v[38:39] op_sel_hi:[1,0,1]
v_pk_fma_f32 v[48:49], v[48:49], v[4:5], v[52:53] op_sel_hi:[1,0,1]
v_pk_fma_f32 v[32:33], v[40:41], v[8:9], v[32:33] op_sel_hi:[1,0,1]
v_pk_fma_f32 v[46:47], v[54:55], v[8:9], v[46:47] op_sel_hi:[1,0,1]
v_pk_fma_f32 v[34:35], v[42:43], v[8:9], v[34:35] op_sel_hi:[1,0,1]
v_pk_fma_f32 v[48:49], v[56:57], v[8:9], v[48:49] op_sel_hi:[1,0,1]
v_cvt_pk_bf16_f32 v44, v32, v33
v_cvt_pk_bf16_f32 v58, v46, v47
v_cvt_pk_bf16_f32 v45, v34, v35
v_cvt_pk_bf16_f32 v59, v48, v49
ds_write_b64 v11, v[44:45] offset:128
ds_write_b64 v11, v[58:59] offset:144
s_add_u32 s84, s47, 0
buffer_load_dwordx4 v[72:75], v10, s[32:35], s84 offen offset:2048 sc1
s_add_u32 s84, s46, 5120
buffer_load_dwordx4 v[176:179], v10, s[32:35], s84 offen offset:0 sc1
v_accvgpr_read_b32 v60, a226
v_accvgpr_read_b32 v61, a227
v_accvgpr_read_b32 v62, a210
v_accvgpr_read_b32 v63, a211
s_waitcnt vmcnt(16)
s_nop 0
v_permlane16_swap_b32 v60, v62
v_permlane16_swap_b32 v61, v63
v_accvgpr_read_b32 v32, a136
v_accvgpr_read_b32 v46, a140
v_accvgpr_read_b32 v33, a137
v_accvgpr_read_b32 v47, a141
v_accvgpr_read_b32 v34, a138
v_accvgpr_read_b32 v48, a142
v_accvgpr_read_b32 v35, a139
v_accvgpr_read_b32 v49, a143
v_lshlrev_b32 v40, 16, v228
v_lshlrev_b32 v54, 16, v230
v_and_b32 v41, 0xffff0000, v228
v_and_b32 v55, 0xffff0000, v230
v_lshlrev_b32 v42, 16, v229
v_lshlrev_b32 v56, 16, v231
v_and_b32 v43, 0xffff0000, v229
v_and_b32 v57, 0xffff0000, v231
v_lshlrev_b32 v36, 16, v60
v_lshlrev_b32 v50, 16, v62
v_and_b32 v37, 0xffff0000, v60
v_and_b32 v51, 0xffff0000, v62
v_lshlrev_b32 v38, 16, v61
v_lshlrev_b32 v52, 16, v63
v_and_b32 v39, 0xffff0000, v61
v_and_b32 v53, 0xffff0000, v63
v_pk_fma_f32 v[32:33], v[32:33], v[4:5], v[36:37] op_sel_hi:[1,0,1]
v_pk_fma_f32 v[46:47], v[46:47], v[4:5], v[50:51] op_sel_hi:[1,0,1]
v_pk_fma_f32 v[34:35], v[34:35], v[4:5], v[38:39] op_sel_hi:[1,0,1]
v_pk_fma_f32 v[48:49], v[48:49], v[4:5], v[52:53] op_sel_hi:[1,0,1]
v_pk_fma_f32 v[32:33], v[40:41], v[8:9], v[32:33] op_sel_hi:[1,0,1]
v_pk_fma_f32 v[46:47], v[54:55], v[8:9], v[46:47] op_sel_hi:[1,0,1]
v_pk_fma_f32 v[34:35], v[42:43], v[8:9], v[34:35] op_sel_hi:[1,0,1]
v_pk_fma_f32 v[48:49], v[56:57], v[8:9], v[48:49] op_sel_hi:[1,0,1]
v_cvt_pk_bf16_f32 v44, v32, v33
v_cvt_pk_bf16_f32 v58, v46, v47
v_cvt_pk_bf16_f32 v45, v34, v35
v_cvt_pk_bf16_f32 v59, v48, v49
ds_write_b64 v11, v[44:45] offset:160
ds_write_b64 v11, v[58:59] offset:176
s_add_u32 s84, s47, 6144
buffer_load_dwordx4 v[96:99], v10, s[32:35], s84 offen offset:2048 sc1
s_add_u32 s84, s46, 5120
buffer_load_dwordx4 v[180:183], v10, s[32:35], s84 offen offset:1024 sc1
v_accvgpr_read_b32 v60, a228
v_accvgpr_read_b32 v61, a229
v_accvgpr_read_b32 v62, a212
v_accvgpr_read_b32 v63, a213
s_waitcnt vmcnt(17)
s_nop 0
v_permlane16_swap_b32 v60, v62
v_permlane16_swap_b32 v61, v63
v_accvgpr_read_b32 v32, a144
v_accvgpr_read_b32 v46, a148
v_accvgpr_read_b32 v33, a145
v_accvgpr_read_b32 v47, a149
v_accvgpr_read_b32 v34, a146
v_accvgpr_read_b32 v48, a150
v_accvgpr_read_b32 v35, a147
v_accvgpr_read_b32 v49, a151
v_lshlrev_b32 v40, 16, v232
v_lshlrev_b32 v54, 16, v234
v_and_b32 v41, 0xffff0000, v232
v_and_b32 v55, 0xffff0000, v234
v_lshlrev_b32 v42, 16, v233
v_lshlrev_b32 v56, 16, v235
v_and_b32 v43, 0xffff0000, v233
v_and_b32 v57, 0xffff0000, v235
v_lshlrev_b32 v36, 16, v60
v_lshlrev_b32 v50, 16, v62
v_and_b32 v37, 0xffff0000, v60
v_and_b32 v51, 0xffff0000, v62
v_lshlrev_b32 v38, 16, v61
v_lshlrev_b32 v52, 16, v63
v_and_b32 v39, 0xffff0000, v61
v_and_b32 v53, 0xffff0000, v63
v_pk_fma_f32 v[32:33], v[32:33], v[4:5], v[36:37] op_sel_hi:[1,0,1]
v_pk_fma_f32 v[46:47], v[46:47], v[4:5], v[50:51] op_sel_hi:[1,0,1]
v_pk_fma_f32 v[34:35], v[34:35], v[4:5], v[38:39] op_sel_hi:[1,0,1]
v_pk_fma_f32 v[48:49], v[48:49], v[4:5], v[52:53] op_sel_hi:[1,0,1]
v_pk_fma_f32 v[32:33], v[40:41], v[8:9], v[32:33] op_sel_hi:[1,0,1]
v_pk_fma_f32 v[46:47], v[54:55], v[8:9], v[46:47] op_sel_hi:[1,0,1]
v_pk_fma_f32 v[34:35], v[42:43], v[8:9], v[34:35] op_sel_hi:[1,0,1]
v_pk_fma_f32 v[48:49], v[56:57], v[8:9], v[48:49] op_sel_hi:[1,0,1]
v_cvt_pk_bf16_f32 v44, v32, v33
v_cvt_pk_bf16_f32 v58, v46, v47
v_cvt_pk_bf16_f32 v45, v34, v35
v_cvt_pk_bf16_f32 v59, v48, v49
ds_write_b64 v11, v[44:45] offset:192
ds_write_b64 v11, v[58:59] offset:208
s_add_u32 s84, s47, 0
buffer_load_dwordx4 v[76:79], v10, s[32:35], s84 offen offset:3072 sc1
s_add_u32 s84, s46, 5120
buffer_load_dwordx4 v[184:187], v10, s[32:35], s84 offen offset:2048 sc1
v_accvgpr_read_b32 v60, a230
v_accvgpr_read_b32 v61, a231
v_accvgpr_read_b32 v62, a214
v_accvgpr_read_b32 v63, a215
s_waitcnt vmcnt(18)
s_nop 0
v_permlane16_swap_b32 v60, v62
v_permlane16_swap_b32 v61, v63
v_accvgpr_read_b32 v32, a152
v_accvgpr_read_b32 v46, a156
v_accvgpr_read_b32 v33, a153
v_accvgpr_read_b32 v47, a157
v_accvgpr_read_b32 v34, a154
v_accvgpr_read_b32 v48, a158
v_accvgpr_read_b32 v35, a155
v_accvgpr_read_b32 v49, a159
v_lshlrev_b32 v40, 16, v236
v_lshlrev_b32 v54, 16, v238
v_and_b32 v41, 0xffff0000, v236
v_and_b32 v55, 0xffff0000, v238
v_lshlrev_b32 v42, 16, v237
v_lshlrev_b32 v56, 16, v239
v_and_b32 v43, 0xffff0000, v237
v_and_b32 v57, 0xffff0000, v239
v_lshlrev_b32 v36, 16, v60
v_lshlrev_b32 v50, 16, v62
v_and_b32 v37, 0xffff0000, v60
v_and_b32 v51, 0xffff0000, v62
v_lshlrev_b32 v38, 16, v61
v_lshlrev_b32 v52, 16, v63
v_and_b32 v39, 0xffff0000, v61
v_and_b32 v53, 0xffff0000, v63
v_pk_fma_f32 v[32:33], v[32:33], v[4:5], v[36:37] op_sel_hi:[1,0,1]
v_pk_fma_f32 v[46:47], v[46:47], v[4:5], v[50:51] op_sel_hi:[1,0,1]
v_pk_fma_f32 v[34:35], v[34:35], v[4:5], v[38:39] op_sel_hi:[1,0,1]
v_pk_fma_f32 v[48:49], v[48:49], v[4:5], v[52:53] op_sel_hi:[1,0,1]
v_pk_fma_f32 v[32:33], v[40:41], v[8:9], v[32:33] op_sel_hi:[1,0,1]
v_pk_fma_f32 v[46:47], v[54:55], v[8:9], v[46:47] op_sel_hi:[1,0,1]
v_pk_fma_f32 v[34:35], v[42:43], v[8:9], v[34:35] op_sel_hi:[1,0,1]
v_pk_fma_f32 v[48:49], v[56:57], v[8:9], v[48:49] op_sel_hi:[1,0,1]
v_cvt_pk_bf16_f32 v44, v32, v33
v_cvt_pk_bf16_f32 v58, v46, v47
v_cvt_pk_bf16_f32 v45, v34, v35
v_cvt_pk_bf16_f32 v59, v48, v49
ds_write_b64 v11, v[44:45] offset:224
ds_write_b64 v11, v[58:59] offset:240
s_add_u32 s84, s47, 6144
buffer_load_dwordx4 v[100:103], v10, s[32:35], s84 offen offset:3072 sc1
s_add_u32 s84, s46, 5120
buffer_load_dwordx4 v[188:191], v10, s[32:35], s84 offen offset:3072 sc1
v_accvgpr_read_b32 v60, a192
v_accvgpr_read_b32 v61, a193
v_accvgpr_read_b32 v62, a216
v_accvgpr_read_b32 v63, a217
s_waitcnt vmcnt(19)
s_nop 0
v_permlane16_swap_b32 v60, v62
v_permlane16_swap_b32 v61, v63
v_accvgpr_read_b32 v32, a160
v_accvgpr_read_b32 v46, a164
v_accvgpr_read_b32 v33, a161
v_accvgpr_read_b32 v47, a165
v_accvgpr_read_b32 v34, a162
v_accvgpr_read_b32 v48, a166
v_accvgpr_read_b32 v35, a163
v_accvgpr_read_b32 v49, a167
v_lshlrev_b32 v40, 16, v240
v_lshlrev_b32 v54, 16, v242
v_and_b32 v41, 0xffff0000, v240
v_and_b32 v55, 0xffff0000, v242
v_lshlrev_b32 v42, 16, v241
v_lshlrev_b32 v56, 16, v243
v_and_b32 v43, 0xffff0000, v241
v_and_b32 v57, 0xffff0000, v243
v_lshlrev_b32 v36, 16, v60
v_lshlrev_b32 v50, 16, v62
v_and_b32 v37, 0xffff0000, v60
v_and_b32 v51, 0xffff0000, v62
v_lshlrev_b32 v38, 16, v61
v_lshlrev_b32 v52, 16, v63
v_and_b32 v39, 0xffff0000, v61
v_and_b32 v53, 0xffff0000, v63
v_pk_fma_f32 v[32:33], v[32:33], v[4:5], v[36:37] op_sel_hi:[1,0,1]
v_pk_fma_f32 v[46:47], v[46:47], v[4:5], v[50:51] op_sel_hi:[1,0,1]
v_pk_fma_f32 v[34:35], v[34:35], v[4:5], v[38:39] op_sel_hi:[1,0,1]
v_pk_fma_f32 v[48:49], v[48:49], v[4:5], v[52:53] op_sel_hi:[1,0,1]
v_pk_fma_f32 v[32:33], v[40:41], v[8:9], v[32:33] op_sel_hi:[1,0,1]
v_pk_fma_f32 v[46:47], v[54:55], v[8:9], v[46:47] op_sel_hi:[1,0,1]
v_pk_fma_f32 v[34:35], v[42:43], v[8:9], v[34:35] op_sel_hi:[1,0,1]
v_pk_fma_f32 v[48:49], v[56:57], v[8:9], v[48:49] op_sel_hi:[1,0,1]
v_cvt_pk_bf16_f32 v44, v32, v33
v_cvt_pk_bf16_f32 v58, v46, v47
v_cvt_pk_bf16_f32 v45, v34, v35
v_cvt_pk_bf16_f32 v59, v48, v49
ds_write_b64 v11, v[44:45] offset:256
ds_write_b64 v11, v[58:59] offset:272
s_add_u32 s84, s47, 4096
buffer_load_dwordx4 v[80:83], v10, s[32:35], s84 offen offset:0 sc1
s_add_u32 s84, s46, 9216
buffer_load_dwordx4 v[192:195], v10, s[32:35], s84 offen offset:0 sc1
v_accvgpr_read_b32 v60, a194
v_accvgpr_read_b32 v61, a195
v_accvgpr_read_b32 v62, a218
v_accvgpr_read_b32 v63, a219
s_waitcnt vmcnt(20)
s_nop 0
v_permlane16_swap_b32 v60, v62
v_permlane16_swap_b32 v61, v63
v_accvgpr_read_b32 v32, a168
v_accvgpr_read_b32 v46, a172
v_accvgpr_read_b32 v33, a169
v_accvgpr_read_b32 v47, a173
v_accvgpr_read_b32 v34, a170
v_accvgpr_read_b32 v48, a174
v_accvgpr_read_b32 v35, a171
v_accvgpr_read_b32 v49, a175
v_lshlrev_b32 v40, 16, v244
v_lshlrev_b32 v54, 16, v246
v_and_b32 v41, 0xffff0000, v244
v_and_b32 v55, 0xffff0000, v246
v_lshlrev_b32 v42, 16, v245
v_lshlrev_b32 v56, 16, v247
v_and_b32 v43, 0xffff0000, v245
v_and_b32 v57, 0xffff0000, v247
v_lshlrev_b32 v36, 16, v60
v_lshlrev_b32 v50, 16, v62
v_and_b32 v37, 0xffff0000, v60
v_and_b32 v51, 0xffff0000, v62
v_lshlrev_b32 v38, 16, v61
v_lshlrev_b32 v52, 16, v63
v_and_b32 v39, 0xffff0000, v61
v_and_b32 v53, 0xffff0000, v63
v_pk_fma_f32 v[32:33], v[32:33], v[4:5], v[36:37] op_sel_hi:[1,0,1]
v_pk_fma_f32 v[46:47], v[46:47], v[4:5], v[50:51] op_sel_hi:[1,0,1]
v_pk_fma_f32 v[34:35], v[34:35], v[4:5], v[38:39] op_sel_hi:[1,0,1]
v_pk_fma_f32 v[48:49], v[48:49], v[4:5], v[52:53] op_sel_hi:[1,0,1]
v_pk_fma_f32 v[32:33], v[40:41], v[8:9], v[32:33] op_sel_hi:[1,0,1]
v_pk_fma_f32 v[46:47], v[54:55], v[8:9], v[46:47] op_sel_hi:[1,0,1]
v_pk_fma_f32 v[34:35], v[42:43], v[8:9], v[34:35] op_sel_hi:[1,0,1]
v_pk_fma_f32 v[48:49], v[56:57], v[8:9], v[48:49] op_sel_hi:[1,0,1]
v_cvt_pk_bf16_f32 v44, v32, v33
v_cvt_pk_bf16_f32 v58, v46, v47
v_cvt_pk_bf16_f32 v45, v34, v35
v_cvt_pk_bf16_f32 v59, v48, v49
ds_write_b64 v11, v[44:45] offset:288
ds_write_b64 v11, v[58:59] offset:304
s_add_u32 s84, s47, 10240
buffer_load_dwordx4 v[104:107], v10, s[32:35], s84 offen offset:0 sc1
s_add_u32 s84, s46, 9216
buffer_load_dwordx4 v[196:199], v10, s[32:35], s84 offen offset:1024 sc1
v_accvgpr_read_b32 v60, a196
v_accvgpr_read_b32 v61, a197
v_accvgpr_read_b32 v62, a220
v_accvgpr_read_b32 v63, a221
s_waitcnt vmcnt(21)
s_nop 0
v_permlane16_swap_b32 v60, v62
v_permlane16_swap_b32 v61, v63
v_accvgpr_read_b32 v32, a176
v_accvgpr_read_b32 v46, a180
v_accvgpr_read_b32 v33, a177
v_accvgpr_read_b32 v47, a181
v_accvgpr_read_b32 v34, a178
v_accvgpr_read_b32 v48, a182
v_accvgpr_read_b32 v35, a179
v_accvgpr_read_b32 v49, a183
v_lshlrev_b32 v40, 16, v248
v_lshlrev_b32 v54, 16, v250
v_and_b32 v41, 0xffff0000, v248
v_and_b32 v55, 0xffff0000, v250
v_lshlrev_b32 v42, 16, v249
v_lshlrev_b32 v56, 16, v251
v_and_b32 v43, 0xffff0000, v249
v_and_b32 v57, 0xffff0000, v251
v_lshlrev_b32 v36, 16, v60
v_lshlrev_b32 v50, 16, v62
v_and_b32 v37, 0xffff0000, v60
v_and_b32 v51, 0xffff0000, v62
v_lshlrev_b32 v38, 16, v61
v_lshlrev_b32 v52, 16, v63
v_and_b32 v39, 0xffff0000, v61
v_and_b32 v53, 0xffff0000, v63
v_pk_fma_f32 v[32:33], v[32:33], v[4:5], v[36:37] op_sel_hi:[1,0,1]
v_pk_fma_f32 v[46:47], v[46:47], v[4:5], v[50:51] op_sel_hi:[1,0,1]
v_pk_fma_f32 v[34:35], v[34:35], v[4:5], v[38:39] op_sel_hi:[1,0,1]
v_pk_fma_f32 v[48:49], v[48:49], v[4:5], v[52:53] op_sel_hi:[1,0,1]
v_pk_fma_f32 v[32:33], v[40:41], v[8:9], v[32:33] op_sel_hi:[1,0,1]
v_pk_fma_f32 v[46:47], v[54:55], v[8:9], v[46:47] op_sel_hi:[1,0,1]
v_pk_fma_f32 v[34:35], v[42:43], v[8:9], v[34:35] op_sel_hi:[1,0,1]
v_pk_fma_f32 v[48:49], v[56:57], v[8:9], v[48:49] op_sel_hi:[1,0,1]
v_cvt_pk_bf16_f32 v44, v32, v33
v_cvt_pk_bf16_f32 v58, v46, v47
v_cvt_pk_bf16_f32 v45, v34, v35
v_cvt_pk_bf16_f32 v59, v48, v49
ds_write_b64 v11, v[44:45] offset:320
ds_write_b64 v11, v[58:59] offset:336
s_add_u32 s84, s47, 4096
buffer_load_dwordx4 v[84:87], v10, s[32:35], s84 offen offset:1024 sc1
s_add_u32 s84, s46, 9216
buffer_load_dwordx4 v[200:203], v10, s[32:35], s84 offen offset:2048 sc1
v_accvgpr_read_b32 v60, a198
v_accvgpr_read_b32 v61, a199
v_accvgpr_read_b32 v62, a222
v_accvgpr_read_b32 v63, a223
s_waitcnt vmcnt(22)
s_nop 0
v_permlane16_swap_b32 v60, v62
v_permlane16_swap_b32 v61, v63
v_accvgpr_read_b32 v32, a184
v_accvgpr_read_b32 v46, a188
v_accvgpr_read_b32 v33, a185
v_accvgpr_read_b32 v47, a189
v_accvgpr_read_b32 v34, a186
v_accvgpr_read_b32 v48, a190
v_accvgpr_read_b32 v35, a187
v_accvgpr_read_b32 v49, a191
v_lshlrev_b32 v40, 16, v252
v_lshlrev_b32 v54, 16, v254
v_and_b32 v41, 0xffff0000, v252
v_and_b32 v55, 0xffff0000, v254
v_lshlrev_b32 v42, 16, v253
v_lshlrev_b32 v56, 16, v255
v_and_b32 v43, 0xffff0000, v253
v_and_b32 v57, 0xffff0000, v255
v_lshlrev_b32 v36, 16, v60
v_lshlrev_b32 v50, 16, v62
v_and_b32 v37, 0xffff0000, v60
v_and_b32 v51, 0xffff0000, v62
v_lshlrev_b32 v38, 16, v61
v_lshlrev_b32 v52, 16, v63
v_and_b32 v39, 0xffff0000, v61
v_and_b32 v53, 0xffff0000, v63
v_pk_fma_f32 v[32:33], v[32:33], v[4:5], v[36:37] op_sel_hi:[1,0,1]
v_pk_fma_f32 v[46:47], v[46:47], v[4:5], v[50:51] op_sel_hi:[1,0,1]
v_pk_fma_f32 v[34:35], v[34:35], v[4:5], v[38:39] op_sel_hi:[1,0,1]
v_pk_fma_f32 v[48:49], v[48:49], v[4:5], v[52:53] op_sel_hi:[1,0,1]
v_pk_fma_f32 v[32:33], v[40:41], v[8:9], v[32:33] op_sel_hi:[1,0,1]
v_pk_fma_f32 v[46:47], v[54:55], v[8:9], v[46:47] op_sel_hi:[1,0,1]
v_pk_fma_f32 v[34:35], v[42:43], v[8:9], v[34:35] op_sel_hi:[1,0,1]
v_pk_fma_f32 v[48:49], v[56:57], v[8:9], v[48:49] op_sel_hi:[1,0,1]
v_cvt_pk_bf16_f32 v44, v32, v33
v_cvt_pk_bf16_f32 v58, v46, v47
v_cvt_pk_bf16_f32 v45, v34, v35
v_cvt_pk_bf16_f32 v59, v48, v49
ds_write_b64 v11, v[44:45] offset:352
ds_write_b64 v11, v[58:59] offset:368
s_add_u32 s84, s47, 10240
buffer_load_dwordx4 v[108:111], v10, s[32:35], s84 offen offset:1024 sc1
s_add_u32 s84, s46, 9216
buffer_load_dwordx4 v[204:207], v10, s[32:35], s84 offen offset:3072 sc1
s_waitcnt lgkmcnt(0)
s_mul_i32 s85, s45, 98304
s_mul_i32 s86, s36, 12288
s_add_u32 s85, s85, s86
s_add_u32 s85, s85, 49152
ds_read_b128 v[112:115], v12 offset:0
ds_read_b128 v[116:119], v13 offset:0
ds_read_b128 v[120:123], v20 offset:0
ds_read_b128 v[124:127], v12 offset:3200
ds_read_b128 v[128:131], v13 offset:3200
ds_read_b128 v[132:135], v20 offset:3200
ds_read_b128 v[136:139], v12 offset:6400
ds_read_b128 v[140:143], v13 offset:6400
ds_read_b128 v[144:147], v20 offset:6400
ds_read_b128 v[148:151], v12 offset:9600
ds_read_b128 v[152:155], v13 offset:9600
ds_read_b128 v[156:159], v20 offset:9600
s_waitcnt lgkmcnt(11)
buffer_store_dwordx4 v[112:115], v10, s[28:31], s85 offen offset:0
s_waitcnt lgkmcnt(10)
buffer_store_dwordx4 v[116:119], v10, s[28:31], s85 offen offset:1024
s_waitcnt lgkmcnt(9)
buffer_store_dwordx4 v[120:123], v10, s[28:31], s85 offen offset:2048
s_waitcnt lgkmcnt(8)
buffer_store_dwordx4 v[124:127], v10, s[28:31], s85 offen offset:3072
s_waitcnt lgkmcnt(7)
s_add_u32 s85, s85, 4096
buffer_store_dwordx4 v[128:131], v10, s[28:31], s85 offen offset:0
s_waitcnt lgkmcnt(6)
buffer_store_dwordx4 v[132:135], v10, s[28:31], s85 offen offset:1024
s_waitcnt lgkmcnt(5)
buffer_store_dwordx4 v[136:139], v10, s[28:31], s85 offen offset:2048
s_waitcnt lgkmcnt(4)
buffer_store_dwordx4 v[140:143], v10, s[28:31], s85 offen offset:3072
s_waitcnt lgkmcnt(3)
s_add_u32 s85, s85, 4096
buffer_store_dwordx4 v[144:147], v10, s[28:31], s85 offen offset:0
s_waitcnt lgkmcnt(2)
buffer_store_dwordx4 v[148:151], v10, s[28:31], s85 offen offset:1024
s_waitcnt lgkmcnt(1)
buffer_store_dwordx4 v[152:155], v10, s[28:31], s85 offen offset:2048
s_waitcnt lgkmcnt(0)
buffer_store_dwordx4 v[156:159], v10, s[28:31], s85 offen offset:3072
s_waitcnt lgkmcnt(0)
s_waitcnt vmcnt(33)
v_permlane16_swap_b32 v64, v88
v_permlane16_swap_b32 v65, v89
v_accvgpr_read_b32 v32, a0
v_accvgpr_read_b32 v46, a4
v_accvgpr_read_b32 v33, a1
v_accvgpr_read_b32 v47, a5
v_accvgpr_read_b32 v34, a2
v_accvgpr_read_b32 v48, a6
v_accvgpr_read_b32 v35, a3
v_accvgpr_read_b32 v49, a7
v_lshlrev_b32 v40, 16, v160
v_lshlrev_b32 v54, 16, v162
v_and_b32 v41, 0xffff0000, v160
v_and_b32 v55, 0xffff0000, v162
v_lshlrev_b32 v42, 16, v161
v_lshlrev_b32 v56, 16, v163
v_and_b32 v43, 0xffff0000, v161
v_and_b32 v57, 0xffff0000, v163
v_lshlrev_b32 v36, 16, v64
v_lshlrev_b32 v50, 16, v88
v_and_b32 v37, 0xffff0000, v64
v_and_b32 v51, 0xffff0000, v88
v_lshlrev_b32 v38, 16, v65
v_lshlrev_b32 v52, 16, v89
v_and_b32 v39, 0xffff0000, v65
v_and_b32 v53, 0xffff0000, v89
v_pk_fma_f32 v[32:33], v[32:33], v[2:3], v[36:37] op_sel_hi:[1,0,1]
v_pk_fma_f32 v[46:47], v[46:47], v[2:3], v[50:51] op_sel_hi:[1,0,1]
v_pk_fma_f32 v[34:35], v[34:35], v[2:3], v[38:39] op_sel_hi:[1,0,1]
v_pk_fma_f32 v[48:49], v[48:49], v[2:3], v[52:53] op_sel_hi:[1,0,1]
v_pk_fma_f32 v[32:33], v[40:41], v[6:7], v[32:33] op_sel_hi:[1,0,1]
v_pk_fma_f32 v[46:47], v[54:55], v[6:7], v[46:47] op_sel_hi:[1,0,1]
v_pk_fma_f32 v[34:35], v[42:43], v[6:7], v[34:35] op_sel_hi:[1,0,1]
v_pk_fma_f32 v[48:49], v[56:57], v[6:7], v[48:49] op_sel_hi:[1,0,1]
v_cvt_pk_bf16_f32 v44, v32, v33
v_cvt_pk_bf16_f32 v58, v46, v47
v_cvt_pk_bf16_f32 v45, v34, v35
v_cvt_pk_bf16_f32 v59, v48, v49
ds_write_b64 v11, v[44:45] offset:0
ds_write_b64 v11, v[58:59] offset:16
s_waitcnt vmcnt(32)
v_permlane16_swap_b32 v66, v90
v_permlane16_swap_b32 v67, v91
v_accvgpr_read_b32 v32, a8
v_accvgpr_read_b32 v46, a12
v_accvgpr_read_b32 v33, a9
v_accvgpr_read_b32 v47, a13
v_accvgpr_read_b32 v34, a10
v_accvgpr_read_b32 v48, a14
v_accvgpr_read_b32 v35, a11
v_accvgpr_read_b32 v49, a15
v_lshlrev_b32 v40, 16, v164
v_lshlrev_b32 v54, 16, v166
v_and_b32 v41, 0xffff0000, v164
v_and_b32 v55, 0xffff0000, v166
v_lshlrev_b32 v42, 16, v165
v_lshlrev_b32 v56, 16, v167
v_and_b32 v43, 0xffff0000, v165
v_and_b32 v57, 0xffff0000, v167
v_lshlrev_b32 v36, 16, v66
v_lshlrev_b32 v50, 16, v90
v_and_b32 v37, 0xffff0000, v66
v_and_b32 v51, 0xffff0000, v90
v_lshlrev_b32 v38, 16, v67
v_lshlrev_b32 v52, 16, v91
v_and_b32 v39, 0xffff0000, v67
v_and_b32 v53, 0xffff0000, v91
v_pk_fma_f32 v[32:33], v[32:33], v[2:3], v[36:37] op_sel_hi:[1,0,1]
v_pk_fma_f32 v[46:47], v[46:47], v[2:3], v[50:51] op_sel_hi:[1,0,1]
v_pk_fma_f32 v[34:35], v[34:35], v[2:3], v[38:39] op_sel_hi:[1,0,1]
v_pk_fma_f32 v[48:49], v[48:49], v[2:3], v[52:53] op_sel_hi:[1,0,1]
v_pk_fma_f32 v[32:33], v[40:41], v[6:7], v[32:33] op_sel_hi:[1,0,1]
v_pk_fma_f32 v[46:47], v[54:55], v[6:7], v[46:47] op_sel_hi:[1,0,1]
v_pk_fma_f32 v[34:35], v[42:43], v[6:7], v[34:35] op_sel_hi:[1,0,1]
v_pk_fma_f32 v[48:49], v[56:57], v[6:7], v[48:49] op_sel_hi:[1,0,1]
v_cvt_pk_bf16_f32 v44, v32, v33
v_cvt_pk_bf16_f32 v58, v46, v47
v_cvt_pk_bf16_f32 v45, v34, v35
v_cvt_pk_bf16_f32 v59, v48, v49
ds_write_b64 v11, v[44:45] offset:32
ds_write_b64 v11, v[58:59] offset:48
s_waitcnt vmcnt(29)
v_permlane16_swap_b32 v68, v92
v_permlane16_swap_b32 v69, v93
v_accvgpr_read_b32 v32, a16
v_accvgpr_read_b32 v46, a20
v_accvgpr_read_b32 v33, a17
v_accvgpr_read_b32 v47, a21
v_accvgpr_read_b32 v34, a18
v_accvgpr_read_b32 v48, a22
v_accvgpr_read_b32 v35, a19
v_accvgpr_read_b32 v49, a23
v_lshlrev_b32 v40, 16, v168
v_lshlrev_b32 v54, 16, v170
v_and_b32 v41, 0xffff0000, v168
v_and_b32 v55, 0xffff0000, v170
v_lshlrev_b32 v42, 16, v169
v_lshlrev_b32 v56, 16, v171
v_and_b32 v43, 0xffff0000, v169
v_and_b32 v57, 0xffff0000, v171
v_lshlrev_b32 v36, 16, v68
v_lshlrev_b32 v50, 16, v92
v_and_b32 v37, 0xffff0000, v68
v_and_b32 v51, 0xffff0000, v92
v_lshlrev_b32 v38, 16, v69
v_lshlrev_b32 v52, 16, v93
v_and_b32 v39, 0xffff0000, v69
v_and_b32 v53, 0xffff0000, v93
v_pk_fma_f32 v[32:33], v[32:33], v[2:3], v[36:37] op_sel_hi:[1,0,1]
v_pk_fma_f32 v[46:47], v[46:47], v[2:3], v[50:51] op_sel_hi:[1,0,1]
v_pk_fma_f32 v[34:35], v[34:35], v[2:3], v[38:39] op_sel_hi:[1,0,1]
v_pk_fma_f32 v[48:49], v[48:49], v[2:3], v[52:53] op_sel_hi:[1,0,1]
v_pk_fma_f32 v[32:33], v[40:41], v[6:7], v[32:33] op_sel_hi:[1,0,1]
v_pk_fma_f32 v[46:47], v[54:55], v[6:7], v[46:47] op_sel_hi:[1,0,1]
v_pk_fma_f32 v[34:35], v[42:43], v[6:7], v[34:35] op_sel_hi:[1,0,1]
v_pk_fma_f32 v[48:49], v[56:57], v[6:7], v[48:49] op_sel_hi:[1,0,1]
v_cvt_pk_bf16_f32 v44, v32, v33
v_cvt_pk_bf16_f32 v58, v46, v47
v_cvt_pk_bf16_f32 v45, v34, v35
v_cvt_pk_bf16_f32 v59, v48, v49
ds_write_b64 v11, v[44:45] offset:64
ds_write_b64 v11, v[58:59] offset:80
s_waitcnt vmcnt(28)
v_permlane16_swap_b32 v70, v94
v_permlane16_swap_b32 v71, v95
v_accvgpr_read_b32 v32, a24
v_accvgpr_read_b32 v46, a28
v_accvgpr_read_b32 v33, a25
v_accvgpr_read_b32 v47, a29
v_accvgpr_read_b32 v34, a26
v_accvgpr_read_b32 v48, a30
v_accvgpr_read_b32 v35, a27
v_accvgpr_read_b32 v49, a31
v_lshlrev_b32 v40, 16, v172
v_lshlrev_b32 v54, 16, v174
v_and_b32 v41, 0xffff0000, v172
v_and_b32 v55, 0xffff0000, v174
v_lshlrev_b32 v42, 16, v173
v_lshlrev_b32 v56, 16, v175
v_and_b32 v43, 0xffff0000, v173
v_and_b32 v57, 0xffff0000, v175
v_lshlrev_b32 v36, 16, v70
v_lshlrev_b32 v50, 16, v94
v_and_b32 v37, 0xffff0000, v70
v_and_b32 v51, 0xffff0000, v94
v_lshlrev_b32 v38, 16, v71
v_lshlrev_b32 v52, 16, v95
v_and_b32 v39, 0xffff0000, v71
v_and_b32 v53, 0xffff0000, v95
v_pk_fma_f32 v[32:33], v[32:33], v[2:3], v[36:37] op_sel_hi:[1,0,1]
v_pk_fma_f32 v[46:47], v[46:47], v[2:3], v[50:51] op_sel_hi:[1,0,1]
v_pk_fma_f32 v[34:35], v[34:35], v[2:3], v[38:39] op_sel_hi:[1,0,1]
v_pk_fma_f32 v[48:49], v[48:49], v[2:3], v[52:53] op_sel_hi:[1,0,1]
v_pk_fma_f32 v[32:33], v[40:41], v[6:7], v[32:33] op_sel_hi:[1,0,1]
v_pk_fma_f32 v[46:47], v[54:55], v[6:7], v[46:47] op_sel_hi:[1,0,1]
v_pk_fma_f32 v[34:35], v[42:43], v[6:7], v[34:35] op_sel_hi:[1,0,1]
v_pk_fma_f32 v[48:49], v[56:57], v[6:7], v[48:49] op_sel_hi:[1,0,1]
v_cvt_pk_bf16_f32 v44, v32, v33
v_cvt_pk_bf16_f32 v58, v46, v47
v_cvt_pk_bf16_f32 v45, v34, v35
v_cvt_pk_bf16_f32 v59, v48, v49
ds_write_b64 v11, v[44:45] offset:96
ds_write_b64 v11, v[58:59] offset:112
s_waitcnt vmcnt(25)
v_permlane16_swap_b32 v72, v96
v_permlane16_swap_b32 v73, v97
v_accvgpr_read_b32 v32, a32
v_accvgpr_read_b32 v46, a36
v_accvgpr_read_b32 v33, a33
v_accvgpr_read_b32 v47, a37
v_accvgpr_read_b32 v34, a34
v_accvgpr_read_b32 v48, a38
v_accvgpr_read_b32 v35, a35
v_accvgpr_read_b32 v49, a39
v_lshlrev_b32 v40, 16, v176
v_lshlrev_b32 v54, 16, v178
v_and_b32 v41, 0xffff0000, v176
v_and_b32 v55, 0xffff0000, v178
v_lshlrev_b32 v42, 16, v177
v_lshlrev_b32 v56, 16, v179
v_and_b32 v43, 0xffff0000, v177
v_and_b32 v57, 0xffff0000, v179
v_lshlrev_b32 v36, 16, v72
v_lshlrev_b32 v50, 16, v96
v_and_b32 v37, 0xffff0000, v72
v_and_b32 v51, 0xffff0000, v96
v_lshlrev_b32 v38, 16, v73
v_lshlrev_b32 v52, 16, v97
v_and_b32 v39, 0xffff0000, v73
v_and_b32 v53, 0xffff0000, v97
v_pk_fma_f32 v[32:33], v[32:33], v[2:3], v[36:37] op_sel_hi:[1,0,1]
v_pk_fma_f32 v[46:47], v[46:47], v[2:3], v[50:51] op_sel_hi:[1,0,1]
v_pk_fma_f32 v[34:35], v[34:35], v[2:3], v[38:39] op_sel_hi:[1,0,1]
v_pk_fma_f32 v[48:49], v[48:49], v[2:3], v[52:53] op_sel_hi:[1,0,1]
v_pk_fma_f32 v[32:33], v[40:41], v[6:7], v[32:33] op_sel_hi:[1,0,1]
v_pk_fma_f32 v[46:47], v[54:55], v[6:7], v[46:47] op_sel_hi:[1,0,1]
v_pk_fma_f32 v[34:35], v[42:43], v[6:7], v[34:35] op_sel_hi:[1,0,1]
v_pk_fma_f32 v[48:49], v[56:57], v[6:7], v[48:49] op_sel_hi:[1,0,1]
v_cvt_pk_bf16_f32 v44, v32, v33
v_cvt_pk_bf16_f32 v58, v46, v47
v_cvt_pk_bf16_f32 v45, v34, v35
v_cvt_pk_bf16_f32 v59, v48, v49
ds_write_b64 v11, v[44:45] offset:128
ds_write_b64 v11, v[58:59] offset:144
s_waitcnt vmcnt(24)
v_permlane16_swap_b32 v74, v98
v_permlane16_swap_b32 v75, v99
v_accvgpr_read_b32 v32, a40
v_accvgpr_read_b32 v46, a44
v_accvgpr_read_b32 v33, a41
v_accvgpr_read_b32 v47, a45
v_accvgpr_read_b32 v34, a42
v_accvgpr_read_b32 v48, a46
v_accvgpr_read_b32 v35, a43
v_accvgpr_read_b32 v49, a47
v_lshlrev_b32 v40, 16, v180
v_lshlrev_b32 v54, 16, v182
v_and_b32 v41, 0xffff0000, v180
v_and_b32 v55, 0xffff0000, v182
v_lshlrev_b32 v42, 16, v181
v_lshlrev_b32 v56, 16, v183
v_and_b32 v43, 0xffff0000, v181
v_and_b32 v57, 0xffff0000, v183
v_lshlrev_b32 v36, 16, v74
v_lshlrev_b32 v50, 16, v98
v_and_b32 v37, 0xffff0000, v74
v_and_b32 v51, 0xffff0000, v98
v_lshlrev_b32 v38, 16, v75
v_lshlrev_b32 v52, 16, v99
v_and_b32 v39, 0xffff0000, v75
v_and_b32 v53, 0xffff0000, v99
v_pk_fma_f32 v[32:33], v[32:33], v[2:3], v[36:37] op_sel_hi:[1,0,1]
v_pk_fma_f32 v[46:47], v[46:47], v[2:3], v[50:51] op_sel_hi:[1,0,1]
v_pk_fma_f32 v[34:35], v[34:35], v[2:3], v[38:39] op_sel_hi:[1,0,1]
v_pk_fma_f32 v[48:49], v[48:49], v[2:3], v[52:53] op_sel_hi:[1,0,1]
v_pk_fma_f32 v[32:33], v[40:41], v[6:7], v[32:33] op_sel_hi:[1,0,1]
v_pk_fma_f32 v[46:47], v[54:55], v[6:7], v[46:47] op_sel_hi:[1,0,1]
v_pk_fma_f32 v[34:35], v[42:43], v[6:7], v[34:35] op_sel_hi:[1,0,1]
v_pk_fma_f32 v[48:49], v[56:57], v[6:7], v[48:49] op_sel_hi:[1,0,1]
v_cvt_pk_bf16_f32 v44, v32, v33
v_cvt_pk_bf16_f32 v58, v46, v47
v_cvt_pk_bf16_f32 v45, v34, v35
v_cvt_pk_bf16_f32 v59, v48, v49
ds_write_b64 v11, v[44:45] offset:160
ds_write_b64 v11, v[58:59] offset:176
s_waitcnt vmcnt(21)
v_permlane16_swap_b32 v76, v100
v_permlane16_swap_b32 v77, v101
v_accvgpr_read_b32 v32, a48
v_accvgpr_read_b32 v46, a52
v_accvgpr_read_b32 v33, a49
v_accvgpr_read_b32 v47, a53
v_accvgpr_read_b32 v34, a50
v_accvgpr_read_b32 v48, a54
v_accvgpr_read_b32 v35, a51
v_accvgpr_read_b32 v49, a55
v_lshlrev_b32 v40, 16, v184
v_lshlrev_b32 v54, 16, v186
v_and_b32 v41, 0xffff0000, v184
v_and_b32 v55, 0xffff0000, v186
v_lshlrev_b32 v42, 16, v185
v_lshlrev_b32 v56, 16, v187
v_and_b32 v43, 0xffff0000, v185
v_and_b32 v57, 0xffff0000, v187
v_lshlrev_b32 v36, 16, v76
v_lshlrev_b32 v50, 16, v100
v_and_b32 v37, 0xffff0000, v76
v_and_b32 v51, 0xffff0000, v100
v_lshlrev_b32 v38, 16, v77
v_lshlrev_b32 v52, 16, v101
v_and_b32 v39, 0xffff0000, v77
v_and_b32 v53, 0xffff0000, v101
v_pk_fma_f32 v[32:33], v[32:33], v[2:3], v[36:37] op_sel_hi:[1,0,1]
v_pk_fma_f32 v[46:47], v[46:47], v[2:3], v[50:51] op_sel_hi:[1,0,1]
v_pk_fma_f32 v[34:35], v[34:35], v[2:3], v[38:39] op_sel_hi:[1,0,1]
v_pk_fma_f32 v[48:49], v[48:49], v[2:3], v[52:53] op_sel_hi:[1,0,1]
v_pk_fma_f32 v[32:33], v[40:41], v[6:7], v[32:33] op_sel_hi:[1,0,1]
v_pk_fma_f32 v[46:47], v[54:55], v[6:7], v[46:47] op_sel_hi:[1,0,1]
v_pk_fma_f32 v[34:35], v[42:43], v[6:7], v[34:35] op_sel_hi:[1,0,1]
v_pk_fma_f32 v[48:49], v[56:57], v[6:7], v[48:49] op_sel_hi:[1,0,1]
v_cvt_pk_bf16_f32 v44, v32, v33
v_cvt_pk_bf16_f32 v58, v46, v47
v_cvt_pk_bf16_f32 v45, v34, v35
v_cvt_pk_bf16_f32 v59, v48, v49
ds_write_b64 v11, v[44:45] offset:192
ds_write_b64 v11, v[58:59] offset:208
s_waitcnt vmcnt(20)
v_permlane16_swap_b32 v78, v102
v_permlane16_swap_b32 v79, v103
v_accvgpr_read_b32 v32, a56
v_accvgpr_read_b32 v46, a60
v_accvgpr_read_b32 v33, a57
v_accvgpr_read_b32 v47, a61
v_accvgpr_read_b32 v34, a58
v_accvgpr_read_b32 v48, a62
v_accvgpr_read_b32 v35, a59
v_accvgpr_read_b32 v49, a63
v_lshlrev_b32 v40, 16, v188
v_lshlrev_b32 v54, 16, v190
v_and_b32 v41, 0xffff0000, v188
v_and_b32 v55, 0xffff0000, v190
v_lshlrev_b32 v42, 16, v189
v_lshlrev_b32 v56, 16, v191
v_and_b32 v43, 0xffff0000, v189
v_and_b32 v57, 0xffff0000, v191
v_lshlrev_b32 v36, 16, v78
v_lshlrev_b32 v50, 16, v102
v_and_b32 v37, 0xffff0000, v78
v_and_b32 v51, 0xffff0000, v102
v_lshlrev_b32 v38, 16, v79
v_lshlrev_b32 v52, 16, v103
v_and_b32 v39, 0xffff0000, v79
v_and_b32 v53, 0xffff0000, v103
v_pk_fma_f32 v[32:33], v[32:33], v[2:3], v[36:37] op_sel_hi:[1,0,1]
v_pk_fma_f32 v[46:47], v[46:47], v[2:3], v[50:51] op_sel_hi:[1,0,1]
v_pk_fma_f32 v[34:35], v[34:35], v[2:3], v[38:39] op_sel_hi:[1,0,1]
v_pk_fma_f32 v[48:49], v[48:49], v[2:3], v[52:53] op_sel_hi:[1,0,1]
v_pk_fma_f32 v[32:33], v[40:41], v[6:7], v[32:33] op_sel_hi:[1,0,1]
v_pk_fma_f32 v[46:47], v[54:55], v[6:7], v[46:47] op_sel_hi:[1,0,1]
v_pk_fma_f32 v[34:35], v[42:43], v[6:7], v[34:35] op_sel_hi:[1,0,1]
v_pk_fma_f32 v[48:49], v[56:57], v[6:7], v[48:49] op_sel_hi:[1,0,1]
v_cvt_pk_bf16_f32 v44, v32, v33
v_cvt_pk_bf16_f32 v58, v46, v47
v_cvt_pk_bf16_f32 v45, v34, v35
v_cvt_pk_bf16_f32 v59, v48, v49
ds_write_b64 v11, v[44:45] offset:224
ds_write_b64 v11, v[58:59] offset:240
s_waitcnt vmcnt(17)
v_permlane16_swap_b32 v80, v104
v_permlane16_swap_b32 v81, v105
v_accvgpr_read_b32 v32, a64
v_accvgpr_read_b32 v46, a68
v_accvgpr_read_b32 v33, a65
v_accvgpr_read_b32 v47, a69
v_accvgpr_read_b32 v34, a66
v_accvgpr_read_b32 v48, a70
v_accvgpr_read_b32 v35, a67
v_accvgpr_read_b32 v49, a71
v_lshlrev_b32 v40, 16, v192
v_lshlrev_b32 v54, 16, v194
v_and_b32 v41, 0xffff0000, v192
v_and_b32 v55, 0xffff0000, v194
v_lshlrev_b32 v42, 16, v193
v_lshlrev_b32 v56, 16, v195
v_and_b32 v43, 0xffff0000, v193
v_and_b32 v57, 0xffff0000, v195
v_lshlrev_b32 v36, 16, v80
v_lshlrev_b32 v50, 16, v104
v_and_b32 v37, 0xffff0000, v80
v_and_b32 v51, 0xffff0000, v104
v_lshlrev_b32 v38, 16, v81
v_lshlrev_b32 v52, 16, v105
v_and_b32 v39, 0xffff0000, v81
v_and_b32 v53, 0xffff0000, v105
v_pk_fma_f32 v[32:33], v[32:33], v[2:3], v[36:37] op_sel_hi:[1,0,1]
v_pk_fma_f32 v[46:47], v[46:47], v[2:3], v[50:51] op_sel_hi:[1,0,1]
v_pk_fma_f32 v[34:35], v[34:35], v[2:3], v[38:39] op_sel_hi:[1,0,1]
v_pk_fma_f32 v[48:49], v[48:49], v[2:3], v[52:53] op_sel_hi:[1,0,1]
v_pk_fma_f32 v[32:33], v[40:41], v[6:7], v[32:33] op_sel_hi:[1,0,1]
v_pk_fma_f32 v[46:47], v[54:55], v[6:7], v[46:47] op_sel_hi:[1,0,1]
v_pk_fma_f32 v[34:35], v[42:43], v[6:7], v[34:35] op_sel_hi:[1,0,1]
v_pk_fma_f32 v[48:49], v[56:57], v[6:7], v[48:49] op_sel_hi:[1,0,1]
v_cvt_pk_bf16_f32 v44, v32, v33
v_cvt_pk_bf16_f32 v58, v46, v47
v_cvt_pk_bf16_f32 v45, v34, v35
v_cvt_pk_bf16_f32 v59, v48, v49
ds_write_b64 v11, v[44:45] offset:256
ds_write_b64 v11, v[58:59] offset:272
s_waitcnt vmcnt(16)
v_permlane16_swap_b32 v82, v106
v_permlane16_swap_b32 v83, v107
v_accvgpr_read_b32 v32, a72
v_accvgpr_read_b32 v46, a76
v_accvgpr_read_b32 v33, a73
v_accvgpr_read_b32 v47, a77
v_accvgpr_read_b32 v34, a74
v_accvgpr_read_b32 v48, a78
v_accvgpr_read_b32 v35, a75
v_accvgpr_read_b32 v49, a79
v_lshlrev_b32 v40, 16, v196
v_lshlrev_b32 v54, 16, v198
v_and_b32 v41, 0xffff0000, v196
v_and_b32 v55, 0xffff0000, v198
v_lshlrev_b32 v42, 16, v197
v_lshlrev_b32 v56, 16, v199
v_and_b32 v43, 0xffff0000, v197
v_and_b32 v57, 0xffff0000, v199
v_lshlrev_b32 v36, 16, v82
v_lshlrev_b32 v50, 16, v106
v_and_b32 v37, 0xffff0000, v82
v_and_b32 v51, 0xffff0000, v106
v_lshlrev_b32 v38, 16, v83
v_lshlrev_b32 v52, 16, v107
v_and_b32 v39, 0xffff0000, v83
v_and_b32 v53, 0xffff0000, v107
v_pk_fma_f32 v[32:33], v[32:33], v[2:3], v[36:37] op_sel_hi:[1,0,1]
v_pk_fma_f32 v[46:47], v[46:47], v[2:3], v[50:51] op_sel_hi:[1,0,1]
v_pk_fma_f32 v[34:35], v[34:35], v[2:3], v[38:39] op_sel_hi:[1,0,1]
v_pk_fma_f32 v[48:49], v[48:49], v[2:3], v[52:53] op_sel_hi:[1,0,1]
v_pk_fma_f32 v[32:33], v[40:41], v[6:7], v[32:33] op_sel_hi:[1,0,1]
v_pk_fma_f32 v[46:47], v[54:55], v[6:7], v[46:47] op_sel_hi:[1,0,1]
v_pk_fma_f32 v[34:35], v[42:43], v[6:7], v[34:35] op_sel_hi:[1,0,1]
v_pk_fma_f32 v[48:49], v[56:57], v[6:7], v[48:49] op_sel_hi:[1,0,1]
v_cvt_pk_bf16_f32 v44, v32, v33
v_cvt_pk_bf16_f32 v58, v46, v47
v_cvt_pk_bf16_f32 v45, v34, v35
v_cvt_pk_bf16_f32 v59, v48, v49
ds_write_b64 v11, v[44:45] offset:288
ds_write_b64 v11, v[58:59] offset:304
s_waitcnt vmcnt(13)
v_permlane16_swap_b32 v84, v108
v_permlane16_swap_b32 v85, v109
v_accvgpr_read_b32 v32, a80
v_accvgpr_read_b32 v46, a84
v_accvgpr_read_b32 v33, a81
v_accvgpr_read_b32 v47, a85
v_accvgpr_read_b32 v34, a82
v_accvgpr_read_b32 v48, a86
v_accvgpr_read_b32 v35, a83
v_accvgpr_read_b32 v49, a87
v_lshlrev_b32 v40, 16, v200
v_lshlrev_b32 v54, 16, v202
v_and_b32 v41, 0xffff0000, v200
v_and_b32 v55, 0xffff0000, v202
v_lshlrev_b32 v42, 16, v201
v_lshlrev_b32 v56, 16, v203
v_and_b32 v43, 0xffff0000, v201
v_and_b32 v57, 0xffff0000, v203
v_lshlrev_b32 v36, 16, v84
v_lshlrev_b32 v50, 16, v108
v_and_b32 v37, 0xffff0000, v84
v_and_b32 v51, 0xffff0000, v108
v_lshlrev_b32 v38, 16, v85
v_lshlrev_b32 v52, 16, v109
v_and_b32 v39, 0xffff0000, v85
v_and_b32 v53, 0xffff0000, v109
v_pk_fma_f32 v[32:33], v[32:33], v[2:3], v[36:37] op_sel_hi:[1,0,1]
v_pk_fma_f32 v[46:47], v[46:47], v[2:3], v[50:51] op_sel_hi:[1,0,1]
v_pk_fma_f32 v[34:35], v[34:35], v[2:3], v[38:39] op_sel_hi:[1,0,1]
v_pk_fma_f32 v[48:49], v[48:49], v[2:3], v[52:53] op_sel_hi:[1,0,1]
v_pk_fma_f32 v[32:33], v[40:41], v[6:7], v[32:33] op_sel_hi:[1,0,1]
v_pk_fma_f32 v[46:47], v[54:55], v[6:7], v[46:47] op_sel_hi:[1,0,1]
v_pk_fma_f32 v[34:35], v[42:43], v[6:7], v[34:35] op_sel_hi:[1,0,1]
v_pk_fma_f32 v[48:49], v[56:57], v[6:7], v[48:49] op_sel_hi:[1,0,1]
v_cvt_pk_bf16_f32 v44, v32, v33
v_cvt_pk_bf16_f32 v58, v46, v47
v_cvt_pk_bf16_f32 v45, v34, v35
v_cvt_pk_bf16_f32 v59, v48, v49
ds_write_b64 v11, v[44:45] offset:320
ds_write_b64 v11, v[58:59] offset:336
s_waitcnt vmcnt(12)
v_permlane16_swap_b32 v86, v110
v_permlane16_swap_b32 v87, v111
v_accvgpr_read_b32 v32, a88
v_accvgpr_read_b32 v46, a92
v_accvgpr_read_b32 v33, a89
v_accvgpr_read_b32 v47, a93
v_accvgpr_read_b32 v34, a90
v_accvgpr_read_b32 v48, a94
v_accvgpr_read_b32 v35, a91
v_accvgpr_read_b32 v49, a95
v_lshlrev_b32 v40, 16, v204
v_lshlrev_b32 v54, 16, v206
v_and_b32 v41, 0xffff0000, v204
v_and_b32 v55, 0xffff0000, v206
v_lshlrev_b32 v42, 16, v205
v_lshlrev_b32 v56, 16, v207
v_and_b32 v43, 0xffff0000, v205
v_and_b32 v57, 0xffff0000, v207
v_lshlrev_b32 v36, 16, v86
v_lshlrev_b32 v50, 16, v110
v_and_b32 v37, 0xffff0000, v86
v_and_b32 v51, 0xffff0000, v110
v_lshlrev_b32 v38, 16, v87
v_lshlrev_b32 v52, 16, v111
v_and_b32 v39, 0xffff0000, v87
v_and_b32 v53, 0xffff0000, v111
v_pk_fma_f32 v[32:33], v[32:33], v[2:3], v[36:37] op_sel_hi:[1,0,1]
v_pk_fma_f32 v[46:47], v[46:47], v[2:3], v[50:51] op_sel_hi:[1,0,1]
v_pk_fma_f32 v[34:35], v[34:35], v[2:3], v[38:39] op_sel_hi:[1,0,1]
v_pk_fma_f32 v[48:49], v[48:49], v[2:3], v[52:53] op_sel_hi:[1,0,1]
v_pk_fma_f32 v[32:33], v[40:41], v[6:7], v[32:33] op_sel_hi:[1,0,1]
v_pk_fma_f32 v[46:47], v[54:55], v[6:7], v[46:47] op_sel_hi:[1,0,1]
v_pk_fma_f32 v[34:35], v[42:43], v[6:7], v[34:35] op_sel_hi:[1,0,1]
v_pk_fma_f32 v[48:49], v[56:57], v[6:7], v[48:49] op_sel_hi:[1,0,1]
v_cvt_pk_bf16_f32 v44, v32, v33
v_cvt_pk_bf16_f32 v58, v46, v47
v_cvt_pk_bf16_f32 v45, v34, v35
v_cvt_pk_bf16_f32 v59, v48, v49
ds_write_b64 v11, v[44:45] offset:352
ds_write_b64 v11, v[58:59] offset:368
s_waitcnt lgkmcnt(0)
s_mul_i32 s85, s45, 98304
s_mul_i32 s86, s36, 12288
s_add_u32 s85, s85, s86
ds_read_b128 v[64:67], v12 offset:0
ds_read_b128 v[68:71], v13 offset:0
ds_read_b128 v[72:75], v20 offset:0
ds_read_b128 v[76:79], v12 offset:3200
ds_read_b128 v[80:83], v13 offset:3200
ds_read_b128 v[84:87], v20 offset:3200
ds_read_b128 v[88:91], v12 offset:6400
ds_read_b128 v[92:95], v13 offset:6400
ds_read_b128 v[96:99], v20 offset:6400
ds_read_b128 v[100:103], v12 offset:9600
ds_read_b128 v[104:107], v13 offset:9600
ds_read_b128 v[108:111], v20 offset:9600
s_waitcnt lgkmcnt(11)
buffer_store_dwordx4 v[64:67], v10, s[28:31], s85 offen offset:0
s_waitcnt lgkmcnt(10)
buffer_store_dwordx4 v[68:71], v10, s[28:31], s85 offen offset:1024
s_waitcnt lgkmcnt(9)
buffer_store_dwordx4 v[72:75], v10, s[28:31], s85 offen offset:2048
s_waitcnt lgkmcnt(8)
buffer_store_dwordx4 v[76:79], v10, s[28:31], s85 offen offset:3072
s_waitcnt lgkmcnt(7)
s_add_u32 s85, s85, 4096
buffer_store_dwordx4 v[80:83], v10, s[28:31], s85 offen offset:0
s_waitcnt lgkmcnt(6)
buffer_store_dwordx4 v[84:87], v10, s[28:31], s85 offen offset:1024
s_waitcnt lgkmcnt(5)
buffer_store_dwordx4 v[88:91], v10, s[28:31], s85 offen offset:2048
s_waitcnt lgkmcnt(4)
buffer_store_dwordx4 v[92:95], v10, s[28:31], s85 offen offset:3072
s_waitcnt lgkmcnt(3)
s_add_u32 s85, s85, 4096
buffer_store_dwordx4 v[96:99], v10, s[28:31], s85 offen offset:0
s_waitcnt lgkmcnt(2)
buffer_store_dwordx4 v[100:103], v10, s[28:31], s85 offen offset:1024
s_waitcnt lgkmcnt(1)
buffer_store_dwordx4 v[104:107], v10, s[28:31], s85 offen offset:2048
s_waitcnt lgkmcnt(0)
buffer_store_dwordx4 v[108:111], v10, s[28:31], s85 offen offset:3072
s_branch L_fin
L_final_s:
v_lshlrev_b32 v10, 4, v1
s_add_u32 s84, s47, 12288
buffer_load_dwordx4 v[112:115], v10, s[32:35], s84 offen offset:0 sc1
s_add_u32 s84, s47, 12288
buffer_load_dwordx4 v[116:119], v10, s[32:35], s84 offen offset:1024 sc1
v_and_b32 v11, 31, v1
v_mul_u32_u24 v11, 400, v11
v_lshrrev_b32 v22, 5, v1
v_lshl_add_u32 v11, v22, 3, v11
v_add_u32 v11, s53, v11
v_add_u32 v22, 0, v1
v_mul_u32_u24 v23, 2731, v22
v_lshrrev_b32 v23, 16, v23
v_mul_u32_u24 v24, 24, v23
v_sub_u32 v22, v22, v24
v_mul_u32_u24 v23, 400, v23
v_lshl_add_u32 v12, v22, 4, v23
v_add_u32 v12, s53, v12
v_add_u32 v22, 64, v1
v_mul_u32_u24 v23, 2731, v22
v_lshrrev_b32 v23, 16, v23
v_mul_u32_u24 v24, 24, v23
v_sub_u32 v22, v22, v24
v_mul_u32_u24 v23, 400, v23
v_lshl_add_u32 v13, v22, 4, v23
v_add_u32 v13, s53, v13
v_add_u32 v22, 128, v1
v_mul_u32_u24 v23, 2731, v22
v_lshrrev_b32 v23, 16, v23
v_mul_u32_u24 v24, 24, v23
v_sub_u32 v22, v22, v24
v_mul_u32_u24 v23, 400, v23
v_lshl_add_u32 v20, v22, 4, v23
v_add_u32 v20, s53, v20
v_mov_b32 v22, v16
v_mov_b32 v25, v22
s_nop 1
v_permlane32_swap_b32 v22, v25
s_nop 0
v_add_f32 v22, v22, v25
v_rcp_f32 v22, v22
s_nop 0
v_mul_f32 v22, s51, v22
v_mov_b32 v2, v22
v_mov_b32 v22, v17
v_mov_b32 v25, v22
s_nop 1
v_permlane32_swap_b32 v22, v25
s_nop 0
v_add_f32 v22, v22, v25
v_rcp_f32 v22, v22
s_nop 0
v_mul_f32 v22, s51, v22
v_mov_b32 v4, v22
v_accvgpr_read_b32 v62, a200
v_accvgpr_read_b32 v63, a201
s_waitcnt vmcnt(1)
s_nop 0
v_permlane16_swap_b32 v112, v62
v_permlane16_swap_b32 v113, v63
v_accvgpr_read_b32 v32, a96
v_accvgpr_read_b32 v46, a100
v_accvgpr_read_b32 v33, a97
v_accvgpr_read_b32 v47, a101
v_accvgpr_read_b32 v34, a98
v_accvgpr_read_b32 v48, a102
v_accvgpr_read_b32 v35, a99
v_accvgpr_read_b32 v49, a103
v_lshlrev_b32 v36, 16, v112
v_lshlrev_b32 v50, 16, v62
v_and_b32 v37, 0xffff0000, v112
v_and_b32 v51, 0xffff0000, v62
v_lshlrev_b32 v38, 16, v113
v_lshlrev_b32 v52, 16, v63
v_and_b32 v39, 0xffff0000, v113
v_and_b32 v53, 0xffff0000, v63
v_pk_fma_f32 v[32:33], v[32:33], v[4:5], v[36:37] op_sel_hi:[1,0,1]
v_pk_fma_f32 v[46:47], v[46:47], v[4:5], v[50:51] op_sel_hi:[1,0,1]
v_pk_fma_f32 v[34:35], v[34:35], v[4:5], v[38:39] op_sel_hi:[1,0,1]
v_pk_fma_f32 v[48:49], v[48:49], v[4:5], v[52:53] op_sel_hi:[1,0,1]
v_cvt_pk_bf16_f32 v44, v32, v33
v_cvt_pk_bf16_f32 v58, v46, v47
v_cvt_pk_bf16_f32 v45, v34, v35
v_cvt_pk_bf16_f32 v59, v48, v49
ds_write_b64 v11, v[44:45] offset:0
ds_write_b64 v11, v[58:59] offset:16
s_add_u32 s84, s47, 0
buffer_load_dwordx4 v[64:67], v10, s[32:35], s84 offen offset:0 sc1
s_add_u32 s84, s47, 6144
buffer_load_dwordx4 v[88:91], v10, s[32:35], s84 offen offset:0 sc1
v_accvgpr_read_b32 v62, a202
v_accvgpr_read_b32 v63, a203
s_nop 0
v_permlane16_swap_b32 v114, v62
v_permlane16_swap_b32 v115, v63
v_accvgpr_read_b32 v32, a104
v_accvgpr_read_b32 v46, a108
v_accvgpr_read_b32 v33, a105
v_accvgpr_read_b32 v47, a109
v_accvgpr_read_b32 v34, a106
v_accvgpr_read_b32 v48, a110
v_accvgpr_read_b32 v35, a107
v_accvgpr_read_b32 v49, a111
v_lshlrev_b32 v36, 16, v114
v_lshlrev_b32 v50, 16, v62
v_and_b32 v37, 0xffff0000, v114
v_and_b32 v51, 0xffff0000, v62
v_lshlrev_b32 v38, 16, v115
v_lshlrev_b32 v52, 16, v63
v_and_b32 v39, 0xffff0000, v115
v_and_b32 v53, 0xffff0000, v63
v_pk_fma_f32 v[32:33], v[32:33], v[4:5], v[36:37] op_sel_hi:[1,0,1]
v_pk_fma_f32 v[46:47], v[46:47], v[4:5], v[50:51] op_sel_hi:[1,0,1]
v_pk_fma_f32 v[34:35], v[34:35], v[4:5], v[38:39] op_sel_hi:[1,0,1]
v_pk_fma_f32 v[48:49], v[48:49], v[4:5], v[52:53] op_sel_hi:[1,0,1]
v_cvt_pk_bf16_f32 v44, v32, v33
v_cvt_pk_bf16_f32 v58, v46, v47
v_cvt_pk_bf16_f32 v45, v34, v35
v_cvt_pk_bf16_f32 v59, v48, v49
ds_write_b64 v11, v[44:45] offset:32
ds_write_b64 v11, v[58:59] offset:48
s_add_u32 s84, s47, 0
buffer_load_dwordx4 v[68:71], v10, s[32:35], s84 offen offset:1024 sc1
s_add_u32 s84, s47, 6144
buffer_load_dwordx4 v[92:95], v10, s[32:35], s84 offen offset:1024 sc1
v_accvgpr_read_b32 v62, a204
v_accvgpr_read_b32 v63, a205
s_waitcnt vmcnt(4)
s_nop 0
v_permlane16_swap_b32 v116, v62
v_permlane16_swap_b32 v117, v63
v_accvgpr_read_b32 v32, a112
v_accvgpr_read_b32 v46, a116
v_accvgpr_read_b32 v33, a113
v_accvgpr_read_b32 v47, a117
v_accvgpr_read_b32 v34, a114
v_accvgpr_read_b32 v48, a118
v_accvgpr_read_b32 v35, a115
v_accvgpr_read_b32 v49, a119
v_lshlrev_b32 v36, 16, v116
v_lshlrev_b32 v50, 16, v62
v_and_b32 v37, 0xffff0000, v116
v_and_b32 v51, 0xffff0000, v62
v_lshlrev_b32 v38, 16, v117
v_lshlrev_b32 v52, 16, v63
v_and_b32 v39, 0xffff0000, v117
v_and_b32 v53, 0xffff0000, v63
v_pk_fma_f32 v[32:33], v[32:33], v[4:5], v[36:37] op_sel_hi:[1,0,1]
v_pk_fma_f32 v[46:47], v[46:47], v[4:5], v[50:51] op_sel_hi:[1,0,1]
v_pk_fma_f32 v[34:35], v[34:35], v[4:5], v[38:39] op_sel_hi:[1,0,1]
v_pk_fma_f32 v[48:49], v[48:49], v[4:5], v[52:53] op_sel_hi:[1,0,1]
v_cvt_pk_bf16_f32 v44, v32, v33
v_cvt_pk_bf16_f32 v58, v46, v47
v_cvt_pk_bf16_f32 v45, v34, v35
v_cvt_pk_bf16_f32 v59, v48, v49
ds_write_b64 v11, v[44:45] offset:64
ds_write_b64 v11, v[58:59] offset:80
s_add_u32 s84, s47, 0
buffer_load_dwordx4 v[72:75], v10, s[32:35], s84 offen offset:2048 sc1
s_add_u32 s84, s47, 6144
buffer_load_dwordx4 v[96:99], v10, s[32:35], s84 offen offset:2048 sc1
v_accvgpr_read_b32 v62, a206
v_accvgpr_read_b32 v63, a207
s_nop 0
v_permlane16_swap_b32 v118, v62
v_permlane16_swap_b32 v119, v63
v_accvgpr_read_b32 v32, a120
v_accvgpr_read_b32 v46, a124
v_accvgpr_read_b32 v33, a121
v_accvgpr_read_b32 v47, a125
v_accvgpr_read_b32 v34, a122
v_accvgpr_read_b32 v48, a126
v_accvgpr_read_b32 v35, a123
v_accvgpr_read_b32 v49, a127
v_lshlrev_b32 v36, 16, v118
v_lshlrev_b32 v50, 16, v62
v_and_b32 v37, 0xffff0000, v118
v_and_b32 v51, 0xffff0000, v62
v_lshlrev_b32 v38, 16, v119
v_lshlrev_b32 v52, 16, v63
v_and_b32 v39, 0xffff0000, v119
v_and_b32 v53, 0xffff0000, v63
v_pk_fma_f32 v[32:33], v[32:33], v[4:5], v[36:37] op_sel_hi:[1,0,1]
v_pk_fma_f32 v[46:47], v[46:47], v[4:5], v[50:51] op_sel_hi:[1,0,1]
v_pk_fma_f32 v[34:35], v[34:35], v[4:5], v[38:39] op_sel_hi:[1,0,1]
v_pk_fma_f32 v[48:49], v[48:49], v[4:5], v[52:53] op_sel_hi:[1,0,1]
v_cvt_pk_bf16_f32 v44, v32, v33
v_cvt_pk_bf16_f32 v58, v46, v47
v_cvt_pk_bf16_f32 v45, v34, v35
v_cvt_pk_bf16_f32 v59, v48, v49
ds_write_b64 v11, v[44:45] offset:96
ds_write_b64 v11, v[58:59] offset:112
s_add_u32 s84, s47, 0
buffer_load_dwordx4 v[76:79], v10, s[32:35], s84 offen offset:3072 sc1
s_add_u32 s84, s47, 6144
buffer_load_dwordx4 v[100:103], v10, s[32:35], s84 offen offset:3072 sc1
v_accvgpr_read_b32 v60, a224
v_accvgpr_read_b32 v61, a225
v_accvgpr_read_b32 v62, a208
v_accvgpr_read_b32 v63, a209
s_nop 0
v_permlane16_swap_b32 v60, v62
v_permlane16_swap_b32 v61, v63
v_accvgpr_read_b32 v32, a128
v_accvgpr_read_b32 v46, a132
v_accvgpr_read_b32 v33, a129
v_accvgpr_read_b32 v47, a133
v_accvgpr_read_b32 v34, a130
v_accvgpr_read_b32 v48, a134
v_accvgpr_read_b32 v35, a131
v_accvgpr_read_b32 v49, a135
v_lshlrev_b32 v36, 16, v60
v_lshlrev_b32 v50, 16, v62
v_and_b32 v37, 0xffff0000, v60
v_and_b32 v51, 0xffff0000, v62
v_lshlrev_b32 v38, 16, v61
v_lshlrev_b32 v52, 16, v63
v_and_b32 v39, 0xffff0000, v61
v_and_b32 v53, 0xffff0000, v63
v_pk_fma_f32 v[32:33], v[32:33], v[4:5], v[36:37] op_sel_hi:[1,0,1]
v_pk_fma_f32 v[46:47], v[46:47], v[4:5], v[50:51] op_sel_hi:[1,0,1]
v_pk_fma_f32 v[34:35], v[34:35], v[4:5], v[38:39] op_sel_hi:[1,0,1]
v_pk_fma_f32 v[48:49], v[48:49], v[4:5], v[52:53] op_sel_hi:[1,0,1]
v_cvt_pk_bf16_f32 v44, v32, v33
v_cvt_pk_bf16_f32 v58, v46, v47
v_cvt_pk_bf16_f32 v45, v34, v35
v_cvt_pk_bf16_f32 v59, v48, v49
ds_write_b64 v11, v[44:45] offset:128
ds_write_b64 v11, v[58:59] offset:144
s_add_u32 s84, s47, 4096
buffer_load_dwordx4 v[80:83], v10, s[32:35], s84 offen offset:0 sc1
s_add_u32 s84, s47, 10240
buffer_load_dwordx4 v[104:107], v10, s[32:35], s84 offen offset:0 sc1
v_accvgpr_read_b32 v60, a226
v_accvgpr_read_b32 v61, a227
v_accvgpr_read_b32 v62, a210
v_accvgpr_read_b32 v63, a211
s_nop 0
v_permlane16_swap_b32 v60, v62
v_permlane16_swap_b32 v61, v63
v_accvgpr_read_b32 v32, a136
v_accvgpr_read_b32 v46, a140
v_accvgpr_read_b32 v33, a137
v_accvgpr_read_b32 v47, a141
v_accvgpr_read_b32 v34, a138
v_accvgpr_read_b32 v48, a142
v_accvgpr_read_b32 v35, a139
v_accvgpr_read_b32 v49, a143
v_lshlrev_b32 v36, 16, v60
v_lshlrev_b32 v50, 16, v62
v_and_b32 v37, 0xffff0000, v60
v_and_b32 v51, 0xffff0000, v62
v_lshlrev_b32 v38, 16, v61
v_lshlrev_b32 v52, 16, v63
v_and_b32 v39, 0xffff0000, v61
v_and_b32 v53, 0xffff0000, v63
v_pk_fma_f32 v[32:33], v[32:33], v[4:5], v[36:37] op_sel_hi:[1,0,1]
v_pk_fma_f32 v[46:47], v[46:47], v[4:5], v[50:51] op_sel_hi:[1,0,1]
v_pk_fma_f32 v[34:35], v[34:35], v[4:5], v[38:39] op_sel_hi:[1,0,1]
v_pk_fma_f32 v[48:49], v[48:49], v[4:5], v[52:53] op_sel_hi:[1,0,1]
v_cvt_pk_bf16_f32 v44, v32, v33
v_cvt_pk_bf16_f32 v58, v46, v47
v_cvt_pk_bf16_f32 v45, v34, v35
v_cvt_pk_bf16_f32 v59, v48, v49
ds_write_b64 v11, v[44:45] offset:160
ds_write_b64 v11, v[58:59] offset:176
s_add_u32 s84, s47, 4096
buffer_load_dwordx4 v[84:87], v10, s[32:35], s84 offen offset:1024 sc1
s_add_u32 s84, s47, 10240
buffer_load_dwordx4 v[108:111], v10, s[32:35], s84 offen offset:1024 sc1
v_accvgpr_read_b32 v60, a228
v_accvgpr_read_b32 v61, a229
v_accvgpr_read_b32 v62, a212
v_accvgpr_read_b32 v63, a213
s_nop 0
v_permlane16_swap_b32 v60, v62
v_permlane16_swap_b32 v61, v63
v_accvgpr_read_b32 v32, a144
v_accvgpr_read_b32 v46, a148
v_accvgpr_read_b32 v33, a145
v_accvgpr_read_b32 v47, a149
v_accvgpr_read_b32 v34, a146
v_accvgpr_read_b32 v48, a150
v_accvgpr_read_b32 v35, a147
v_accvgpr_read_b32 v49, a151
v_lshlrev_b32 v36, 16, v60
v_lshlrev_b32 v50, 16, v62
v_and_b32 v37, 0xffff0000, v60
v_and_b32 v51, 0xffff0000, v62
v_lshlrev_b32 v38, 16, v61
v_lshlrev_b32 v52, 16, v63
v_and_b32 v39, 0xffff0000, v61
v_and_b32 v53, 0xffff0000, v63
v_pk_fma_f32 v[32:33], v[32:33], v[4:5], v[36:37] op_sel_hi:[1,0,1]
v_pk_fma_f32 v[46:47], v[46:47], v[4:5], v[50:51] op_sel_hi:[1,0,1]
v_pk_fma_f32 v[34:35], v[34:35], v[4:5], v[38:39] op_sel_hi:[1,0,1]
v_pk_fma_f32 v[48:49], v[48:49], v[4:5], v[52:53] op_sel_hi:[1,0,1]
v_cvt_pk_bf16_f32 v44, v32, v33
v_cvt_pk_bf16_f32 v58, v46, v47
v_cvt_pk_bf16_f32 v45, v34, v35
v_cvt_pk_bf16_f32 v59, v48, v49
ds_write_b64 v11, v[44:45] offset:192
ds_write_b64 v11, v[58:59] offset:208
v_accvgpr_read_b32 v60, a230
v_accvgpr_read_b32 v61, a231
v_accvgpr_read_b32 v62, a214
v_accvgpr_read_b32 v63, a215
s_nop 0
v_permlane16_swap_b32 v60, v62
v_permlane16_swap_b32 v61, v63
v_accvgpr_read_b32 v32, a152
v_accvgpr_read_b32 v46, a156
v_accvgpr_read_b32 v33, a153
v_accvgpr_read_b32 v47, a157
v_accvgpr_read_b32 v34, a154
v_accvgpr_read_b32 v48, a158
v_accvgpr_read_b32 v35, a155
v_accvgpr_read_b32 v49, a159
v_lshlrev_b32 v36, 16, v60
v_lshlrev_b32 v50, 16, v62
v_and_b32 v37, 0xffff0000, v60
v_and_b32 v51, 0xffff0000, v62
v_lshlrev_b32 v38, 16, v61
v_lshlrev_b32 v52, 16, v63
v_and_b32 v39, 0xffff0000, v61
v_and_b32 v53, 0xffff0000, v63
v_pk_fma_f32 v[32:33], v[32:33], v[4:5], v[36:37] op_sel_hi:[1,0,1]
v_pk_fma_f32 v[46:47], v[46:47], v[4:5], v[50:51] op_sel_hi:[1,0,1]
v_pk_fma_f32 v[34:35], v[34:35], v[4:5], v[38:39] op_sel_hi:[1,0,1]
v_pk_fma_f32 v[48:49], v[48:49], v[4:5], v[52:53] op_sel_hi:[1,0,1]
v_cvt_pk_bf16_f32 v44, v32, v33
v_cvt_pk_bf16_f32 v58, v46, v47
v_cvt_pk_bf16_f32 v45, v34, v35
v_cvt_pk_bf16_f32 v59, v48, v49
ds_write_b64 v11, v[44:45] offset:224
ds_write_b64 v11, v[58:59] offset:240
v_accvgpr_read_b32 v60, a192
v_accvgpr_read_b32 v61, a193
v_accvgpr_read_b32 v62, a216
v_accvgpr_read_b32 v63, a217
s_nop 0
v_permlane16_swap_b32 v60, v62
v_permlane16_swap_b32 v61, v63
v_accvgpr_read_b32 v32, a160
v_accvgpr_read_b32 v46, a164
v_accvgpr_read_b32 v33, a161
v_accvgpr_read_b32 v47, a165
v_accvgpr_read_b32 v34, a162
v_accvgpr_read_b32 v48, a166
v_accvgpr_read_b32 v35, a163
v_accvgpr_read_b32 v49, a167
v_lshlrev_b32 v36, 16, v60
v_lshlrev_b32 v50, 16, v62
v_and_b32 v37, 0xffff0000, v60
v_and_b32 v51, 0xffff0000, v62
v_lshlrev_b32 v38, 16, v61
v_lshlrev_b32 v52, 16, v63
v_and_b32 v39, 0xffff0000, v61
v_and_b32 v53, 0xffff0000, v63
v_pk_fma_f32 v[32:33], v[32:33], v[4:5], v[36:37] op_sel_hi:[1,0,1]
v_pk_fma_f32 v[46:47], v[46:47], v[4:5], v[50:51] op_sel_hi:[1,0,1]
v_pk_fma_f32 v[34:35], v[34:35], v[4:5], v[38:39] op_sel_hi:[1,0,1]
v_pk_fma_f32 v[48:49], v[48:49], v[4:5], v[52:53] op_sel_hi:[1,0,1]
v_cvt_pk_bf16_f32 v44, v32, v33
v_cvt_pk_bf16_f32 v58, v46, v47
v_cvt_pk_bf16_f32 v45, v34, v35
v_cvt_pk_bf16_f32 v59, v48, v49
ds_write_b64 v11, v[44:45] offset:256
ds_write_b64 v11, v[58:59] offset:272
v_accvgpr_read_b32 v60, a194
v_accvgpr_read_b32 v61, a195
v_accvgpr_read_b32 v62, a218
v_accvgpr_read_b32 v63, a219
s_nop 0
v_permlane16_swap_b32 v60, v62
v_permlane16_swap_b32 v61, v63
v_accvgpr_read_b32 v32, a168
v_accvgpr_read_b32 v46, a172
v_accvgpr_read_b32 v33, a169
v_accvgpr_read_b32 v47, a173
v_accvgpr_read_b32 v34, a170
v_accvgpr_read_b32 v48, a174
v_accvgpr_read_b32 v35, a171
v_accvgpr_read_b32 v49, a175
v_lshlrev_b32 v36, 16, v60
v_lshlrev_b32 v50, 16, v62
v_and_b32 v37, 0xffff0000, v60
v_and_b32 v51, 0xffff0000, v62
v_lshlrev_b32 v38, 16, v61
v_lshlrev_b32 v52, 16, v63
v_and_b32 v39, 0xffff0000, v61
v_and_b32 v53, 0xffff0000, v63
v_pk_fma_f32 v[32:33], v[32:33], v[4:5], v[36:37] op_sel_hi:[1,0,1]
v_pk_fma_f32 v[46:47], v[46:47], v[4:5], v[50:51] op_sel_hi:[1,0,1]
v_pk_fma_f32 v[34:35], v[34:35], v[4:5], v[38:39] op_sel_hi:[1,0,1]
v_pk_fma_f32 v[48:49], v[48:49], v[4:5], v[52:53] op_sel_hi:[1,0,1]
v_cvt_pk_bf16_f32 v44, v32, v33
v_cvt_pk_bf16_f32 v58, v46, v47
v_cvt_pk_bf16_f32 v45, v34, v35
v_cvt_pk_bf16_f32 v59, v48, v49
ds_write_b64 v11, v[44:45] offset:288
ds_write_b64 v11, v[58:59] offset:304
v_accvgpr_read_b32 v60, a196
v_accvgpr_read_b32 v61, a197
v_accvgpr_read_b32 v62, a220
v_accvgpr_read_b32 v63, a221
s_nop 0
v_permlane16_swap_b32 v60, v62
v_permlane16_swap_b32 v61, v63
v_accvgpr_read_b32 v32, a176
v_accvgpr_read_b32 v46, a180
v_accvgpr_read_b32 v33, a177
v_accvgpr_read_b32 v47, a181
v_accvgpr_read_b32 v34, a178
v_accvgpr_read_b32 v48, a182
v_accvgpr_read_b32 v35, a179
v_accvgpr_read_b32 v49, a183
v_lshlrev_b32 v36, 16, v60
v_lshlrev_b32 v50, 16, v62
v_and_b32 v37, 0xffff0000, v60
v_and_b32 v51, 0xffff0000, v62
v_lshlrev_b32 v38, 16, v61
v_lshlrev_b32 v52, 16, v63
v_and_b32 v39, 0xffff0000, v61
v_and_b32 v53, 0xffff0000, v63
v_pk_fma_f32 v[32:33], v[32:33], v[4:5], v[36:37] op_sel_hi:[1,0,1]
v_pk_fma_f32 v[46:47], v[46:47], v[4:5], v[50:51] op_sel_hi:[1,0,1]
v_pk_fma_f32 v[34:35], v[34:35], v[4:5], v[38:39] op_sel_hi:[1,0,1]
v_pk_fma_f32 v[48:49], v[48:49], v[4:5], v[52:53] op_sel_hi:[1,0,1]
v_cvt_pk_bf16_f32 v44, v32, v33
v_cvt_pk_bf16_f32 v58, v46, v47
v_cvt_pk_bf16_f32 v45, v34, v35
v_cvt_pk_bf16_f32 v59, v48, v49
ds_write_b64 v11, v[44:45] offset:320
ds_write_b64 v11, v[58:59] offset:336
v_accvgpr_read_b32 v60, a198
v_accvgpr_read_b32 v61, a199
v_accvgpr_read_b32 v62, a222
v_accvgpr_read_b32 v63, a223
s_nop 0
v_permlane16_swap_b32 v60, v62
v_permlane16_swap_b32 v61, v63
v_accvgpr_read_b32 v32, a184
v_accvgpr_read_b32 v46, a188
v_accvgpr_read_b32 v33, a185
v_accvgpr_read_b32 v47, a189
v_accvgpr_read_b32 v34, a186
v_accvgpr_read_b32 v48, a190
v_accvgpr_read_b32 v35, a187
v_accvgpr_read_b32 v49, a191
v_lshlrev_b32 v36, 16, v60
v_lshlrev_b32 v50, 16, v62
v_and_b32 v37, 0xffff0000, v60
v_and_b32 v51, 0xffff0000, v62
v_lshlrev_b32 v38, 16, v61
v_lshlrev_b32 v52, 16, v63
v_and_b32 v39, 0xffff0000, v61
v_and_b32 v53, 0xffff0000, v63
v_pk_fma_f32 v[32:33], v[32:33], v[4:5], v[36:37] op_sel_hi:[1,0,1]
v_pk_fma_f32 v[46:47], v[46:47], v[4:5], v[50:51] op_sel_hi:[1,0,1]
v_pk_fma_f32 v[34:35], v[34:35], v[4:5], v[38:39] op_sel_hi:[1,0,1]
v_pk_fma_f32 v[48:49], v[48:49], v[4:5], v[52:53] op_sel_hi:[1,0,1]
v_cvt_pk_bf16_f32 v44, v32, v33
v_cvt_pk_bf16_f32 v58, v46, v47
v_cvt_pk_bf16_f32 v45, v34, v35
v_cvt_pk_bf16_f32 v59, v48, v49
ds_write_b64 v11, v[44:45] offset:352
ds_write_b64 v11, v[58:59] offset:368
s_waitcnt lgkmcnt(0)
s_mul_i32 s85, s45, 98304
s_mul_i32 s86, s36, 12288
s_add_u32 s85, s85, s86
s_add_u32 s85, s85, 49152
ds_read_b128 v[112:115], v12 offset:0
ds_read_b128 v[116:119], v13 offset:0
ds_read_b128 v[120:123], v20 offset:0
ds_read_b128 v[124:127], v12 offset:3200
ds_read_b128 v[128:131], v13 offset:3200
ds_read_b128 v[132:135], v20 offset:3200
ds_read_b128 v[136:139], v12 offset:6400
ds_read_b128 v[140:143], v13 offset:6400
ds_read_b128 v[144:147], v20 offset:6400
ds_read_b128 v[148:151], v12 offset:9600
ds_read_b128 v[152:155], v13 offset:9600
ds_read_b128 v[156:159], v20 offset:9600
s_waitcnt lgkmcnt(11)
buffer_store_dwordx4 v[112:115], v10, s[28:31], s85 offen offset:0
s_waitcnt lgkmcnt(10)
buffer_store_dwordx4 v[116:119], v10, s[28:31], s85 offen offset:1024
s_waitcnt lgkmcnt(9)
buffer_store_dwordx4 v[120:123], v10, s[28:31], s85 offen offset:2048
s_waitcnt lgkmcnt(8)
buffer_store_dwordx4 v[124:127], v10, s[28:31], s85 offen offset:3072
s_waitcnt lgkmcnt(7)
s_add_u32 s85, s85, 4096
buffer_store_dwordx4 v[128:131], v10, s[28:31], s85 offen offset:0
s_waitcnt lgkmcnt(6)
buffer_store_dwordx4 v[132:135], v10, s[28:31], s85 offen offset:1024
s_waitcnt lgkmcnt(5)
buffer_store_dwordx4 v[136:139], v10, s[28:31], s85 offen offset:2048
s_waitcnt lgkmcnt(4)
buffer_store_dwordx4 v[140:143], v10, s[28:31], s85 offen offset:3072
s_waitcnt lgkmcnt(3)
s_add_u32 s85, s85, 4096
buffer_store_dwordx4 v[144:147], v10, s[28:31], s85 offen offset:0
s_waitcnt lgkmcnt(2)
buffer_store_dwordx4 v[148:151], v10, s[28:31], s85 offen offset:1024
s_waitcnt lgkmcnt(1)
buffer_store_dwordx4 v[152:155], v10, s[28:31], s85 offen offset:2048
s_waitcnt lgkmcnt(0)
buffer_store_dwordx4 v[156:159], v10, s[28:31], s85 offen offset:3072
s_waitcnt lgkmcnt(0)
s_waitcnt vmcnt(22)
v_permlane16_swap_b32 v64, v88
v_permlane16_swap_b32 v65, v89
v_accvgpr_read_b32 v32, a0
v_accvgpr_read_b32 v46, a4
v_accvgpr_read_b32 v33, a1
v_accvgpr_read_b32 v47, a5
v_accvgpr_read_b32 v34, a2
v_accvgpr_read_b32 v48, a6
v_accvgpr_read_b32 v35, a3
v_accvgpr_read_b32 v49, a7
v_lshlrev_b32 v36, 16, v64
v_lshlrev_b32 v50, 16, v88
v_and_b32 v37, 0xffff0000, v64
v_and_b32 v51, 0xffff0000, v88
v_lshlrev_b32 v38, 16, v65
v_lshlrev_b32 v52, 16, v89
v_and_b32 v39, 0xffff0000, v65
v_and_b32 v53, 0xffff0000, v89
v_pk_fma_f32 v[32:33], v[32:33], v[2:3], v[36:37] op_sel_hi:[1,0,1]
v_pk_fma_f32 v[46:47], v[46:47], v[2:3], v[50:51] op_sel_hi:[1,0,1]
v_pk_fma_f32 v[34:35], v[34:35], v[2:3], v[38:39] op_sel_hi:[1,0,1]
v_pk_fma_f32 v[48:49], v[48:49], v[2:3], v[52:53] op_sel_hi:[1,0,1]
v_cvt_pk_bf16_f32 v44, v32, v33
v_cvt_pk_bf16_f32 v58, v46, v47
v_cvt_pk_bf16_f32 v45, v34, v35
v_cvt_pk_bf16_f32 v59, v48, v49
ds_write_b64 v11, v[44:45] offset:0
ds_write_b64 v11, v[58:59] offset:16
v_permlane16_swap_b32 v66, v90
v_permlane16_swap_b32 v67, v91
v_accvgpr_read_b32 v32, a8
v_accvgpr_read_b32 v46, a12
v_accvgpr_read_b32 v33, a9
v_accvgpr_read_b32 v47, a13
v_accvgpr_read_b32 v34, a10
v_accvgpr_read_b32 v48, a14
v_accvgpr_read_b32 v35, a11
v_accvgpr_read_b32 v49, a15
v_lshlrev_b32 v36, 16, v66
v_lshlrev_b32 v50, 16, v90
v_and_b32 v37, 0xffff0000, v66
v_and_b32 v51, 0xffff0000, v90
v_lshlrev_b32 v38, 16, v67
v_lshlrev_b32 v52, 16, v91
v_and_b32 v39, 0xffff0000, v67
v_and_b32 v53, 0xffff0000, v91
v_pk_fma_f32 v[32:33], v[32:33], v[2:3], v[36:37] op_sel_hi:[1,0,1]
v_pk_fma_f32 v[46:47], v[46:47], v[2:3], v[50:51] op_sel_hi:[1,0,1]
v_pk_fma_f32 v[34:35], v[34:35], v[2:3], v[38:39] op_sel_hi:[1,0,1]
v_pk_fma_f32 v[48:49], v[48:49], v[2:3], v[52:53] op_sel_hi:[1,0,1]
v_cvt_pk_bf16_f32 v44, v32, v33
v_cvt_pk_bf16_f32 v58, v46, v47
v_cvt_pk_bf16_f32 v45, v34, v35
v_cvt_pk_bf16_f32 v59, v48, v49
ds_write_b64 v11, v[44:45] offset:32
ds_write_b64 v11, v[58:59] offset:48
s_waitcnt vmcnt(20)
v_permlane16_swap_b32 v68, v92
v_permlane16_swap_b32 v69, v93
v_accvgpr_read_b32 v32, a16
v_accvgpr_read_b32 v46, a20
v_accvgpr_read_b32 v33, a17
v_accvgpr_read_b32 v47, a21
v_accvgpr_read_b32 v34, a18
v_accvgpr_read_b32 v48, a22
v_accvgpr_read_b32 v35, a19
v_accvgpr_read_b32 v49, a23
v_lshlrev_b32 v36, 16, v68
v_lshlrev_b32 v50, 16, v92
v_and_b32 v37, 0xffff0000, v68
v_and_b32 v51, 0xffff0000, v92
v_lshlrev_b32 v38, 16, v69
v_lshlrev_b32 v52, 16, v93
v_and_b32 v39, 0xffff0000, v69
v_and_b32 v53, 0xffff0000, v93
v_pk_fma_f32 v[32:33], v[32:33], v[2:3], v[36:37] op_sel_hi:[1,0,1]
v_pk_fma_f32 v[46:47], v[46:47], v[2:3], v[50:51] op_sel_hi:[1,0,1]
v_pk_fma_f32 v[34:35], v[34:35], v[2:3], v[38:39] op_sel_hi:[1,0,1]
v_pk_fma_f32 v[48:49], v[48:49], v[2:3], v[52:53] op_sel_hi:[1,0,1]
v_cvt_pk_bf16_f32 v44, v32, v33
v_cvt_pk_bf16_f32 v58, v46, v47
v_cvt_pk_bf16_f32 v45, v34, v35
v_cvt_pk_bf16_f32 v59, v48, v49
ds_write_b64 v11, v[44:45] offset:64
ds_write_b64 v11, v[58:59] offset:80
v_permlane16_swap_b32 v70, v94
v_permlane16_swap_b32 v71, v95
v_accvgpr_read_b32 v32, a24
v_accvgpr_read_b32 v46, a28
v_accvgpr_read_b32 v33, a25
v_accvgpr_read_b32 v47, a29
v_accvgpr_read_b32 v34, a26
v_accvgpr_read_b32 v48, a30
v_accvgpr_read_b32 v35, a27
v_accvgpr_read_b32 v49, a31
v_lshlrev_b32 v36, 16, v70
v_lshlrev_b32 v50, 16, v94
v_and_b32 v37, 0xffff0000, v70
v_and_b32 v51, 0xffff0000, v94
v_lshlrev_b32 v38, 16, v71
v_lshlrev_b32 v52, 16, v95
v_and_b32 v39, 0xffff0000, v71
v_and_b32 v53, 0xffff0000, v95
v_pk_fma_f32 v[32:33], v[32:33], v[2:3], v[36:37] op_sel_hi:[1,0,1]
v_pk_fma_f32 v[46:47], v[46:47], v[2:3], v[50:51] op_sel_hi:[1,0,1]
v_pk_fma_f32 v[34:35], v[34:35], v[2:3], v[38:39] op_sel_hi:[1,0,1]
v_pk_fma_f32 v[48:49], v[48:49], v[2:3], v[52:53] op_sel_hi:[1,0,1]
v_cvt_pk_bf16_f32 v44, v32, v33
v_cvt_pk_bf16_f32 v58, v46, v47
v_cvt_pk_bf16_f32 v45, v34, v35
v_cvt_pk_bf16_f32 v59, v48, v49
ds_write_b64 v11, v[44:45] offset:96
ds_write_b64 v11, v[58:59] offset:112
s_waitcnt vmcnt(18)
v_permlane16_swap_b32 v72, v96
v_permlane16_swap_b32 v73, v97
v_accvgpr_read_b32 v32, a32
v_accvgpr_read_b32 v46, a36
v_accvgpr_read_b32 v33, a33
v_accvgpr_read_b32 v47, a37
v_accvgpr_read_b32 v34, a34
v_accvgpr_read_b32 v48, a38
v_accvgpr_read_b32 v35, a35
v_accvgpr_read_b32 v49, a39
v_lshlrev_b32 v36, 16, v72
v_lshlrev_b32 v50, 16, v96
v_and_b32 v37, 0xffff0000, v72
v_and_b32 v51, 0xffff0000, v96
v_lshlrev_b32 v38, 16, v73
v_lshlrev_b32 v52, 16, v97
v_and_b32 v39, 0xffff0000, v73
v_and_b32 v53, 0xffff0000, v97
v_pk_fma_f32 v[32:33], v[32:33], v[2:3], v[36:37] op_sel_hi:[1,0,1]
v_pk_fma_f32 v[46:47], v[46:47], v[2:3], v[50:51] op_sel_hi:[1,0,1]
v_pk_fma_f32 v[34:35], v[34:35], v[2:3], v[38:39] op_sel_hi:[1,0,1]
v_pk_fma_f32 v[48:49], v[48:49], v[2:3], v[52:53] op_sel_hi:[1,0,1]
v_cvt_pk_bf16_f32 v44, v32, v33
v_cvt_pk_bf16_f32 v58, v46, v47
v_cvt_pk_bf16_f32 v45, v34, v35
v_cvt_pk_bf16_f32 v59, v48, v49
ds_write_b64 v11, v[44:45] offset:128
ds_write_b64 v11, v[58:59] offset:144
v_permlane16_swap_b32 v74, v98
v_permlane16_swap_b32 v75, v99
v_accvgpr_read_b32 v32, a40
v_accvgpr_read_b32 v46, a44
v_accvgpr_read_b32 v33, a41
v_accvgpr_read_b32 v47, a45
v_accvgpr_read_b32 v34, a42
v_accvgpr_read_b32 v48, a46
v_accvgpr_read_b32 v35, a43
v_accvgpr_read_b32 v49, a47
v_lshlrev_b32 v36, 16, v74
v_lshlrev_b32 v50, 16, v98
v_and_b32 v37, 0xffff0000, v74
v_and_b32 v51, 0xffff0000, v98
v_lshlrev_b32 v38, 16, v75
v_lshlrev_b32 v52, 16, v99
v_and_b32 v39, 0xffff0000, v75
v_and_b32 v53, 0xffff0000, v99
v_pk_fma_f32 v[32:33], v[32:33], v[2:3], v[36:37] op_sel_hi:[1,0,1]
v_pk_fma_f32 v[46:47], v[46:47], v[2:3], v[50:51] op_sel_hi:[1,0,1]
v_pk_fma_f32 v[34:35], v[34:35], v[2:3], v[38:39] op_sel_hi:[1,0,1]
v_pk_fma_f32 v[48:49], v[48:49], v[2:3], v[52:53] op_sel_hi:[1,0,1]
v_cvt_pk_bf16_f32 v44, v32, v33
v_cvt_pk_bf16_f32 v58, v46, v47
v_cvt_pk_bf16_f32 v45, v34, v35
v_cvt_pk_bf16_f32 v59, v48, v49
ds_write_b64 v11, v[44:45] offset:160
ds_write_b64 v11, v[58:59] offset:176
s_waitcnt vmcnt(16)
v_permlane16_swap_b32 v76, v100
v_permlane16_swap_b32 v77, v101
v_accvgpr_read_b32 v32, a48
v_accvgpr_read_b32 v46, a52
v_accvgpr_read_b32 v33, a49
v_accvgpr_read_b32 v47, a53
v_accvgpr_read_b32 v34, a50
v_accvgpr_read_b32 v48, a54
v_accvgpr_read_b32 v35, a51
v_accvgpr_read_b32 v49, a55
v_lshlrev_b32 v36, 16, v76
v_lshlrev_b32 v50, 16, v100
v_and_b32 v37, 0xffff0000, v76
v_and_b32 v51, 0xffff0000, v100
v_lshlrev_b32 v38, 16, v77
v_lshlrev_b32 v52, 16, v101
v_and_b32 v39, 0xffff0000, v77
v_and_b32 v53, 0xffff0000, v101
v_pk_fma_f32 v[32:33], v[32:33], v[2:3], v[36:37] op_sel_hi:[1,0,1]
v_pk_fma_f32 v[46:47], v[46:47], v[2:3], v[50:51] op_sel_hi:[1,0,1]
v_pk_fma_f32 v[34:35], v[34:35], v[2:3], v[38:39] op_sel_hi:[1,0,1]
v_pk_fma_f32 v[48:49], v[48:49], v[2:3], v[52:53] op_sel_hi:[1,0,1]
v_cvt_pk_bf16_f32 v44, v32, v33
v_cvt_pk_bf16_f32 v58, v46, v47
v_cvt_pk_bf16_f32 v45, v34, v35
v_cvt_pk_bf16_f32 v59, v48, v49
ds_write_b64 v11, v[44:45] offset:192
ds_write_b64 v11, v[58:59] offset:208
v_permlane16_swap_b32 v78, v102
v_permlane16_swap_b32 v79, v103
v_accvgpr_read_b32 v32, a56
v_accvgpr_read_b32 v46, a60
v_accvgpr_read_b32 v33, a57
v_accvgpr_read_b32 v47, a61
v_accvgpr_read_b32 v34, a58
v_accvgpr_read_b32 v48, a62
v_accvgpr_read_b32 v35, a59
v_accvgpr_read_b32 v49, a63
v_lshlrev_b32 v36, 16, v78
v_lshlrev_b32 v50, 16, v102
v_and_b32 v37, 0xffff0000, v78
v_and_b32 v51, 0xffff0000, v102
v_lshlrev_b32 v38, 16, v79
v_lshlrev_b32 v52, 16, v103
v_and_b32 v39, 0xffff0000, v79
v_and_b32 v53, 0xffff0000, v103
v_pk_fma_f32 v[32:33], v[32:33], v[2:3], v[36:37] op_sel_hi:[1,0,1]
v_pk_fma_f32 v[46:47], v[46:47], v[2:3], v[50:51] op_sel_hi:[1,0,1]
v_pk_fma_f32 v[34:35], v[34:35], v[2:3], v[38:39] op_sel_hi:[1,0,1]
v_pk_fma_f32 v[48:49], v[48:49], v[2:3], v[52:53] op_sel_hi:[1,0,1]
v_cvt_pk_bf16_f32 v44, v32, v33
v_cvt_pk_bf16_f32 v58, v46, v47
v_cvt_pk_bf16_f32 v45, v34, v35
v_cvt_pk_bf16_f32 v59, v48, v49
ds_write_b64 v11, v[44:45] offset:224
ds_write_b64 v11, v[58:59] offset:240
s_waitcnt vmcnt(14)
v_permlane16_swap_b32 v80, v104
v_permlane16_swap_b32 v81, v105
v_accvgpr_read_b32 v32, a64
v_accvgpr_read_b32 v46, a68
v_accvgpr_read_b32 v33, a65
v_accvgpr_read_b32 v47, a69
v_accvgpr_read_b32 v34, a66
v_accvgpr_read_b32 v48, a70
v_accvgpr_read_b32 v35, a67
v_accvgpr_read_b32 v49, a71
v_lshlrev_b32 v36, 16, v80
v_lshlrev_b32 v50, 16, v104
v_and_b32 v37, 0xffff0000, v80
v_and_b32 v51, 0xffff0000, v104
v_lshlrev_b32 v38, 16, v81
v_lshlrev_b32 v52, 16, v105
v_and_b32 v39, 0xffff0000, v81
v_and_b32 v53, 0xffff0000, v105
v_pk_fma_f32 v[32:33], v[32:33], v[2:3], v[36:37] op_sel_hi:[1,0,1]
v_pk_fma_f32 v[46:47], v[46:47], v[2:3], v[50:51] op_sel_hi:[1,0,1]
v_pk_fma_f32 v[34:35], v[34:35], v[2:3], v[38:39] op_sel_hi:[1,0,1]
v_pk_fma_f32 v[48:49], v[48:49], v[2:3], v[52:53] op_sel_hi:[1,0,1]
v_cvt_pk_bf16_f32 v44, v32, v33
v_cvt_pk_bf16_f32 v58, v46, v47
v_cvt_pk_bf16_f32 v45, v34, v35
v_cvt_pk_bf16_f32 v59, v48, v49
ds_write_b64 v11, v[44:45] offset:256
ds_write_b64 v11, v[58:59] offset:272
v_permlane16_swap_b32 v82, v106
v_permlane16_swap_b32 v83, v107
v_accvgpr_read_b32 v32, a72
v_accvgpr_read_b32 v46, a76
v_accvgpr_read_b32 v33, a73
v_accvgpr_read_b32 v47, a77
v_accvgpr_read_b32 v34, a74
v_accvgpr_read_b32 v48, a78
v_accvgpr_read_b32 v35, a75
v_accvgpr_read_b32 v49, a79
v_lshlrev_b32 v36, 16, v82
v_lshlrev_b32 v50, 16, v106
v_and_b32 v37, 0xffff0000, v82
v_and_b32 v51, 0xffff0000, v106
v_lshlrev_b32 v38, 16, v83
v_lshlrev_b32 v52, 16, v107
v_and_b32 v39, 0xffff0000, v83
v_and_b32 v53, 0xffff0000, v107
v_pk_fma_f32 v[32:33], v[32:33], v[2:3], v[36:37] op_sel_hi:[1,0,1]
v_pk_fma_f32 v[46:47], v[46:47], v[2:3], v[50:51] op_sel_hi:[1,0,1]
v_pk_fma_f32 v[34:35], v[34:35], v[2:3], v[38:39] op_sel_hi:[1,0,1]
v_pk_fma_f32 v[48:49], v[48:49], v[2:3], v[52:53] op_sel_hi:[1,0,1]
v_cvt_pk_bf16_f32 v44, v32, v33
v_cvt_pk_bf16_f32 v58, v46, v47
v_cvt_pk_bf16_f32 v45, v34, v35
v_cvt_pk_bf16_f32 v59, v48, v49
ds_write_b64 v11, v[44:45] offset:288
ds_write_b64 v11, v[58:59] offset:304
s_waitcnt vmcnt(12)
v_permlane16_swap_b32 v84, v108
v_permlane16_swap_b32 v85, v109
v_accvgpr_read_b32 v32, a80
v_accvgpr_read_b32 v46, a84
v_accvgpr_read_b32 v33, a81
v_accvgpr_read_b32 v47, a85
v_accvgpr_read_b32 v34, a82
v_accvgpr_read_b32 v48, a86
v_accvgpr_read_b32 v35, a83
v_accvgpr_read_b32 v49, a87
v_lshlrev_b32 v36, 16, v84
v_lshlrev_b32 v50, 16, v108
v_and_b32 v37, 0xffff0000, v84
v_and_b32 v51, 0xffff0000, v108
v_lshlrev_b32 v38, 16, v85
v_lshlrev_b32 v52, 16, v109
v_and_b32 v39, 0xffff0000, v85
v_and_b32 v53, 0xffff0000, v109
v_pk_fma_f32 v[32:33], v[32:33], v[2:3], v[36:37] op_sel_hi:[1,0,1]
v_pk_fma_f32 v[46:47], v[46:47], v[2:3], v[50:51] op_sel_hi:[1,0,1]
v_pk_fma_f32 v[34:35], v[34:35], v[2:3], v[38:39] op_sel_hi:[1,0,1]
v_pk_fma_f32 v[48:49], v[48:49], v[2:3], v[52:53] op_sel_hi:[1,0,1]
v_cvt_pk_bf16_f32 v44, v32, v33
v_cvt_pk_bf16_f32 v58, v46, v47
v_cvt_pk_bf16_f32 v45, v34, v35
v_cvt_pk_bf16_f32 v59, v48, v49
ds_write_b64 v11, v[44:45] offset:320
ds_write_b64 v11, v[58:59] offset:336
v_permlane16_swap_b32 v86, v110
v_permlane16_swap_b32 v87, v111
v_accvgpr_read_b32 v32, a88
v_accvgpr_read_b32 v46, a92
v_accvgpr_read_b32 v33, a89
v_accvgpr_read_b32 v47, a93
v_accvgpr_read_b32 v34, a90
v_accvgpr_read_b32 v48, a94
v_accvgpr_read_b32 v35, a91
v_accvgpr_read_b32 v49, a95
v_lshlrev_b32 v36, 16, v86
v_lshlrev_b32 v50, 16, v110
v_and_b32 v37, 0xffff0000, v86
v_and_b32 v51, 0xffff0000, v110
v_lshlrev_b32 v38, 16, v87
v_lshlrev_b32 v52, 16, v111
v_and_b32 v39, 0xffff0000, v87
v_and_b32 v53, 0xffff0000, v111
v_pk_fma_f32 v[32:33], v[32:33], v[2:3], v[36:37] op_sel_hi:[1,0,1]
v_pk_fma_f32 v[46:47], v[46:47], v[2:3], v[50:51] op_sel_hi:[1,0,1]
v_pk_fma_f32 v[34:35], v[34:35], v[2:3], v[38:39] op_sel_hi:[1,0,1]
v_pk_fma_f32 v[48:49], v[48:49], v[2:3], v[52:53] op_sel_hi:[1,0,1]
v_cvt_pk_bf16_f32 v44, v32, v33
v_cvt_pk_bf16_f32 v58, v46, v47
v_cvt_pk_bf16_f32 v45, v34, v35
v_cvt_pk_bf16_f32 v59, v48, v49
ds_write_b64 v11, v[44:45] offset:352
ds_write_b64 v11, v[58:59] offset:368
s_waitcnt lgkmcnt(0)
s_mul_i32 s85, s45, 98304
s_mul_i32 s86, s36, 12288
s_add_u32 s85, s85, s86
ds_read_b128 v[64:67], v12 offset:0
ds_read_b128 v[68:71], v13 offset:0
ds_read_b128 v[72:75], v20 offset:0
ds_read_b128 v[76:79], v12 offset:3200
ds_read_b128 v[80:83], v13 offset:3200
ds_read_b128 v[84:87], v20 offset:3200
ds_read_b128 v[88:91], v12 offset:6400
ds_read_b128 v[92:95], v13 offset:6400
ds_read_b128 v[96:99], v20 offset:6400
ds_read_b128 v[100:103], v12 offset:9600
ds_read_b128 v[104:107], v13 offset:9600
ds_read_b128 v[108:111], v20 offset:9600
s_waitcnt lgkmcnt(11)
buffer_store_dwordx4 v[64:67], v10, s[28:31], s85 offen offset:0
s_waitcnt lgkmcnt(10)
buffer_store_dwordx4 v[68:71], v10, s[28:31], s85 offen offset:1024
s_waitcnt lgkmcnt(9)
buffer_store_dwordx4 v[72:75], v10, s[28:31], s85 offen offset:2048
s_waitcnt lgkmcnt(8)
buffer_store_dwordx4 v[76:79], v10, s[28:31], s85 offen offset:3072
s_waitcnt lgkmcnt(7)
s_add_u32 s85, s85, 4096
buffer_store_dwordx4 v[80:83], v10, s[28:31], s85 offen offset:0
s_waitcnt lgkmcnt(6)
buffer_store_dwordx4 v[84:87], v10, s[28:31], s85 offen offset:1024
s_waitcnt lgkmcnt(5)
buffer_store_dwordx4 v[88:91], v10, s[28:31], s85 offen offset:2048
s_waitcnt lgkmcnt(4)
buffer_store_dwordx4 v[92:95], v10, s[28:31], s85 offen offset:3072
s_waitcnt lgkmcnt(3)
s_add_u32 s85, s85, 4096
buffer_store_dwordx4 v[96:99], v10, s[28:31], s85 offen offset:0
s_waitcnt lgkmcnt(2)
buffer_store_dwordx4 v[100:103], v10, s[28:31], s85 offen offset:1024
s_waitcnt lgkmcnt(1)
buffer_store_dwordx4 v[104:107], v10, s[28:31], s85 offen offset:2048
s_waitcnt lgkmcnt(0)
buffer_store_dwordx4 v[108:111], v10, s[28:31], s85 offen offset:3072
L_fin:
L_end:
s_endpgm
L_b0m:
v_and_b32 v20, 31, v1
v_lshrrev_b32 v30, 5, v1
v_lshlrev_b32 v30, 2, v30
v_sub_u32 v20, v20, v30
s_lshl_b32 s84, s36, 5
v_add_u32 v20, s84, v20
s_nop 7
s_nop 3
v_cmp_gt_i32_e64 s[54:55], 0, v20
v_cmp_gt_i32_e64 s[56:57], 1, v20
v_cmp_gt_i32_e64 s[58:59], 2, v20
v_cndmask_b32_e64 v64, v64, v21, s[54:55]
v_cmp_gt_i32_e64 s[54:55], 3, v20
v_cndmask_b32_e64 v65, v65, v21, s[56:57]
v_cndmask_b32_e64 v66, v66, v21, s[58:59]
v_cmp_gt_i32_e64 s[56:57], 8, v20
v_cmp_gt_i32_e64 s[58:59], 9, v20
v_cndmask_b32_e64 v67, v67, v21, s[54:55]
v_cmp_gt_i32_e64 s[54:55], 10, v20
v_cndmask_b32_e64 v68, v68, v21, s[56:57]
v_cndmask_b32_e64 v69, v69, v21, s[58:59]
v_cmp_gt_i32_e64 s[56:57], 11, v20
v_cmp_gt_i32_e64 s[58:59], 16, v20
v_cndmask_b32_e64 v70, v70, v21, s[54:55]
v_max3_f32 v28, v64, v65, v66
v_cmp_gt_i32_e64 s[54:55], 17, v20
v_cndmask_b32_e64 v71, v71, v21, s[56:57]
v_cndmask_b32_e64 v72, v72, v21, s[58:59]
v_max3_f32 v28, v28, v67, v68
v_cmp_gt_i32_e64 s[56:57], 18, v20
v_cmp_gt_i32_e64 s[58:59], 19, v20
v_cndmask_b32_e64 v73, v73, v21, s[54:55]
v_max3_f32 v28, v28, v69, v70
v_cmp_gt_i32_e64 s[54:55], 24, v20
v_cndmask_b32_e64 v74, v74, v21, s[56:57]
v_cndmask_b32_e64 v75, v75, v21, s[58:59]
v_max3_f32 v28, v28, v71, v72
v_cmp_gt_i32_e64 s[56:57], 25, v20
v_cmp_gt_i32_e64 s[58:59], 26, v20
v_cndmask_b32_e64 v76, v76, v21, s[54:55]
v_max3_f32 v28, v28, v73, v74
v_cmp_gt_i32_e64 s[54:55], 27, v20
v_cndmask_b32_e64 v77, v77, v21, s[56:57]
v_cndmask_b32_e64 v78, v78, v21, s[58:59]
v_max3_f32 v28, v28, v75, v76
v_cndmask_b32_e64 v79, v79, v21, s[54:55]
v_max3_f32 v28, v28, v77, v78
v_max_f32 v28, v28, v79
v_mov_b32 v29, v28
ds_read_b128 v[152:155], v2 offset:12416
ds_read_b128 v[156:159], v3 offset:12416
v_permlane32_swap_b32 v28, v29
v_max_f32 v28, v28, v29
v_mul_f32_e64 v14, -v28, s37
v_fma_f32 v22, v64, s37, v14
v_fma_f32 v23, v65, s37, v14
v_exp_f32 v22, v22
v_fma_f32 v24, v66, s37, v14
v_exp_f32 v23, v23
v_fma_f32 v25, v67, s37, v14
v_exp_f32 v24, v24
v_add_f32 v18, v22, v23
v_fma_f32 v26, v68, s37, v14
v_exp_f32 v25, v25
v_add_f32 v18, v18, v24
v_cvt_pk_bf16_f32 v112, v22, v23
v_fma_f32 v27, v69, s37, v14
v_exp_f32 v26, v26
v_add_f32 v18, v18, v25
v_fma_f32 v22, v70, s37, v14
v_exp_f32 v27, v27
v_add_f32 v18, v18, v26
v_cvt_pk_bf16_f32 v113, v24, v25
v_fma_f32 v23, v71, s37, v14
v_exp_f32 v22, v22
v_add_f32 v18, v18, v27
v_fma_f32 v24, v72, s37, v14
v_exp_f32 v23, v23
v_add_f32 v18, v18, v22
v_fma_f32 v25, v73, s37, v14
v_exp_f32 v24, v24
v_add_f32 v18, v18, v23
v_exp_f32 v25, v25
v_add_f32 v18, v18, v24
v_cvt_pk_bf16_f32 v114, v26, v27
v_cvt_pk_bf16_f32 v115, v22, v23
v_add_f32 v18, v18, v25
v_cvt_pk_bf16_f32 v116, v24, v25
v_fma_f32 v26, v74, s37, v14
v_fma_f32 v27, v75, s37, v14
v_fma_f32 v22, v76, s37, v14
v_fma_f32 v23, v77, s37, v14
v_fma_f32 v24, v78, s37, v14
v_fma_f32 v25, v79, s37, v14
s_waitcnt lgkmcnt(4)
v_mfma_f32_32x32x16_bf16 v[64:79], v[136:139], a[192:195], 0
v_max3_f32 v28, v80, v81, v82
v_max3_f32 v28, v28, v83, v84
v_max3_f32 v28, v28, v85, v86
v_max3_f32 v28, v28, v87, v88
v_max3_f32 v28, v28, v89, v90
v_mfma_f32_16x16x32_bf16 v[176:179], v[224:227], v[204:207], v[176:179]
v_max3_f32 v28, v28, v91, v92
v_max3_f32 v28, v28, v93, v94
v_mfma_f32_16x16x32_bf16 v[180:183], v[228:231], v[204:207], v[180:183]
s_waitcnt vmcnt(8)
ds_read_b64_tr_b16 v[224:225], v232 offset:12288
ds_read_b64_tr_b16 v[226:227], v232 offset:14336
ds_read_b64_tr_b16 v[228:229], v233 offset:12288
ds_read_b64_tr_b16 v[230:231], v233 offset:14336
v_mfma_f32_32x32x16_bf16 v[96:111], v[136:139], a[240:243], 0
v_cvt_pk_bf16_f32 v184, v168, v169
v_cvt_pk_bf16_f32 v185, v170, v171
v_cvt_pk_bf16_f32 v186, v172, v173
v_cvt_pk_bf16_f32 v187, v174, v175
s_add_u32 m0, s53, 8192
v_mfma_f32_32x32x16_bf16 v[64:79], v[140:143], a[196:199], v[64:79]
buffer_load_dwordx4 v214, s[20:23], 0 offen offset:0 lds
ds_read_b128 v[136:139], v4 offset:12416
v_lshlrev_b32 v254, 4, v1
v_exp_f32 v26, v26
v_mfma_f32_32x32x16_bf16 v[96:111], v[140:143], a[244:247], v[96:111]
ds_read_b128 v[140:143], v5 offset:12416
v_exp_f32 v27, v27
v_max_f32 v28, v28, v95
v_add_f32 v18, v18, v26
s_waitcnt lgkmcnt(8)
v_mfma_f32_32x32x16_bf16 v[64:79], v[144:147], a[200:203], v[64:79]
v_exp_f32 v22, v22
v_mov_b32 v29, v28
v_add_f32 v18, v18, v27
v_add_f32 v18, v18, v22
s_waitcnt lgkmcnt(4)
v_mfma_f32_16x16x32_bf16 v[168:171], v[224:227], v[192:195], 0
buffer_load_dwordx4 v222, s[20:23], 0 offen offset:1024 lds
v_permlane32_swap_b32 v28, v29
s_waitcnt lgkmcnt(2)
v_mfma_f32_16x16x32_bf16 v[172:175], v[228:231], v[192:195], 0
ds_read_b64_tr_b16 v[224:225], v234 offset:12288
ds_read_b64_tr_b16 v[226:227], v234 offset:14336
ds_read_b64_tr_b16 v[228:229], v235 offset:12288
ds_read_b64_tr_b16 v[230:231], v235 offset:14336
v_mfma_f32_32x32x16_bf16 v[96:111], v[144:147], a[248:251], v[96:111]
v_cvt_pk_bf16_f32 v188, v176, v177
v_cvt_pk_bf16_f32 v189, v178, v179
v_cvt_pk_bf16_f32 v190, v180, v181
v_cvt_pk_bf16_f32 v191, v182, v183
ds_read_b128 v[144:147], v2 offset:12544
v_mfma_f32_32x32x16_bf16 v[64:79], v[148:151], a[204:207], v[64:79]
buffer_load_dwordx4 v215, s[20:23], 0 offen offset:2048 lds
v_and_b32 v204, v166, v250
v_and_b32 v205, v166, v251
v_and_b32 v206, v167, v250
v_and_b32 v207, v167, v251
v_mfma_f32_32x32x16_bf16 v[96:111], v[148:151], a[252:255], v[96:111]
ds_read_b128 v[148:151], v3 offset:12544
v_exp_f32 v23, v23
v_exp_f32 v24, v24
v_mfma_f32_32x32x16_bf16 v[64:79], v[152:155], a[208:211], v[64:79]
v_exp_f32 v25, v25
v_max_f32 v28, v28, v29
v_add_f32 v18, v18, v23
v_cvt_pk_bf16_f32 v118, v22, v23
s_waitcnt lgkmcnt(4)
v_mfma_f32_16x16x32_bf16 v[176:179], v[224:227], v[192:195], 0
buffer_load_dwordx4 v223, s[20:23], 0 offen offset:3072 lds
s_add_u32 m0, s48, 0
s_waitcnt lgkmcnt(2)
v_mfma_f32_16x16x32_bf16 v[180:183], v[228:231], v[192:195], 0
s_waitcnt vmcnt(8)
ds_read_b64_tr_b16 v[224:225], v232 offset:0
ds_read_b64_tr_b16 v[226:227], v232 offset:2048
ds_read_b64_tr_b16 v[228:229], v233 offset:0
ds_read_b64_tr_b16 v[230:231], v233 offset:2048
v_mfma_f32_32x32x16_bf16 v[96:111], v[152:155], v[32:35], v[96:111]
ds_read_b128 v[152:155], v4 offset:12544
v_mul_f32_e64 v15, -v28, s37
v_add_f32 v18, v18, v24
v_cvt_pk_bf16_f32 v119, v24, v25
v_fma_f32 v22, v80, s37, v15
v_mfma_f32_32x32x16_bf16 v[64:79], v[156:159], a[212:215], v[64:79]
buffer_store_dwordx4 v[184:187], v254, s[32:35], s74 offen offset:0
v_fma_f32 v23, v81, s37, v15
v_add_f32 v18, v18, v25
v_lshlrev_b32 v254, 4, v1
v_fma_f32 v24, v82, s37, v15
v_mfma_f32_32x32x16_bf16 v[96:111], v[156:159], v[36:39], v[96:111]
ds_read_b128 v[156:159], v5 offset:12544
v_exp_f32 v22, v22
v_exp_f32 v23, v23
v_mfma_f32_32x32x16_bf16 v[64:79], v[136:139], a[216:219], v[64:79]
v_cvt_pk_bf16_f32 v117, v26, v27
v_fma_f32 v25, v83, s37, v15
v_exp_f32 v24, v24
v_add_f32 v19, v22, v23
s_waitcnt lgkmcnt(4)
v_mfma_f32_16x16x32_bf16 v[168:171], v[224:227], v[196:199], v[168:171]
buffer_load_dwordx4 v8, s[8:11], s38 offen offset:0 nt lds
v_fma_f32 v26, v84, s37, v15
s_waitcnt lgkmcnt(2)
v_mfma_f32_16x16x32_bf16 v[172:175], v[228:231], v[196:199], v[172:175]
ds_read_b64_tr_b16 v[224:225], v234 offset:0
ds_read_b64_tr_b16 v[226:227], v234 offset:2048
ds_read_b64_tr_b16 v[228:229], v235 offset:0
ds_read_b64_tr_b16 v[230:231], v235 offset:2048
v_mfma_f32_32x32x16_bf16 v[96:111], v[136:139], v[40:43], v[96:111]
v_exp_f32 v25, v25
v_add_f32 v19, v19, v24
v_cvt_pk_bf16_f32 v128, v22, v23
v_fma_f32 v27, v85, s37, v15
v_mfma_f32_32x32x16_bf16 v[64:79], v[140:143], a[220:223], v[64:79]
buffer_load_dwordx4 v9, s[8:11], s38 offen offset:1024 nt lds
v_exp_f32 v26, v26
v_add_f32 v19, v19, v25
v_fma_f32 v22, v86, s37, v15
v_mfma_f32_32x32x16_bf16 v[96:111], v[140:143], v[44:47], v[96:111]
v_exp_f32 v27, v27
v_add_f32 v19, v19, v26
v_cvt_pk_bf16_f32 v129, v24, v25
v_fma_f32 v23, v87, s37, v15
v_mfma_f32_32x32x16_bf16 v[64:79], v[144:147], a[224:227], v[64:79]
v_exp_f32 v22, v22
v_add_f32 v19, v19, v27
v_fma_f32 v24, v88, s37, v15
v_add_f32 v19, v19, v22
s_waitcnt lgkmcnt(2)
v_mfma_f32_16x16x32_bf16 v[176:179], v[224:227], v[196:199], v[176:179]
buffer_load_dwordx4 v10, s[8:11], s38 offen offset:2048 nt lds
s_add_u32 m0, s49, 24576
s_waitcnt lgkmcnt(0)
v_mfma_f32_16x16x32_bf16 v[180:183], v[228:231], v[196:199], v[180:183]
s_waitcnt vmcnt(8)
ds_read_b64_tr_b16 v[224:225], v232 offset:4096
ds_read_b64_tr_b16 v[226:227], v232 offset:6144
ds_read_b64_tr_b16 v[228:229], v233 offset:4096
ds_read_b64_tr_b16 v[230:231], v233 offset:6144
v_mfma_f32_32x32x16_bf16 v[96:111], v[144:147], v[48:51], v[96:111]
v_exp_f32 v23, v23
v_cvt_pk_bf16_f32 v130, v26, v27
v_fma_f32 v25, v89, s37, v15
v_add_f32 v19, v19, v23
v_mfma_f32_32x32x16_bf16 v[64:79], v[148:151], a[228:231], v[64:79]
buffer_load_dwordx4 v11, s[12:15], s39 offen offset:0 nt lds
v_exp_f32 v24, v24
v_fma_f32 v26, v90, s37, v15
v_add_f32 v19, v19, v24
v_mfma_f32_32x32x16_bf16 v[96:111], v[148:151], v[52:55], v[96:111]
v_exp_f32 v25, v25
v_cvt_pk_bf16_f32 v131, v22, v23
v_fma_f32 v27, v91, s37, v15
v_add_f32 v19, v19, v25
v_mfma_f32_32x32x16_bf16 v[64:79], v[152:155], a[232:235], v[64:79]
s_barrier
v_exp_f32 v26, v26
v_fma_f32 v22, v92, s37, v15
v_exp_f32 v27, v27
s_waitcnt lgkmcnt(2)
v_mfma_f32_16x16x32_bf16 v[168:171], v[224:227], v[200:203], v[168:171]
buffer_load_dwordx4 v12, s[12:15], s39 offen offset:1024 nt lds
v_add_f32 v19, v19, v26
s_waitcnt lgkmcnt(0)
v_mfma_f32_16x16x32_bf16 v[172:175], v[228:231], v[200:203], v[172:175]
v_cvt_pk_bf16_f32 v132, v24, v25
v_fma_f32 v23, v93, s37, v15
v_mfma_f32_32x32x16_bf16 v[96:111], v[152:155], v[56:59], v[96:111]
v_exp_f32 v22, v22
v_add_f32 v19, v19, v27
v_fma_f32 v24, v94, s37, v15
ds_read_b64_tr_b16 v[136:137], v6 offset:0
v_mfma_f32_32x32x16_bf16 v[64:79], v[156:159], a[236:239], v[64:79]
buffer_load_dwordx4 v13, s[12:15], s39 offen offset:2048 nt lds
s_add_u32 m0, s53, 12160
v_exp_f32 v23, v23
ds_read_b64_tr_b16 v[138:139], v6 offset:3072
ds_read_b64_tr_b16 v[140:141], v7 offset:0
ds_read_b64_tr_b16 v[142:143], v7 offset:3072
ds_read_b64_tr_b16 v[144:145], v6 offset:128
ds_read_b64_tr_b16 v[146:147], v6 offset:3200
ds_read_b64_tr_b16 v[148:149], v7 offset:128
ds_read_b64_tr_b16 v[150:151], v7 offset:3200
ds_read_b64_tr_b16 v[224:225], v234 offset:4096
ds_read_b64_tr_b16 v[226:227], v234 offset:6144
ds_read_b64_tr_b16 v[228:229], v235 offset:4096
ds_read_b64_tr_b16 v[230:231], v235 offset:6144
v_mfma_f32_32x32x16_bf16 v[96:111], v[156:159], v[60:63], v[96:111]
buffer_store_dwordx4 v[188:191], v254, s[32:35], s74 offen offset:1024
buffer_load_dwordx4 v208, s[20:23], 0 offen offset:128 lds
buffer_load_dwordx4 v216, s[20:23], 0 offen offset:1152 lds
buffer_load_dwordx4 v209, s[20:23], 0 offen offset:2176 lds
buffer_load_dwordx4 v217, s[20:23], 0 offen offset:3200 lds
s_sub_u32 m0, s53, 128
v_add_f32 v19, v19, v22
buffer_load_dwordx4 v210, s[20:23], 0 offen offset:128 lds
buffer_load_dwordx4 v218, s[20:23], 0 offen offset:1152 lds
buffer_load_dwordx4 v211, s[20:23], 0 offen offset:2176 lds
buffer_load_dwordx4 v219, s[20:23], 0 offen offset:3200 lds
v_fma_f32 v25, v95, s37, v15
v_exp_f32 v24, v24
v_add_f32 v19, v19, v23
v_exp_f32 v25, v25
v_add_f32 v19, v19, v24
v_add_f32 v19, v19, v25
v_add_u32 v20, -32, v20
v_mov_b32 v16, v18
v_cvt_pk_bf16_f32 v133, v26, v27
v_cvt_pk_bf16_f32 v134, v22, v23
v_cvt_pk_bf16_f32 v135, v24, v25
s_add_u32 s38, s38, s78
s_add_u32 s39, s39, s98
v_mov_b32 v17, v19
s_cmp_eq_u32 s43, -2
s_cbranch_scc0 L_nf_b0m
s_mov_b32 s43, -1
s_cmp_eq_u32 s36, 0
s_cbranch_scc0 L_sent_b0m
s_lshr_b32 s84, s92, 2
s_lshl_b32 s84, s84, 2
s_add_u32 s84, s84, 128
s_and_b32 s85, s92, 3
s_lshl_b32 s85, s85, 3
s_lshl_b32 s85, 1, s85
v_mov_b32 v30, s84
v_mov_b32 v31, s85
v_cmp_eq_u32 vcc, 0, v1
s_and_saveexec_b64 s[54:55], vcc
global_atomic_or v30, v31, s[80:81] sc1
s_mov_b64 exec, s[54:55]
L_sent_b0m:
L_nf_b0m:
s_branch L_d1
L_t3_N:
s_waitcnt lgkmcnt(4)
v_mfma_f32_32x32x16_bf16 a[0:15], v[136:139], v[112:115], a[0:15]
ds_read_b64_tr_b16 v[152:153], v6 offset:24832
ds_read_b64_tr_b16 v[154:155], v6 offset:27904
ds_read_b64_tr_b16 v[156:157], v7 offset:24832
ds_read_b64_tr_b16 v[158:159], v7 offset:27904
s_add_u32 m0, s48, 36864
v_mfma_f32_32x32x16_bf16 a[96:111], v[136:139], v[128:131], a[96:111]
ds_read_b64_tr_b16 v[136:137], v6 offset:30720
ds_read_b64_tr_b16 v[138:139], v6 offset:33792
buffer_load_dwordx4 v8, s[8:11], s38 offen offset:0 lds
v_mfma_f32_32x32x16_bf16 a[16:31], v[140:143], v[112:115], a[16:31]
v_fma_f32 v22, v64, s37, v14
v_fma_f32 v23, v65, s37, v14
v_exp_f32 v22, v22
v_fma_f32 v24, v66, s37, v14
v_mfma_f32_32x32x16_bf16 a[112:127], v[140:143], v[128:131], a[112:127]
ds_read_b64_tr_b16 v[140:141], v7 offset:30720
ds_read_b64_tr_b16 v[142:143], v7 offset:33792
v_exp_f32 v23, v23
v_fma_f32 v25, v67, s37, v14
s_waitcnt lgkmcnt(8)
v_mfma_f32_32x32x16_bf16 a[32:47], v[144:147], v[112:115], a[32:47]
buffer_load_dwordx4 v9, s[8:11], s38 offen offset:1024 lds
v_exp_f32 v24, v24
v_add_f32 v18, v22, v23
v_fma_f32 v26, v68, s37, v14
v_mfma_f32_32x32x16_bf16 a[128:143], v[144:147], v[128:131], a[128:143]
ds_read_b64_tr_b16 v[144:145], v6 offset:30848
ds_read_b64_tr_b16 v[146:147], v6 offset:33920
v_exp_f32 v25, v25
v_add_f32 v18, v18, v24
v_mfma_f32_32x32x16_bf16 a[48:63], v[148:151], v[112:115], a[48:63]
v_cvt_pk_bf16_f32 v120, v22, v23
v_fma_f32 v27, v69, s37, v14
v_exp_f32 v26, v26
v_add_f32 v18, v18, v25
v_mfma_f32_32x32x16_bf16 a[144:159], v[148:151], v[128:131], a[144:159]
buffer_load_dwordx4 v10, s[8:11], s38 offen offset:2048 lds
ds_read_b64_tr_b16 v[148:149], v7 offset:30848
ds_read_b64_tr_b16 v[150:151], v7 offset:33920
v_fma_f32 v22, v70, s37, v14
v_add_f32 v18, v18, v26
s_waitcnt lgkmcnt(8)
v_mfma_f32_32x32x16_bf16 a[64:79], v[152:155], v[112:115], a[64:79]
v_exp_f32 v27, v27
v_cvt_pk_bf16_f32 v121, v24, v25
v_fma_f32 v23, v71, s37, v14
v_add_f32 v18, v18, v27
v_mfma_f32_32x32x16_bf16 a[160:175], v[152:155], v[128:131], a[160:175]
ds_read_b64_tr_b16 v[152:153], v6 offset:30976
ds_read_b64_tr_b16 v[154:155], v6 offset:34048
v_exp_f32 v22, v22
v_fma_f32 v24, v72, s37, v14
v_mfma_f32_32x32x16_bf16 a[80:95], v[156:159], v[112:115], a[80:95]
v_exp_f32 v23, v23
v_add_f32 v18, v18, v22
v_cvt_pk_bf16_f32 v122, v26, v27
v_fma_f32 v25, v73, s37, v14
v_mfma_f32_32x32x16_bf16 a[176:191], v[156:159], v[128:131], a[176:191]
ds_read_b64_tr_b16 v[156:157], v7 offset:30976
ds_read_b64_tr_b16 v[158:159], v7 offset:34048
v_exp_f32 v24, v24
v_add_f32 v18, v18, v23
s_waitcnt lgkmcnt(8)
v_mfma_f32_32x32x16_bf16 a[0:15], v[136:139], v[116:119], a[0:15]
v_fma_f32 v26, v74, s37, v14
v_exp_f32 v25, v25
v_add_f32 v18, v18, v24
v_cvt_pk_bf16_f32 v123, v22, v23
v_mfma_f32_32x32x16_bf16 a[96:111], v[136:139], v[132:135], a[96:111]
v_fma_f32 v27, v75, s37, v14
v_exp_f32 v26, v26
v_add_f32 v18, v18, v25
v_fma_f32 v22, v76, s37, v14
v_mfma_f32_32x32x16_bf16 a[16:31], v[140:143], v[116:119], a[16:31]
v_exp_f32 v27, v27
v_add_f32 v18, v18, v26
v_cvt_pk_bf16_f32 v124, v24, v25
v_fma_f32 v23, v77, s37, v14
v_mfma_f32_32x32x16_bf16 a[112:127], v[140:143], v[132:135], a[112:127]
v_exp_f32 v22, v22
v_add_f32 v18, v18, v27
v_fma_f32 v24, v78, s37, v14
v_fma_f32 v25, v79, s37, v14
s_waitcnt lgkmcnt(4)
v_mfma_f32_32x32x16_bf16 a[32:47], v[144:147], v[116:119], a[32:47]
v_exp_f32 v23, v23
v_add_f32 v18, v18, v22
v_exp_f32 v24, v24
v_mfma_f32_32x32x16_bf16 a[128:143], v[144:147], v[132:135], a[128:143]
v_exp_f32 v25, v25
v_add_f32 v18, v18, v23
v_cvt_pk_bf16_f32 v126, v22, v23
v_add_f32 v18, v18, v24
v_mfma_f32_32x32x16_bf16 a[48:63], v[148:151], v[116:119], a[48:63]
v_cvt_pk_bf16_f32 v127, v24, v25
v_fma_f32 v22, v96, s37, v15
v_fma_f32 v23, v97, s37, v15
v_add_f32 v18, v18, v25
v_fma_f32 v24, v98, s37, v15
v_mfma_f32_32x32x16_bf16 a[144:159], v[148:151], v[132:135], a[144:159]
v_exp_f32 v22, v22
v_exp_f32 v23, v23
v_cvt_pk_bf16_f32 v125, v26, v27
v_fma_f32 v25, v99, s37, v15
v_exp_f32 v24, v24
v_add_f32 v19, v22, v23
v_fma_f32 v26, v100, s37, v15
v_exp_f32 v25, v25
s_waitcnt lgkmcnt(0)
v_mfma_f32_32x32x16_bf16 a[64:79], v[152:155], v[116:119], a[64:79]
v_add_f32 v19, v19, v24
v_cvt_pk_bf16_f32 v80, v22, v23
v_fma_f32 v27, v101, s37, v15
v_exp_f32 v26, v26
v_add_f32 v19, v19, v25
v_fma_f32 v22, v102, s37, v15
v_exp_f32 v27, v27
v_add_f32 v19, v19, v26
v_cvt_pk_bf16_f32 v81, v24, v25
v_fma_f32 v23, v103, s37, v15
v_exp_f32 v22, v22
v_add_f32 v19, v19, v27
v_fma_f32 v24, v104, s37, v15
v_exp_f32 v23, v23
v_mfma_f32_32x32x16_bf16 a[160:175], v[152:155], v[132:135], a[160:175]
v_add_f32 v19, v19, v22
v_cvt_pk_bf16_f32 v82, v26, v27
v_fma_f32 v25, v105, s37, v15
v_exp_f32 v24, v24
s_add_u32 m0, s49, 12288
v_add_f32 v19, v19, v23
v_fma_f32 v26, v106, s37, v15
v_exp_f32 v25, v25
buffer_load_dwordx4 v11, s[12:15], s39 offen offset:0 lds
v_add_f32 v19, v19, v24
v_cvt_pk_bf16_f32 v83, v22, v23
v_fma_f32 v27, v107, s37, v15
v_exp_f32 v26, v26
v_add_f32 v19, v19, v25
v_fma_f32 v22, v108, s37, v15
v_exp_f32 v27, v27
v_add_f32 v19, v19, v26
v_cvt_pk_bf16_f32 v84, v24, v25
v_fma_f32 v23, v109, s37, v15
v_exp_f32 v22, v22
v_mfma_f32_32x32x16_bf16 a[80:95], v[156:159], v[116:119], a[80:95]
v_add_f32 v19, v19, v27
v_fma_f32 v24, v110, s37, v15
v_exp_f32 v23, v23
v_add_f32 v19, v19, v22
v_fma_f32 v25, v111, s37, v15
v_exp_f32 v24, v24
v_add_f32 v19, v19, v23
v_exp_f32 v25, v25
v_add_f32 v19, v19, v24
ds_read_b64_tr_b16 v[136:137], v6 offset:36864
ds_read_b64_tr_b16 v[138:139], v6 offset:39936
ds_read_b64_tr_b16 v[140:141], v7 offset:36864
ds_read_b64_tr_b16 v[142:143], v7 offset:39936
ds_read_b64_tr_b16 v[144:145], v6 offset:36992
ds_read_b64_tr_b16 v[146:147], v6 offset:40064
ds_read_b64_tr_b16 v[148:149], v7 offset:36992
ds_read_b64_tr_b16 v[150:151], v7 offset:40064
v_mfma_f32_32x32x16_bf16 a[176:191], v[156:159], v[132:135], a[176:191]
buffer_load_dwordx4 v12, s[12:15], s39 offen offset:1024 lds
buffer_load_dwordx4 v13, s[12:15], s39 offen offset:2048 lds
v_cvt_pk_bf16_f32 v85, v26, v27
v_cvt_pk_bf16_f32 v86, v22, v23
v_add_f32 v19, v19, v25
v_cvt_pk_bf16_f32 v87, v24, v25
v_cmp_nge_f32 vcc, s52, v18
s_cbranch_vccnz Lst_t3N_X
Lct_t3N_X:
v_add_f32 v16, v16, v18
s_add_u32 s38, s38, s78
s_add_u32 s99, s99, 4
s_cmp_eq_u32 s99, s40
s_cselect_b32 s38, s88, s38
s_cselect_b32 s78, -12288, s78
s_cmp_eq_u32 s99, 28
s_cselect_b32 s38, s41, s38
s_cselect_b32 s78, 12288, s78
s_add_u32 s39, s39, s98
v_cmp_nge_f32 vcc, s52, v19
s_cbranch_vccnz Lst_t3N_Y
Lct_t3N_Y:
v_add_f32 v17, v17, v19
s_branch L_switch
L_t3_K:
s_waitcnt lgkmcnt(8)
v_mfma_f32_32x32x16_bf16 a[0:15], v[136:139], v[112:115], a[0:15]
ds_read_b64_tr_b16 v[152:153], v6 offset:24832
ds_read_b64_tr_b16 v[154:155], v6 offset:27904
ds_read_b64_tr_b16 v[156:157], v7 offset:24832
ds_read_b64_tr_b16 v[158:159], v7 offset:27904
s_waitcnt lgkmcnt(11)
v_mfma_f32_16x16x32_bf16 v[172:175], v[224:227], v[192:195], v[172:175]
s_waitcnt lgkmcnt(10)
v_mfma_f32_16x16x32_bf16 v[172:175], v[228:231], v[196:199], v[172:175]
s_waitcnt vmcnt(13)
ds_read_b128 v[224:227], v232 offset:0
ds_read_b128 v[228:231], v233 offset:0
v_mfma_f32_32x32x16_bf16 a[96:111], v[136:139], v[128:131], a[96:111]
s_add_u32 m0, s53, 9984
ds_read_b64_tr_b16 v[136:137], v6 offset:30720
buffer_load_dwordx4 v215, s[16:19], 0 offen offset:256 lds
ds_read_b64_tr_b16 v[138:139], v6 offset:33792
v_fma_f32 v22, v64, s37, v14
v_mfma_f32_32x32x16_bf16 a[16:31], v[140:143], v[112:115], a[16:31]
v_fma_f32 v23, v65, s37, v14
v_exp_f32 v22, v22
v_fma_f32 v24, v66, s37, v14
v_fma_f32 v25, v67, s37, v14
v_mfma_f32_32x32x16_bf16 a[112:127], v[140:143], v[128:131], a[112:127]
ds_read_b64_tr_b16 v[140:141], v7 offset:30720
ds_read_b64_tr_b16 v[142:143], v7 offset:33792
v_exp_f32 v23, v23
v_fma_f32 v26, v68, s37, v14
s_waitcnt lgkmcnt(12)
v_mfma_f32_32x32x16_bf16 a[32:47], v[144:147], v[112:115], a[32:47]
buffer_load_dwordx4 v223, s[16:19], 0 offen offset:1280 lds
s_add_u32 m0, s48, 36864
v_exp_f32 v24, v24
v_add_f32 v18, v22, v23
s_waitcnt lgkmcnt(5)
v_mfma_f32_16x16x32_bf16 v[176:179], v[224:227], v[192:195], v[176:179]
v_exp_f32 v25, v25
s_waitcnt lgkmcnt(4)
v_mfma_f32_16x16x32_bf16 v[176:179], v[228:231], v[196:199], v[176:179]
s_waitcnt vmcnt(8)
ds_read_b128 v[224:227], v232 offset:2048
ds_read_b128 v[228:231], v233 offset:2048
v_mfma_f32_32x32x16_bf16 a[128:143], v[144:147], v[128:131], a[128:143]
ds_read_b64_tr_b16 v[144:145], v6 offset:30848
ds_read_b64_tr_b16 v[146:147], v6 offset:33920
v_add_f32 v18, v18, v24
v_cvt_pk_bf16_f32 v120, v22, v23
v_fma_f32 v27, v69, s37, v14
v_mfma_f32_32x32x16_bf16 a[48:63], v[148:151], v[112:115], a[48:63]
buffer_load_dwordx4 v8, s[8:11], s38 offen offset:0 lds
v_exp_f32 v26, v26
v_add_f32 v18, v18, v25
v_fma_f32 v22, v70, s37, v14
v_mfma_f32_32x32x16_bf16 a[144:159], v[148:151], v[128:131], a[144:159]
ds_read_b64_tr_b16 v[148:149], v7 offset:30848
ds_read_b64_tr_b16 v[150:151], v7 offset:33920
v_exp_f32 v27, v27
v_add_f32 v18, v18, v26
v_mfma_f32_32x32x16_bf16 a[64:79], v[152:155], v[112:115], a[64:79]
v_cvt_pk_bf16_f32 v121, v24, v25
v_fma_f32 v23, v71, s37, v14
v_exp_f32 v22, v22
v_add_f32 v18, v18, v27
s_waitcnt lgkmcnt(5)
v_mfma_f32_16x16x32_bf16 v[180:183], v[224:227], v[192:195], v[180:183]
buffer_load_dwordx4 v9, s[8:11], s38 offen offset:1024 lds
v_fma_f32 v24, v72, s37, v14
s_waitcnt lgkmcnt(4)
v_mfma_f32_16x16x32_bf16 v[180:183], v[228:231], v[196:199], v[180:183]
s_waitcnt vmcnt(8)
ds_read_b128 v[224:227], v232 offset:4096
ds_read_b128 v[228:231], v233 offset:4096
v_mfma_f32_32x32x16_bf16 a[160:175], v[152:155], v[128:131], a[160:175]
ds_read_b64_tr_b16 v[152:153], v6 offset:30976
ds_read_b64_tr_b16 v[154:155], v6 offset:34048
v_exp_f32 v23, v23
v_add_f32 v18, v18, v22
v_mfma_f32_32x32x16_bf16 a[80:95], v[156:159], v[112:115], a[80:95]
buffer_load_dwordx4 v10, s[8:11], s38 offen offset:2048 lds
s_add_u32 m0, s53, 12032
v_cvt_pk_bf16_f32 v122, v26, v27
v_fma_f32 v25, v73, s37, v14
v_add_f32 v18, v18, v23
v_mfma_f32_32x32x16_bf16 a[176:191], v[156:159], v[128:131], a[176:191]
ds_read_b64_tr_b16 v[156:157], v7 offset:30976
ds_read_b64_tr_b16 v[158:159], v7 offset:34048
v_exp_f32 v24, v24
v_fma_f32 v26, v74, s37, v14
v_mfma_f32_32x32x16_bf16 a[0:15], v[136:139], v[116:119], a[0:15]
v_exp_f32 v25, v25
v_add_f32 v18, v18, v24
v_cvt_pk_bf16_f32 v123, v22, v23
v_fma_f32 v27, v75, s37, v14
s_waitcnt lgkmcnt(5)
v_mfma_f32_16x16x32_bf16 v[168:171], v[224:227], v[200:203], v[168:171]
buffer_load_dwordx4 v236, s[4:7], s79 offen offset:256 lds
v_add_f32 v18, v18, v25
s_waitcnt lgkmcnt(4)
v_mfma_f32_16x16x32_bf16 v[168:171], v[228:231], v[204:207], v[168:171]
s_waitcnt vmcnt(8)
ds_read_b128 v[224:227], v232 offset:6144
ds_read_b128 v[228:231], v233 offset:6144
v_mfma_f32_32x32x16_bf16 a[96:111], v[136:139], v[132:135], a[96:111]
v_exp_f32 v26, v26
v_fma_f32 v22, v76, s37, v14
v_exp_f32 v27, v27
v_mfma_f32_32x32x16_bf16 a[16:31], v[140:143], v[116:119], a[16:31]
buffer_load_dwordx4 v237, s[4:7], s79 offen offset:1280 lds
v_add_f32 v18, v18, v26
v_cvt_pk_bf16_f32 v124, v24, v25
v_fma_f32 v23, v77, s37, v14
v_add_f32 v18, v18, v27
v_mfma_f32_32x32x16_bf16 a[112:127], v[140:143], v[132:135], a[112:127]
v_exp_f32 v22, v22
v_fma_f32 v24, v78, s37, v14
v_exp_f32 v23, v23
v_mfma_f32_32x32x16_bf16 a[32:47], v[144:147], v[116:119], a[32:47]
v_fma_f32 v25, v79, s37, v14
v_add_f32 v18, v18, v22
v_exp_f32 v24, v24
v_add_f32 v18, v18, v23
s_waitcnt lgkmcnt(1)
v_mfma_f32_16x16x32_bf16 v[172:175], v[224:227], v[200:203], v[172:175]
v_exp_f32 v25, v25
s_waitcnt lgkmcnt(0)
v_mfma_f32_16x16x32_bf16 v[172:175], v[228:231], v[204:207], v[172:175]
s_waitcnt vmcnt(7)
ds_read_b128 v[224:227], v232 offset:8192
ds_read_b128 v[228:231], v233 offset:8192
v_mfma_f32_32x32x16_bf16 a[128:143], v[144:147], v[132:135], a[128:143]
v_cvt_pk_bf16_f32 v126, v22, v23
v_add_f32 v18, v18, v24
v_cvt_pk_bf16_f32 v127, v24, v25
v_fma_f32 v22, v96, s37, v15
v_fma_f32 v23, v97, s37, v15
v_mfma_f32_32x32x16_bf16 a[48:63], v[148:151], v[116:119], a[48:63]
v_add_f32 v18, v18, v25
v_exp_f32 v22, v22
v_fma_f32 v24, v98, s37, v15
v_cvt_pk_bf16_f32 v125, v26, v27
v_mfma_f32_32x32x16_bf16 a[144:159], v[148:151], v[132:135], a[144:159]
v_exp_f32 v23, v23
v_fma_f32 v25, v99, s37, v15
v_exp_f32 v24, v24
v_mfma_f32_32x32x16_bf16 a[64:79], v[152:155], v[116:119], a[64:79]
ds_read_b128 v[192:195], v232 offset:14336
ds_read_b128 v[196:199], v233 offset:14336
v_add_f32 v19, v22, v23
v_fma_f32 v26, v100, s37, v15
v_add_f32 v19, v19, v24
s_waitcnt lgkmcnt(3)
v_mfma_f32_16x16x32_bf16 v[176:179], v[224:227], v[200:203], v[176:179]
v_exp_f32 v25, v25
s_waitcnt lgkmcnt(2)
v_mfma_f32_16x16x32_bf16 v[176:179], v[228:231], v[204:207], v[176:179]
v_cvt_pk_bf16_f32 v80, v22, v23
v_fma_f32 v27, v101, s37, v15
v_exp_f32 v26, v26
s_add_u32 m0, s49, 12288
v_add_f32 v19, v19, v25
v_fma_f32 v22, v102, s37, v15
v_exp_f32 v27, v27
buffer_load_dwordx4 v11, s[12:15], s39 offen offset:0 lds
v_add_f32 v19, v19, v26
v_cvt_pk_bf16_f32 v81, v24, v25
v_fma_f32 v23, v103, s37, v15
v_exp_f32 v22, v22
v_add_f32 v19, v19, v27
v_fma_f32 v24, v104, s37, v15
v_exp_f32 v23, v23
v_mfma_f32_32x32x16_bf16 a[160:175], v[152:155], v[132:135], a[160:175]
v_add_f32 v19, v19, v22
v_cvt_pk_bf16_f32 v82, v26, v27
v_fma_f32 v25, v105, s37, v15
v_exp_f32 v24, v24
v_add_f32 v19, v19, v23
v_fma_f32 v26, v106, s37, v15
v_exp_f32 v25, v25
v_add_f32 v19, v19, v24
v_cvt_pk_bf16_f32 v83, v22, v23
v_fma_f32 v27, v107, s37, v15
v_exp_f32 v26, v26
v_add_f32 v19, v19, v25
v_fma_f32 v22, v108, s37, v15
v_exp_f32 v27, v27
v_add_f32 v19, v19, v26
v_cvt_pk_bf16_f32 v84, v24, v25
v_fma_f32 v23, v109, s37, v15
v_exp_f32 v22, v22
v_mfma_f32_32x32x16_bf16 a[80:95], v[156:159], v[116:119], a[80:95]
v_add_f32 v19, v19, v27
v_fma_f32 v24, v110, s37, v15
v_exp_f32 v23, v23
v_add_f32 v19, v19, v22
v_fma_f32 v25, v111, s37, v15
v_exp_f32 v24, v24
v_cndmask_b32_e64 v240, v168, v169, s[66:67]
v_add_f32 v19, v19, v23
v_exp_f32 v25, v25
v_cndmask_b32_e64 v240, v240, v170, s[68:69]
v_add_f32 v19, v19, v24
v_cndmask_b32_e64 v240, v240, v171, s[70:71]
ds_read_b64_tr_b16 v[136:137], v6 offset:36864
ds_read_b64_tr_b16 v[138:139], v6 offset:39936
ds_read_b64_tr_b16 v[140:141], v7 offset:36864
ds_read_b64_tr_b16 v[142:143], v7 offset:39936
ds_read_b64_tr_b16 v[144:145], v6 offset:36992
ds_read_b64_tr_b16 v[146:147], v6 offset:40064
ds_read_b64_tr_b16 v[148:149], v7 offset:36992
ds_read_b64_tr_b16 v[150:151], v7 offset:40064
s_waitcnt vmcnt(6)
ds_read_b128 v[224:227], v232 offset:10240
ds_read_b128 v[228:231], v233 offset:10240
v_mfma_f32_32x32x16_bf16 a[176:191], v[156:159], v[132:135], a[176:191]
buffer_load_dwordx4 v12, s[12:15], s39 offen offset:1024 lds
buffer_load_dwordx4 v13, s[12:15], s39 offen offset:2048 lds
v_cvt_pk_bf16_f32 v85, v26, v27
v_cvt_pk_bf16_f32 v86, v22, v23
v_add_f32 v19, v19, v25
v_cvt_pk_bf16_f32 v87, v24, v25
v_cndmask_b32_e64 v164, v164, v240, s[72:73]
v_cndmask_b32_e64 v240, v172, v173, s[66:67]
v_cmp_nge_f32 vcc, s52, v18
s_cbranch_vccnz Lst_t3K_X
Lct_t3K_X:
v_add_f32 v16, v16, v18
v_cndmask_b32_e64 v240, v240, v174, s[68:69]
v_cndmask_b32_e64 v240, v240, v175, s[70:71]
s_add_u32 s38, s38, s78
s_add_u32 s99, s99, 4
s_cmp_eq_u32 s99, s40
s_cselect_b32 s38, s88, s38
s_cselect_b32 s78, -12288, s78
s_cmp_eq_u32 s99, 28
s_cselect_b32 s38, s41, s38
s_cselect_b32 s78, 12288, s78
s_add_u32 s39, s39, s98
v_cndmask_b32_e64 v165, v165, v240, s[72:73]
v_cmp_nge_f32 vcc, s52, v19
s_cbranch_vccnz Lst_t3K_Y
Lct_t3K_Y:
v_add_f32 v17, v17, v19
s_waitcnt lgkmcnt(0)
v_mfma_f32_16x16x32_bf16 v[180:183], v[224:227], v[200:203], v[180:183]
v_mfma_f32_16x16x32_bf16 v[180:183], v[228:231], v[204:207], v[180:183]
s_nop 7
v_cndmask_b32_e64 v240, v176, v177, s[66:67]
v_cndmask_b32_e64 v240, v240, v178, s[68:69]
v_cndmask_b32_e64 v240, v240, v179, s[70:71]
v_cndmask_b32_e64 v166, v166, v240, s[72:73]
v_cndmask_b32_e64 v240, v180, v181, s[66:67]
v_cndmask_b32_e64 v240, v240, v182, s[68:69]
v_cndmask_b32_e64 v240, v240, v183, s[70:71]
v_cndmask_b32_e64 v167, v167, v240, s[72:73]
s_branch L_switch
L_t3_V:
s_waitcnt lgkmcnt(8)
v_mfma_f32_32x32x16_bf16 a[0:15], v[136:139], v[112:115], a[0:15]
ds_read_b64_tr_b16 v[152:153], v6 offset:24832
ds_read_b64_tr_b16 v[154:155], v6 offset:27904
ds_read_b64_tr_b16 v[156:157], v7 offset:24832
ds_read_b64_tr_b16 v[158:159], v7 offset:27904
s_add_u32 m0, s48, 36864
s_waitcnt lgkmcnt(10)
v_mfma_f32_16x16x32_bf16 v[176:179], v[224:227], v[192:195], 0
buffer_load_dwordx4 v8, s[8:11], s38 offen offset:0 nt lds
s_waitcnt lgkmcnt(8)
v_mfma_f32_16x16x32_bf16 v[180:183], v[228:231], v[192:195], 0
s_waitcnt vmcnt(17)
ds_read_b64_tr_b16 v[224:225], v232 offset:0
ds_read_b64_tr_b16 v[226:227], v232 offset:2048
ds_read_b64_tr_b16 v[228:229], v233 offset:0
ds_read_b64_tr_b16 v[230:231], v233 offset:2048
v_mfma_f32_32x32x16_bf16 a[96:111], v[136:139], v[128:131], a[96:111]
ds_read_b64_tr_b16 v[136:137], v6 offset:30720
ds_read_b64_tr_b16 v[138:139], v6 offset:33792
v_fma_f32 v22, v64, s37, v14
v_fma_f32 v23, v65, s37, v14
v_fma_f32 v24, v66, s37, v14
v_mfma_f32_32x32x16_bf16 a[16:31], v[140:143], v[112:115], a[16:31]
buffer_load_dwordx4 v9, s[8:11], s38 offen offset:1024 nt lds
v_exp_f32 v22, v22
v_exp_f32 v23, v23
v_mfma_f32_32x32x16_bf16 a[112:127], v[140:143], v[128:131], a[112:127]
ds_read_b64_tr_b16 v[140:141], v7 offset:30720
ds_read_b64_tr_b16 v[142:143], v7 offset:33792
v_fma_f32 v25, v67, s37, v14
v_exp_f32 v24, v24
s_waitcnt lgkmcnt(12)
v_mfma_f32_32x32x16_bf16 a[32:47], v[144:147], v[112:115], a[32:47]
v_add_f32 v18, v22, v23
v_fma_f32 v26, v68, s37, v14
v_exp_f32 v25, v25
v_add_f32 v18, v18, v24
s_waitcnt lgkmcnt(6)
v_mfma_f32_16x16x32_bf16 v[168:171], v[224:227], v[196:199], v[168:171]
buffer_load_dwordx4 v10, s[8:11], s38 offen offset:2048 nt lds
v_cvt_pk_bf16_f32 v120, v22, v23
s_waitcnt lgkmcnt(4)
v_mfma_f32_16x16x32_bf16 v[172:175], v[228:231], v[196:199], v[172:175]
ds_read_b64_tr_b16 v[224:225], v234 offset:0
ds_read_b64_tr_b16 v[226:227], v234 offset:2048
ds_read_b64_tr_b16 v[228:229], v235 offset:0
ds_read_b64_tr_b16 v[230:231], v235 offset:2048
v_mfma_f32_32x32x16_bf16 a[128:143], v[144:147], v[128:131], a[128:143]
ds_read_b64_tr_b16 v[144:145], v6 offset:30848
ds_read_b64_tr_b16 v[146:147], v6 offset:33920
v_fma_f32 v27, v69, s37, v14
v_exp_f32 v26, v26
v_mfma_f32_32x32x16_bf16 a[48:63], v[148:151], v[112:115], a[48:63]
v_add_f32 v18, v18, v25
v_fma_f32 v22, v70, s37, v14
v_exp_f32 v27, v27
v_add_f32 v18, v18, v26
v_mfma_f32_32x32x16_bf16 a[144:159], v[148:151], v[128:131], a[144:159]
ds_read_b64_tr_b16 v[148:149], v7 offset:30848
ds_read_b64_tr_b16 v[150:151], v7 offset:33920
v_cvt_pk_bf16_f32 v121, v24, v25
v_fma_f32 v23, v71, s37, v14
v_add_f32 v18, v18, v27
v_mfma_f32_32x32x16_bf16 a[64:79], v[152:155], v[112:115], a[64:79]
v_exp_f32 v22, v22
v_fma_f32 v24, v72, s37, v14
v_exp_f32 v23, v23
s_waitcnt lgkmcnt(6)
v_mfma_f32_16x16x32_bf16 v[176:179], v[224:227], v[196:199], v[176:179]
v_add_f32 v18, v18, v22
v_cvt_pk_bf16_f32 v122, v26, v27
s_waitcnt lgkmcnt(4)
v_mfma_f32_16x16x32_bf16 v[180:183], v[228:231], v[196:199], v[180:183]
s_waitcnt vmcnt(9)
ds_read_b64_tr_b16 v[224:225], v232 offset:4096
ds_read_b64_tr_b16 v[226:227], v232 offset:6144
ds_read_b64_tr_b16 v[228:229], v233 offset:4096
ds_read_b64_tr_b16 v[230:231], v233 offset:6144
v_mfma_f32_32x32x16_bf16 a[160:175], v[152:155], v[128:131], a[160:175]
ds_read_b64_tr_b16 v[152:153], v6 offset:30976
ds_read_b64_tr_b16 v[154:155], v6 offset:34048
v_fma_f32 v25, v73, s37, v14
v_exp_f32 v24, v24
v_mfma_f32_32x32x16_bf16 a[80:95], v[156:159], v[112:115], a[80:95]
v_add_f32 v18, v18, v23
v_fma_f32 v26, v74, s37, v14
v_exp_f32 v25, v25
v_add_f32 v18, v18, v24
v_mfma_f32_32x32x16_bf16 a[176:191], v[156:159], v[128:131], a[176:191]
ds_read_b64_tr_b16 v[156:157], v7 offset:30976
ds_read_b64_tr_b16 v[158:159], v7 offset:34048
v_cvt_pk_bf16_f32 v123, v22, v23
v_fma_f32 v27, v75, s37, v14
v_add_f32 v18, v18, v25
v_mfma_f32_32x32x16_bf16 a[0:15], v[136:139], v[116:119], a[0:15]
v_exp_f32 v26, v26
v_fma_f32 v22, v76, s37, v14
v_exp_f32 v27, v27
s_waitcnt lgkmcnt(6)
v_mfma_f32_16x16x32_bf16 v[168:171], v[224:227], v[200:203], v[168:171]
v_add_f32 v18, v18, v26
v_cvt_pk_bf16_f32 v124, v24, v25
s_waitcnt lgkmcnt(4)
v_mfma_f32_16x16x32_bf16 v[172:175], v[228:231], v[200:203], v[172:175]
ds_read_b64_tr_b16 v[224:225], v234 offset:4096
ds_read_b64_tr_b16 v[226:227], v234 offset:6144
ds_read_b64_tr_b16 v[228:229], v235 offset:4096
ds_read_b64_tr_b16 v[230:231], v235 offset:6144
v_mfma_f32_32x32x16_bf16 a[96:111], v[136:139], v[132:135], a[96:111]
v_fma_f32 v23, v77, s37, v14
v_exp_f32 v22, v22
v_add_f32 v18, v18, v27
v_fma_f32 v24, v78, s37, v14
v_mfma_f32_32x32x16_bf16 a[16:31], v[140:143], v[116:119], a[16:31]
v_exp_f32 v23, v23
v_fma_f32 v25, v79, s37, v14
v_add_f32 v18, v18, v22
v_add_f32 v18, v18, v23
v_mfma_f32_32x32x16_bf16 a[112:127], v[140:143], v[132:135], a[112:127]
v_exp_f32 v24, v24
v_exp_f32 v25, v25
v_cvt_pk_bf16_f32 v126, v22, v23
v_mfma_f32_32x32x16_bf16 a[32:47], v[144:147], v[116:119], a[32:47]
v_add_f32 v18, v18, v24
v_cvt_pk_bf16_f32 v127, v24, v25
v_fma_f32 v22, v96, s37, v15
v_fma_f32 v23, v97, s37, v15
v_add_f32 v18, v18, v25
s_waitcnt lgkmcnt(2)
v_mfma_f32_16x16x32_bf16 v[176:179], v[224:227], v[200:203], v[176:179]
v_exp_f32 v22, v22
s_waitcnt lgkmcnt(0)
v_mfma_f32_16x16x32_bf16 v[180:183], v[228:231], v[200:203], v[180:183]
s_waitcnt vmcnt(5)
ds_read_b64_tr_b16 v[224:225], v232 offset:8192
ds_read_b64_tr_b16 v[226:227], v232 offset:10240
ds_read_b64_tr_b16 v[228:229], v233 offset:8192
ds_read_b64_tr_b16 v[230:231], v233 offset:10240
v_mfma_f32_32x32x16_bf16 a[128:143], v[144:147], v[132:135], a[128:143]
v_fma_f32 v24, v98, s37, v15
v_exp_f32 v23, v23
v_cvt_pk_bf16_f32 v125, v26, v27
v_fma_f32 v25, v99, s37, v15
v_mfma_f32_32x32x16_bf16 a[48:63], v[148:151], v[116:119], a[48:63]
v_exp_f32 v24, v24
v_add_f32 v19, v22, v23
v_fma_f32 v26, v100, s37, v15
v_add_f32 v19, v19, v24
v_mfma_f32_32x32x16_bf16 a[144:159], v[148:151], v[132:135], a[144:159]
v_exp_f32 v25, v25
v_cvt_pk_bf16_f32 v80, v22, v23
v_fma_f32 v27, v101, s37, v15
s_add_u32 m0, s49, 12288
v_mfma_f32_32x32x16_bf16 a[64:79], v[152:155], v[116:119], a[64:79]
v_exp_f32 v26, v26
v_add_f32 v19, v19, v25
v_fma_f32 v22, v102, s37, v15
buffer_load_dwordx4 v11, s[12:15], s39 offen offset:0 nt lds
s_waitcnt lgkmcnt(2)
v_mfma_f32_16x16x32_bf16 v[168:171], v[224:227], v[204:207], v[168:171]
v_exp_f32 v27, v27
s_waitcnt lgkmcnt(0)
v_mfma_f32_16x16x32_bf16 v[172:175], v[228:231], v[204:207], v[172:175]
v_add_f32 v19, v19, v26
v_cvt_pk_bf16_f32 v81, v24, v25
v_fma_f32 v23, v103, s37, v15
v_exp_f32 v22, v22
v_add_f32 v19, v19, v27
v_fma_f32 v24, v104, s37, v15
v_exp_f32 v23, v23
v_mfma_f32_32x32x16_bf16 a[160:175], v[152:155], v[132:135], a[160:175]
v_add_f32 v19, v19, v22
v_cvt_pk_bf16_f32 v82, v26, v27
v_fma_f32 v25, v105, s37, v15
v_exp_f32 v24, v24
v_add_f32 v19, v19, v23
v_fma_f32 v26, v106, s37, v15
v_exp_f32 v25, v25
v_add_f32 v19, v19, v24
v_cvt_pk_bf16_f32 v83, v22, v23
v_fma_f32 v27, v107, s37, v15
v_exp_f32 v26, v26
v_add_f32 v19, v19, v25
v_fma_f32 v22, v108, s37, v15
v_exp_f32 v27, v27
v_add_f32 v19, v19, v26
v_cvt_pk_bf16_f32 v84, v24, v25
v_fma_f32 v23, v109, s37, v15
v_exp_f32 v22, v22
v_mfma_f32_32x32x16_bf16 a[80:95], v[156:159], v[116:119], a[80:95]
buffer_load_dwordx4 v12, s[12:15], s39 offen offset:1024 nt lds
v_add_f32 v19, v19, v27
v_fma_f32 v24, v110, s37, v15
v_exp_f32 v23, v23
v_add_f32 v19, v19, v22
v_fma_f32 v25, v111, s37, v15
v_exp_f32 v24, v24
v_add_f32 v19, v19, v23
v_exp_f32 v25, v25
v_add_f32 v19, v19, v24
ds_read_b64_tr_b16 v[136:137], v6 offset:36864
ds_read_b64_tr_b16 v[138:139], v6 offset:39936
ds_read_b64_tr_b16 v[140:141], v7 offset:36864
ds_read_b64_tr_b16 v[142:143], v7 offset:39936
ds_read_b64_tr_b16 v[144:145], v6 offset:36992
ds_read_b64_tr_b16 v[146:147], v6 offset:40064
ds_read_b64_tr_b16 v[148:149], v7 offset:36992
ds_read_b64_tr_b16 v[150:151], v7 offset:40064
ds_read_b64_tr_b16 v[224:225], v234 offset:8192
ds_read_b64_tr_b16 v[226:227], v234 offset:10240
ds_read_b64_tr_b16 v[228:229], v235 offset:8192
ds_read_b64_tr_b16 v[230:231], v235 offset:10240
v_mfma_f32_32x32x16_bf16 a[176:191], v[156:159], v[132:135], a[176:191]
buffer_load_dwordx4 v13, s[12:15], s39 offen offset:2048 nt lds
v_cvt_pk_bf16_f32 v85, v26, v27
v_cvt_pk_bf16_f32 v86, v22, v23
v_add_f32 v19, v19, v25
v_cvt_pk_bf16_f32 v87, v24, v25
v_cmp_nge_f32 vcc, s52, v18
s_cbranch_vccnz Lst_t3V_X
Lct_t3V_X:
v_add_f32 v16, v16, v18
s_add_u32 s38, s38, s78
s_add_u32 s99, s99, 4
s_cmp_eq_u32 s99, s40
s_cselect_b32 s38, s88, s38
s_cselect_b32 s78, -12288, s78
s_cmp_eq_u32 s99, 28
s_cselect_b32 s38, s41, s38
s_cselect_b32 s78, 12288, s78
s_add_u32 s39, s39, s98
v_cmp_nge_f32 vcc, s52, v19
s_cbranch_vccnz Lst_t3V_Y
Lct_t3V_Y:
v_add_f32 v17, v17, v19
s_waitcnt lgkmcnt(0)
v_mfma_f32_16x16x32_bf16 v[176:179], v[224:227], v[204:207], v[176:179]
v_mfma_f32_16x16x32_bf16 v[180:183], v[228:231], v[204:207], v[180:183]
s_nop 7
s_add_u32 s74, s75, 4096
v_cvt_pk_bf16_f32 v184, v168, v169
v_cvt_pk_bf16_f32 v185, v170, v171
v_cvt_pk_bf16_f32 v186, v172, v173
v_cvt_pk_bf16_f32 v187, v174, v175
v_lshlrev_b32 v254, 4, v1
buffer_store_dwordx4 v[184:187], v254, s[32:35], s74 offen offset:0
v_cvt_pk_bf16_f32 v188, v176, v177
v_cvt_pk_bf16_f32 v189, v178, v179
v_cvt_pk_bf16_f32 v190, v180, v181
v_cvt_pk_bf16_f32 v191, v182, v183
v_lshlrev_b32 v254, 4, v1
buffer_store_dwordx4 v[188:191], v254, s[32:35], s74 offen offset:1024
s_branch L_switch
L_switch:
s_mul_i32 s90, s45, 98304
s_mul_i32 s84, s36, 12288
s_add_u32 s90, s90, s84
v_and_b32 v22, 7, v1
v_and_b32 v23, 0x38, v1
v_add_u32 v24, 0, v1
v_mul_u32_u24 v24, 2731, v24
v_lshrrev_b32 v24, 16, v24
v_bfe_u32 v25, v24, 1, 3
v_xor_b32 v25, v25, v22
v_or_b32 v25, v25, v23
v_lshlrev_b32 v112, 4, v25
v_add_u32 v24, 64, v1
v_mul_u32_u24 v24, 2731, v24
v_lshrrev_b32 v24, 16, v24
v_bfe_u32 v25, v24, 1, 3
v_xor_b32 v25, v25, v22
v_or_b32 v25, v25, v23
v_lshlrev_b32 v113, 4, v25
v_add_u32 v24, 128, v1
v_mul_u32_u24 v24, 2731, v24
v_lshrrev_b32 v24, 16, v24
v_bfe_u32 v25, v24, 1, 3
v_xor_b32 v25, v25, v22
v_or_b32 v25, v25, v23
v_lshlrev_b32 v114, 4, v25
v_add_u32 v24, 192, v1
v_mul_u32_u24 v24, 2731, v24
v_lshrrev_b32 v24, 16, v24
v_bfe_u32 v25, v24, 1, 3
v_xor_b32 v25, v25, v22
v_or_b32 v25, v25, v23
v_lshlrev_b32 v115, 4, v25
v_add_u32 v24, 256, v1
v_mul_u32_u24 v24, 2731, v24
v_lshrrev_b32 v24, 16, v24
v_bfe_u32 v25, v24, 1, 3
v_xor_b32 v25, v25, v22
v_or_b32 v25, v25, v23
v_lshlrev_b32 v116, 4, v25
v_add_u32 v24, 320, v1
v_mul_u32_u24 v24, 2731, v24
v_lshrrev_b32 v24, 16, v24
v_bfe_u32 v25, v24, 1, 3
v_xor_b32 v25, v25, v22
v_or_b32 v25, v25, v23
v_lshlrev_b32 v117, 4, v25
s_add_u32 m0, s53, 0
s_add_u32 s63, s90, 0
buffer_load_dwordx4 v112, s[4:7], s63 offen offset:0 nt lds
buffer_load_dwordx4 v113, s[4:7], s63 offen offset:1024 nt lds
buffer_load_dwordx4 v114, s[4:7], s63 offen offset:2048 nt lds
buffer_load_dwordx4 v115, s[4:7], s63 offen offset:3072 nt lds
s_add_u32 m0, s53, 4096
s_add_u32 s63, s90, 4096
buffer_load_dwordx4 v116, s[4:7], s63 offen offset:0 nt lds
buffer_load_dwordx4 v117, s[4:7], s63 offen offset:1024 nt lds
buffer_load_dwordx4 v112, s[4:7], s63 offen offset:2048 nt lds
buffer_load_dwordx4 v113, s[4:7], s63 offen offset:3072 nt lds
s_add_u32 m0, s53, 8192
s_add_u32 s63, s90, 8192
buffer_load_dwordx4 v114, s[4:7], s63 offen offset:0 nt lds
buffer_load_dwordx4 v115, s[4:7], s63 offen offset:1024 nt lds
buffer_load_dwordx4 v116, s[4:7], s63 offen offset:2048 nt lds
buffer_load_dwordx4 v117, s[4:7], s63 offen offset:3072 nt lds
s_waitcnt lgkmcnt(4)
v_mfma_f32_32x32x16_bf16 a[0:15], v[136:139], v[120:123], a[0:15]
ds_read_b64_tr_b16 v[152:153], v6 offset:37120
ds_read_b64_tr_b16 v[154:155], v6 offset:40192
ds_read_b64_tr_b16 v[156:157], v7 offset:37120
ds_read_b64_tr_b16 v[158:159], v7 offset:40192
v_mfma_f32_32x32x16_bf16 a[96:111], v[136:139], v[80:83], a[96:111]
ds_read_b64_tr_b16 v[136:137], v6 offset:43008
ds_read_b64_tr_b16 v[138:139], v6 offset:46080
v_mfma_f32_32x32x16_bf16 a[16:31], v[140:143], v[120:123], a[16:31]
v_mfma_f32_32x32x16_bf16 a[112:127], v[140:143], v[80:83], a[112:127]
ds_read_b64_tr_b16 v[140:141], v7 offset:43008
ds_read_b64_tr_b16 v[142:143], v7 offset:46080
s_waitcnt lgkmcnt(8)
v_mfma_f32_32x32x16_bf16 a[32:47], v[144:147], v[120:123], a[32:47]
v_mfma_f32_32x32x16_bf16 a[128:143], v[144:147], v[80:83], a[128:143]
ds_read_b64_tr_b16 v[144:145], v6 offset:43136
ds_read_b64_tr_b16 v[146:147], v6 offset:46208
v_mfma_f32_32x32x16_bf16 a[48:63], v[148:151], v[120:123], a[48:63]
v_mfma_f32_32x32x16_bf16 a[144:159], v[148:151], v[80:83], a[144:159]
ds_read_b64_tr_b16 v[148:149], v7 offset:43136
ds_read_b64_tr_b16 v[150:151], v7 offset:46208
s_waitcnt lgkmcnt(8)
v_mfma_f32_32x32x16_bf16 a[64:79], v[152:155], v[120:123], a[64:79]
v_mfma_f32_32x32x16_bf16 a[160:175], v[152:155], v[80:83], a[160:175]
ds_read_b64_tr_b16 v[152:153], v6 offset:43264
ds_read_b64_tr_b16 v[154:155], v6 offset:46336
v_mfma_f32_32x32x16_bf16 a[80:95], v[156:159], v[120:123], a[80:95]
v_mfma_f32_32x32x16_bf16 a[176:191], v[156:159], v[80:83], a[176:191]
ds_read_b64_tr_b16 v[156:157], v7 offset:43264
ds_read_b64_tr_b16 v[158:159], v7 offset:46336
s_waitcnt lgkmcnt(8)
v_mfma_f32_32x32x16_bf16 a[0:15], v[136:139], v[124:127], a[0:15]
v_mfma_f32_32x32x16_bf16 a[96:111], v[136:139], v[84:87], a[96:111]
v_mfma_f32_32x32x16_bf16 a[16:31], v[140:143], v[124:127], a[16:31]
v_mfma_f32_32x32x16_bf16 a[112:127], v[140:143], v[84:87], a[112:127]
s_waitcnt lgkmcnt(4)
v_mfma_f32_32x32x16_bf16 a[32:47], v[144:147], v[124:127], a[32:47]
v_mfma_f32_32x32x16_bf16 a[128:143], v[144:147], v[84:87], a[128:143]
v_mfma_f32_32x32x16_bf16 a[48:63], v[148:151], v[124:127], a[48:63]
v_mfma_f32_32x32x16_bf16 a[144:159], v[148:151], v[84:87], a[144:159]
s_waitcnt lgkmcnt(0)
v_mfma_f32_32x32x16_bf16 a[64:79], v[152:155], v[124:127], a[64:79]
v_mfma_f32_32x32x16_bf16 a[160:175], v[152:155], v[84:87], a[160:175]
v_mfma_f32_32x32x16_bf16 a[80:95], v[156:159], v[124:127], a[80:95]
v_mfma_f32_32x32x16_bf16 a[176:191], v[156:159], v[84:87], a[176:191]
v_add_u32 v22, s53, v2
v_add_u32 v23, s53, v3
v_add_u32 v24, s53, v4
v_add_u32 v25, s53, v5
s_waitcnt vmcnt(0)
ds_read_b128 a[192:195], v22 offset:0
ds_read_b128 a[196:199], v23 offset:0
ds_read_b128 a[200:203], v24 offset:0
ds_read_b128 a[204:207], v25 offset:0
ds_read_b128 a[208:211], v22 offset:128
ds_read_b128 a[212:215], v23 offset:128
ds_read_b128 a[216:219], v24 offset:128
ds_read_b128 a[220:223], v25 offset:128
ds_read_b128 a[224:227], v22 offset:256
ds_read_b128 a[228:231], v23 offset:256
ds_read_b128 a[232:235], v24 offset:256
ds_read_b128 a[236:239], v25 offset:256
s_waitcnt lgkmcnt(0)
s_add_u32 s85, s90, 49152
s_add_u32 m0, s53, 0
s_add_u32 s63, s85, 0
buffer_load_dwordx4 v112, s[4:7], s63 offen offset:0 nt lds
buffer_load_dwordx4 v113, s[4:7], s63 offen offset:1024 nt lds
buffer_load_dwordx4 v114, s[4:7], s63 offen offset:2048 nt lds
buffer_load_dwordx4 v115, s[4:7], s63 offen offset:3072 nt lds
s_add_u32 m0, s53, 4096
s_add_u32 s63, s85, 4096
buffer_load_dwordx4 v116, s[4:7], s63 offen offset:0 nt lds
buffer_load_dwordx4 v117, s[4:7], s63 offen offset:1024 nt lds
buffer_load_dwordx4 v112, s[4:7], s63 offen offset:2048 nt lds
buffer_load_dwordx4 v113, s[4:7], s63 offen offset:3072 nt lds
s_add_u32 m0, s53, 8192
s_add_u32 s63, s85, 8192
buffer_load_dwordx4 v114, s[4:7], s63 offen offset:0 nt lds
buffer_load_dwordx4 v115, s[4:7], s63 offen offset:1024 nt lds
buffer_load_dwordx4 v116, s[4:7], s63 offen offset:2048 nt lds
buffer_load_dwordx4 v117, s[4:7], s63 offen offset:3072 nt lds
s_nop 15
v_lshlrev_b32 v30, 4, v1
s_mov_b32 s84, s46
buffer_store_dwordx4 v[14:17], v30, s[32:35], s84 offen offset:0 sc1
s_add_u32 s84, s84, 1024
v_accvgpr_read_b32 v64, a0
v_accvgpr_read_b32 v65, a1
v_accvgpr_read_b32 v66, a2
v_accvgpr_read_b32 v67, a3
v_accvgpr_read_b32 v68, a4
v_accvgpr_read_b32 v69, a5
v_accvgpr_read_b32 v70, a6
v_accvgpr_read_b32 v71, a7
v_accvgpr_read_b32 v72, a8
v_accvgpr_read_b32 v73, a9
v_accvgpr_read_b32 v74, a10
v_accvgpr_read_b32 v75, a11
v_accvgpr_read_b32 v76, a12
v_accvgpr_read_b32 v77, a13
v_accvgpr_read_b32 v78, a14
v_accvgpr_read_b32 v79, a15
v_cvt_pk_bf16_f32 v64, v64, v65
v_cvt_pk_bf16_f32 v65, v66, v67
v_cvt_pk_bf16_f32 v66, v68, v69
v_cvt_pk_bf16_f32 v67, v70, v71
v_cvt_pk_bf16_f32 v68, v72, v73
v_cvt_pk_bf16_f32 v69, v74, v75
v_cvt_pk_bf16_f32 v70, v76, v77
v_cvt_pk_bf16_f32 v71, v78, v79
buffer_store_dwordx4 v[64:67], v30, s[32:35], s84 offen offset:0 sc1
v_accvgpr_read_b32 v80, a16
v_accvgpr_read_b32 v81, a17
v_accvgpr_read_b32 v82, a18
v_accvgpr_read_b32 v83, a19
v_accvgpr_read_b32 v84, a20
v_accvgpr_read_b32 v85, a21
v_accvgpr_read_b32 v86, a22
v_accvgpr_read_b32 v87, a23
v_accvgpr_read_b32 v88, a24
v_accvgpr_read_b32 v89, a25
v_accvgpr_read_b32 v90, a26
v_accvgpr_read_b32 v91, a27
buffer_store_dwordx4 v[68:71], v30, s[32:35], s84 offen offset:1024 sc1
v_accvgpr_read_b32 v92, a28
v_accvgpr_read_b32 v93, a29
v_accvgpr_read_b32 v94, a30
v_accvgpr_read_b32 v95, a31
v_cvt_pk_bf16_f32 v80, v80, v81
v_cvt_pk_bf16_f32 v81, v82, v83
v_cvt_pk_bf16_f32 v82, v84, v85
v_cvt_pk_bf16_f32 v83, v86, v87
v_cvt_pk_bf16_f32 v84, v88, v89
v_cvt_pk_bf16_f32 v85, v90, v91
v_cvt_pk_bf16_f32 v86, v92, v93
v_cvt_pk_bf16_f32 v87, v94, v95
buffer_store_dwordx4 v[80:83], v30, s[32:35], s84 offen offset:2048 sc1
v_accvgpr_read_b32 v96, a32
v_accvgpr_read_b32 v97, a33
v_accvgpr_read_b32 v98, a34
v_accvgpr_read_b32 v99, a35
v_accvgpr_read_b32 v100, a36
v_accvgpr_read_b32 v101, a37
v_accvgpr_read_b32 v102, a38
v_accvgpr_read_b32 v103, a39
v_accvgpr_read_b32 v104, a40
v_accvgpr_read_b32 v105, a41
v_accvgpr_read_b32 v106, a42
v_accvgpr_read_b32 v107, a43
buffer_store_dwordx4 v[84:87], v30, s[32:35], s84 offen offset:3072 sc1
v_accvgpr_read_b32 v108, a44
v_accvgpr_read_b32 v109, a45
v_accvgpr_read_b32 v110, a46
v_accvgpr_read_b32 v111, a47
v_cvt_pk_bf16_f32 v96, v96, v97
v_cvt_pk_bf16_f32 v97, v98, v99
v_cvt_pk_bf16_f32 v98, v100, v101
v_cvt_pk_bf16_f32 v99, v102, v103
v_cvt_pk_bf16_f32 v100, v104, v105
v_cvt_pk_bf16_f32 v101, v106, v107
v_cvt_pk_bf16_f32 v102, v108, v109
v_cvt_pk_bf16_f32 v103, v110, v111
s_add_u32 s84, s84, 4096
buffer_store_dwordx4 v[96:99], v30, s[32:35], s84 offen offset:0 sc1
v_accvgpr_read_b32 v64, a48
v_accvgpr_read_b32 v65, a49
v_accvgpr_read_b32 v66, a50
v_accvgpr_read_b32 v67, a51
v_accvgpr_read_b32 v68, a52
v_accvgpr_read_b32 v69, a53
v_accvgpr_read_b32 v70, a54
v_accvgpr_read_b32 v71, a55
v_accvgpr_read_b32 v72, a56
v_accvgpr_read_b32 v73, a57
v_accvgpr_read_b32 v74, a58
v_accvgpr_read_b32 v75, a59
buffer_store_dwordx4 v[100:103], v30, s[32:35], s84 offen offset:1024 sc1
v_accvgpr_read_b32 v76, a60
v_accvgpr_read_b32 v77, a61
v_accvgpr_read_b32 v78, a62
v_accvgpr_read_b32 v79, a63
v_cvt_pk_bf16_f32 v64, v64, v65
v_cvt_pk_bf16_f32 v65, v66, v67
v_cvt_pk_bf16_f32 v66, v68, v69
v_cvt_pk_bf16_f32 v67, v70, v71
v_cvt_pk_bf16_f32 v68, v72, v73
v_cvt_pk_bf16_f32 v69, v74, v75
v_cvt_pk_bf16_f32 v70, v76, v77
v_cvt_pk_bf16_f32 v71, v78, v79
buffer_store_dwordx4 v[64:67], v30, s[32:35], s84 offen offset:2048 sc1
v_accvgpr_read_b32 v80, a64
v_accvgpr_read_b32 v81, a65
v_accvgpr_read_b32 v82, a66
v_accvgpr_read_b32 v83, a67
v_accvgpr_read_b32 v84, a68
v_accvgpr_read_b32 v85, a69
v_accvgpr_read_b32 v86, a70
v_accvgpr_read_b32 v87, a71
v_accvgpr_read_b32 v88, a72
v_accvgpr_read_b32 v89, a73
v_accvgpr_read_b32 v90, a74
v_accvgpr_read_b32 v91, a75
buffer_store_dwordx4 v[68:71], v30, s[32:35], s84 offen offset:3072 sc1
v_accvgpr_read_b32 v92, a76
v_accvgpr_read_b32 v93, a77
v_accvgpr_read_b32 v94, a78
v_accvgpr_read_b32 v95, a79
v_cvt_pk_bf16_f32 v80, v80, v81
v_cvt_pk_bf16_f32 v81, v82, v83
v_cvt_pk_bf16_f32 v82, v84, v85
v_cvt_pk_bf16_f32 v83, v86, v87
v_cvt_pk_bf16_f32 v84, v88, v89
v_cvt_pk_bf16_f32 v85, v90, v91
v_cvt_pk_bf16_f32 v86, v92, v93
v_cvt_pk_bf16_f32 v87, v94, v95
s_add_u32 s84, s84, 4096
buffer_store_dwordx4 v[80:83], v30, s[32:35], s84 offen offset:0 sc1
v_accvgpr_read_b32 v96, a80
v_accvgpr_read_b32 v97, a81
v_accvgpr_read_b32 v98, a82
v_accvgpr_read_b32 v99, a83
v_accvgpr_read_b32 v100, a84
v_accvgpr_read_b32 v101, a85
v_accvgpr_read_b32 v102, a86
v_accvgpr_read_b32 v103, a87
v_accvgpr_read_b32 v104, a88
v_accvgpr_read_b32 v105, a89
v_accvgpr_read_b32 v106, a90
v_accvgpr_read_b32 v107, a91
buffer_store_dwordx4 v[84:87], v30, s[32:35], s84 offen offset:1024 sc1
v_accvgpr_read_b32 v108, a92
v_accvgpr_read_b32 v109, a93
v_accvgpr_read_b32 v110, a94
v_accvgpr_read_b32 v111, a95
v_cvt_pk_bf16_f32 v96, v96, v97
v_cvt_pk_bf16_f32 v97, v98, v99
v_cvt_pk_bf16_f32 v98, v100, v101
v_cvt_pk_bf16_f32 v99, v102, v103
v_cvt_pk_bf16_f32 v100, v104, v105
v_cvt_pk_bf16_f32 v101, v106, v107
v_cvt_pk_bf16_f32 v102, v108, v109
v_cvt_pk_bf16_f32 v103, v110, v111
buffer_store_dwordx4 v[96:99], v30, s[32:35], s84 offen offset:2048 sc1
v_accvgpr_read_b32 v64, a96
v_accvgpr_read_b32 v65, a97
v_accvgpr_read_b32 v66, a98
v_accvgpr_read_b32 v67, a99
v_accvgpr_read_b32 v68, a100
v_accvgpr_read_b32 v69, a101
v_accvgpr_read_b32 v70, a102
v_accvgpr_read_b32 v71, a103
v_accvgpr_read_b32 v72, a104
v_accvgpr_read_b32 v73, a105
v_accvgpr_read_b32 v74, a106
v_accvgpr_read_b32 v75, a107
buffer_store_dwordx4 v[100:103], v30, s[32:35], s84 offen offset:3072 sc1
v_accvgpr_read_b32 v76, a108
v_accvgpr_read_b32 v77, a109
v_accvgpr_read_b32 v78, a110
v_accvgpr_read_b32 v79, a111
v_cvt_pk_bf16_f32 v64, v64, v65
v_cvt_pk_bf16_f32 v65, v66, v67
v_cvt_pk_bf16_f32 v66, v68, v69
v_cvt_pk_bf16_f32 v67, v70, v71
v_cvt_pk_bf16_f32 v68, v72, v73
v_cvt_pk_bf16_f32 v69, v74, v75
v_cvt_pk_bf16_f32 v70, v76, v77
v_cvt_pk_bf16_f32 v71, v78, v79
s_add_u32 s84, s84, 4096
buffer_store_dwordx4 v[64:67], v30, s[32:35], s84 offen offset:0 sc1
v_accvgpr_read_b32 v80, a112
v_accvgpr_read_b32 v81, a113
v_accvgpr_read_b32 v82, a114
v_accvgpr_read_b32 v83, a115
v_accvgpr_read_b32 v84, a116
v_accvgpr_read_b32 v85, a117
v_accvgpr_read_b32 v86, a118
v_accvgpr_read_b32 v87, a119
v_accvgpr_read_b32 v88, a120
v_accvgpr_read_b32 v89, a121
v_accvgpr_read_b32 v90, a122
v_accvgpr_read_b32 v91, a123
buffer_store_dwordx4 v[68:71], v30, s[32:35], s84 offen offset:1024 sc1
v_accvgpr_read_b32 v92, a124
v_accvgpr_read_b32 v93, a125
v_accvgpr_read_b32 v94, a126
v_accvgpr_read_b32 v95, a127
v_cvt_pk_bf16_f32 v80, v80, v81
v_cvt_pk_bf16_f32 v81, v82, v83
v_cvt_pk_bf16_f32 v82, v84, v85
v_cvt_pk_bf16_f32 v83, v86, v87
v_cvt_pk_bf16_f32 v84, v88, v89
v_cvt_pk_bf16_f32 v85, v90, v91
v_cvt_pk_bf16_f32 v86, v92, v93
v_cvt_pk_bf16_f32 v87, v94, v95
buffer_store_dwordx4 v[80:83], v30, s[32:35], s84 offen offset:2048 sc1
v_accvgpr_read_b32 v96, a128
v_accvgpr_read_b32 v97, a129
v_accvgpr_read_b32 v98, a130
v_accvgpr_read_b32 v99, a131
v_accvgpr_read_b32 v100, a132
v_accvgpr_read_b32 v101, a133
v_accvgpr_read_b32 v102, a134
v_accvgpr_read_b32 v103, a135
v_accvgpr_read_b32 v104, a136
v_accvgpr_read_b32 v105, a137
v_accvgpr_read_b32 v106, a138
v_accvgpr_read_b32 v107, a139
buffer_store_dwordx4 v[84:87], v30, s[32:35], s84 offen offset:3072 sc1
v_accvgpr_read_b32 v108, a140
v_accvgpr_read_b32 v109, a141
v_accvgpr_read_b32 v110, a142
v_accvgpr_read_b32 v111, a143
v_cvt_pk_bf16_f32 v96, v96, v97
v_cvt_pk_bf16_f32 v97, v98, v99
v_cvt_pk_bf16_f32 v98, v100, v101
v_cvt_pk_bf16_f32 v99, v102, v103
v_cvt_pk_bf16_f32 v100, v104, v105
v_cvt_pk_bf16_f32 v101, v106, v107
v_cvt_pk_bf16_f32 v102, v108, v109
v_cvt_pk_bf16_f32 v103, v110, v111
s_add_u32 s84, s84, 4096
buffer_store_dwordx4 v[96:99], v30, s[32:35], s84 offen offset:0 sc1
v_accvgpr_read_b32 v64, a144
v_accvgpr_read_b32 v65, a145
v_accvgpr_read_b32 v66, a146
v_accvgpr_read_b32 v67, a147
v_accvgpr_read_b32 v68, a148
v_accvgpr_read_b32 v69, a149
v_accvgpr_read_b32 v70, a150
v_accvgpr_read_b32 v71, a151
v_accvgpr_read_b32 v72, a152
v_accvgpr_read_b32 v73, a153
v_accvgpr_read_b32 v74, a154
v_accvgpr_read_b32 v75, a155
buffer_store_dwordx4 v[100:103], v30, s[32:35], s84 offen offset:1024 sc1
v_accvgpr_read_b32 v76, a156
v_accvgpr_read_b32 v77, a157
v_accvgpr_read_b32 v78, a158
v_accvgpr_read_b32 v79, a159
v_cvt_pk_bf16_f32 v64, v64, v65
v_cvt_pk_bf16_f32 v65, v66, v67
v_cvt_pk_bf16_f32 v66, v68, v69
v_cvt_pk_bf16_f32 v67, v70, v71
v_cvt_pk_bf16_f32 v68, v72, v73
v_cvt_pk_bf16_f32 v69, v74, v75
v_cvt_pk_bf16_f32 v70, v76, v77
v_cvt_pk_bf16_f32 v71, v78, v79
buffer_store_dwordx4 v[64:67], v30, s[32:35], s84 offen offset:2048 sc1
v_accvgpr_read_b32 v80, a160
v_accvgpr_read_b32 v81, a161
v_accvgpr_read_b32 v82, a162
v_accvgpr_read_b32 v83, a163
v_accvgpr_read_b32 v84, a164
v_accvgpr_read_b32 v85, a165
v_accvgpr_read_b32 v86, a166
v_accvgpr_read_b32 v87, a167
v_accvgpr_read_b32 v88, a168
v_accvgpr_read_b32 v89, a169
v_accvgpr_read_b32 v90, a170
v_accvgpr_read_b32 v91, a171
buffer_store_dwordx4 v[68:71], v30, s[32:35], s84 offen offset:3072 sc1
v_accvgpr_read_b32 v92, a172
v_accvgpr_read_b32 v93, a173
v_accvgpr_read_b32 v94, a174
v_accvgpr_read_b32 v95, a175
v_cvt_pk_bf16_f32 v80, v80, v81
v_cvt_pk_bf16_f32 v81, v82, v83
v_cvt_pk_bf16_f32 v82, v84, v85
v_cvt_pk_bf16_f32 v83, v86, v87
v_cvt_pk_bf16_f32 v84, v88, v89
v_cvt_pk_bf16_f32 v85, v90, v91
v_cvt_pk_bf16_f32 v86, v92, v93
v_cvt_pk_bf16_f32 v87, v94, v95
s_add_u32 s84, s84, 4096
buffer_store_dwordx4 v[80:83], v30, s[32:35], s84 offen offset:0 sc1
v_accvgpr_read_b32 v96, a176
v_accvgpr_read_b32 v97, a177
v_accvgpr_read_b32 v98, a178
v_accvgpr_read_b32 v99, a179
v_accvgpr_read_b32 v100, a180
v_accvgpr_read_b32 v101, a181
v_accvgpr_read_b32 v102, a182
v_accvgpr_read_b32 v103, a183
v_accvgpr_read_b32 v104, a184
v_accvgpr_read_b32 v105, a185
v_accvgpr_read_b32 v106, a186
v_accvgpr_read_b32 v107, a187
buffer_store_dwordx4 v[84:87], v30, s[32:35], s84 offen offset:1024 sc1
v_accvgpr_read_b32 v108, a188
v_accvgpr_read_b32 v109, a189
v_accvgpr_read_b32 v110, a190
v_accvgpr_read_b32 v111, a191
v_cvt_pk_bf16_f32 v96, v96, v97
v_cvt_pk_bf16_f32 v97, v98, v99
v_cvt_pk_bf16_f32 v98, v100, v101
v_cvt_pk_bf16_f32 v99, v102, v103
v_cvt_pk_bf16_f32 v100, v104, v105
v_cvt_pk_bf16_f32 v101, v106, v107
v_cvt_pk_bf16_f32 v102, v108, v109
v_cvt_pk_bf16_f32 v103, v110, v111
buffer_store_dwordx4 v[96:99], v30, s[32:35], s84 offen offset:2048 sc1
buffer_store_dwordx4 v[100:103], v30, s[32:35], s84 offen offset:3072 sc1
v_add_u32 v22, s53, v2
v_add_u32 v23, s53, v3
v_add_u32 v24, s53, v4
v_add_u32 v25, s53, v5
s_waitcnt vmcnt(25)
ds_read_b128 a[240:243], v22 offset:0
ds_read_b128 a[244:247], v23 offset:0
ds_read_b128 a[248:251], v24 offset:0
ds_read_b128 a[252:255], v25 offset:0
ds_read_b128 v[32:35], v22 offset:128
ds_read_b128 v[36:39], v23 offset:128
ds_read_b128 v[40:43], v24 offset:128
ds_read_b128 v[44:47], v25 offset:128
ds_read_b128 v[48:51], v22 offset:256
ds_read_b128 v[52:55], v23 offset:256
ds_read_b128 v[56:59], v24 offset:256
ds_read_b128 v[60:63], v25 offset:256
s_waitcnt lgkmcnt(0)
s_add_u32 s42, s42, 1
s_mov_b32 s43, -2
s_cmp_eq_u32 s42, 5
s_cbranch_scc1 L_sw_v5
s_cmp_eq_u32 s42, 7
s_cbranch_scc1 L_sw_v7
s_cmp_eq_u32 s42, 1
s_cbranch_scc1 L_sw_k1
v_mov_b32_dpp v242, v242 row_ror:4 row_mask:0xf bank_mask:0xf
v_mov_b32_dpp v243, v243 row_ror:4 row_mask:0xf bank_mask:0xf
v_mov_b32_dpp v244, v244 row_ror:4 row_mask:0xf bank_mask:0xf
v_mov_b32_dpp v245, v245 row_ror:4 row_mask:0xf bank_mask:0xf
s_branch L_sw_k2
L_sw_k1:
L_sw_k2:
s_nop 1
v_add_u32_dpp v208, v242, v234 row_newbcast:0 row_mask:0xf bank_mask:0x3
v_add_u32_dpp v208, v242, v234 row_newbcast:1 row_mask:0xf bank_mask:0xc
v_add_u32_dpp v216, v242, v235 row_newbcast:2 row_mask:0xf bank_mask:0x3
v_add_u32_dpp v216, v242, v235 row_newbcast:3 row_mask:0xf bank_mask:0xc
v_mov_b32_dpp v242, v242 row_ror:12 row_mask:0xf bank_mask:0xf
v_add_u32_dpp v209, v243, v234 row_newbcast:0 row_mask:0xf bank_mask:0x3
v_add_u32_dpp v209, v243, v234 row_newbcast:1 row_mask:0xf bank_mask:0xc
v_add_u32_dpp v217, v243, v235 row_newbcast:2 row_mask:0xf bank_mask:0x3
v_add_u32_dpp v217, v243, v235 row_newbcast:3 row_mask:0xf bank_mask:0xc
v_mov_b32_dpp v243, v243 row_ror:12 row_mask:0xf bank_mask:0xf
v_add_u32_dpp v210, v244, v234 row_newbcast:0 row_mask:0xf bank_mask:0x3
v_add_u32_dpp v210, v244, v234 row_newbcast:1 row_mask:0xf bank_mask:0xc
v_add_u32_dpp v218, v244, v235 row_newbcast:2 row_mask:0xf bank_mask:0x3
v_add_u32_dpp v218, v244, v235 row_newbcast:3 row_mask:0xf bank_mask:0xc
v_mov_b32_dpp v244, v244 row_ror:12 row_mask:0xf bank_mask:0xf
v_add_u32_dpp v211, v245, v234 row_newbcast:0 row_mask:0xf bank_mask:0x3
v_add_u32_dpp v211, v245, v234 row_newbcast:1 row_mask:0xf bank_mask:0xc
v_add_u32_dpp v219, v245, v235 row_newbcast:2 row_mask:0xf bank_mask:0x3
v_add_u32_dpp v219, v245, v235 row_newbcast:3 row_mask:0xf bank_mask:0xc
v_mov_b32_dpp v245, v245 row_ror:12 row_mask:0xf bank_mask:0xf
s_add_u32 m0, s53, 0
s_nop 0
buffer_load_dwordx4 v208, s[16:19], 0 offen offset:0 lds
buffer_load_dwordx4 v216, s[16:19], 0 offen offset:1024 lds
s_add_u32 m0, s53, 2048
s_nop 0
buffer_load_dwordx4 v209, s[16:19], 0 offen offset:0 lds
buffer_load_dwordx4 v217, s[16:19], 0 offen offset:1024 lds
s_add_u32 m0, s53, 4096
s_nop 0
buffer_load_dwordx4 v210, s[16:19], 0 offen offset:0 lds
buffer_load_dwordx4 v218, s[16:19], 0 offen offset:1024 lds
s_add_u32 m0, s53, 6144
s_nop 0
buffer_load_dwordx4 v211, s[16:19], 0 offen offset:0 lds
buffer_load_dwordx4 v219, s[16:19], 0 offen offset:1024 lds
s_add_u32 m0, s53, 8064
s_nop 0
buffer_load_dwordx4 v208, s[16:19], 0 offen offset:128 lds
buffer_load_dwordx4 v216, s[16:19], 0 offen offset:1152 lds
s_mov_b64 s[72:73], 0
s_sub_u32 s87, s42, 1
s_mov_b64 s[74:75], s[72:73]
v_cmp_eq_u32_e64 s[72:73], s87, v253
s_mov_b32 s3, s79
s_add_u32 s87, s87, 1
s_lshl_b32 s77, s87, 2
s_lshr_b32 s84, s87, 1
s_and_b32 s85, s87, 1
s_lshl_b32 s86, s45, 8
s_lshl_b32 s63, s36, 5
s_add_u32 s86, s86, s63
s_lshl_b32 s84, s84, 7
s_add_u32 s86, s86, s84
s_lshl_b32 s85, s85, 4
s_add_u32 s86, s86, s85
s_mul_i32 s79, s86, 384
s_branch L_sw_done
L_sw_v5:
v_max3_f32 v22, v160, v161, v162
v_max3_f32 v22, v22, v163, v164
v_max3_f32 v22, v22, v165, v166
v_max_f32 v22, v22, v167
v_mul_f32_e64 v22, -v22, s37
v_fma_f32 v160, v160, s37, v22
v_fma_f32 v161, v161, s37, v22
v_fma_f32 v162, v162, s37, v22
v_fma_f32 v163, v163, s37, v22
v_fma_f32 v164, v164, s37, v22
v_fma_f32 v165, v165, s37, v22
v_fma_f32 v166, v166, s37, v22
v_fma_f32 v167, v167, s37, v22
v_exp_f32 v160, v160
v_exp_f32 v161, v161
v_exp_f32 v162, v162
v_exp_f32 v163, v163
v_exp_f32 v164, v164
v_exp_f32 v165, v165
v_exp_f32 v166, v166
v_exp_f32 v167, v167
s_nop 0
v_add_f32 v23, v160, v161
v_add_f32 v23, v23, v162
v_add_f32 v23, v23, v163
v_add_f32 v23, v23, v164
v_add_f32 v23, v23, v165
v_add_f32 v23, v23, v166
v_add_f32 v23, v23, v167
v_rcp_f32 v23, v23
s_nop 0
v_mul_f32 v23, s50, v23
v_mul_f32 v160, v160, v23
v_mul_f32 v161, v161, v23
v_mul_f32 v162, v162, v23
v_mul_f32 v163, v163, v23
v_mul_f32 v164, v164, v23
v_mul_f32 v165, v165, v23
v_mul_f32 v166, v166, v23
v_mul_f32 v167, v167, v23
v_cvt_pk_bf16_f32 v160, v160, v160
v_cvt_pk_bf16_f32 v161, v161, v161
v_cvt_pk_bf16_f32 v162, v162, v162
v_cvt_pk_bf16_f32 v163, v163, v163
v_cvt_pk_bf16_f32 v164, v164, v164
v_cvt_pk_bf16_f32 v165, v165, v165
v_cvt_pk_bf16_f32 v166, v166, v166
v_cvt_pk_bf16_f32 v167, v167, v167
v_lshrrev_b32 v22, 2, v1
v_lshrrev_b32 v23, 3, v22
v_lshlrev_b32 v23, 10, v23
v_and_b32 v24, 7, v22
v_lshl_add_u32 v23, v24, 7, v23
v_bfe_u32 v24, v1, 1, 1
v_lshl_add_u32 v23, v24, 3, v23
v_add_u32 v23, s53, v23
v_bfe_u32 v24, v22, 1, 2
v_lshlrev_b32 v24, 1, v24
v_and_b32 v25, 1, v1
v_or_b32 v24, v24, v25
v_xor_b32 v25, 0, v24
v_lshl_add_u32 v232, v25, 4, v23
v_xor_b32 v25, 2, v24
v_lshl_add_u32 v233, v25, 4, v23
v_xor_b32 v25, 4, v24
v_lshl_add_u32 v234, v25, 4, v23
v_xor_b32 v25, 6, v24
v_lshl_add_u32 v235, v25, 4, v23
v_mov_b32 v22, 0xffff
v_mov_b32 v23, 0xffff0000
v_cndmask_b32_e64 v240, 0, v22, s[64:65]
v_cndmask_b32_e64 v240, v240, v23, s[66:67]
v_cndmask_b32_e64 v241, 0, v22, s[68:69]
v_cndmask_b32_e64 v241, v241, v23, s[70:71]
s_mov_b32 s87, 0
v_bfe_u32 v236, v1, 4, 2
v_lshlrev_b32 v236, 1, v236
v_and_b32 v237, 7, v1
v_xor_b32 v236, v236, v237
v_lshlrev_b32 v239, 4, v236
v_add_u32 v236, 3072, v239
v_add_u32 v237, 2048, v239
v_add_u32 v238, 1024, v239
v_mov_b32_dpp v242, v242 row_ror:4 row_mask:0xf bank_mask:0xf
v_mov_b32_dpp v243, v243 row_ror:4 row_mask:0xf bank_mask:0xf
v_mov_b32_dpp v244, v244 row_ror:4 row_mask:0xf bank_mask:0xf
v_mov_b32_dpp v245, v245 row_ror:4 row_mask:0xf bank_mask:0xf
s_nop 1
v_add_u32_dpp v208, v242, v236 row_newbcast:0 row_mask:0xf bank_mask:0x3
v_add_u32_dpp v208, v242, v236 row_newbcast:1 row_mask:0xf bank_mask:0xc
v_add_u32_dpp v216, v242, v237 row_newbcast:2 row_mask:0xf bank_mask:0x3
v_add_u32_dpp v216, v242, v237 row_newbcast:3 row_mask:0xf bank_mask:0xc
v_mov_b32_dpp v242, v242 row_ror:12 row_mask:0xf bank_mask:0xf
v_add_u32_dpp v209, v243, v238 row_newbcast:0 row_mask:0xf bank_mask:0x3
v_add_u32_dpp v209, v243, v238 row_newbcast:1 row_mask:0xf bank_mask:0xc
v_add_u32_dpp v217, v243, v239 row_newbcast:2 row_mask:0xf bank_mask:0x3
v_add_u32_dpp v217, v243, v239 row_newbcast:3 row_mask:0xf bank_mask:0xc
v_mov_b32_dpp v243, v243 row_ror:12 row_mask:0xf bank_mask:0xf
v_add_u32_dpp v210, v244, v236 row_newbcast:0 row_mask:0xf bank_mask:0x3
v_add_u32_dpp v210, v244, v236 row_newbcast:1 row_mask:0xf bank_mask:0xc
v_add_u32_dpp v218, v244, v237 row_newbcast:2 row_mask:0xf bank_mask:0x3
v_add_u32_dpp v218, v244, v237 row_newbcast:3 row_mask:0xf bank_mask:0xc
v_mov_b32_dpp v244, v244 row_ror:12 row_mask:0xf bank_mask:0xf
v_add_u32_dpp v211, v245, v238 row_newbcast:0 row_mask:0xf bank_mask:0x3
v_add_u32_dpp v211, v245, v238 row_newbcast:1 row_mask:0xf bank_mask:0xc
v_add_u32_dpp v219, v245, v239 row_newbcast:2 row_mask:0xf bank_mask:0x3
v_add_u32_dpp v219, v245, v239 row_newbcast:3 row_mask:0xf bank_mask:0xc
v_mov_b32_dpp v245, v245 row_ror:12 row_mask:0xf bank_mask:0xf
v_add_u32_dpp v212, v246, v236 row_newbcast:0 row_mask:0xf bank_mask:0x3
v_add_u32_dpp v212, v246, v236 row_newbcast:1 row_mask:0xf bank_mask:0xc
v_add_u32_dpp v220, v246, v237 row_newbcast:2 row_mask:0xf bank_mask:0x3
v_add_u32_dpp v220, v246, v237 row_newbcast:3 row_mask:0xf bank_mask:0xc
v_mov_b32_dpp v246, v246 row_ror:12 row_mask:0xf bank_mask:0xf
v_add_u32_dpp v213, v247, v238 row_newbcast:0 row_mask:0xf bank_mask:0x3
v_add_u32_dpp v213, v247, v238 row_newbcast:1 row_mask:0xf bank_mask:0xc
v_add_u32_dpp v221, v247, v239 row_newbcast:2 row_mask:0xf bank_mask:0x3
v_add_u32_dpp v221, v247, v239 row_newbcast:3 row_mask:0xf bank_mask:0xc
v_mov_b32_dpp v247, v247 row_ror:12 row_mask:0xf bank_mask:0xf
v_add_u32_dpp v214, v248, v236 row_newbcast:0 row_mask:0xf bank_mask:0x3
v_add_u32_dpp v214, v248, v236 row_newbcast:1 row_mask:0xf bank_mask:0xc
v_add_u32_dpp v222, v248, v237 row_newbcast:2 row_mask:0xf bank_mask:0x3
v_add_u32_dpp v222, v248, v237 row_newbcast:3 row_mask:0xf bank_mask:0xc
v_mov_b32_dpp v248, v248 row_ror:12 row_mask:0xf bank_mask:0xf
v_add_u32_dpp v215, v249, v238 row_newbcast:0 row_mask:0xf bank_mask:0x3
v_add_u32_dpp v215, v249, v238 row_newbcast:1 row_mask:0xf bank_mask:0xc
v_add_u32_dpp v223, v249, v239 row_newbcast:2 row_mask:0xf bank_mask:0x3
v_add_u32_dpp v223, v249, v239 row_newbcast:3 row_mask:0xf bank_mask:0xc
v_mov_b32_dpp v249, v249 row_ror:12 row_mask:0xf bank_mask:0xf
s_add_u32 m0, s53, 12288
s_nop 0
buffer_load_dwordx4 v208, s[20:23], 0 offen offset:0 lds
buffer_load_dwordx4 v216, s[20:23], 0 offen offset:1024 lds
buffer_load_dwordx4 v209, s[20:23], 0 offen offset:2048 lds
buffer_load_dwordx4 v217, s[20:23], 0 offen offset:3072 lds
s_add_u32 m0, s53, 0
s_nop 0
buffer_load_dwordx4 v210, s[20:23], 0 offen offset:0 lds
buffer_load_dwordx4 v218, s[20:23], 0 offen offset:1024 lds
buffer_load_dwordx4 v211, s[20:23], 0 offen offset:2048 lds
buffer_load_dwordx4 v219, s[20:23], 0 offen offset:3072 lds
s_add_u32 m0, s53, 4096
s_nop 0
buffer_load_dwordx4 v212, s[20:23], 0 offen offset:0 lds
buffer_load_dwordx4 v220, s[20:23], 0 offen offset:1024 lds
buffer_load_dwordx4 v213, s[20:23], 0 offen offset:2048 lds
buffer_load_dwordx4 v221, s[20:23], 0 offen offset:3072 lds
s_lshl_b32 s77, s87, 2
s_lshr_b32 s84, s87, 1
s_and_b32 s85, s87, 1
s_lshl_b32 s86, s45, 8
s_lshl_b32 s63, s36, 5
s_add_u32 s86, s86, s63
s_lshl_b32 s84, s84, 7
s_add_u32 s86, s86, s84
s_lshl_b32 s85, s85, 4
s_add_u32 s86, s86, s85
s_mul_i32 s79, s86, 384
s_lshr_b32 s63, s77, 2
v_cmp_eq_u32_e64 s[72:73], s63, v253
s_nop 1
v_cndmask_b32_e64 v250, 0, v240, s[72:73]
v_cndmask_b32_e64 v251, 0, v241, s[72:73]
v_and_b32 v192, v160, v250
v_and_b32 v193, v160, v251
v_and_b32 v194, v161, v250
v_and_b32 v195, v161, v251
v_and_b32 v196, v162, v250
v_and_b32 v197, v162, v251
v_and_b32 v198, v163, v250
v_and_b32 v199, v163, v251
v_and_b32 v200, v164, v250
v_and_b32 v201, v164, v251
v_and_b32 v202, v165, v250
v_and_b32 v203, v165, v251
s_add_u32 s75, s47, 18432
s_mov_b32 s87, 0
s_add_u32 s74, s75, 4096
s_mul_i32 s75, s87, 6144
s_add_u32 s75, s75, s47
s_add_u32 s87, s87, 1
s_lshl_b32 s77, s87, 2
s_lshr_b32 s84, s87, 1
s_and_b32 s85, s87, 1
s_lshl_b32 s86, s45, 8
s_lshl_b32 s63, s36, 5
s_add_u32 s86, s86, s63
s_lshl_b32 s84, s84, 7
s_add_u32 s86, s86, s84
s_lshl_b32 s85, s85, 4
s_add_u32 s86, s86, s85
s_mul_i32 s79, s86, 384
s_branch L_sw_done
L_sw_v7:
s_mov_b32 s87, 2
v_bfe_u32 v236, v1, 4, 2
v_lshlrev_b32 v236, 1, v236
v_and_b32 v237, 7, v1
v_xor_b32 v236, v236, v237
v_lshlrev_b32 v239, 4, v236
v_add_u32 v236, 3072, v239
v_add_u32 v237, 2048, v239
v_add_u32 v238, 1024, v239
v_mov_b32_dpp v242, v242 row_ror:4 row_mask:0xf bank_mask:0xf
v_mov_b32_dpp v243, v243 row_ror:4 row_mask:0xf bank_mask:0xf
v_mov_b32_dpp v244, v244 row_ror:4 row_mask:0xf bank_mask:0xf
v_mov_b32_dpp v245, v245 row_ror:4 row_mask:0xf bank_mask:0xf
s_nop 1
v_add_u32_dpp v208, v242, v236 row_newbcast:0 row_mask:0xf bank_mask:0x3
v_add_u32_dpp v208, v242, v236 row_newbcast:1 row_mask:0xf bank_mask:0xc
v_add_u32_dpp v216, v242, v237 row_newbcast:2 row_mask:0xf bank_mask:0x3
v_add_u32_dpp v216, v242, v237 row_newbcast:3 row_mask:0xf bank_mask:0xc
v_mov_b32_dpp v242, v242 row_ror:12 row_mask:0xf bank_mask:0xf
v_add_u32_dpp v209, v243, v238 row_newbcast:0 row_mask:0xf bank_mask:0x3
v_add_u32_dpp v209, v243, v238 row_newbcast:1 row_mask:0xf bank_mask:0xc
v_add_u32_dpp v217, v243, v239 row_newbcast:2 row_mask:0xf bank_mask:0x3
v_add_u32_dpp v217, v243, v239 row_newbcast:3 row_mask:0xf bank_mask:0xc
v_mov_b32_dpp v243, v243 row_ror:12 row_mask:0xf bank_mask:0xf
v_add_u32_dpp v210, v244, v236 row_newbcast:0 row_mask:0xf bank_mask:0x3
v_add_u32_dpp v210, v244, v236 row_newbcast:1 row_mask:0xf bank_mask:0xc
v_add_u32_dpp v218, v244, v237 row_newbcast:2 row_mask:0xf bank_mask:0x3
v_add_u32_dpp v218, v244, v237 row_newbcast:3 row_mask:0xf bank_mask:0xc
v_mov_b32_dpp v244, v244 row_ror:12 row_mask:0xf bank_mask:0xf
v_add_u32_dpp v211, v245, v238 row_newbcast:0 row_mask:0xf bank_mask:0x3
v_add_u32_dpp v211, v245, v238 row_newbcast:1 row_mask:0xf bank_mask:0xc
v_add_u32_dpp v219, v245, v239 row_newbcast:2 row_mask:0xf bank_mask:0x3
v_add_u32_dpp v219, v245, v239 row_newbcast:3 row_mask:0xf bank_mask:0xc
v_mov_b32_dpp v245, v245 row_ror:12 row_mask:0xf bank_mask:0xf
v_add_u32_dpp v212, v246, v236 row_newbcast:0 row_mask:0xf bank_mask:0x3
v_add_u32_dpp v212, v246, v236 row_newbcast:1 row_mask:0xf bank_mask:0xc
v_add_u32_dpp v220, v246, v237 row_newbcast:2 row_mask:0xf bank_mask:0x3
v_add_u32_dpp v220, v246, v237 row_newbcast:3 row_mask:0xf bank_mask:0xc
v_mov_b32_dpp v246, v246 row_ror:12 row_mask:0xf bank_mask:0xf
v_add_u32_dpp v213, v247, v238 row_newbcast:0 row_mask:0xf bank_mask:0x3
v_add_u32_dpp v213, v247, v238 row_newbcast:1 row_mask:0xf bank_mask:0xc
v_add_u32_dpp v221, v247, v239 row_newbcast:2 row_mask:0xf bank_mask:0x3
v_add_u32_dpp v221, v247, v239 row_newbcast:3 row_mask:0xf bank_mask:0xc
v_mov_b32_dpp v247, v247 row_ror:12 row_mask:0xf bank_mask:0xf
v_add_u32_dpp v214, v248, v236 row_newbcast:0 row_mask:0xf bank_mask:0x3
v_add_u32_dpp v214, v248, v236 row_newbcast:1 row_mask:0xf bank_mask:0xc
v_add_u32_dpp v222, v248, v237 row_newbcast:2 row_mask:0xf bank_mask:0x3
v_add_u32_dpp v222, v248, v237 row_newbcast:3 row_mask:0xf bank_mask:0xc
v_mov_b32_dpp v248, v248 row_ror:12 row_mask:0xf bank_mask:0xf
v_add_u32_dpp v215, v249, v238 row_newbcast:0 row_mask:0xf bank_mask:0x3
v_add_u32_dpp v215, v249, v238 row_newbcast:1 row_mask:0xf bank_mask:0xc
v_add_u32_dpp v223, v249, v239 row_newbcast:2 row_mask:0xf bank_mask:0x3
v_add_u32_dpp v223, v249, v239 row_newbcast:3 row_mask:0xf bank_mask:0xc
v_mov_b32_dpp v249, v249 row_ror:12 row_mask:0xf bank_mask:0xf
s_add_u32 m0, s53, 12288
s_nop 0
buffer_load_dwordx4 v208, s[20:23], 0 offen offset:0 lds
buffer_load_dwordx4 v216, s[20:23], 0 offen offset:1024 lds
buffer_load_dwordx4 v209, s[20:23], 0 offen offset:2048 lds
buffer_load_dwordx4 v217, s[20:23], 0 offen offset:3072 lds
s_add_u32 m0, s53, 0
s_nop 0
buffer_load_dwordx4 v210, s[20:23], 0 offen offset:0 lds
buffer_load_dwordx4 v218, s[20:23], 0 offen offset:1024 lds
buffer_load_dwordx4 v211, s[20:23], 0 offen offset:2048 lds
buffer_load_dwordx4 v219, s[20:23], 0 offen offset:3072 lds
s_add_u32 m0, s53, 4096
s_nop 0
buffer_load_dwordx4 v212, s[20:23], 0 offen offset:0 lds
buffer_load_dwordx4 v220, s[20:23], 0 offen offset:1024 lds
buffer_load_dwordx4 v213, s[20:23], 0 offen offset:2048 lds
buffer_load_dwordx4 v221, s[20:23], 0 offen offset:3072 lds
s_lshl_b32 s77, s87, 2
s_lshr_b32 s84, s87, 1
s_and_b32 s85, s87, 1
s_lshl_b32 s86, s45, 8
s_lshl_b32 s63, s36, 5
s_add_u32 s86, s86, s63
s_lshl_b32 s84, s84, 7
s_add_u32 s86, s86, s84
s_lshl_b32 s85, s85, 4
s_add_u32 s86, s86, s85
s_mul_i32 s79, s86, 384
s_lshr_b32 s63, s77, 2
v_cmp_eq_u32_e64 s[72:73], s63, v253
s_nop 1
v_cndmask_b32_e64 v250, 0, v240, s[72:73]
v_cndmask_b32_e64 v251, 0, v241, s[72:73]
v_and_b32 v192, v160, v250
v_and_b32 v193, v160, v251
v_and_b32 v194, v161, v250
v_and_b32 v195, v161, v251
v_and_b32 v196, v162, v250
v_and_b32 v197, v162, v251
v_and_b32 v198, v163, v250
v_and_b32 v199, v163, v251
v_and_b32 v200, v164, v250
v_and_b32 v201, v164, v251
v_and_b32 v202, v165, v250
v_and_b32 v203, v165, v251
s_add_u32 s75, s47, 18432
s_mov_b32 s87, 2
s_add_u32 s74, s75, 4096
s_mul_i32 s75, s87, 6144
s_add_u32 s75, s75, s47
s_add_u32 s87, s87, 1
s_lshl_b32 s77, s87, 2
s_lshr_b32 s84, s87, 1
s_and_b32 s85, s87, 1
s_lshl_b32 s86, s45, 8
s_lshl_b32 s63, s36, 5
s_add_u32 s86, s86, s63
s_lshl_b32 s84, s84, 7
s_add_u32 s86, s86, s84
s_lshl_b32 s85, s85, 4
s_add_u32 s86, s86, s85
s_mul_i32 s79, s86, 384
L_sw_done:
s_branch L_js
Lst_p0N_X:
s_call_b64 s[60:61], Lrare_X0_112
s_branch Lct_p0N_X
Lst_p0N_Y:
s_call_b64 s[60:61], Lrare_Y0_128
s_branch Lct_p0N_Y
Lst_p1N_X:
s_call_b64 s[60:61], Lrare_X1_120
s_branch Lct_p1N_X
Lst_p1N_Y:
s_call_b64 s[60:61], Lrare_Y1_128
s_branch Lct_p1N_Y
Lst_p2N_X:
s_call_b64 s[60:61], Lrare_X0_112
s_branch Lct_p2N_X
Lst_p2N_Y:
s_call_b64 s[60:61], Lrare_Y0_128
s_branch Lct_p2N_Y
Lst_p3N_X:
s_call_b64 s[60:61], Lrare_X1_120
s_branch Lct_p3N_X
Lst_p3N_Y:
s_call_b64 s[60:61], Lrare_Y1_128
s_branch Lct_p3N_Y
Lst_p0K_X:
s_call_b64 s[60:61], Lrare_X0_112
s_branch Lct_p0K_X
Lst_p0K_Y:
s_call_b64 s[60:61], Lrare_Y0_128
s_branch Lct_p0K_Y
Lst_p1K_X:
s_call_b64 s[60:61], Lrare_X1_120
s_branch Lct_p1K_X
Lst_p1K_Y:
s_call_b64 s[60:61], Lrare_Y1_128
s_branch Lct_p1K_Y
Lst_p2K_X:
s_call_b64 s[60:61], Lrare_X0_112
s_branch Lct_p2K_X
Lst_p2K_Y:
s_call_b64 s[60:61], Lrare_Y0_128
s_branch Lct_p2K_Y
Lst_p3K_X:
s_call_b64 s[60:61], Lrare_X1_120
s_branch Lct_p3K_X
Lst_p3K_Y:
s_call_b64 s[60:61], Lrare_Y1_128
s_branch Lct_p3K_Y
Lst_p0V_X:
s_call_b64 s[60:61], Lrare_X0_112
s_branch Lct_p0V_X
Lst_p0V_Y:
s_call_b64 s[60:61], Lrare_Y0_128
s_branch Lct_p0V_Y
Lst_p1V_X:
s_call_b64 s[60:61], Lrare_X1_120
s_branch Lct_p1V_X
Lst_p1V_Y:
s_call_b64 s[60:61], Lrare_Y1_128
s_branch Lct_p1V_Y
Lst_p2V_X:
s_call_b64 s[60:61], Lrare_X0_112
s_branch Lct_p2V_X
Lst_p2V_Y:
s_call_b64 s[60:61], Lrare_Y0_128
s_branch Lct_p2V_Y
Lst_p3V_X:
s_call_b64 s[60:61], Lrare_X1_120
s_branch Lct_p3V_X
Lst_p3V_Y:
s_call_b64 s[60:61], Lrare_Y1_128
s_branch Lct_p3V_Y
Lst_p3Kl_X:
s_call_b64 s[60:61], Lrare_X1_120
s_branch Lct_p3Kl_X
Lst_p3Kl_Y:
s_call_b64 s[60:61], Lrare_Y1_128
s_branch Lct_p3Kl_Y
Lst_d0_X:
s_call_b64 s[60:61], Lrare_X0_112
s_branch Lct_d0_X
Lst_d0_Y:
s_call_b64 s[60:61], Lrare_Y0_128
s_branch Lct_d0_Y
Lst_d1_X:
s_call_b64 s[60:61], Lrare_X1_120
s_branch Lct_d1_X
Lst_d1_Y:
s_call_b64 s[60:61], Lrare_Y1_128
s_branch Lct_d1_Y
Lst_d2_X:
s_call_b64 s[60:61], Lrare_X0_112
s_branch Lct_d2_X
Lst_d2_Y:
s_call_b64 s[60:61], Lrare_Y0_128
s_branch Lct_d2_Y
Lst_d3_X:
s_call_b64 s[60:61], Lrare_X1_120
s_branch Lct_d3_X
Lst_d3_Y:
s_call_b64 s[60:61], Lrare_Y1_128
s_branch Lct_d3_Y
Lst_d4_Y:
s_call_b64 s[60:61], Lrare_Y0_112
s_branch Lct_d4_Y
Lst_d5_Y:
s_call_b64 s[60:61], Lrare_Y1_120
s_branch Lct_d5_Y
Lst_d6_Y:
s_call_b64 s[60:61], Lrare_Y0_112
s_branch Lct_d6_Y
Lst_d7_Y:
s_call_b64 s[60:61], Lrare_Y1_120
s_branch Lct_d7_Y
Lst_t3N_X:
s_call_b64 s[60:61], Lrare_X1_120
s_branch Lct_t3N_X
Lst_t3N_Y:
s_call_b64 s[60:61], Lrare_Y1_80
s_branch Lct_t3N_Y
Lst_t3K_X:
s_call_b64 s[60:61], Lrare_X1_120
s_branch Lct_t3K_X
Lst_t3K_Y:
s_call_b64 s[60:61], Lrare_Y1_80
s_branch Lct_t3K_Y
Lst_t3V_X:
s_call_b64 s[60:61], Lrare_X1_120
s_branch Lct_t3V_X
Lst_t3V_Y:
s_call_b64 s[60:61], Lrare_Y1_80
s_branch Lct_t3V_Y
Lrare_X0_112:
s_nop 15
v_max3_f32 v28, v64, v65, v66
v_max3_f32 v28, v28, v67, v68
v_max3_f32 v28, v28, v69, v70
v_max3_f32 v28, v28, v71, v72
v_max3_f32 v28, v28, v73, v74
v_max3_f32 v28, v28, v75, v76
v_max3_f32 v28, v28, v77, v78
v_max_f32 v28, v28, v79
v_mov_b32 v29, v28
s_nop 1
v_permlane32_swap_b32 v28, v29
s_nop 0
v_max_f32 v28, v28, v29
v_mul_f32_e64 v28, -v28, s37
v_min_f32 v28, v28, v14
v_sub_f32 v31, v28, v14
v_exp_f32 v31, v31
v_mov_b32 v14, v28
v_mul_f32 v16, v16, v31
v_accvgpr_read_b32 v22, a0
v_accvgpr_read_b32 v23, a1
v_accvgpr_read_b32 v24, a2
v_accvgpr_read_b32 v25, a3
v_mul_f32 v22, v22, v31
v_mul_f32 v23, v23, v31
v_mul_f32 v24, v24, v31
v_mul_f32 v25, v25, v31
v_accvgpr_write_b32 a0, v22
v_accvgpr_write_b32 a1, v23
v_accvgpr_write_b32 a2, v24
v_accvgpr_write_b32 a3, v25
v_accvgpr_read_b32 v22, a4
v_accvgpr_read_b32 v23, a5
v_accvgpr_read_b32 v24, a6
v_accvgpr_read_b32 v25, a7
v_mul_f32 v22, v22, v31
v_mul_f32 v23, v23, v31
v_mul_f32 v24, v24, v31
v_mul_f32 v25, v25, v31
v_accvgpr_write_b32 a4, v22
v_accvgpr_write_b32 a5, v23
v_accvgpr_write_b32 a6, v24
v_accvgpr_write_b32 a7, v25
v_accvgpr_read_b32 v22, a8
v_accvgpr_read_b32 v23, a9
v_accvgpr_read_b32 v24, a10
v_accvgpr_read_b32 v25, a11
v_mul_f32 v22, v22, v31
v_mul_f32 v23, v23, v31
v_mul_f32 v24, v24, v31
v_mul_f32 v25, v25, v31
v_accvgpr_write_b32 a8, v22
v_accvgpr_write_b32 a9, v23
v_accvgpr_write_b32 a10, v24
v_accvgpr_write_b32 a11, v25
v_accvgpr_read_b32 v22, a12
v_accvgpr_read_b32 v23, a13
v_accvgpr_read_b32 v24, a14
v_accvgpr_read_b32 v25, a15
v_mul_f32 v22, v22, v31
v_mul_f32 v23, v23, v31
v_mul_f32 v24, v24, v31
v_mul_f32 v25, v25, v31
v_accvgpr_write_b32 a12, v22
v_accvgpr_write_b32 a13, v23
v_accvgpr_write_b32 a14, v24
v_accvgpr_write_b32 a15, v25
v_accvgpr_read_b32 v22, a16
v_accvgpr_read_b32 v23, a17
v_accvgpr_read_b32 v24, a18
v_accvgpr_read_b32 v25, a19
v_mul_f32 v22, v22, v31
v_mul_f32 v23, v23, v31
v_mul_f32 v24, v24, v31
v_mul_f32 v25, v25, v31
v_accvgpr_write_b32 a16, v22
v_accvgpr_write_b32 a17, v23
v_accvgpr_write_b32 a18, v24
v_accvgpr_write_b32 a19, v25
v_accvgpr_read_b32 v22, a20
v_accvgpr_read_b32 v23, a21
v_accvgpr_read_b32 v24, a22
v_accvgpr_read_b32 v25, a23
v_mul_f32 v22, v22, v31
v_mul_f32 v23, v23, v31
v_mul_f32 v24, v24, v31
v_mul_f32 v25, v25, v31
v_accvgpr_write_b32 a20, v22
v_accvgpr_write_b32 a21, v23
v_accvgpr_write_b32 a22, v24
v_accvgpr_write_b32 a23, v25
v_accvgpr_read_b32 v22, a24
v_accvgpr_read_b32 v23, a25
v_accvgpr_read_b32 v24, a26
v_accvgpr_read_b32 v25, a27
v_mul_f32 v22, v22, v31
v_mul_f32 v23, v23, v31
v_mul_f32 v24, v24, v31
v_mul_f32 v25, v25, v31
v_accvgpr_write_b32 a24, v22
v_accvgpr_write_b32 a25, v23
v_accvgpr_write_b32 a26, v24
v_accvgpr_write_b32 a27, v25
v_accvgpr_read_b32 v22, a28
v_accvgpr_read_b32 v23, a29
v_accvgpr_read_b32 v24, a30
v_accvgpr_read_b32 v25, a31
v_mul_f32 v22, v22, v31
v_mul_f32 v23, v23, v31
v_mul_f32 v24, v24, v31
v_mul_f32 v25, v25, v31
v_accvgpr_write_b32 a28, v22
v_accvgpr_write_b32 a29, v23
v_accvgpr_write_b32 a30, v24
v_accvgpr_write_b32 a31, v25
v_accvgpr_read_b32 v22, a32
v_accvgpr_read_b32 v23, a33
v_accvgpr_read_b32 v24, a34
v_accvgpr_read_b32 v25, a35
v_mul_f32 v22, v22, v31
v_mul_f32 v23, v23, v31
v_mul_f32 v24, v24, v31
v_mul_f32 v25, v25, v31
v_accvgpr_write_b32 a32, v22
v_accvgpr_write_b32 a33, v23
v_accvgpr_write_b32 a34, v24
v_accvgpr_write_b32 a35, v25
v_accvgpr_read_b32 v22, a36
v_accvgpr_read_b32 v23, a37
v_accvgpr_read_b32 v24, a38
v_accvgpr_read_b32 v25, a39
v_mul_f32 v22, v22, v31
v_mul_f32 v23, v23, v31
v_mul_f32 v24, v24, v31
v_mul_f32 v25, v25, v31
v_accvgpr_write_b32 a36, v22
v_accvgpr_write_b32 a37, v23
v_accvgpr_write_b32 a38, v24
v_accvgpr_write_b32 a39, v25
v_accvgpr_read_b32 v22, a40
v_accvgpr_read_b32 v23, a41
v_accvgpr_read_b32 v24, a42
v_accvgpr_read_b32 v25, a43
v_mul_f32 v22, v22, v31
v_mul_f32 v23, v23, v31
v_mul_f32 v24, v24, v31
v_mul_f32 v25, v25, v31
v_accvgpr_write_b32 a40, v22
v_accvgpr_write_b32 a41, v23
v_accvgpr_write_b32 a42, v24
v_accvgpr_write_b32 a43, v25
v_accvgpr_read_b32 v22, a44
v_accvgpr_read_b32 v23, a45
v_accvgpr_read_b32 v24, a46
v_accvgpr_read_b32 v25, a47
v_mul_f32 v22, v22, v31
v_mul_f32 v23, v23, v31
v_mul_f32 v24, v24, v31
v_mul_f32 v25, v25, v31
v_accvgpr_write_b32 a44, v22
v_accvgpr_write_b32 a45, v23
v_accvgpr_write_b32 a46, v24
v_accvgpr_write_b32 a47, v25
v_accvgpr_read_b32 v22, a48
v_accvgpr_read_b32 v23, a49
v_accvgpr_read_b32 v24, a50
v_accvgpr_read_b32 v25, a51
v_mul_f32 v22, v22, v31
v_mul_f32 v23, v23, v31
v_mul_f32 v24, v24, v31
v_mul_f32 v25, v25, v31
v_accvgpr_write_b32 a48, v22
v_accvgpr_write_b32 a49, v23
v_accvgpr_write_b32 a50, v24
v_accvgpr_write_b32 a51, v25
v_accvgpr_read_b32 v22, a52
v_accvgpr_read_b32 v23, a53
v_accvgpr_read_b32 v24, a54
v_accvgpr_read_b32 v25, a55
v_mul_f32 v22, v22, v31
v_mul_f32 v23, v23, v31
v_mul_f32 v24, v24, v31
v_mul_f32 v25, v25, v31
v_accvgpr_write_b32 a52, v22
v_accvgpr_write_b32 a53, v23
v_accvgpr_write_b32 a54, v24
v_accvgpr_write_b32 a55, v25
v_accvgpr_read_b32 v22, a56
v_accvgpr_read_b32 v23, a57
v_accvgpr_read_b32 v24, a58
v_accvgpr_read_b32 v25, a59
v_mul_f32 v22, v22, v31
v_mul_f32 v23, v23, v31
v_mul_f32 v24, v24, v31
v_mul_f32 v25, v25, v31
v_accvgpr_write_b32 a56, v22
v_accvgpr_write_b32 a57, v23
v_accvgpr_write_b32 a58, v24
v_accvgpr_write_b32 a59, v25
v_accvgpr_read_b32 v22, a60
v_accvgpr_read_b32 v23, a61
v_accvgpr_read_b32 v24, a62
v_accvgpr_read_b32 v25, a63
v_mul_f32 v22, v22, v31
v_mul_f32 v23, v23, v31
v_mul_f32 v24, v24, v31
v_mul_f32 v25, v25, v31
v_accvgpr_write_b32 a60, v22
v_accvgpr_write_b32 a61, v23
v_accvgpr_write_b32 a62, v24
v_accvgpr_write_b32 a63, v25
v_accvgpr_read_b32 v22, a64
v_accvgpr_read_b32 v23, a65
v_accvgpr_read_b32 v24, a66
v_accvgpr_read_b32 v25, a67
v_mul_f32 v22, v22, v31
v_mul_f32 v23, v23, v31
v_mul_f32 v24, v24, v31
v_mul_f32 v25, v25, v31
v_accvgpr_write_b32 a64, v22
v_accvgpr_write_b32 a65, v23
v_accvgpr_write_b32 a66, v24
v_accvgpr_write_b32 a67, v25
v_accvgpr_read_b32 v22, a68
v_accvgpr_read_b32 v23, a69
v_accvgpr_read_b32 v24, a70
v_accvgpr_read_b32 v25, a71
v_mul_f32 v22, v22, v31
v_mul_f32 v23, v23, v31
v_mul_f32 v24, v24, v31
v_mul_f32 v25, v25, v31
v_accvgpr_write_b32 a68, v22
v_accvgpr_write_b32 a69, v23
v_accvgpr_write_b32 a70, v24
v_accvgpr_write_b32 a71, v25
v_accvgpr_read_b32 v22, a72
v_accvgpr_read_b32 v23, a73
v_accvgpr_read_b32 v24, a74
v_accvgpr_read_b32 v25, a75
v_mul_f32 v22, v22, v31
v_mul_f32 v23, v23, v31
v_mul_f32 v24, v24, v31
v_mul_f32 v25, v25, v31
v_accvgpr_write_b32 a72, v22
v_accvgpr_write_b32 a73, v23
v_accvgpr_write_b32 a74, v24
v_accvgpr_write_b32 a75, v25
v_accvgpr_read_b32 v22, a76
v_accvgpr_read_b32 v23, a77
v_accvgpr_read_b32 v24, a78
v_accvgpr_read_b32 v25, a79
v_mul_f32 v22, v22, v31
v_mul_f32 v23, v23, v31
v_mul_f32 v24, v24, v31
v_mul_f32 v25, v25, v31
v_accvgpr_write_b32 a76, v22
v_accvgpr_write_b32 a77, v23
v_accvgpr_write_b32 a78, v24
v_accvgpr_write_b32 a79, v25
v_accvgpr_read_b32 v22, a80
v_accvgpr_read_b32 v23, a81
v_accvgpr_read_b32 v24, a82
v_accvgpr_read_b32 v25, a83
v_mul_f32 v22, v22, v31
v_mul_f32 v23, v23, v31
v_mul_f32 v24, v24, v31
v_mul_f32 v25, v25, v31
v_accvgpr_write_b32 a80, v22
v_accvgpr_write_b32 a81, v23
v_accvgpr_write_b32 a82, v24
v_accvgpr_write_b32 a83, v25
v_accvgpr_read_b32 v22, a84
v_accvgpr_read_b32 v23, a85
v_accvgpr_read_b32 v24, a86
v_accvgpr_read_b32 v25, a87
v_mul_f32 v22, v22, v31
v_mul_f32 v23, v23, v31
v_mul_f32 v24, v24, v31
v_mul_f32 v25, v25, v31
v_accvgpr_write_b32 a84, v22
v_accvgpr_write_b32 a85, v23
v_accvgpr_write_b32 a86, v24
v_accvgpr_write_b32 a87, v25
v_accvgpr_read_b32 v22, a88
v_accvgpr_read_b32 v23, a89
v_accvgpr_read_b32 v24, a90
v_accvgpr_read_b32 v25, a91
v_mul_f32 v22, v22, v31
v_mul_f32 v23, v23, v31
v_mul_f32 v24, v24, v31
v_mul_f32 v25, v25, v31
v_accvgpr_write_b32 a88, v22
v_accvgpr_write_b32 a89, v23
v_accvgpr_write_b32 a90, v24
v_accvgpr_write_b32 a91, v25
v_accvgpr_read_b32 v22, a92
v_accvgpr_read_b32 v23, a93
v_accvgpr_read_b32 v24, a94
v_accvgpr_read_b32 v25, a95
v_mul_f32 v22, v22, v31
v_mul_f32 v23, v23, v31
v_mul_f32 v24, v24, v31
v_mul_f32 v25, v25, v31
v_accvgpr_write_b32 a92, v22
v_accvgpr_write_b32 a93, v23
v_accvgpr_write_b32 a94, v24
v_accvgpr_write_b32 a95, v25
v_fma_f32 v22, v64, s37, v14
v_fma_f32 v23, v65, s37, v14
v_exp_f32 v22, v22
v_fma_f32 v24, v66, s37, v14
v_exp_f32 v23, v23
v_fma_f32 v25, v67, s37, v14
v_exp_f32 v24, v24
v_add_f32 v18, v22, v23
v_fma_f32 v26, v68, s37, v14
v_exp_f32 v25, v25
v_add_f32 v18, v18, v24
v_cvt_pk_bf16_f32 v112, v22, v23
v_fma_f32 v27, v69, s37, v14
v_exp_f32 v26, v26
v_add_f32 v18, v18, v25
v_fma_f32 v22, v70, s37, v14
v_exp_f32 v27, v27
v_add_f32 v18, v18, v26
v_cvt_pk_bf16_f32 v113, v24, v25
v_fma_f32 v23, v71, s37, v14
v_exp_f32 v22, v22
v_add_f32 v18, v18, v27
v_fma_f32 v24, v72, s37, v14
v_exp_f32 v23, v23
v_add_f32 v18, v18, v22
v_cvt_pk_bf16_f32 v114, v26, v27
v_fma_f32 v25, v73, s37, v14
v_exp_f32 v24, v24
v_add_f32 v18, v18, v23
v_fma_f32 v26, v74, s37, v14
v_exp_f32 v25, v25
v_add_f32 v18, v18, v24
v_cvt_pk_bf16_f32 v115, v22, v23
v_fma_f32 v27, v75, s37, v14
v_exp_f32 v26, v26
v_add_f32 v18, v18, v25
v_fma_f32 v22, v76, s37, v14
v_exp_f32 v27, v27
v_add_f32 v18, v18, v26
v_cvt_pk_bf16_f32 v116, v24, v25
v_fma_f32 v23, v77, s37, v14
v_exp_f32 v22, v22
v_add_f32 v18, v18, v27
v_fma_f32 v24, v78, s37, v14
v_exp_f32 v23, v23
v_add_f32 v18, v18, v22
v_cvt_pk_bf16_f32 v117, v26, v27
v_fma_f32 v25, v79, s37, v14
v_exp_f32 v24, v24
v_add_f32 v18, v18, v23
v_exp_f32 v25, v25
v_add_f32 v18, v18, v24
v_cvt_pk_bf16_f32 v118, v22, v23
v_add_f32 v18, v18, v25
v_cvt_pk_bf16_f32 v119, v24, v25
s_nop 1
s_setpc_b64 s[60:61]
Lrare_X1_120:
s_nop 15
v_max3_f32 v28, v64, v65, v66
v_max3_f32 v28, v28, v67, v68
v_max3_f32 v28, v28, v69, v70
v_max3_f32 v28, v28, v71, v72
v_max3_f32 v28, v28, v73, v74
v_max3_f32 v28, v28, v75, v76
v_max3_f32 v28, v28, v77, v78
v_max_f32 v28, v28, v79
v_mov_b32 v29, v28
s_nop 1
v_permlane32_swap_b32 v28, v29
s_nop 0
v_max_f32 v28, v28, v29
v_mul_f32_e64 v28, -v28, s37
v_min_f32 v28, v28, v14
v_sub_f32 v31, v28, v14
v_exp_f32 v31, v31
v_mov_b32 v14, v28
v_mul_f32 v16, v16, v31
v_accvgpr_read_b32 v22, a0
v_accvgpr_read_b32 v23, a1
v_accvgpr_read_b32 v24, a2
v_accvgpr_read_b32 v25, a3
v_mul_f32 v22, v22, v31
v_mul_f32 v23, v23, v31
v_mul_f32 v24, v24, v31
v_mul_f32 v25, v25, v31
v_accvgpr_write_b32 a0, v22
v_accvgpr_write_b32 a1, v23
v_accvgpr_write_b32 a2, v24
v_accvgpr_write_b32 a3, v25
v_accvgpr_read_b32 v22, a4
v_accvgpr_read_b32 v23, a5
v_accvgpr_read_b32 v24, a6
v_accvgpr_read_b32 v25, a7
v_mul_f32 v22, v22, v31
v_mul_f32 v23, v23, v31
v_mul_f32 v24, v24, v31
v_mul_f32 v25, v25, v31
v_accvgpr_write_b32 a4, v22
v_accvgpr_write_b32 a5, v23
v_accvgpr_write_b32 a6, v24
v_accvgpr_write_b32 a7, v25
v_accvgpr_read_b32 v22, a8
v_accvgpr_read_b32 v23, a9
v_accvgpr_read_b32 v24, a10
v_accvgpr_read_b32 v25, a11
v_mul_f32 v22, v22, v31
v_mul_f32 v23, v23, v31
v_mul_f32 v24, v24, v31
v_mul_f32 v25, v25, v31
v_accvgpr_write_b32 a8, v22
v_accvgpr_write_b32 a9, v23
v_accvgpr_write_b32 a10, v24
v_accvgpr_write_b32 a11, v25
v_accvgpr_read_b32 v22, a12
v_accvgpr_read_b32 v23, a13
v_accvgpr_read_b32 v24, a14
v_accvgpr_read_b32 v25, a15
v_mul_f32 v22, v22, v31
v_mul_f32 v23, v23, v31
v_mul_f32 v24, v24, v31
v_mul_f32 v25, v25, v31
v_accvgpr_write_b32 a12, v22
v_accvgpr_write_b32 a13, v23
v_accvgpr_write_b32 a14, v24
v_accvgpr_write_b32 a15, v25
v_accvgpr_read_b32 v22, a16
v_accvgpr_read_b32 v23, a17
v_accvgpr_read_b32 v24, a18
v_accvgpr_read_b32 v25, a19
v_mul_f32 v22, v22, v31
v_mul_f32 v23, v23, v31
v_mul_f32 v24, v24, v31
v_mul_f32 v25, v25, v31
v_accvgpr_write_b32 a16, v22
v_accvgpr_write_b32 a17, v23
v_accvgpr_write_b32 a18, v24
v_accvgpr_write_b32 a19, v25
v_accvgpr_read_b32 v22, a20
v_accvgpr_read_b32 v23, a21
v_accvgpr_read_b32 v24, a22
v_accvgpr_read_b32 v25, a23
v_mul_f32 v22, v22, v31
v_mul_f32 v23, v23, v31
v_mul_f32 v24, v24, v31
v_mul_f32 v25, v25, v31
v_accvgpr_write_b32 a20, v22
v_accvgpr_write_b32 a21, v23
v_accvgpr_write_b32 a22, v24
v_accvgpr_write_b32 a23, v25
v_accvgpr_read_b32 v22, a24
v_accvgpr_read_b32 v23, a25
v_accvgpr_read_b32 v24, a26
v_accvgpr_read_b32 v25, a27
v_mul_f32 v22, v22, v31
v_mul_f32 v23, v23, v31
v_mul_f32 v24, v24, v31
v_mul_f32 v25, v25, v31
v_accvgpr_write_b32 a24, v22
v_accvgpr_write_b32 a25, v23
v_accvgpr_write_b32 a26, v24
v_accvgpr_write_b32 a27, v25
v_accvgpr_read_b32 v22, a28
v_accvgpr_read_b32 v23, a29
v_accvgpr_read_b32 v24, a30
v_accvgpr_read_b32 v25, a31
v_mul_f32 v22, v22, v31
v_mul_f32 v23, v23, v31
v_mul_f32 v24, v24, v31
v_mul_f32 v25, v25, v31
v_accvgpr_write_b32 a28, v22
v_accvgpr_write_b32 a29, v23
v_accvgpr_write_b32 a30, v24
v_accvgpr_write_b32 a31, v25
v_accvgpr_read_b32 v22, a32
v_accvgpr_read_b32 v23, a33
v_accvgpr_read_b32 v24, a34
v_accvgpr_read_b32 v25, a35
v_mul_f32 v22, v22, v31
v_mul_f32 v23, v23, v31
v_mul_f32 v24, v24, v31
v_mul_f32 v25, v25, v31
v_accvgpr_write_b32 a32, v22
v_accvgpr_write_b32 a33, v23
v_accvgpr_write_b32 a34, v24
v_accvgpr_write_b32 a35, v25
v_accvgpr_read_b32 v22, a36
v_accvgpr_read_b32 v23, a37
v_accvgpr_read_b32 v24, a38
v_accvgpr_read_b32 v25, a39
v_mul_f32 v22, v22, v31
v_mul_f32 v23, v23, v31
v_mul_f32 v24, v24, v31
v_mul_f32 v25, v25, v31
v_accvgpr_write_b32 a36, v22
v_accvgpr_write_b32 a37, v23
v_accvgpr_write_b32 a38, v24
v_accvgpr_write_b32 a39, v25
v_accvgpr_read_b32 v22, a40
v_accvgpr_read_b32 v23, a41
v_accvgpr_read_b32 v24, a42
v_accvgpr_read_b32 v25, a43
v_mul_f32 v22, v22, v31
v_mul_f32 v23, v23, v31
v_mul_f32 v24, v24, v31
v_mul_f32 v25, v25, v31
v_accvgpr_write_b32 a40, v22
v_accvgpr_write_b32 a41, v23
v_accvgpr_write_b32 a42, v24
v_accvgpr_write_b32 a43, v25
v_accvgpr_read_b32 v22, a44
v_accvgpr_read_b32 v23, a45
v_accvgpr_read_b32 v24, a46
v_accvgpr_read_b32 v25, a47
v_mul_f32 v22, v22, v31
v_mul_f32 v23, v23, v31
v_mul_f32 v24, v24, v31
v_mul_f32 v25, v25, v31
v_accvgpr_write_b32 a44, v22
v_accvgpr_write_b32 a45, v23
v_accvgpr_write_b32 a46, v24
v_accvgpr_write_b32 a47, v25
v_accvgpr_read_b32 v22, a48
v_accvgpr_read_b32 v23, a49
v_accvgpr_read_b32 v24, a50
v_accvgpr_read_b32 v25, a51
v_mul_f32 v22, v22, v31
v_mul_f32 v23, v23, v31
v_mul_f32 v24, v24, v31
v_mul_f32 v25, v25, v31
v_accvgpr_write_b32 a48, v22
v_accvgpr_write_b32 a49, v23
v_accvgpr_write_b32 a50, v24
v_accvgpr_write_b32 a51, v25
v_accvgpr_read_b32 v22, a52
v_accvgpr_read_b32 v23, a53
v_accvgpr_read_b32 v24, a54
v_accvgpr_read_b32 v25, a55
v_mul_f32 v22, v22, v31
v_mul_f32 v23, v23, v31
v_mul_f32 v24, v24, v31
v_mul_f32 v25, v25, v31
v_accvgpr_write_b32 a52, v22
v_accvgpr_write_b32 a53, v23
v_accvgpr_write_b32 a54, v24
v_accvgpr_write_b32 a55, v25
v_accvgpr_read_b32 v22, a56
v_accvgpr_read_b32 v23, a57
v_accvgpr_read_b32 v24, a58
v_accvgpr_read_b32 v25, a59
v_mul_f32 v22, v22, v31
v_mul_f32 v23, v23, v31
v_mul_f32 v24, v24, v31
v_mul_f32 v25, v25, v31
v_accvgpr_write_b32 a56, v22
v_accvgpr_write_b32 a57, v23
v_accvgpr_write_b32 a58, v24
v_accvgpr_write_b32 a59, v25
v_accvgpr_read_b32 v22, a60
v_accvgpr_read_b32 v23, a61
v_accvgpr_read_b32 v24, a62
v_accvgpr_read_b32 v25, a63
v_mul_f32 v22, v22, v31
v_mul_f32 v23, v23, v31
v_mul_f32 v24, v24, v31
v_mul_f32 v25, v25, v31
v_accvgpr_write_b32 a60, v22
v_accvgpr_write_b32 a61, v23
v_accvgpr_write_b32 a62, v24
v_accvgpr_write_b32 a63, v25
v_accvgpr_read_b32 v22, a64
v_accvgpr_read_b32 v23, a65
v_accvgpr_read_b32 v24, a66
v_accvgpr_read_b32 v25, a67
v_mul_f32 v22, v22, v31
v_mul_f32 v23, v23, v31
v_mul_f32 v24, v24, v31
v_mul_f32 v25, v25, v31
v_accvgpr_write_b32 a64, v22
v_accvgpr_write_b32 a65, v23
v_accvgpr_write_b32 a66, v24
v_accvgpr_write_b32 a67, v25
v_accvgpr_read_b32 v22, a68
v_accvgpr_read_b32 v23, a69
v_accvgpr_read_b32 v24, a70
v_accvgpr_read_b32 v25, a71
v_mul_f32 v22, v22, v31
v_mul_f32 v23, v23, v31
v_mul_f32 v24, v24, v31
v_mul_f32 v25, v25, v31
v_accvgpr_write_b32 a68, v22
v_accvgpr_write_b32 a69, v23
v_accvgpr_write_b32 a70, v24
v_accvgpr_write_b32 a71, v25
v_accvgpr_read_b32 v22, a72
v_accvgpr_read_b32 v23, a73
v_accvgpr_read_b32 v24, a74
v_accvgpr_read_b32 v25, a75
v_mul_f32 v22, v22, v31
v_mul_f32 v23, v23, v31
v_mul_f32 v24, v24, v31
v_mul_f32 v25, v25, v31
v_accvgpr_write_b32 a72, v22
v_accvgpr_write_b32 a73, v23
v_accvgpr_write_b32 a74, v24
v_accvgpr_write_b32 a75, v25
v_accvgpr_read_b32 v22, a76
v_accvgpr_read_b32 v23, a77
v_accvgpr_read_b32 v24, a78
v_accvgpr_read_b32 v25, a79
v_mul_f32 v22, v22, v31
v_mul_f32 v23, v23, v31
v_mul_f32 v24, v24, v31
v_mul_f32 v25, v25, v31
v_accvgpr_write_b32 a76, v22
v_accvgpr_write_b32 a77, v23
v_accvgpr_write_b32 a78, v24
v_accvgpr_write_b32 a79, v25
v_accvgpr_read_b32 v22, a80
v_accvgpr_read_b32 v23, a81
v_accvgpr_read_b32 v24, a82
v_accvgpr_read_b32 v25, a83
v_mul_f32 v22, v22, v31
v_mul_f32 v23, v23, v31
v_mul_f32 v24, v24, v31
v_mul_f32 v25, v25, v31
v_accvgpr_write_b32 a80, v22
v_accvgpr_write_b32 a81, v23
v_accvgpr_write_b32 a82, v24
v_accvgpr_write_b32 a83, v25
v_accvgpr_read_b32 v22, a84
v_accvgpr_read_b32 v23, a85
v_accvgpr_read_b32 v24, a86
v_accvgpr_read_b32 v25, a87
v_mul_f32 v22, v22, v31
v_mul_f32 v23, v23, v31
v_mul_f32 v24, v24, v31
v_mul_f32 v25, v25, v31
v_accvgpr_write_b32 a84, v22
v_accvgpr_write_b32 a85, v23
v_accvgpr_write_b32 a86, v24
v_accvgpr_write_b32 a87, v25
v_accvgpr_read_b32 v22, a88
v_accvgpr_read_b32 v23, a89
v_accvgpr_read_b32 v24, a90
v_accvgpr_read_b32 v25, a91
v_mul_f32 v22, v22, v31
v_mul_f32 v23, v23, v31
v_mul_f32 v24, v24, v31
v_mul_f32 v25, v25, v31
v_accvgpr_write_b32 a88, v22
v_accvgpr_write_b32 a89, v23
v_accvgpr_write_b32 a90, v24
v_accvgpr_write_b32 a91, v25
v_accvgpr_read_b32 v22, a92
v_accvgpr_read_b32 v23, a93
v_accvgpr_read_b32 v24, a94
v_accvgpr_read_b32 v25, a95
v_mul_f32 v22, v22, v31
v_mul_f32 v23, v23, v31
v_mul_f32 v24, v24, v31
v_mul_f32 v25, v25, v31
v_accvgpr_write_b32 a92, v22
v_accvgpr_write_b32 a93, v23
v_accvgpr_write_b32 a94, v24
v_accvgpr_write_b32 a95, v25
v_fma_f32 v22, v64, s37, v14
v_fma_f32 v23, v65, s37, v14
v_exp_f32 v22, v22
v_fma_f32 v24, v66, s37, v14
v_exp_f32 v23, v23
v_fma_f32 v25, v67, s37, v14
v_exp_f32 v24, v24
v_add_f32 v18, v22, v23
v_fma_f32 v26, v68, s37, v14
v_exp_f32 v25, v25
v_add_f32 v18, v18, v24
v_cvt_pk_bf16_f32 v120, v22, v23
v_fma_f32 v27, v69, s37, v14
v_exp_f32 v26, v26
v_add_f32 v18, v18, v25
v_fma_f32 v22, v70, s37, v14
v_exp_f32 v27, v27
v_add_f32 v18, v18, v26
v_cvt_pk_bf16_f32 v121, v24, v25
v_fma_f32 v23, v71, s37, v14
v_exp_f32 v22, v22
v_add_f32 v18, v18, v27
v_fma_f32 v24, v72, s37, v14
v_exp_f32 v23, v23
v_add_f32 v18, v18, v22
v_cvt_pk_bf16_f32 v122, v26, v27
v_fma_f32 v25, v73, s37, v14
v_exp_f32 v24, v24
v_add_f32 v18, v18, v23
v_fma_f32 v26, v74, s37, v14
v_exp_f32 v25, v25
v_add_f32 v18, v18, v24
v_cvt_pk_bf16_f32 v123, v22, v23
v_fma_f32 v27, v75, s37, v14
v_exp_f32 v26, v26
v_add_f32 v18, v18, v25
v_fma_f32 v22, v76, s37, v14
v_exp_f32 v27, v27
v_add_f32 v18, v18, v26
v_cvt_pk_bf16_f32 v124, v24, v25
v_fma_f32 v23, v77, s37, v14
v_exp_f32 v22, v22
v_add_f32 v18, v18, v27
v_fma_f32 v24, v78, s37, v14
v_exp_f32 v23, v23
v_add_f32 v18, v18, v22
v_cvt_pk_bf16_f32 v125, v26, v27
v_fma_f32 v25, v79, s37, v14
v_exp_f32 v24, v24
v_add_f32 v18, v18, v23
v_exp_f32 v25, v25
v_add_f32 v18, v18, v24
v_cvt_pk_bf16_f32 v126, v22, v23
v_add_f32 v18, v18, v25
v_cvt_pk_bf16_f32 v127, v24, v25
s_nop 1
s_setpc_b64 s[60:61]
Lrare_Y0_112:
s_nop 15
v_max3_f32 v28, v80, v81, v82
v_max3_f32 v28, v28, v83, v84
v_max3_f32 v28, v28, v85, v86
v_max3_f32 v28, v28, v87, v88
v_max3_f32 v28, v28, v89, v90
v_max3_f32 v28, v28, v91, v92
v_max3_f32 v28, v28, v93, v94
v_max_f32 v28, v28, v95
v_mov_b32 v29, v28
s_nop 1
v_permlane32_swap_b32 v28, v29
s_nop 0
v_max_f32 v28, v28, v29
v_mul_f32_e64 v28, -v28, s37
v_min_f32 v28, v28, v15
v_sub_f32 v31, v28, v15
v_exp_f32 v31, v31
v_mov_b32 v15, v28
v_mul_f32 v17, v17, v31
v_accvgpr_read_b32 v22, a96
v_accvgpr_read_b32 v23, a97
v_accvgpr_read_b32 v24, a98
v_accvgpr_read_b32 v25, a99
v_mul_f32 v22, v22, v31
v_mul_f32 v23, v23, v31
v_mul_f32 v24, v24, v31
v_mul_f32 v25, v25, v31
v_accvgpr_write_b32 a96, v22
v_accvgpr_write_b32 a97, v23
v_accvgpr_write_b32 a98, v24
v_accvgpr_write_b32 a99, v25
v_accvgpr_read_b32 v22, a100
v_accvgpr_read_b32 v23, a101
v_accvgpr_read_b32 v24, a102
v_accvgpr_read_b32 v25, a103
v_mul_f32 v22, v22, v31
v_mul_f32 v23, v23, v31
v_mul_f32 v24, v24, v31
v_mul_f32 v25, v25, v31
v_accvgpr_write_b32 a100, v22
v_accvgpr_write_b32 a101, v23
v_accvgpr_write_b32 a102, v24
v_accvgpr_write_b32 a103, v25
v_accvgpr_read_b32 v22, a104
v_accvgpr_read_b32 v23, a105
v_accvgpr_read_b32 v24, a106
v_accvgpr_read_b32 v25, a107
v_mul_f32 v22, v22, v31
v_mul_f32 v23, v23, v31
v_mul_f32 v24, v24, v31
v_mul_f32 v25, v25, v31
v_accvgpr_write_b32 a104, v22
v_accvgpr_write_b32 a105, v23
v_accvgpr_write_b32 a106, v24
v_accvgpr_write_b32 a107, v25
v_accvgpr_read_b32 v22, a108
v_accvgpr_read_b32 v23, a109
v_accvgpr_read_b32 v24, a110
v_accvgpr_read_b32 v25, a111
v_mul_f32 v22, v22, v31
v_mul_f32 v23, v23, v31
v_mul_f32 v24, v24, v31
v_mul_f32 v25, v25, v31
v_accvgpr_write_b32 a108, v22
v_accvgpr_write_b32 a109, v23
v_accvgpr_write_b32 a110, v24
v_accvgpr_write_b32 a111, v25
v_accvgpr_read_b32 v22, a112
v_accvgpr_read_b32 v23, a113
v_accvgpr_read_b32 v24, a114
v_accvgpr_read_b32 v25, a115
v_mul_f32 v22, v22, v31
v_mul_f32 v23, v23, v31
v_mul_f32 v24, v24, v31
v_mul_f32 v25, v25, v31
v_accvgpr_write_b32 a112, v22
v_accvgpr_write_b32 a113, v23
v_accvgpr_write_b32 a114, v24
v_accvgpr_write_b32 a115, v25
v_accvgpr_read_b32 v22, a116
v_accvgpr_read_b32 v23, a117
v_accvgpr_read_b32 v24, a118
v_accvgpr_read_b32 v25, a119
v_mul_f32 v22, v22, v31
v_mul_f32 v23, v23, v31
v_mul_f32 v24, v24, v31
v_mul_f32 v25, v25, v31
v_accvgpr_write_b32 a116, v22
v_accvgpr_write_b32 a117, v23
v_accvgpr_write_b32 a118, v24
v_accvgpr_write_b32 a119, v25
v_accvgpr_read_b32 v22, a120
v_accvgpr_read_b32 v23, a121
v_accvgpr_read_b32 v24, a122
v_accvgpr_read_b32 v25, a123
v_mul_f32 v22, v22, v31
v_mul_f32 v23, v23, v31
v_mul_f32 v24, v24, v31
v_mul_f32 v25, v25, v31
v_accvgpr_write_b32 a120, v22
v_accvgpr_write_b32 a121, v23
v_accvgpr_write_b32 a122, v24
v_accvgpr_write_b32 a123, v25
v_accvgpr_read_b32 v22, a124
v_accvgpr_read_b32 v23, a125
v_accvgpr_read_b32 v24, a126
v_accvgpr_read_b32 v25, a127
v_mul_f32 v22, v22, v31
v_mul_f32 v23, v23, v31
v_mul_f32 v24, v24, v31
v_mul_f32 v25, v25, v31
v_accvgpr_write_b32 a124, v22
v_accvgpr_write_b32 a125, v23
v_accvgpr_write_b32 a126, v24
v_accvgpr_write_b32 a127, v25
v_accvgpr_read_b32 v22, a128
v_accvgpr_read_b32 v23, a129
v_accvgpr_read_b32 v24, a130
v_accvgpr_read_b32 v25, a131
v_mul_f32 v22, v22, v31
v_mul_f32 v23, v23, v31
v_mul_f32 v24, v24, v31
v_mul_f32 v25, v25, v31
v_accvgpr_write_b32 a128, v22
v_accvgpr_write_b32 a129, v23
v_accvgpr_write_b32 a130, v24
v_accvgpr_write_b32 a131, v25
v_accvgpr_read_b32 v22, a132
v_accvgpr_read_b32 v23, a133
v_accvgpr_read_b32 v24, a134
v_accvgpr_read_b32 v25, a135
v_mul_f32 v22, v22, v31
v_mul_f32 v23, v23, v31
v_mul_f32 v24, v24, v31
v_mul_f32 v25, v25, v31
v_accvgpr_write_b32 a132, v22
v_accvgpr_write_b32 a133, v23
v_accvgpr_write_b32 a134, v24
v_accvgpr_write_b32 a135, v25
v_accvgpr_read_b32 v22, a136
v_accvgpr_read_b32 v23, a137
v_accvgpr_read_b32 v24, a138
v_accvgpr_read_b32 v25, a139
v_mul_f32 v22, v22, v31
v_mul_f32 v23, v23, v31
v_mul_f32 v24, v24, v31
v_mul_f32 v25, v25, v31
v_accvgpr_write_b32 a136, v22
v_accvgpr_write_b32 a137, v23
v_accvgpr_write_b32 a138, v24
v_accvgpr_write_b32 a139, v25
v_accvgpr_read_b32 v22, a140
v_accvgpr_read_b32 v23, a141
v_accvgpr_read_b32 v24, a142
v_accvgpr_read_b32 v25, a143
v_mul_f32 v22, v22, v31
v_mul_f32 v23, v23, v31
v_mul_f32 v24, v24, v31
v_mul_f32 v25, v25, v31
v_accvgpr_write_b32 a140, v22
v_accvgpr_write_b32 a141, v23
v_accvgpr_write_b32 a142, v24
v_accvgpr_write_b32 a143, v25
v_accvgpr_read_b32 v22, a144
v_accvgpr_read_b32 v23, a145
v_accvgpr_read_b32 v24, a146
v_accvgpr_read_b32 v25, a147
v_mul_f32 v22, v22, v31
v_mul_f32 v23, v23, v31
v_mul_f32 v24, v24, v31
v_mul_f32 v25, v25, v31
v_accvgpr_write_b32 a144, v22
v_accvgpr_write_b32 a145, v23
v_accvgpr_write_b32 a146, v24
v_accvgpr_write_b32 a147, v25
v_accvgpr_read_b32 v22, a148
v_accvgpr_read_b32 v23, a149
v_accvgpr_read_b32 v24, a150
v_accvgpr_read_b32 v25, a151
v_mul_f32 v22, v22, v31
v_mul_f32 v23, v23, v31
v_mul_f32 v24, v24, v31
v_mul_f32 v25, v25, v31
v_accvgpr_write_b32 a148, v22
v_accvgpr_write_b32 a149, v23
v_accvgpr_write_b32 a150, v24
v_accvgpr_write_b32 a151, v25
v_accvgpr_read_b32 v22, a152
v_accvgpr_read_b32 v23, a153
v_accvgpr_read_b32 v24, a154
v_accvgpr_read_b32 v25, a155
v_mul_f32 v22, v22, v31
v_mul_f32 v23, v23, v31
v_mul_f32 v24, v24, v31
v_mul_f32 v25, v25, v31
v_accvgpr_write_b32 a152, v22
v_accvgpr_write_b32 a153, v23
v_accvgpr_write_b32 a154, v24
v_accvgpr_write_b32 a155, v25
v_accvgpr_read_b32 v22, a156
v_accvgpr_read_b32 v23, a157
v_accvgpr_read_b32 v24, a158
v_accvgpr_read_b32 v25, a159
v_mul_f32 v22, v22, v31
v_mul_f32 v23, v23, v31
v_mul_f32 v24, v24, v31
v_mul_f32 v25, v25, v31
v_accvgpr_write_b32 a156, v22
v_accvgpr_write_b32 a157, v23
v_accvgpr_write_b32 a158, v24
v_accvgpr_write_b32 a159, v25
v_accvgpr_read_b32 v22, a160
v_accvgpr_read_b32 v23, a161
v_accvgpr_read_b32 v24, a162
v_accvgpr_read_b32 v25, a163
v_mul_f32 v22, v22, v31
v_mul_f32 v23, v23, v31
v_mul_f32 v24, v24, v31
v_mul_f32 v25, v25, v31
v_accvgpr_write_b32 a160, v22
v_accvgpr_write_b32 a161, v23
v_accvgpr_write_b32 a162, v24
v_accvgpr_write_b32 a163, v25
v_accvgpr_read_b32 v22, a164
v_accvgpr_read_b32 v23, a165
v_accvgpr_read_b32 v24, a166
v_accvgpr_read_b32 v25, a167
v_mul_f32 v22, v22, v31
v_mul_f32 v23, v23, v31
v_mul_f32 v24, v24, v31
v_mul_f32 v25, v25, v31
v_accvgpr_write_b32 a164, v22
v_accvgpr_write_b32 a165, v23
v_accvgpr_write_b32 a166, v24
v_accvgpr_write_b32 a167, v25
v_accvgpr_read_b32 v22, a168
v_accvgpr_read_b32 v23, a169
v_accvgpr_read_b32 v24, a170
v_accvgpr_read_b32 v25, a171
v_mul_f32 v22, v22, v31
v_mul_f32 v23, v23, v31
v_mul_f32 v24, v24, v31
v_mul_f32 v25, v25, v31
v_accvgpr_write_b32 a168, v22
v_accvgpr_write_b32 a169, v23
v_accvgpr_write_b32 a170, v24
v_accvgpr_write_b32 a171, v25
v_accvgpr_read_b32 v22, a172
v_accvgpr_read_b32 v23, a173
v_accvgpr_read_b32 v24, a174
v_accvgpr_read_b32 v25, a175
v_mul_f32 v22, v22, v31
v_mul_f32 v23, v23, v31
v_mul_f32 v24, v24, v31
v_mul_f32 v25, v25, v31
v_accvgpr_write_b32 a172, v22
v_accvgpr_write_b32 a173, v23
v_accvgpr_write_b32 a174, v24
v_accvgpr_write_b32 a175, v25
v_accvgpr_read_b32 v22, a176
v_accvgpr_read_b32 v23, a177
v_accvgpr_read_b32 v24, a178
v_accvgpr_read_b32 v25, a179
v_mul_f32 v22, v22, v31
v_mul_f32 v23, v23, v31
v_mul_f32 v24, v24, v31
v_mul_f32 v25, v25, v31
v_accvgpr_write_b32 a176, v22
v_accvgpr_write_b32 a177, v23
v_accvgpr_write_b32 a178, v24
v_accvgpr_write_b32 a179, v25
v_accvgpr_read_b32 v22, a180
v_accvgpr_read_b32 v23, a181
v_accvgpr_read_b32 v24, a182
v_accvgpr_read_b32 v25, a183
v_mul_f32 v22, v22, v31
v_mul_f32 v23, v23, v31
v_mul_f32 v24, v24, v31
v_mul_f32 v25, v25, v31
v_accvgpr_write_b32 a180, v22
v_accvgpr_write_b32 a181, v23
v_accvgpr_write_b32 a182, v24
v_accvgpr_write_b32 a183, v25
v_accvgpr_read_b32 v22, a184
v_accvgpr_read_b32 v23, a185
v_accvgpr_read_b32 v24, a186
v_accvgpr_read_b32 v25, a187
v_mul_f32 v22, v22, v31
v_mul_f32 v23, v23, v31
v_mul_f32 v24, v24, v31
v_mul_f32 v25, v25, v31
v_accvgpr_write_b32 a184, v22
v_accvgpr_write_b32 a185, v23
v_accvgpr_write_b32 a186, v24
v_accvgpr_write_b32 a187, v25
v_accvgpr_read_b32 v22, a188
v_accvgpr_read_b32 v23, a189
v_accvgpr_read_b32 v24, a190
v_accvgpr_read_b32 v25, a191
v_mul_f32 v22, v22, v31
v_mul_f32 v23, v23, v31
v_mul_f32 v24, v24, v31
v_mul_f32 v25, v25, v31
v_accvgpr_write_b32 a188, v22
v_accvgpr_write_b32 a189, v23
v_accvgpr_write_b32 a190, v24
v_accvgpr_write_b32 a191, v25
v_fma_f32 v22, v80, s37, v15
v_fma_f32 v23, v81, s37, v15
v_exp_f32 v22, v22
v_fma_f32 v24, v82, s37, v15
v_exp_f32 v23, v23
v_fma_f32 v25, v83, s37, v15
v_exp_f32 v24, v24
v_add_f32 v19, v22, v23
v_fma_f32 v26, v84, s37, v15
v_exp_f32 v25, v25
v_add_f32 v19, v19, v24
v_cvt_pk_bf16_f32 v112, v22, v23
v_fma_f32 v27, v85, s37, v15
v_exp_f32 v26, v26
v_add_f32 v19, v19, v25
v_fma_f32 v22, v86, s37, v15
v_exp_f32 v27, v27
v_add_f32 v19, v19, v26
v_cvt_pk_bf16_f32 v113, v24, v25
v_fma_f32 v23, v87, s37, v15
v_exp_f32 v22, v22
v_add_f32 v19, v19, v27
v_fma_f32 v24, v88, s37, v15
v_exp_f32 v23, v23
v_add_f32 v19, v19, v22
v_cvt_pk_bf16_f32 v114, v26, v27
v_fma_f32 v25, v89, s37, v15
v_exp_f32 v24, v24
v_add_f32 v19, v19, v23
v_fma_f32 v26, v90, s37, v15
v_exp_f32 v25, v25
v_add_f32 v19, v19, v24
v_cvt_pk_bf16_f32 v115, v22, v23
v_fma_f32 v27, v91, s37, v15
v_exp_f32 v26, v26
v_add_f32 v19, v19, v25
v_fma_f32 v22, v92, s37, v15
v_exp_f32 v27, v27
v_add_f32 v19, v19, v26
v_cvt_pk_bf16_f32 v116, v24, v25
v_fma_f32 v23, v93, s37, v15
v_exp_f32 v22, v22
v_add_f32 v19, v19, v27
v_fma_f32 v24, v94, s37, v15
v_exp_f32 v23, v23
v_add_f32 v19, v19, v22
v_cvt_pk_bf16_f32 v117, v26, v27
v_fma_f32 v25, v95, s37, v15
v_exp_f32 v24, v24
v_add_f32 v19, v19, v23
v_exp_f32 v25, v25
v_add_f32 v19, v19, v24
v_cvt_pk_bf16_f32 v118, v22, v23
v_add_f32 v19, v19, v25
v_cvt_pk_bf16_f32 v119, v24, v25
s_nop 1
s_setpc_b64 s[60:61]
Lrare_Y0_128:
s_nop 15
v_max3_f32 v28, v80, v81, v82
v_max3_f32 v28, v28, v83, v84
v_max3_f32 v28, v28, v85, v86
v_max3_f32 v28, v28, v87, v88
v_max3_f32 v28, v28, v89, v90
v_max3_f32 v28, v28, v91, v92
v_max3_f32 v28, v28, v93, v94
v_max_f32 v28, v28, v95
v_mov_b32 v29, v28
s_nop 1
v_permlane32_swap_b32 v28, v29
s_nop 0
v_max_f32 v28, v28, v29
v_mul_f32_e64 v28, -v28, s37
v_min_f32 v28, v28, v15
v_sub_f32 v31, v28, v15
v_exp_f32 v31, v31
v_mov_b32 v15, v28
v_mul_f32 v17, v17, v31
v_accvgpr_read_b32 v22, a96
v_accvgpr_read_b32 v23, a97
v_accvgpr_read_b32 v24, a98
v_accvgpr_read_b32 v25, a99
v_mul_f32 v22, v22, v31
v_mul_f32 v23, v23, v31
v_mul_f32 v24, v24, v31
v_mul_f32 v25, v25, v31
v_accvgpr_write_b32 a96, v22
v_accvgpr_write_b32 a97, v23
v_accvgpr_write_b32 a98, v24
v_accvgpr_write_b32 a99, v25
v_accvgpr_read_b32 v22, a100
v_accvgpr_read_b32 v23, a101
v_accvgpr_read_b32 v24, a102
v_accvgpr_read_b32 v25, a103
v_mul_f32 v22, v22, v31
v_mul_f32 v23, v23, v31
v_mul_f32 v24, v24, v31
v_mul_f32 v25, v25, v31
v_accvgpr_write_b32 a100, v22
v_accvgpr_write_b32 a101, v23
v_accvgpr_write_b32 a102, v24
v_accvgpr_write_b32 a103, v25
v_accvgpr_read_b32 v22, a104
v_accvgpr_read_b32 v23, a105
v_accvgpr_read_b32 v24, a106
v_accvgpr_read_b32 v25, a107
v_mul_f32 v22, v22, v31
v_mul_f32 v23, v23, v31
v_mul_f32 v24, v24, v31
v_mul_f32 v25, v25, v31
v_accvgpr_write_b32 a104, v22
v_accvgpr_write_b32 a105, v23
v_accvgpr_write_b32 a106, v24
v_accvgpr_write_b32 a107, v25
v_accvgpr_read_b32 v22, a108
v_accvgpr_read_b32 v23, a109
v_accvgpr_read_b32 v24, a110
v_accvgpr_read_b32 v25, a111
v_mul_f32 v22, v22, v31
v_mul_f32 v23, v23, v31
v_mul_f32 v24, v24, v31
v_mul_f32 v25, v25, v31
v_accvgpr_write_b32 a108, v22
v_accvgpr_write_b32 a109, v23
v_accvgpr_write_b32 a110, v24
v_accvgpr_write_b32 a111, v25
v_accvgpr_read_b32 v22, a112
v_accvgpr_read_b32 v23, a113
v_accvgpr_read_b32 v24, a114
v_accvgpr_read_b32 v25, a115
v_mul_f32 v22, v22, v31
v_mul_f32 v23, v23, v31
v_mul_f32 v24, v24, v31
v_mul_f32 v25, v25, v31
v_accvgpr_write_b32 a112, v22
v_accvgpr_write_b32 a113, v23
v_accvgpr_write_b32 a114, v24
v_accvgpr_write_b32 a115, v25
v_accvgpr_read_b32 v22, a116
v_accvgpr_read_b32 v23, a117
v_accvgpr_read_b32 v24, a118
v_accvgpr_read_b32 v25, a119
v_mul_f32 v22, v22, v31
v_mul_f32 v23, v23, v31
v_mul_f32 v24, v24, v31
v_mul_f32 v25, v25, v31
v_accvgpr_write_b32 a116, v22
v_accvgpr_write_b32 a117, v23
v_accvgpr_write_b32 a118, v24
v_accvgpr_write_b32 a119, v25
v_accvgpr_read_b32 v22, a120
v_accvgpr_read_b32 v23, a121
v_accvgpr_read_b32 v24, a122
v_accvgpr_read_b32 v25, a123
v_mul_f32 v22, v22, v31
v_mul_f32 v23, v23, v31
v_mul_f32 v24, v24, v31
v_mul_f32 v25, v25, v31
v_accvgpr_write_b32 a120, v22
v_accvgpr_write_b32 a121, v23
v_accvgpr_write_b32 a122, v24
v_accvgpr_write_b32 a123, v25
v_accvgpr_read_b32 v22, a124
v_accvgpr_read_b32 v23, a125
v_accvgpr_read_b32 v24, a126
v_accvgpr_read_b32 v25, a127
v_mul_f32 v22, v22, v31
v_mul_f32 v23, v23, v31
v_mul_f32 v24, v24, v31
v_mul_f32 v25, v25, v31
v_accvgpr_write_b32 a124, v22
v_accvgpr_write_b32 a125, v23
v_accvgpr_write_b32 a126, v24
v_accvgpr_write_b32 a127, v25
v_accvgpr_read_b32 v22, a128
v_accvgpr_read_b32 v23, a129
v_accvgpr_read_b32 v24, a130
v_accvgpr_read_b32 v25, a131
v_mul_f32 v22, v22, v31
v_mul_f32 v23, v23, v31
v_mul_f32 v24, v24, v31
v_mul_f32 v25, v25, v31
v_accvgpr_write_b32 a128, v22
v_accvgpr_write_b32 a129, v23
v_accvgpr_write_b32 a130, v24
v_accvgpr_write_b32 a131, v25
v_accvgpr_read_b32 v22, a132
v_accvgpr_read_b32 v23, a133
v_accvgpr_read_b32 v24, a134
v_accvgpr_read_b32 v25, a135
v_mul_f32 v22, v22, v31
v_mul_f32 v23, v23, v31
v_mul_f32 v24, v24, v31
v_mul_f32 v25, v25, v31
v_accvgpr_write_b32 a132, v22
v_accvgpr_write_b32 a133, v23
v_accvgpr_write_b32 a134, v24
v_accvgpr_write_b32 a135, v25
v_accvgpr_read_b32 v22, a136
v_accvgpr_read_b32 v23, a137
v_accvgpr_read_b32 v24, a138
v_accvgpr_read_b32 v25, a139
v_mul_f32 v22, v22, v31
v_mul_f32 v23, v23, v31
v_mul_f32 v24, v24, v31
v_mul_f32 v25, v25, v31
v_accvgpr_write_b32 a136, v22
v_accvgpr_write_b32 a137, v23
v_accvgpr_write_b32 a138, v24
v_accvgpr_write_b32 a139, v25
v_accvgpr_read_b32 v22, a140
v_accvgpr_read_b32 v23, a141
v_accvgpr_read_b32 v24, a142
v_accvgpr_read_b32 v25, a143
v_mul_f32 v22, v22, v31
v_mul_f32 v23, v23, v31
v_mul_f32 v24, v24, v31
v_mul_f32 v25, v25, v31
v_accvgpr_write_b32 a140, v22
v_accvgpr_write_b32 a141, v23
v_accvgpr_write_b32 a142, v24
v_accvgpr_write_b32 a143, v25
v_accvgpr_read_b32 v22, a144
v_accvgpr_read_b32 v23, a145
v_accvgpr_read_b32 v24, a146
v_accvgpr_read_b32 v25, a147
v_mul_f32 v22, v22, v31
v_mul_f32 v23, v23, v31
v_mul_f32 v24, v24, v31
v_mul_f32 v25, v25, v31
v_accvgpr_write_b32 a144, v22
v_accvgpr_write_b32 a145, v23
v_accvgpr_write_b32 a146, v24
v_accvgpr_write_b32 a147, v25
v_accvgpr_read_b32 v22, a148
v_accvgpr_read_b32 v23, a149
v_accvgpr_read_b32 v24, a150
v_accvgpr_read_b32 v25, a151
v_mul_f32 v22, v22, v31
v_mul_f32 v23, v23, v31
v_mul_f32 v24, v24, v31
v_mul_f32 v25, v25, v31
v_accvgpr_write_b32 a148, v22
v_accvgpr_write_b32 a149, v23
v_accvgpr_write_b32 a150, v24
v_accvgpr_write_b32 a151, v25
v_accvgpr_read_b32 v22, a152
v_accvgpr_read_b32 v23, a153
v_accvgpr_read_b32 v24, a154
v_accvgpr_read_b32 v25, a155
v_mul_f32 v22, v22, v31
v_mul_f32 v23, v23, v31
v_mul_f32 v24, v24, v31
v_mul_f32 v25, v25, v31
v_accvgpr_write_b32 a152, v22
v_accvgpr_write_b32 a153, v23
v_accvgpr_write_b32 a154, v24
v_accvgpr_write_b32 a155, v25
v_accvgpr_read_b32 v22, a156
v_accvgpr_read_b32 v23, a157
v_accvgpr_read_b32 v24, a158
v_accvgpr_read_b32 v25, a159
v_mul_f32 v22, v22, v31
v_mul_f32 v23, v23, v31
v_mul_f32 v24, v24, v31
v_mul_f32 v25, v25, v31
v_accvgpr_write_b32 a156, v22
v_accvgpr_write_b32 a157, v23
v_accvgpr_write_b32 a158, v24
v_accvgpr_write_b32 a159, v25
v_accvgpr_read_b32 v22, a160
v_accvgpr_read_b32 v23, a161
v_accvgpr_read_b32 v24, a162
v_accvgpr_read_b32 v25, a163
v_mul_f32 v22, v22, v31
v_mul_f32 v23, v23, v31
v_mul_f32 v24, v24, v31
v_mul_f32 v25, v25, v31
v_accvgpr_write_b32 a160, v22
v_accvgpr_write_b32 a161, v23
v_accvgpr_write_b32 a162, v24
v_accvgpr_write_b32 a163, v25
v_accvgpr_read_b32 v22, a164
v_accvgpr_read_b32 v23, a165
v_accvgpr_read_b32 v24, a166
v_accvgpr_read_b32 v25, a167
v_mul_f32 v22, v22, v31
v_mul_f32 v23, v23, v31
v_mul_f32 v24, v24, v31
v_mul_f32 v25, v25, v31
v_accvgpr_write_b32 a164, v22
v_accvgpr_write_b32 a165, v23
v_accvgpr_write_b32 a166, v24
v_accvgpr_write_b32 a167, v25
v_accvgpr_read_b32 v22, a168
v_accvgpr_read_b32 v23, a169
v_accvgpr_read_b32 v24, a170
v_accvgpr_read_b32 v25, a171
v_mul_f32 v22, v22, v31
v_mul_f32 v23, v23, v31
v_mul_f32 v24, v24, v31
v_mul_f32 v25, v25, v31
v_accvgpr_write_b32 a168, v22
v_accvgpr_write_b32 a169, v23
v_accvgpr_write_b32 a170, v24
v_accvgpr_write_b32 a171, v25
v_accvgpr_read_b32 v22, a172
v_accvgpr_read_b32 v23, a173
v_accvgpr_read_b32 v24, a174
v_accvgpr_read_b32 v25, a175
v_mul_f32 v22, v22, v31
v_mul_f32 v23, v23, v31
v_mul_f32 v24, v24, v31
v_mul_f32 v25, v25, v31
v_accvgpr_write_b32 a172, v22
v_accvgpr_write_b32 a173, v23
v_accvgpr_write_b32 a174, v24
v_accvgpr_write_b32 a175, v25
v_accvgpr_read_b32 v22, a176
v_accvgpr_read_b32 v23, a177
v_accvgpr_read_b32 v24, a178
v_accvgpr_read_b32 v25, a179
v_mul_f32 v22, v22, v31
v_mul_f32 v23, v23, v31
v_mul_f32 v24, v24, v31
v_mul_f32 v25, v25, v31
v_accvgpr_write_b32 a176, v22
v_accvgpr_write_b32 a177, v23
v_accvgpr_write_b32 a178, v24
v_accvgpr_write_b32 a179, v25
v_accvgpr_read_b32 v22, a180
v_accvgpr_read_b32 v23, a181
v_accvgpr_read_b32 v24, a182
v_accvgpr_read_b32 v25, a183
v_mul_f32 v22, v22, v31
v_mul_f32 v23, v23, v31
v_mul_f32 v24, v24, v31
v_mul_f32 v25, v25, v31
v_accvgpr_write_b32 a180, v22
v_accvgpr_write_b32 a181, v23
v_accvgpr_write_b32 a182, v24
v_accvgpr_write_b32 a183, v25
v_accvgpr_read_b32 v22, a184
v_accvgpr_read_b32 v23, a185
v_accvgpr_read_b32 v24, a186
v_accvgpr_read_b32 v25, a187
v_mul_f32 v22, v22, v31
v_mul_f32 v23, v23, v31
v_mul_f32 v24, v24, v31
v_mul_f32 v25, v25, v31
v_accvgpr_write_b32 a184, v22
v_accvgpr_write_b32 a185, v23
v_accvgpr_write_b32 a186, v24
v_accvgpr_write_b32 a187, v25
v_accvgpr_read_b32 v22, a188
v_accvgpr_read_b32 v23, a189
v_accvgpr_read_b32 v24, a190
v_accvgpr_read_b32 v25, a191
v_mul_f32 v22, v22, v31
v_mul_f32 v23, v23, v31
v_mul_f32 v24, v24, v31
v_mul_f32 v25, v25, v31
v_accvgpr_write_b32 a188, v22
v_accvgpr_write_b32 a189, v23
v_accvgpr_write_b32 a190, v24
v_accvgpr_write_b32 a191, v25
v_fma_f32 v22, v80, s37, v15
v_fma_f32 v23, v81, s37, v15
v_exp_f32 v22, v22
v_fma_f32 v24, v82, s37, v15
v_exp_f32 v23, v23
v_fma_f32 v25, v83, s37, v15
v_exp_f32 v24, v24
v_add_f32 v19, v22, v23
v_fma_f32 v26, v84, s37, v15
v_exp_f32 v25, v25
v_add_f32 v19, v19, v24
v_cvt_pk_bf16_f32 v128, v22, v23
v_fma_f32 v27, v85, s37, v15
v_exp_f32 v26, v26
v_add_f32 v19, v19, v25
v_fma_f32 v22, v86, s37, v15
v_exp_f32 v27, v27
v_add_f32 v19, v19, v26
v_cvt_pk_bf16_f32 v129, v24, v25
v_fma_f32 v23, v87, s37, v15
v_exp_f32 v22, v22
v_add_f32 v19, v19, v27
v_fma_f32 v24, v88, s37, v15
v_exp_f32 v23, v23
v_add_f32 v19, v19, v22
v_cvt_pk_bf16_f32 v130, v26, v27
v_fma_f32 v25, v89, s37, v15
v_exp_f32 v24, v24
v_add_f32 v19, v19, v23
v_fma_f32 v26, v90, s37, v15
v_exp_f32 v25, v25
v_add_f32 v19, v19, v24
v_cvt_pk_bf16_f32 v131, v22, v23
v_fma_f32 v27, v91, s37, v15
v_exp_f32 v26, v26
v_add_f32 v19, v19, v25
v_fma_f32 v22, v92, s37, v15
v_exp_f32 v27, v27
v_add_f32 v19, v19, v26
v_cvt_pk_bf16_f32 v132, v24, v25
v_fma_f32 v23, v93, s37, v15
v_exp_f32 v22, v22
v_add_f32 v19, v19, v27
v_fma_f32 v24, v94, s37, v15
v_exp_f32 v23, v23
v_add_f32 v19, v19, v22
v_cvt_pk_bf16_f32 v133, v26, v27
v_fma_f32 v25, v95, s37, v15
v_exp_f32 v24, v24
v_add_f32 v19, v19, v23
v_exp_f32 v25, v25
v_add_f32 v19, v19, v24
v_cvt_pk_bf16_f32 v134, v22, v23
v_add_f32 v19, v19, v25
v_cvt_pk_bf16_f32 v135, v24, v25
s_nop 1
s_setpc_b64 s[60:61]
Lrare_Y1_80:
s_nop 15
v_max3_f32 v28, v96, v97, v98
v_max3_f32 v28, v28, v99, v100
v_max3_f32 v28, v28, v101, v102
v_max3_f32 v28, v28, v103, v104
v_max3_f32 v28, v28, v105, v106
v_max3_f32 v28, v28, v107, v108
v_max3_f32 v28, v28, v109, v110
v_max_f32 v28, v28, v111
v_mov_b32 v29, v28
s_nop 1
v_permlane32_swap_b32 v28, v29
s_nop 0
v_max_f32 v28, v28, v29
v_mul_f32_e64 v28, -v28, s37
v_min_f32 v28, v28, v15
v_sub_f32 v31, v28, v15
v_exp_f32 v31, v31
v_mov_b32 v15, v28
v_mul_f32 v17, v17, v31
v_accvgpr_read_b32 v22, a96
v_accvgpr_read_b32 v23, a97
v_accvgpr_read_b32 v24, a98
v_accvgpr_read_b32 v25, a99
v_mul_f32 v22, v22, v31
v_mul_f32 v23, v23, v31
v_mul_f32 v24, v24, v31
v_mul_f32 v25, v25, v31
v_accvgpr_write_b32 a96, v22
v_accvgpr_write_b32 a97, v23
v_accvgpr_write_b32 a98, v24
v_accvgpr_write_b32 a99, v25
v_accvgpr_read_b32 v22, a100
v_accvgpr_read_b32 v23, a101
v_accvgpr_read_b32 v24, a102
v_accvgpr_read_b32 v25, a103
v_mul_f32 v22, v22, v31
v_mul_f32 v23, v23, v31
v_mul_f32 v24, v24, v31
v_mul_f32 v25, v25, v31
v_accvgpr_write_b32 a100, v22
v_accvgpr_write_b32 a101, v23
v_accvgpr_write_b32 a102, v24
v_accvgpr_write_b32 a103, v25
v_accvgpr_read_b32 v22, a104
v_accvgpr_read_b32 v23, a105
v_accvgpr_read_b32 v24, a106
v_accvgpr_read_b32 v25, a107
v_mul_f32 v22, v22, v31
v_mul_f32 v23, v23, v31
v_mul_f32 v24, v24, v31
v_mul_f32 v25, v25, v31
v_accvgpr_write_b32 a104, v22
v_accvgpr_write_b32 a105, v23
v_accvgpr_write_b32 a106, v24
v_accvgpr_write_b32 a107, v25
v_accvgpr_read_b32 v22, a108
v_accvgpr_read_b32 v23, a109
v_accvgpr_read_b32 v24, a110
v_accvgpr_read_b32 v25, a111
v_mul_f32 v22, v22, v31
v_mul_f32 v23, v23, v31
v_mul_f32 v24, v24, v31
v_mul_f32 v25, v25, v31
v_accvgpr_write_b32 a108, v22
v_accvgpr_write_b32 a109, v23
v_accvgpr_write_b32 a110, v24
v_accvgpr_write_b32 a111, v25
v_accvgpr_read_b32 v22, a112
v_accvgpr_read_b32 v23, a113
v_accvgpr_read_b32 v24, a114
v_accvgpr_read_b32 v25, a115
v_mul_f32 v22, v22, v31
v_mul_f32 v23, v23, v31
v_mul_f32 v24, v24, v31
v_mul_f32 v25, v25, v31
v_accvgpr_write_b32 a112, v22
v_accvgpr_write_b32 a113, v23
v_accvgpr_write_b32 a114, v24
v_accvgpr_write_b32 a115, v25
v_accvgpr_read_b32 v22, a116
v_accvgpr_read_b32 v23, a117
v_accvgpr_read_b32 v24, a118
v_accvgpr_read_b32 v25, a119
v_mul_f32 v22, v22, v31
v_mul_f32 v23, v23, v31
v_mul_f32 v24, v24, v31
v_mul_f32 v25, v25, v31
v_accvgpr_write_b32 a116, v22
v_accvgpr_write_b32 a117, v23
v_accvgpr_write_b32 a118, v24
v_accvgpr_write_b32 a119, v25
v_accvgpr_read_b32 v22, a120
v_accvgpr_read_b32 v23, a121
v_accvgpr_read_b32 v24, a122
v_accvgpr_read_b32 v25, a123
v_mul_f32 v22, v22, v31
v_mul_f32 v23, v23, v31
v_mul_f32 v24, v24, v31
v_mul_f32 v25, v25, v31
v_accvgpr_write_b32 a120, v22
v_accvgpr_write_b32 a121, v23
v_accvgpr_write_b32 a122, v24
v_accvgpr_write_b32 a123, v25
v_accvgpr_read_b32 v22, a124
v_accvgpr_read_b32 v23, a125
v_accvgpr_read_b32 v24, a126
v_accvgpr_read_b32 v25, a127
v_mul_f32 v22, v22, v31
v_mul_f32 v23, v23, v31
v_mul_f32 v24, v24, v31
v_mul_f32 v25, v25, v31
v_accvgpr_write_b32 a124, v22
v_accvgpr_write_b32 a125, v23
v_accvgpr_write_b32 a126, v24
v_accvgpr_write_b32 a127, v25
v_accvgpr_read_b32 v22, a128
v_accvgpr_read_b32 v23, a129
v_accvgpr_read_b32 v24, a130
v_accvgpr_read_b32 v25, a131
v_mul_f32 v22, v22, v31
v_mul_f32 v23, v23, v31
v_mul_f32 v24, v24, v31
v_mul_f32 v25, v25, v31
v_accvgpr_write_b32 a128, v22
v_accvgpr_write_b32 a129, v23
v_accvgpr_write_b32 a130, v24
v_accvgpr_write_b32 a131, v25
v_accvgpr_read_b32 v22, a132
v_accvgpr_read_b32 v23, a133
v_accvgpr_read_b32 v24, a134
v_accvgpr_read_b32 v25, a135
v_mul_f32 v22, v22, v31
v_mul_f32 v23, v23, v31
v_mul_f32 v24, v24, v31
v_mul_f32 v25, v25, v31
v_accvgpr_write_b32 a132, v22
v_accvgpr_write_b32 a133, v23
v_accvgpr_write_b32 a134, v24
v_accvgpr_write_b32 a135, v25
v_accvgpr_read_b32 v22, a136
v_accvgpr_read_b32 v23, a137
v_accvgpr_read_b32 v24, a138
v_accvgpr_read_b32 v25, a139
v_mul_f32 v22, v22, v31
v_mul_f32 v23, v23, v31
v_mul_f32 v24, v24, v31
v_mul_f32 v25, v25, v31
v_accvgpr_write_b32 a136, v22
v_accvgpr_write_b32 a137, v23
v_accvgpr_write_b32 a138, v24
v_accvgpr_write_b32 a139, v25
v_accvgpr_read_b32 v22, a140
v_accvgpr_read_b32 v23, a141
v_accvgpr_read_b32 v24, a142
v_accvgpr_read_b32 v25, a143
v_mul_f32 v22, v22, v31
v_mul_f32 v23, v23, v31
v_mul_f32 v24, v24, v31
v_mul_f32 v25, v25, v31
v_accvgpr_write_b32 a140, v22
v_accvgpr_write_b32 a141, v23
v_accvgpr_write_b32 a142, v24
v_accvgpr_write_b32 a143, v25
v_accvgpr_read_b32 v22, a144
v_accvgpr_read_b32 v23, a145
v_accvgpr_read_b32 v24, a146
v_accvgpr_read_b32 v25, a147
v_mul_f32 v22, v22, v31
v_mul_f32 v23, v23, v31
v_mul_f32 v24, v24, v31
v_mul_f32 v25, v25, v31
v_accvgpr_write_b32 a144, v22
v_accvgpr_write_b32 a145, v23
v_accvgpr_write_b32 a146, v24
v_accvgpr_write_b32 a147, v25
v_accvgpr_read_b32 v22, a148
v_accvgpr_read_b32 v23, a149
v_accvgpr_read_b32 v24, a150
v_accvgpr_read_b32 v25, a151
v_mul_f32 v22, v22, v31
v_mul_f32 v23, v23, v31
v_mul_f32 v24, v24, v31
v_mul_f32 v25, v25, v31
v_accvgpr_write_b32 a148, v22
v_accvgpr_write_b32 a149, v23
v_accvgpr_write_b32 a150, v24
v_accvgpr_write_b32 a151, v25
v_accvgpr_read_b32 v22, a152
v_accvgpr_read_b32 v23, a153
v_accvgpr_read_b32 v24, a154
v_accvgpr_read_b32 v25, a155
v_mul_f32 v22, v22, v31
v_mul_f32 v23, v23, v31
v_mul_f32 v24, v24, v31
v_mul_f32 v25, v25, v31
v_accvgpr_write_b32 a152, v22
v_accvgpr_write_b32 a153, v23
v_accvgpr_write_b32 a154, v24
v_accvgpr_write_b32 a155, v25
v_accvgpr_read_b32 v22, a156
v_accvgpr_read_b32 v23, a157
v_accvgpr_read_b32 v24, a158
v_accvgpr_read_b32 v25, a159
v_mul_f32 v22, v22, v31
v_mul_f32 v23, v23, v31
v_mul_f32 v24, v24, v31
v_mul_f32 v25, v25, v31
v_accvgpr_write_b32 a156, v22
v_accvgpr_write_b32 a157, v23
v_accvgpr_write_b32 a158, v24
v_accvgpr_write_b32 a159, v25
v_accvgpr_read_b32 v22, a160
v_accvgpr_read_b32 v23, a161
v_accvgpr_read_b32 v24, a162
v_accvgpr_read_b32 v25, a163
v_mul_f32 v22, v22, v31
v_mul_f32 v23, v23, v31
v_mul_f32 v24, v24, v31
v_mul_f32 v25, v25, v31
v_accvgpr_write_b32 a160, v22
v_accvgpr_write_b32 a161, v23
v_accvgpr_write_b32 a162, v24
v_accvgpr_write_b32 a163, v25
v_accvgpr_read_b32 v22, a164
v_accvgpr_read_b32 v23, a165
v_accvgpr_read_b32 v24, a166
v_accvgpr_read_b32 v25, a167
v_mul_f32 v22, v22, v31
v_mul_f32 v23, v23, v31
v_mul_f32 v24, v24, v31
v_mul_f32 v25, v25, v31
v_accvgpr_write_b32 a164, v22
v_accvgpr_write_b32 a165, v23
v_accvgpr_write_b32 a166, v24
v_accvgpr_write_b32 a167, v25
v_accvgpr_read_b32 v22, a168
v_accvgpr_read_b32 v23, a169
v_accvgpr_read_b32 v24, a170
v_accvgpr_read_b32 v25, a171
v_mul_f32 v22, v22, v31
v_mul_f32 v23, v23, v31
v_mul_f32 v24, v24, v31
v_mul_f32 v25, v25, v31
v_accvgpr_write_b32 a168, v22
v_accvgpr_write_b32 a169, v23
v_accvgpr_write_b32 a170, v24
v_accvgpr_write_b32 a171, v25
v_accvgpr_read_b32 v22, a172
v_accvgpr_read_b32 v23, a173
v_accvgpr_read_b32 v24, a174
v_accvgpr_read_b32 v25, a175
v_mul_f32 v22, v22, v31
v_mul_f32 v23, v23, v31
v_mul_f32 v24, v24, v31
v_mul_f32 v25, v25, v31
v_accvgpr_write_b32 a172, v22
v_accvgpr_write_b32 a173, v23
v_accvgpr_write_b32 a174, v24
v_accvgpr_write_b32 a175, v25
v_accvgpr_read_b32 v22, a176
v_accvgpr_read_b32 v23, a177
v_accvgpr_read_b32 v24, a178
v_accvgpr_read_b32 v25, a179
v_mul_f32 v22, v22, v31
v_mul_f32 v23, v23, v31
v_mul_f32 v24, v24, v31
v_mul_f32 v25, v25, v31
v_accvgpr_write_b32 a176, v22
v_accvgpr_write_b32 a177, v23
v_accvgpr_write_b32 a178, v24
v_accvgpr_write_b32 a179, v25
v_accvgpr_read_b32 v22, a180
v_accvgpr_read_b32 v23, a181
v_accvgpr_read_b32 v24, a182
v_accvgpr_read_b32 v25, a183
v_mul_f32 v22, v22, v31
v_mul_f32 v23, v23, v31
v_mul_f32 v24, v24, v31
v_mul_f32 v25, v25, v31
v_accvgpr_write_b32 a180, v22
v_accvgpr_write_b32 a181, v23
v_accvgpr_write_b32 a182, v24
v_accvgpr_write_b32 a183, v25
v_accvgpr_read_b32 v22, a184
v_accvgpr_read_b32 v23, a185
v_accvgpr_read_b32 v24, a186
v_accvgpr_read_b32 v25, a187
v_mul_f32 v22, v22, v31
v_mul_f32 v23, v23, v31
v_mul_f32 v24, v24, v31
v_mul_f32 v25, v25, v31
v_accvgpr_write_b32 a184, v22
v_accvgpr_write_b32 a185, v23
v_accvgpr_write_b32 a186, v24
v_accvgpr_write_b32 a187, v25
v_accvgpr_read_b32 v22, a188
v_accvgpr_read_b32 v23, a189
v_accvgpr_read_b32 v24, a190
v_accvgpr_read_b32 v25, a191
v_mul_f32 v22, v22, v31
v_mul_f32 v23, v23, v31
v_mul_f32 v24, v24, v31
v_mul_f32 v25, v25, v31
v_accvgpr_write_b32 a188, v22
v_accvgpr_write_b32 a189, v23
v_accvgpr_write_b32 a190, v24
v_accvgpr_write_b32 a191, v25
v_fma_f32 v22, v96, s37, v15
v_fma_f32 v23, v97, s37, v15
v_exp_f32 v22, v22
v_fma_f32 v24, v98, s37, v15
v_exp_f32 v23, v23
v_fma_f32 v25, v99, s37, v15
v_exp_f32 v24, v24
v_add_f32 v19, v22, v23
v_fma_f32 v26, v100, s37, v15
v_exp_f32 v25, v25
v_add_f32 v19, v19, v24
v_cvt_pk_bf16_f32 v80, v22, v23
v_fma_f32 v27, v101, s37, v15
v_exp_f32 v26, v26
v_add_f32 v19, v19, v25
v_fma_f32 v22, v102, s37, v15
v_exp_f32 v27, v27
v_add_f32 v19, v19, v26
v_cvt_pk_bf16_f32 v81, v24, v25
v_fma_f32 v23, v103, s37, v15
v_exp_f32 v22, v22
v_add_f32 v19, v19, v27
v_fma_f32 v24, v104, s37, v15
v_exp_f32 v23, v23
v_add_f32 v19, v19, v22
v_cvt_pk_bf16_f32 v82, v26, v27
v_fma_f32 v25, v105, s37, v15
v_exp_f32 v24, v24
v_add_f32 v19, v19, v23
v_fma_f32 v26, v106, s37, v15
v_exp_f32 v25, v25
v_add_f32 v19, v19, v24
v_cvt_pk_bf16_f32 v83, v22, v23
v_fma_f32 v27, v107, s37, v15
v_exp_f32 v26, v26
v_add_f32 v19, v19, v25
v_fma_f32 v22, v108, s37, v15
v_exp_f32 v27, v27
v_add_f32 v19, v19, v26
v_cvt_pk_bf16_f32 v84, v24, v25
v_fma_f32 v23, v109, s37, v15
v_exp_f32 v22, v22
v_add_f32 v19, v19, v27
v_fma_f32 v24, v110, s37, v15
v_exp_f32 v23, v23
v_add_f32 v19, v19, v22
v_cvt_pk_bf16_f32 v85, v26, v27
v_fma_f32 v25, v111, s37, v15
v_exp_f32 v24, v24
v_add_f32 v19, v19, v23
v_exp_f32 v25, v25
v_add_f32 v19, v19, v24
v_cvt_pk_bf16_f32 v86, v22, v23
v_add_f32 v19, v19, v25
v_cvt_pk_bf16_f32 v87, v24, v25
s_nop 1
s_setpc_b64 s[60:61]
Lrare_Y1_120:
s_nop 15
v_max3_f32 v28, v96, v97, v98
v_max3_f32 v28, v28, v99, v100
v_max3_f32 v28, v28, v101, v102
v_max3_f32 v28, v28, v103, v104
v_max3_f32 v28, v28, v105, v106
v_max3_f32 v28, v28, v107, v108
v_max3_f32 v28, v28, v109, v110
v_max_f32 v28, v28, v111
v_mov_b32 v29, v28
s_nop 1
v_permlane32_swap_b32 v28, v29
s_nop 0
v_max_f32 v28, v28, v29
v_mul_f32_e64 v28, -v28, s37
v_min_f32 v28, v28, v15
v_sub_f32 v31, v28, v15
v_exp_f32 v31, v31
v_mov_b32 v15, v28
v_mul_f32 v17, v17, v31
v_accvgpr_read_b32 v22, a96
v_accvgpr_read_b32 v23, a97
v_accvgpr_read_b32 v24, a98
v_accvgpr_read_b32 v25, a99
v_mul_f32 v22, v22, v31
v_mul_f32 v23, v23, v31
v_mul_f32 v24, v24, v31
v_mul_f32 v25, v25, v31
v_accvgpr_write_b32 a96, v22
v_accvgpr_write_b32 a97, v23
v_accvgpr_write_b32 a98, v24
v_accvgpr_write_b32 a99, v25
v_accvgpr_read_b32 v22, a100
v_accvgpr_read_b32 v23, a101
v_accvgpr_read_b32 v24, a102
v_accvgpr_read_b32 v25, a103
v_mul_f32 v22, v22, v31
v_mul_f32 v23, v23, v31
v_mul_f32 v24, v24, v31
v_mul_f32 v25, v25, v31
v_accvgpr_write_b32 a100, v22
v_accvgpr_write_b32 a101, v23
v_accvgpr_write_b32 a102, v24
v_accvgpr_write_b32 a103, v25
v_accvgpr_read_b32 v22, a104
v_accvgpr_read_b32 v23, a105
v_accvgpr_read_b32 v24, a106
v_accvgpr_read_b32 v25, a107
v_mul_f32 v22, v22, v31
v_mul_f32 v23, v23, v31
v_mul_f32 v24, v24, v31
v_mul_f32 v25, v25, v31
v_accvgpr_write_b32 a104, v22
v_accvgpr_write_b32 a105, v23
v_accvgpr_write_b32 a106, v24
v_accvgpr_write_b32 a107, v25
v_accvgpr_read_b32 v22, a108
v_accvgpr_read_b32 v23, a109
v_accvgpr_read_b32 v24, a110
v_accvgpr_read_b32 v25, a111
v_mul_f32 v22, v22, v31
v_mul_f32 v23, v23, v31
v_mul_f32 v24, v24, v31
v_mul_f32 v25, v25, v31
v_accvgpr_write_b32 a108, v22
v_accvgpr_write_b32 a109, v23
v_accvgpr_write_b32 a110, v24
v_accvgpr_write_b32 a111, v25
v_accvgpr_read_b32 v22, a112
v_accvgpr_read_b32 v23, a113
v_accvgpr_read_b32 v24, a114
v_accvgpr_read_b32 v25, a115
v_mul_f32 v22, v22, v31
v_mul_f32 v23, v23, v31
v_mul_f32 v24, v24, v31
v_mul_f32 v25, v25, v31
v_accvgpr_write_b32 a112, v22
v_accvgpr_write_b32 a113, v23
v_accvgpr_write_b32 a114, v24
v_accvgpr_write_b32 a115, v25
v_accvgpr_read_b32 v22, a116
v_accvgpr_read_b32 v23, a117
v_accvgpr_read_b32 v24, a118
v_accvgpr_read_b32 v25, a119
v_mul_f32 v22, v22, v31
v_mul_f32 v23, v23, v31
v_mul_f32 v24, v24, v31
v_mul_f32 v25, v25, v31
v_accvgpr_write_b32 a116, v22
v_accvgpr_write_b32 a117, v23
v_accvgpr_write_b32 a118, v24
v_accvgpr_write_b32 a119, v25
v_accvgpr_read_b32 v22, a120
v_accvgpr_read_b32 v23, a121
v_accvgpr_read_b32 v24, a122
v_accvgpr_read_b32 v25, a123
v_mul_f32 v22, v22, v31
v_mul_f32 v23, v23, v31
v_mul_f32 v24, v24, v31
v_mul_f32 v25, v25, v31
v_accvgpr_write_b32 a120, v22
v_accvgpr_write_b32 a121, v23
v_accvgpr_write_b32 a122, v24
v_accvgpr_write_b32 a123, v25
v_accvgpr_read_b32 v22, a124
v_accvgpr_read_b32 v23, a125
v_accvgpr_read_b32 v24, a126
v_accvgpr_read_b32 v25, a127
v_mul_f32 v22, v22, v31
v_mul_f32 v23, v23, v31
v_mul_f32 v24, v24, v31
v_mul_f32 v25, v25, v31
v_accvgpr_write_b32 a124, v22
v_accvgpr_write_b32 a125, v23
v_accvgpr_write_b32 a126, v24
v_accvgpr_write_b32 a127, v25
v_accvgpr_read_b32 v22, a128
v_accvgpr_read_b32 v23, a129
v_accvgpr_read_b32 v24, a130
v_accvgpr_read_b32 v25, a131
v_mul_f32 v22, v22, v31
v_mul_f32 v23, v23, v31
v_mul_f32 v24, v24, v31
v_mul_f32 v25, v25, v31
v_accvgpr_write_b32 a128, v22
v_accvgpr_write_b32 a129, v23
v_accvgpr_write_b32 a130, v24
v_accvgpr_write_b32 a131, v25
v_accvgpr_read_b32 v22, a132
v_accvgpr_read_b32 v23, a133
v_accvgpr_read_b32 v24, a134
v_accvgpr_read_b32 v25, a135
v_mul_f32 v22, v22, v31
v_mul_f32 v23, v23, v31
v_mul_f32 v24, v24, v31
v_mul_f32 v25, v25, v31
v_accvgpr_write_b32 a132, v22
v_accvgpr_write_b32 a133, v23
v_accvgpr_write_b32 a134, v24
v_accvgpr_write_b32 a135, v25
v_accvgpr_read_b32 v22, a136
v_accvgpr_read_b32 v23, a137
v_accvgpr_read_b32 v24, a138
v_accvgpr_read_b32 v25, a139
v_mul_f32 v22, v22, v31
v_mul_f32 v23, v23, v31
v_mul_f32 v24, v24, v31
v_mul_f32 v25, v25, v31
v_accvgpr_write_b32 a136, v22
v_accvgpr_write_b32 a137, v23
v_accvgpr_write_b32 a138, v24
v_accvgpr_write_b32 a139, v25
v_accvgpr_read_b32 v22, a140
v_accvgpr_read_b32 v23, a141
v_accvgpr_read_b32 v24, a142
v_accvgpr_read_b32 v25, a143
v_mul_f32 v22, v22, v31
v_mul_f32 v23, v23, v31
v_mul_f32 v24, v24, v31
v_mul_f32 v25, v25, v31
v_accvgpr_write_b32 a140, v22
v_accvgpr_write_b32 a141, v23
v_accvgpr_write_b32 a142, v24
v_accvgpr_write_b32 a143, v25
v_accvgpr_read_b32 v22, a144
v_accvgpr_read_b32 v23, a145
v_accvgpr_read_b32 v24, a146
v_accvgpr_read_b32 v25, a147
v_mul_f32 v22, v22, v31
v_mul_f32 v23, v23, v31
v_mul_f32 v24, v24, v31
v_mul_f32 v25, v25, v31
v_accvgpr_write_b32 a144, v22
v_accvgpr_write_b32 a145, v23
v_accvgpr_write_b32 a146, v24
v_accvgpr_write_b32 a147, v25
v_accvgpr_read_b32 v22, a148
v_accvgpr_read_b32 v23, a149
v_accvgpr_read_b32 v24, a150
v_accvgpr_read_b32 v25, a151
v_mul_f32 v22, v22, v31
v_mul_f32 v23, v23, v31
v_mul_f32 v24, v24, v31
v_mul_f32 v25, v25, v31
v_accvgpr_write_b32 a148, v22
v_accvgpr_write_b32 a149, v23
v_accvgpr_write_b32 a150, v24
v_accvgpr_write_b32 a151, v25
v_accvgpr_read_b32 v22, a152
v_accvgpr_read_b32 v23, a153
v_accvgpr_read_b32 v24, a154
v_accvgpr_read_b32 v25, a155
v_mul_f32 v22, v22, v31
v_mul_f32 v23, v23, v31
v_mul_f32 v24, v24, v31
v_mul_f32 v25, v25, v31
v_accvgpr_write_b32 a152, v22
v_accvgpr_write_b32 a153, v23
v_accvgpr_write_b32 a154, v24
v_accvgpr_write_b32 a155, v25
v_accvgpr_read_b32 v22, a156
v_accvgpr_read_b32 v23, a157
v_accvgpr_read_b32 v24, a158
v_accvgpr_read_b32 v25, a159
v_mul_f32 v22, v22, v31
v_mul_f32 v23, v23, v31
v_mul_f32 v24, v24, v31
v_mul_f32 v25, v25, v31
v_accvgpr_write_b32 a156, v22
v_accvgpr_write_b32 a157, v23
v_accvgpr_write_b32 a158, v24
v_accvgpr_write_b32 a159, v25
v_accvgpr_read_b32 v22, a160
v_accvgpr_read_b32 v23, a161
v_accvgpr_read_b32 v24, a162
v_accvgpr_read_b32 v25, a163
v_mul_f32 v22, v22, v31
v_mul_f32 v23, v23, v31
v_mul_f32 v24, v24, v31
v_mul_f32 v25, v25, v31
v_accvgpr_write_b32 a160, v22
v_accvgpr_write_b32 a161, v23
v_accvgpr_write_b32 a162, v24
v_accvgpr_write_b32 a163, v25
v_accvgpr_read_b32 v22, a164
v_accvgpr_read_b32 v23, a165
v_accvgpr_read_b32 v24, a166
v_accvgpr_read_b32 v25, a167
v_mul_f32 v22, v22, v31
v_mul_f32 v23, v23, v31
v_mul_f32 v24, v24, v31
v_mul_f32 v25, v25, v31
v_accvgpr_write_b32 a164, v22
v_accvgpr_write_b32 a165, v23
v_accvgpr_write_b32 a166, v24
v_accvgpr_write_b32 a167, v25
v_accvgpr_read_b32 v22, a168
v_accvgpr_read_b32 v23, a169
v_accvgpr_read_b32 v24, a170
v_accvgpr_read_b32 v25, a171
v_mul_f32 v22, v22, v31
v_mul_f32 v23, v23, v31
v_mul_f32 v24, v24, v31
v_mul_f32 v25, v25, v31
v_accvgpr_write_b32 a168, v22
v_accvgpr_write_b32 a169, v23
v_accvgpr_write_b32 a170, v24
v_accvgpr_write_b32 a171, v25
v_accvgpr_read_b32 v22, a172
v_accvgpr_read_b32 v23, a173
v_accvgpr_read_b32 v24, a174
v_accvgpr_read_b32 v25, a175
v_mul_f32 v22, v22, v31
v_mul_f32 v23, v23, v31
v_mul_f32 v24, v24, v31
v_mul_f32 v25, v25, v31
v_accvgpr_write_b32 a172, v22
v_accvgpr_write_b32 a173, v23
v_accvgpr_write_b32 a174, v24
v_accvgpr_write_b32 a175, v25
v_accvgpr_read_b32 v22, a176
v_accvgpr_read_b32 v23, a177
v_accvgpr_read_b32 v24, a178
v_accvgpr_read_b32 v25, a179
v_mul_f32 v22, v22, v31
v_mul_f32 v23, v23, v31
v_mul_f32 v24, v24, v31
v_mul_f32 v25, v25, v31
v_accvgpr_write_b32 a176, v22
v_accvgpr_write_b32 a177, v23
v_accvgpr_write_b32 a178, v24
v_accvgpr_write_b32 a179, v25
v_accvgpr_read_b32 v22, a180
v_accvgpr_read_b32 v23, a181
v_accvgpr_read_b32 v24, a182
v_accvgpr_read_b32 v25, a183
v_mul_f32 v22, v22, v31
v_mul_f32 v23, v23, v31
v_mul_f32 v24, v24, v31
v_mul_f32 v25, v25, v31
v_accvgpr_write_b32 a180, v22
v_accvgpr_write_b32 a181, v23
v_accvgpr_write_b32 a182, v24
v_accvgpr_write_b32 a183, v25
v_accvgpr_read_b32 v22, a184
v_accvgpr_read_b32 v23, a185
v_accvgpr_read_b32 v24, a186
v_accvgpr_read_b32 v25, a187
v_mul_f32 v22, v22, v31
v_mul_f32 v23, v23, v31
v_mul_f32 v24, v24, v31
v_mul_f32 v25, v25, v31
v_accvgpr_write_b32 a184, v22
v_accvgpr_write_b32 a185, v23
v_accvgpr_write_b32 a186, v24
v_accvgpr_write_b32 a187, v25
v_accvgpr_read_b32 v22, a188
v_accvgpr_read_b32 v23, a189
v_accvgpr_read_b32 v24, a190
v_accvgpr_read_b32 v25, a191
v_mul_f32 v22, v22, v31
v_mul_f32 v23, v23, v31
v_mul_f32 v24, v24, v31
v_mul_f32 v25, v25, v31
v_accvgpr_write_b32 a188, v22
v_accvgpr_write_b32 a189, v23
v_accvgpr_write_b32 a190, v24
v_accvgpr_write_b32 a191, v25
v_fma_f32 v22, v96, s37, v15
v_fma_f32 v23, v97, s37, v15
v_exp_f32 v22, v22
v_fma_f32 v24, v98, s37, v15
v_exp_f32 v23, v23
v_fma_f32 v25, v99, s37, v15
v_exp_f32 v24, v24
v_add_f32 v19, v22, v23
v_fma_f32 v26, v100, s37, v15
v_exp_f32 v25, v25
v_add_f32 v19, v19, v24
v_cvt_pk_bf16_f32 v120, v22, v23
v_fma_f32 v27, v101, s37, v15
v_exp_f32 v26, v26
v_add_f32 v19, v19, v25
v_fma_f32 v22, v102, s37, v15
v_exp_f32 v27, v27
v_add_f32 v19, v19, v26
v_cvt_pk_bf16_f32 v121, v24, v25
v_fma_f32 v23, v103, s37, v15
v_exp_f32 v22, v22
v_add_f32 v19, v19, v27
v_fma_f32 v24, v104, s37, v15
v_exp_f32 v23, v23
v_add_f32 v19, v19, v22
v_cvt_pk_bf16_f32 v122, v26, v27
v_fma_f32 v25, v105, s37, v15
v_exp_f32 v24, v24
v_add_f32 v19, v19, v23
v_fma_f32 v26, v106, s37, v15
v_exp_f32 v25, v25
v_add_f32 v19, v19, v24
v_cvt_pk_bf16_f32 v123, v22, v23
v_fma_f32 v27, v107, s37, v15
v_exp_f32 v26, v26
v_add_f32 v19, v19, v25
v_fma_f32 v22, v108, s37, v15
v_exp_f32 v27, v27
v_add_f32 v19, v19, v26
v_cvt_pk_bf16_f32 v124, v24, v25
v_fma_f32 v23, v109, s37, v15
v_exp_f32 v22, v22
v_add_f32 v19, v19, v27
v_fma_f32 v24, v110, s37, v15
v_exp_f32 v23, v23
v_add_f32 v19, v19, v22
v_cvt_pk_bf16_f32 v125, v26, v27
v_fma_f32 v25, v111, s37, v15
v_exp_f32 v24, v24
v_add_f32 v19, v19, v23
v_exp_f32 v25, v25
v_add_f32 v19, v19, v24
v_cvt_pk_bf16_f32 v126, v22, v23
v_add_f32 v19, v19, v25
v_cvt_pk_bf16_f32 v127, v24, v25
s_nop 1
s_setpc_b64 s[60:61]
Lrare_Y1_128:
s_nop 15
v_max3_f32 v28, v96, v97, v98
v_max3_f32 v28, v28, v99, v100
v_max3_f32 v28, v28, v101, v102
v_max3_f32 v28, v28, v103, v104
v_max3_f32 v28, v28, v105, v106
v_max3_f32 v28, v28, v107, v108
v_max3_f32 v28, v28, v109, v110
v_max_f32 v28, v28, v111
v_mov_b32 v29, v28
s_nop 1
v_permlane32_swap_b32 v28, v29
s_nop 0
v_max_f32 v28, v28, v29
v_mul_f32_e64 v28, -v28, s37
v_min_f32 v28, v28, v15
v_sub_f32 v31, v28, v15
v_exp_f32 v31, v31
v_mov_b32 v15, v28
v_mul_f32 v17, v17, v31
v_accvgpr_read_b32 v22, a96
v_accvgpr_read_b32 v23, a97
v_accvgpr_read_b32 v24, a98
v_accvgpr_read_b32 v25, a99
v_mul_f32 v22, v22, v31
v_mul_f32 v23, v23, v31
v_mul_f32 v24, v24, v31
v_mul_f32 v25, v25, v31
v_accvgpr_write_b32 a96, v22
v_accvgpr_write_b32 a97, v23
v_accvgpr_write_b32 a98, v24
v_accvgpr_write_b32 a99, v25
v_accvgpr_read_b32 v22, a100
v_accvgpr_read_b32 v23, a101
v_accvgpr_read_b32 v24, a102
v_accvgpr_read_b32 v25, a103
v_mul_f32 v22, v22, v31
v_mul_f32 v23, v23, v31
v_mul_f32 v24, v24, v31
v_mul_f32 v25, v25, v31
v_accvgpr_write_b32 a100, v22
v_accvgpr_write_b32 a101, v23
v_accvgpr_write_b32 a102, v24
v_accvgpr_write_b32 a103, v25
v_accvgpr_read_b32 v22, a104
v_accvgpr_read_b32 v23, a105
v_accvgpr_read_b32 v24, a106
v_accvgpr_read_b32 v25, a107
v_mul_f32 v22, v22, v31
v_mul_f32 v23, v23, v31
v_mul_f32 v24, v24, v31
v_mul_f32 v25, v25, v31
v_accvgpr_write_b32 a104, v22
v_accvgpr_write_b32 a105, v23
v_accvgpr_write_b32 a106, v24
v_accvgpr_write_b32 a107, v25
v_accvgpr_read_b32 v22, a108
v_accvgpr_read_b32 v23, a109
v_accvgpr_read_b32 v24, a110
v_accvgpr_read_b32 v25, a111
v_mul_f32 v22, v22, v31
v_mul_f32 v23, v23, v31
v_mul_f32 v24, v24, v31
v_mul_f32 v25, v25, v31
v_accvgpr_write_b32 a108, v22
v_accvgpr_write_b32 a109, v23
v_accvgpr_write_b32 a110, v24
v_accvgpr_write_b32 a111, v25
v_accvgpr_read_b32 v22, a112
v_accvgpr_read_b32 v23, a113
v_accvgpr_read_b32 v24, a114
v_accvgpr_read_b32 v25, a115
v_mul_f32 v22, v22, v31
v_mul_f32 v23, v23, v31
v_mul_f32 v24, v24, v31
v_mul_f32 v25, v25, v31
v_accvgpr_write_b32 a112, v22
v_accvgpr_write_b32 a113, v23
v_accvgpr_write_b32 a114, v24
v_accvgpr_write_b32 a115, v25
v_accvgpr_read_b32 v22, a116
v_accvgpr_read_b32 v23, a117
v_accvgpr_read_b32 v24, a118
v_accvgpr_read_b32 v25, a119
v_mul_f32 v22, v22, v31
v_mul_f32 v23, v23, v31
v_mul_f32 v24, v24, v31
v_mul_f32 v25, v25, v31
v_accvgpr_write_b32 a116, v22
v_accvgpr_write_b32 a117, v23
v_accvgpr_write_b32 a118, v24
v_accvgpr_write_b32 a119, v25
v_accvgpr_read_b32 v22, a120
v_accvgpr_read_b32 v23, a121
v_accvgpr_read_b32 v24, a122
v_accvgpr_read_b32 v25, a123
v_mul_f32 v22, v22, v31
v_mul_f32 v23, v23, v31
v_mul_f32 v24, v24, v31
v_mul_f32 v25, v25, v31
v_accvgpr_write_b32 a120, v22
v_accvgpr_write_b32 a121, v23
v_accvgpr_write_b32 a122, v24
v_accvgpr_write_b32 a123, v25
v_accvgpr_read_b32 v22, a124
v_accvgpr_read_b32 v23, a125
v_accvgpr_read_b32 v24, a126
v_accvgpr_read_b32 v25, a127
v_mul_f32 v22, v22, v31
v_mul_f32 v23, v23, v31
v_mul_f32 v24, v24, v31
v_mul_f32 v25, v25, v31
v_accvgpr_write_b32 a124, v22
v_accvgpr_write_b32 a125, v23
v_accvgpr_write_b32 a126, v24
v_accvgpr_write_b32 a127, v25
v_accvgpr_read_b32 v22, a128
v_accvgpr_read_b32 v23, a129
v_accvgpr_read_b32 v24, a130
v_accvgpr_read_b32 v25, a131
v_mul_f32 v22, v22, v31
v_mul_f32 v23, v23, v31
v_mul_f32 v24, v24, v31
v_mul_f32 v25, v25, v31
v_accvgpr_write_b32 a128, v22
v_accvgpr_write_b32 a129, v23
v_accvgpr_write_b32 a130, v24
v_accvgpr_write_b32 a131, v25
v_accvgpr_read_b32 v22, a132
v_accvgpr_read_b32 v23, a133
v_accvgpr_read_b32 v24, a134
v_accvgpr_read_b32 v25, a135
v_mul_f32 v22, v22, v31
v_mul_f32 v23, v23, v31
v_mul_f32 v24, v24, v31
v_mul_f32 v25, v25, v31
v_accvgpr_write_b32 a132, v22
v_accvgpr_write_b32 a133, v23
v_accvgpr_write_b32 a134, v24
v_accvgpr_write_b32 a135, v25
v_accvgpr_read_b32 v22, a136
v_accvgpr_read_b32 v23, a137
v_accvgpr_read_b32 v24, a138
v_accvgpr_read_b32 v25, a139
v_mul_f32 v22, v22, v31
v_mul_f32 v23, v23, v31
v_mul_f32 v24, v24, v31
v_mul_f32 v25, v25, v31
v_accvgpr_write_b32 a136, v22
v_accvgpr_write_b32 a137, v23
v_accvgpr_write_b32 a138, v24
v_accvgpr_write_b32 a139, v25
v_accvgpr_read_b32 v22, a140
v_accvgpr_read_b32 v23, a141
v_accvgpr_read_b32 v24, a142
v_accvgpr_read_b32 v25, a143
v_mul_f32 v22, v22, v31
v_mul_f32 v23, v23, v31
v_mul_f32 v24, v24, v31
v_mul_f32 v25, v25, v31
v_accvgpr_write_b32 a140, v22
v_accvgpr_write_b32 a141, v23
v_accvgpr_write_b32 a142, v24
v_accvgpr_write_b32 a143, v25
v_accvgpr_read_b32 v22, a144
v_accvgpr_read_b32 v23, a145
v_accvgpr_read_b32 v24, a146
v_accvgpr_read_b32 v25, a147
v_mul_f32 v22, v22, v31
v_mul_f32 v23, v23, v31
v_mul_f32 v24, v24, v31
v_mul_f32 v25, v25, v31
v_accvgpr_write_b32 a144, v22
v_accvgpr_write_b32 a145, v23
v_accvgpr_write_b32 a146, v24
v_accvgpr_write_b32 a147, v25
v_accvgpr_read_b32 v22, a148
v_accvgpr_read_b32 v23, a149
v_accvgpr_read_b32 v24, a150
v_accvgpr_read_b32 v25, a151
v_mul_f32 v22, v22, v31
v_mul_f32 v23, v23, v31
v_mul_f32 v24, v24, v31
v_mul_f32 v25, v25, v31
v_accvgpr_write_b32 a148, v22
v_accvgpr_write_b32 a149, v23
v_accvgpr_write_b32 a150, v24
v_accvgpr_write_b32 a151, v25
v_accvgpr_read_b32 v22, a152
v_accvgpr_read_b32 v23, a153
v_accvgpr_read_b32 v24, a154
v_accvgpr_read_b32 v25, a155
v_mul_f32 v22, v22, v31
v_mul_f32 v23, v23, v31
v_mul_f32 v24, v24, v31
v_mul_f32 v25, v25, v31
v_accvgpr_write_b32 a152, v22
v_accvgpr_write_b32 a153, v23
v_accvgpr_write_b32 a154, v24
v_accvgpr_write_b32 a155, v25
v_accvgpr_read_b32 v22, a156
v_accvgpr_read_b32 v23, a157
v_accvgpr_read_b32 v24, a158
v_accvgpr_read_b32 v25, a159
v_mul_f32 v22, v22, v31
v_mul_f32 v23, v23, v31
v_mul_f32 v24, v24, v31
v_mul_f32 v25, v25, v31
v_accvgpr_write_b32 a156, v22
v_accvgpr_write_b32 a157, v23
v_accvgpr_write_b32 a158, v24
v_accvgpr_write_b32 a159, v25
v_accvgpr_read_b32 v22, a160
v_accvgpr_read_b32 v23, a161
v_accvgpr_read_b32 v24, a162
v_accvgpr_read_b32 v25, a163
v_mul_f32 v22, v22, v31
v_mul_f32 v23, v23, v31
v_mul_f32 v24, v24, v31
v_mul_f32 v25, v25, v31
v_accvgpr_write_b32 a160, v22
v_accvgpr_write_b32 a161, v23
v_accvgpr_write_b32 a162, v24
v_accvgpr_write_b32 a163, v25
v_accvgpr_read_b32 v22, a164
v_accvgpr_read_b32 v23, a165
v_accvgpr_read_b32 v24, a166
v_accvgpr_read_b32 v25, a167
v_mul_f32 v22, v22, v31
v_mul_f32 v23, v23, v31
v_mul_f32 v24, v24, v31
v_mul_f32 v25, v25, v31
v_accvgpr_write_b32 a164, v22
v_accvgpr_write_b32 a165, v23
v_accvgpr_write_b32 a166, v24
v_accvgpr_write_b32 a167, v25
v_accvgpr_read_b32 v22, a168
v_accvgpr_read_b32 v23, a169
v_accvgpr_read_b32 v24, a170
v_accvgpr_read_b32 v25, a171
v_mul_f32 v22, v22, v31
v_mul_f32 v23, v23, v31
v_mul_f32 v24, v24, v31
v_mul_f32 v25, v25, v31
v_accvgpr_write_b32 a168, v22
v_accvgpr_write_b32 a169, v23
v_accvgpr_write_b32 a170, v24
v_accvgpr_write_b32 a171, v25
v_accvgpr_read_b32 v22, a172
v_accvgpr_read_b32 v23, a173
v_accvgpr_read_b32 v24, a174
v_accvgpr_read_b32 v25, a175
v_mul_f32 v22, v22, v31
v_mul_f32 v23, v23, v31
v_mul_f32 v24, v24, v31
v_mul_f32 v25, v25, v31
v_accvgpr_write_b32 a172, v22
v_accvgpr_write_b32 a173, v23
v_accvgpr_write_b32 a174, v24
v_accvgpr_write_b32 a175, v25
v_accvgpr_read_b32 v22, a176
v_accvgpr_read_b32 v23, a177
v_accvgpr_read_b32 v24, a178
v_accvgpr_read_b32 v25, a179
v_mul_f32 v22, v22, v31
v_mul_f32 v23, v23, v31
v_mul_f32 v24, v24, v31
v_mul_f32 v25, v25, v31
v_accvgpr_write_b32 a176, v22
v_accvgpr_write_b32 a177, v23
v_accvgpr_write_b32 a178, v24
v_accvgpr_write_b32 a179, v25
v_accvgpr_read_b32 v22, a180
v_accvgpr_read_b32 v23, a181
v_accvgpr_read_b32 v24, a182
v_accvgpr_read_b32 v25, a183
v_mul_f32 v22, v22, v31
v_mul_f32 v23, v23, v31
v_mul_f32 v24, v24, v31
v_mul_f32 v25, v25, v31
v_accvgpr_write_b32 a180, v22
v_accvgpr_write_b32 a181, v23
v_accvgpr_write_b32 a182, v24
v_accvgpr_write_b32 a183, v25
v_accvgpr_read_b32 v22, a184
v_accvgpr_read_b32 v23, a185
v_accvgpr_read_b32 v24, a186
v_accvgpr_read_b32 v25, a187
v_mul_f32 v22, v22, v31
v_mul_f32 v23, v23, v31
v_mul_f32 v24, v24, v31
v_mul_f32 v25, v25, v31
v_accvgpr_write_b32 a184, v22
v_accvgpr_write_b32 a185, v23
v_accvgpr_write_b32 a186, v24
v_accvgpr_write_b32 a187, v25
v_accvgpr_read_b32 v22, a188
v_accvgpr_read_b32 v23, a189
v_accvgpr_read_b32 v24, a190
v_accvgpr_read_b32 v25, a191
v_mul_f32 v22, v22, v31
v_mul_f32 v23, v23, v31
v_mul_f32 v24, v24, v31
v_mul_f32 v25, v25, v31
v_accvgpr_write_b32 a188, v22
v_accvgpr_write_b32 a189, v23
v_accvgpr_write_b32 a190, v24
v_accvgpr_write_b32 a191, v25
v_fma_f32 v22, v96, s37, v15
v_fma_f32 v23, v97, s37, v15
v_exp_f32 v22, v22
v_fma_f32 v24, v98, s37, v15
v_exp_f32 v23, v23
v_fma_f32 v25, v99, s37, v15
v_exp_f32 v24, v24
v_add_f32 v19, v22, v23
v_fma_f32 v26, v100, s37, v15
v_exp_f32 v25, v25
v_add_f32 v19, v19, v24
v_cvt_pk_bf16_f32 v128, v22, v23
v_fma_f32 v27, v101, s37, v15
v_exp_f32 v26, v26
v_add_f32 v19, v19, v25
v_fma_f32 v22, v102, s37, v15
v_exp_f32 v27, v27
v_add_f32 v19, v19, v26
v_cvt_pk_bf16_f32 v129, v24, v25
v_fma_f32 v23, v103, s37, v15
v_exp_f32 v22, v22
v_add_f32 v19, v19, v27
v_fma_f32 v24, v104, s37, v15
v_exp_f32 v23, v23
v_add_f32 v19, v19, v22
v_cvt_pk_bf16_f32 v130, v26, v27
v_fma_f32 v25, v105, s37, v15
v_exp_f32 v24, v24
v_add_f32 v19, v19, v23
v_fma_f32 v26, v106, s37, v15
v_exp_f32 v25, v25
v_add_f32 v19, v19, v24
v_cvt_pk_bf16_f32 v131, v22, v23
v_fma_f32 v27, v107, s37, v15
v_exp_f32 v26, v26
v_add_f32 v19, v19, v25
v_fma_f32 v22, v108, s37, v15
v_exp_f32 v27, v27
v_add_f32 v19, v19, v26
v_cvt_pk_bf16_f32 v132, v24, v25
v_fma_f32 v23, v109, s37, v15
v_exp_f32 v22, v22
v_add_f32 v19, v19, v27
v_fma_f32 v24, v110, s37, v15
v_exp_f32 v23, v23
v_add_f32 v19, v19, v22
v_cvt_pk_bf16_f32 v133, v26, v27
v_fma_f32 v25, v111, s37, v15
v_exp_f32 v24, v24
v_add_f32 v19, v19, v23
v_exp_f32 v25, v25
v_add_f32 v19, v19, v24
v_cvt_pk_bf16_f32 v134, v22, v23
v_add_f32 v19, v19, v25
v_cvt_pk_bf16_f32 v135, v24, v25
s_nop 1
s_setpc_b64 s[60:61]

.section .rodata,"a"
.p2align 6
.amdhsa_kernel standalone__memory_aug_memorizing_tr__prompt_kernel
  .amdhsa_next_free_vgpr 512
  .amdhsa_next_free_sgpr 102
  .amdhsa_accum_offset 256
  .amdhsa_group_segment_fixed_size 0
  .amdhsa_kernarg_size 80
  .amdhsa_user_sgpr_count 2
  .amdhsa_user_sgpr_kernarg_segment_ptr 1
  .amdhsa_system_sgpr_workgroup_id_x 1
.end_amdhsa_kernel
```
